```python
import torch

def _softmax(x, axis=-1):
    return torch.softmax(x, dim=axis)

def _gelu(x):
    return torch.nn.functional.gelu(x, approximate='tanh')

def _silu(x):
    return torch.nn.functional.silu(x)

def _sigmoid(x):
    return torch.sigmoid(x)

def _layernorm(x, axis=-1, eps=1e-05):
    m = x.mean(dim=axis, keepdim=True)
    v = x.var(dim=axis, keepdim=True, unbiased=False)
    return (x - m) / torch.sqrt(v + eps)

def _scatter_add(tgt, idx, src, axis=0):
    return tgt.clone().index_add_(axis, idx, src)

def _segment_sum(src, seg, n):
    out = torch.zeros((n,) + src.shape[1:], dtype=src.dtype)
    return out.index_add_(0, seg, src)

def _pad(x, pw):
    flat = tuple((v for pair in reversed(pw) for v in pair))
    return torch.nn.functional.pad(x, flat)
kernel_name = 'recurrent_scan__linear_attn_block__mixer_gmlp__prompt'

def setup_inputs():

    _w = lambda a: (lambda t: t.to(torch.bfloat16) if t.is_floating_point() else t)(torch.as_tensor(a))

    def _A_setup():
        B, S, D = (1, 2048, 1024)
        return {'x': _w((lambda *s: torch.randn(*s, dtype=torch.bfloat16) * 0.05)(B, S, D)), 'wqkv': _w((lambda *s: torch.randn(*s, dtype=torch.bfloat16) * 0.05)(D, 3 * D)), 'wo': _w((lambda *s: torch.randn(*s, dtype=torch.bfloat16) * 0.05)(D, D))}
    _A_in = _A_setup()

    def _B_setup():
        B, S, D, F = (1, 2048, 1024, 3584)
        Fh = F // 2
        return {'x': _w((lambda *s: torch.randn(*s, dtype=torch.bfloat16) * 0.05)(B, S, D)), 'w_in': _w((lambda *s: torch.randn(*s, dtype=torch.bfloat16) * 0.4)(D, 2 * Fh)), 'w_sp': _w(0.01 * (lambda *s: torch.randn(*s, dtype=torch.bfloat16) * 0.4)(S, S)), 'b_sp': _w(1.0 + 0.01 * (lambda *s: torch.randn(*s, dtype=torch.bfloat16) * 0.05)(S)), 'w_out': _w((lambda *s: torch.randn(*s, dtype=torch.bfloat16) * 0.05)(Fh, D))}
    _B_in = _B_setup()
    return {'A_x': _A_in['x'], 'A_wqkv': _A_in['wqkv'], 'A_wo': _A_in['wo'], 'B_x': _B_in['x'], 'B_w_in': _B_in['w_in'], 'B_w_sp': _B_in['w_sp'], 'B_b_sp': _B_in['b_sp'], 'B_w_out': _B_in['w_out']}

def reference(A_x, A_wqkv, A_wo, B_x, B_w_in, B_w_sp, B_b_sp, B_w_out):

    def _A_ref(x, wqkv, wo):
        B, S, D = x.shape
        H = 32
        Dh = D // H
        qkv = (lambda x, *d: x.permute(*d))((x @ wqkv).reshape(B, S, 3, H, Dh), 2, 0, 3, 1, 4)
        q, k, v = (qkv[0], qkv[1], qkv[2])
        phi = lambda t: torch.where(t > 0, t + 1, torch.exp(t)) + 1e-06
        pq, pk = (phi(q), phi(k))
        kv = torch.einsum('bhsd,bhse->bhde', pk, v)
        z = torch.einsum('bhsd->bhd', pk)
        num = torch.einsum('bhqd,bhde->bhqe', pq, kv)
        den = torch.einsum('bhqd,bhd->bhq', pq, z)[..., None] + 1e-06
        o = num / den
        return (lambda x, *d: x.permute(*d))(o, 0, 2, 1, 3).reshape(B, S, D) @ wo

    def _B_ref(x, w_in, w_sp, b_sp, w_out):
        B, S, D = x.shape
        F = w_in.shape[-1]
        Fh = F // 2
        z = _gelu(torch.einsum('bsd,df->bsf', x, w_in))
        z1 = z[..., :Fh].clone()
        z2 = _layernorm(z[..., Fh:], axis=-1)
        g = torch.einsum('ts,bsf->btf', w_sp, z2) + b_sp[None, :, None]
        return torch.einsum('bsf,fd->bsd', z1 * g, w_out)
    x = A_x
    xn = _layernorm(x, axis=-1)
    s = _A_ref(xn, A_wqkv, A_wo)
    g = _silu(_B_ref(xn, B_w_in, B_w_sp, B_b_sp, B_w_out))
    return x + s * g
```

```asm
; @launch kernel=k1_kernel grid=(256,1,1) block=(256,1,1) lds=156672
; @launch kernel=k23_kernel grid=(256,1,1) block=(256,1,1) lds=163840
.amdgcn_target "amdgcn-amd-amdhsa--gfx950"
.text
.globl k1_kernel
.p2align 8
.type k1_kernel,@function
k1_kernel:
    s_cmp_ge_u32 s2, 256
    s_cbranch_scc1 k1_kernel_end
    s_load_dwordx2 s[4:5], s[0:1], 0
    s_load_dwordx2 s[44:45], s[0:1], 72
    s_load_dwordx2 s[8:9], s[0:1], 8
    s_load_dwordx2 s[12:13], s[0:1], 32
    s_load_dwordx2 s[16:17], s[0:1], 80
    s_load_dwordx2 s[68:69], s[0:1], 40
    s_load_dwordx2 s[72:73], s[0:1], 56
    s_load_dwordx2 s[76:77], s[0:1], 16
    v_lshrrev_b32 v1, 6, v0
    v_and_b32 v255, 63, v0
    s_getpc_b64 s[94:95]
k1_kernel_pc0:
    v_and_b32 v249, 63, v0
    v_lshrrev_b32 v248, 6, v0
    v_min_u32 v249, 23, v249
    v_mad_u32_u24 v248, v248, 24, v249
    s_bitcmp1_b32 s2, 5
    s_cselect_b32 s93, k1_kernel_O - k1_kernel_pc0, 0
    s_add_u32 s94, s94, s93
    s_addc_u32 s95, s95, 0
    v_lshlrev_b32 v248, 7, v248
    v_mov_b32 v249, s95
    v_add_co_u32 v248, vcc, s94, v248
    v_addc_co_u32 v249, vcc, 0, v249, vcc
    global_load_dword v254, v[248:249], off
    s_mov_b32 s70, 8388608
    s_mov_b32 s71, 0x20000
    s_mov_b32 s74, 3670016
    s_mov_b32 s75, 0x20000
    s_mov_b32 s78, 2097152
    s_mov_b32 s79, 0x20000
    s_mov_b32 s6, 4194304
    s_mov_b32 s7, 0x20000
    s_mov_b32 s46, 256
    s_mov_b32 s47, 0x20000
    v_readfirstlane_b32 s29, v1
    s_mov_b32 s10, 6291456
    s_mov_b32 s11, 0x20000
    s_mov_b32 s14, 7340032
    s_mov_b32 s15, 0x20000
    s_mov_b32 s18, 268435456
    s_mov_b32 s19, 0x20000
    s_and_b32 s34, s2, 1
    s_lshl_b32 s34, s34, 2
    s_bfe_u32 s35, s2, 0x20003
    s_add_u32 s30, s34, s35
    s_bfe_u32 s34, s2, 0x20001
    s_lshl_b32 s34, s34, 2
    s_bfe_u32 s35, s2, 0x20005
    s_add_u32 s34, s34, s35
    s_bitcmp1_b32 s2, 7
    s_cselect_b32 s35, 0, 16
    s_add_u32 s31, s34, s35
    s_lshr_b32 s32, s31, 1
    s_lshl_b32 s24, s29, 10
    s_mov_b32 s20, 0
    s_mov_b32 s21, 0
    s_mov_b32 s22, 0
    s_lshl_b32 s34, s30, 19
    s_lshl_b32 s35, s29, 17
    s_add_u32 s34, s34, s35
    v_lshrrev_b32 v1, 4, v255
    v_and_b32 v2, 7, v255
    v_xor_b32 v1, v1, v2
    v_lshl_add_u32 v1, v1, 4, s34
    v_lshrrev_b32 v2, 3, v255
    v_lshl_add_u32 v208, v2, 11, v1
    v_xor_b32 v1, 64, v208
    v_add_u32 v209, 16384, v1
    v_lshlrev_b32 v20, 6, v255
    s_mul_i32 s50, s29, 24576
    s_add_u32 s50, s50, 54272
    s_add_u32 s51, s50, 24576
    s_add_u32 s48, s50, 16384
    s_mov_b32 s49, s50
    s_lshl_b32 s53, s30, 5
    s_lshl_b32 s34, s30, 8
    s_lshl_b32 s35, s29, 6
    s_add_u32 s35, s34, s35
    s_lshl_b32 s35, s35, 3
    s_add_u32 s52, s35, 40370176
    s_and_b32 s36, s31, 15
    s_lshl_b32 s36, s36, 14
    s_add_u32 s58, s35, s36
    s_add_u32 s58, s58, 39845888
    s_lshl_b32 s35, s31, 3
    s_add_u32 s34, s34, s35
    s_lshl_b32 s35, s29, 1
    s_add_u32 s34, s34, s35
    s_lshl_b32 s55, s34, 11
    s_lshl_b32 s57, s34, 3
    s_add_u32 s57, s57, 40370176
    s_lshl_b32 s59, s2, 8
    s_add_u32 s59, s59, 40894464
    s_lshl_b32 s83, s30, 2
    s_add_u32 s83, s83, s29
    s_cmp_le_u32 s83, 12
    s_cselect_b32 s84, 0x10001, 0
    s_mov_b32 s85, s84
    s_min_u32 s83, s83, 12
    s_lshl_b32 s87, s31, 10
    s_add_u32 s87, s87, 40435712
    s_lshl_b32 s86, s83, 6
    s_add_u32 s86, s86, s87
    s_cmp_eq_u32 s29, 0
    s_cselect_b32 s92, -1, 0
    s_cselect_b32 s93, -1, 0
    s_cselect_b32 s56, 7, -1
    v_add_u32 v210, 32768, v208
    v_add_u32 v211, 32768, v209
    v_add_u32 v212, 65536, v208
    v_add_u32 v213, 65536, v209
    v_add_u32 v214, 98304, v208
    v_add_u32 v215, 98304, v209
    s_bitcmp1_b32 s31, 0
    s_cbranch_scc1 k1_kernel_O
    v_lshrrev_b32 v246, 3, v255
    s_lshl_b32 s34, s29, 3
    v_add_u32 v247, s34, v246
    v_bfe_u32 v248, v247, 1, 1
    v_bfe_u32 v249, v247, 3, 1
    v_lshl_or_b32 v248, v249, 1, v248
    v_bfe_u32 v249, v255, 1, 2
    v_xor_b32 v248, v248, v249
    v_and_b32 v249, 1, v255
    v_lshlrev_b32 v249, 4, v249
    v_lshl_or_b32 v248, v248, 5, v249
    v_mul_u32_u24 v247, 6144, v247
    v_add_u32 v247, v247, v248
    s_lshl_b32 s34, s32, 7
    s_add_u32 s35, s34, 2048
    v_add_u32 v216, s35, v247
    s_add_u32 s35, s34, 4096
    v_add_u32 v217, s35, v247
    s_mul_i32 s35, s32, 448
    s_lshl_b32 s34, s29, 5
    s_add_u32 s34, s34, 0
    v_lshrrev_b32 v246, 1, v255
    v_add_u32 v246, s34, v246
    v_mul_u32_u24 v247, 13108, v246
    v_bfe_u32 v247, v247, 19, 1
    v_lshlrev_b32 v247, 2, v247
    v_xor_b32 v246, v246, v247
    v_mul_u32_u24 v247, 52429, v246
    v_lshrrev_b32 v247, 18, v247
    v_mul_u32_u24 v248, 5, v247
    v_sub_u32 v248, v246, v248
    v_mul_u32_u24 v247, 7168, v247
    v_lshl_add_u32 v247, v248, 5, v247
    v_and_b32 v248, 1, v255
    v_lshl_add_u32 v247, v248, 4, v247
    v_add_u32 v218, s35, v247
    s_mov_b32 s34, 128
    v_lshrrev_b32 v246, 1, v255
    v_add_u32 v246, s34, v246
    v_mul_u32_u24 v247, 13108, v246
    v_bfe_u32 v247, v247, 19, 1
    v_lshlrev_b32 v247, 2, v247
    v_xor_b32 v246, v246, v247
    v_mul_u32_u24 v247, 52429, v246
    v_lshrrev_b32 v247, 18, v247
    v_mul_u32_u24 v248, 5, v247
    v_sub_u32 v248, v246, v248
    v_mul_u32_u24 v247, 7168, v247
    v_lshl_add_u32 v247, v248, 5, v247
    v_and_b32 v248, 1, v255
    v_lshl_add_u32 v247, v248, 4, v247
    v_add_u32 v219, s35, v247
    s_cmp_eq_u32 s29, 0
    s_cselect_b32 s34, -1, 0
    v_and_b32 v219, s34, v219
    s_mov_b32 s36, 53248
    s_cselect_b32 s40, 12288, s36
    s_cselect_b32 s41, 25600, s36
    s_cselect_b32 s42, 38912, s36
    s_cselect_b32 s43, 52224, s36
    s_waitcnt lgkmcnt(0)
    buffer_load_dwordx4 v[0:3], v20, s[4:7], s55 offen offset:0
    buffer_load_dwordx4 v[4:7], v20, s[4:7], s55 offen offset:16
    buffer_load_dwordx4 v[8:11], v20, s[4:7], s55 offen offset:32
    buffer_load_dwordx4 v[12:15], v20, s[4:7], s55 offen offset:48
    s_add_u32 m0, s24, 0
    s_nop 0
    buffer_load_dwordx4 v216, s[8:11], s21 offen lds
    v_lshrrev_b32 v246, 4, v255
    v_bfe_u32 v247, v255, 2, 2
    v_lshl_add_u32 v247, v246, 3, v247
    v_mul_u32_u24 v248, 5, v247
    v_and_b32 v249, 1, v246
    v_lshlrev_b32 v249, 2, v249
    v_and_b32 v250, 3, v255
    v_lshlrev_b32 v250, 3, v250
    v_add_u32 v251, 0, v248
    v_xor_b32 v251, v251, v249
    v_lshl_add_u32 v226, v251, 5, v250
    v_add_u32 v251, 1, v248
    v_xor_b32 v251, v251, v249
    s_add_u32 m0, s50, 0
    s_nop 0
    buffer_load_dwordx4 v208, s[4:7], s20 offen lds
    v_lshl_add_u32 v227, v251, 5, v250
    v_add_u32 v251, 2, v248
    v_xor_b32 v251, v251, v249
    v_lshl_add_u32 v228, v251, 5, v250
    v_add_u32 v251, 3, v248
    v_xor_b32 v251, v251, v249
    v_lshl_add_u32 v229, v251, 5, v250
    v_add_u32 v251, 4, v248
    v_xor_b32 v251, v251, v249
    v_lshl_add_u32 v230, v251, 5, v250
    v_add_u32 v251, 5, v248
    v_xor_b32 v251, v251, v249
    v_lshl_add_u32 v231, v251, 5, v250
    s_add_u32 m0, s50, 1024
    s_nop 0
    buffer_load_dwordx4 v209, s[4:7], s20 offen lds
    v_add_u32 v251, 6, v248
    v_xor_b32 v251, v251, v249
    v_lshl_add_u32 v232, v251, 5, v250
    v_add_u32 v251, 7, v248
    v_xor_b32 v251, v251, v249
    v_lshl_add_u32 v233, v251, 5, v250
    s_add_u32 s34, s29, 0
    s_and_b32 s35, s34, 7
    s_lshr_b32 s34, s34, 3
    s_lshl_b32 s34, s34, 8
    s_add_u32 s34, s34, 8192
    v_add_u32 v251, s35, v248
    v_xor_b32 v251, v251, v249
    s_add_u32 m0, s24, 4096
    s_nop 0
    buffer_load_dwordx4 v217, s[8:11], s21 offen lds
    v_lshl_add_u32 v251, v251, 5, v250
    v_add_u32 v220, s34, v251
    s_add_u32 s34, s29, 20
    s_and_b32 s35, s34, 7
    s_lshr_b32 s34, s34, 3
    s_lshl_b32 s34, s34, 8
    s_add_u32 s34, s34, 8192
    v_add_u32 v251, s35, v248
    v_xor_b32 v251, v251, v249
    v_lshl_add_u32 v251, v251, 5, v250
    v_add_u32 v221, s34, v251
    s_add_u32 s34, s83, 56
    s_and_b32 s35, s34, 7
    s_add_u32 m0, s50, 2048
    s_nop 0
    buffer_load_dwordx4 v210, s[4:7], s20 offen lds
    s_lshr_b32 s34, s34, 3
    s_lshl_b32 s34, s34, 8
    s_add_u32 s34, s34, 6144
    v_add_u32 v251, s35, v248
    v_xor_b32 v251, v251, v249
    v_lshl_add_u32 v251, v251, 5, v250
    v_add_u32 v234, s34, v251
    s_add_u32 s34, s83, 76
    s_and_b32 s35, s34, 7
    s_lshr_b32 s34, s34, 3
    s_lshl_b32 s34, s34, 8
    s_add_u32 s34, s34, 6144
    v_add_u32 v251, s35, v248
    s_add_u32 m0, s50, 3072
    s_nop 0
    buffer_load_dwordx4 v211, s[4:7], s20 offen lds
    v_xor_b32 v251, v251, v249
    v_lshl_add_u32 v251, v251, 5, v250
    v_add_u32 v235, s34, v251
    v_bfe_u32 v251, v255, 3, 1
    v_lshrrev_b32 v249, 1, v249
    v_or_b32 v251, v251, v249
    v_lshl_add_u32 v250, v247, 7, v250
    v_xor_b32 v252, 0, v251
    v_lshl_add_u32 v222, v252, 5, v250
    v_xor_b32 v252, 1, v251
    v_lshl_add_u32 v223, v252, 5, v250
    v_xor_b32 v252, 2, v251
    v_lshl_add_u32 v224, v252, 5, v250
    s_add_u32 m0, s24, 8192
    s_nop 0
    buffer_load_dwordx4 v218, s[12:15], s22 offen lds
    v_xor_b32 v252, 3, v251
    v_lshl_add_u32 v225, v252, 5, v250
    v_xor_b32 v252, s29, v251
    v_lshl_add_u32 v252, v252, 5, v250
    v_add_u32 v242, 0, v252
    v_add_u32 v243, 512, v252
    v_add_u32 v244, 4096, v252
    v_add_u32 v245, 4608, v252
    s_lshr_b32 s34, s83, 2
    s_lshl_b32 s34, s34, 12
    s_add_u32 s35, s34, 512
    s_cmp_ge_u32 s83, 8
    s_cbranch_scc1 k1_kernel_E_win
    v_add_u32 v234, s34, v252
    v_add_u32 v235, s35, v252
k1_kernel_E_win:
    v_and_b32 v251, 15, v255
    s_add_u32 m0, s50, 4096
    s_nop 0
    buffer_load_dwordx4 v212, s[4:7], s20 offen lds
    v_lshrrev_b32 v252, 1, v251
    v_xor_b32 v252, v252, v246
    v_lshlrev_b32 v252, 4, v252
    v_lshl_add_u32 v238, v251, 7, v252
    v_xor_b32 v239, 64, v238
    v_add_u32 v240, s50, v238
    v_add_u32 v241, s50, v239
    v_mov_b32 v251, 0x3f803f80
    v_accvgpr_write_b32 a112, v251
    v_accvgpr_write_b32 a113, v251
    v_accvgpr_write_b32 a114, v251
    v_accvgpr_write_b32 a115, v251
    v_accvgpr_write_b32 a96, 0
    v_accvgpr_write_b32 a97, 0
    s_add_u32 m0, s50, 5120
    s_nop 0
    buffer_load_dwordx4 v213, s[4:7], s20 offen lds
    v_accvgpr_write_b32 a98, 0
    v_accvgpr_write_b32 a99, 0
    v_accvgpr_write_b32 a100, 0
    v_accvgpr_write_b32 a101, 0
    v_accvgpr_write_b32 a102, 0
    v_accvgpr_write_b32 a103, 0
    v_accvgpr_write_b32 a104, 0
    v_accvgpr_write_b32 a105, 0
    v_accvgpr_write_b32 a106, 0
    v_accvgpr_write_b32 a107, 0
    v_accvgpr_write_b32 a108, 0
    v_accvgpr_write_b32 a109, 0
    v_accvgpr_write_b32 a110, 0
    s_mov_b32 m0, s40
    s_nop 0
    buffer_load_dwordx4 v219, s[12:15], s22 offen lds
    v_accvgpr_write_b32 a111, 0
    v_accvgpr_write_b32 a116, 0
    v_accvgpr_write_b32 a117, 0
    v_accvgpr_write_b32 a118, 0
    v_accvgpr_write_b32 a119, 0
    v_and_b32 v252, 7, v255
    v_lshlrev_b32 v252, 5, v252
    v_mov_b32 v253, 32
    s_lshl_b32 s34, s2, 2
    s_add_u32 s34, s34, s29
    s_lshl_b32 s80, s34, 13
    s_mul_i32 s81, s34, 3584
    s_lshl_b32 s82, s34, 11
    s_add_u32 m0, s50, 6144
    s_nop 0
    buffer_load_dwordx4 v214, s[4:7], s20 offen lds
    v_mov_b32 v24, 0
    v_mov_b32 v25, 0
    v_mov_b32 v26, 0
    v_mov_b32 v27, 0
    v_mov_b32 v28, 0
    v_mov_b32 v29, 0
    v_mov_b32 v30, 0
    v_mov_b32 v31, 0
    v_mov_b32 v32, 0
    v_mov_b32 v33, 0
    v_mov_b32 v34, 0
    v_mov_b32 v35, 0
    v_mov_b32 v36, 0
    s_add_u32 m0, s50, 7168
    s_nop 0
    buffer_load_dwordx4 v215, s[4:7], s20 offen lds
    s_add_u32 s21, s21, 196608
    s_add_u32 s22, s22, 229376
    s_add_u32 s20, s20, 128
    v_mov_b32 v37, 0
    v_mov_b32 v38, 0
    v_mov_b32 v39, 0
    v_mov_b32 v40, 0
    v_mov_b32 v41, 0
    v_mov_b32 v42, 0
    v_mov_b32 v43, 0
    v_mov_b32 v44, 0
    v_mov_b32 v45, 0
    v_mov_b32 v46, 0
    v_mov_b32 v47, 0
    v_mov_b32 v48, 0
    v_mov_b32 v49, 0
    s_add_u32 m0, s24, 13312
    s_nop 0
    buffer_load_dwordx4 v216, s[8:11], s21 offen lds
    v_mov_b32 v50, 0
    v_mov_b32 v51, 0
    v_mov_b32 v52, 0
    v_mov_b32 v53, 0
    v_mov_b32 v54, 0
    v_mov_b32 v55, 0
    v_mov_b32 v56, 0
    v_mov_b32 v57, 0
    v_mov_b32 v58, 0
    v_mov_b32 v59, 0
    v_mov_b32 v60, 0
    v_mov_b32 v61, 0
    v_mov_b32 v62, 0
    s_add_u32 m0, s50, 8192
    s_nop 0
    buffer_load_dwordx4 v208, s[4:7], s20 offen lds
    v_mov_b32 v63, 0
    v_mov_b32 v64, 0
    v_mov_b32 v65, 0
    v_mov_b32 v66, 0
    v_mov_b32 v67, 0
    v_mov_b32 v68, 0
    v_mov_b32 v69, 0
    v_mov_b32 v70, 0
    v_mov_b32 v71, 0
    v_mov_b32 v72, 0
    v_mov_b32 v73, 0
    v_mov_b32 v74, 0
    v_mov_b32 v75, 0
    s_add_u32 m0, s50, 9216
    s_nop 0
    buffer_load_dwordx4 v209, s[4:7], s20 offen lds
    v_mov_b32 v76, 0
    v_mov_b32 v77, 0
    v_mov_b32 v78, 0
    v_mov_b32 v79, 0
    v_mov_b32 v80, 0
    v_mov_b32 v81, 0
    v_mov_b32 v82, 0
    v_mov_b32 v83, 0
    v_mov_b32 v84, 0
    v_mov_b32 v85, 0
    v_mov_b32 v86, 0
    v_mov_b32 v87, 0
    v_mov_b32 v88, 0
    s_add_u32 m0, s24, 17408
    s_nop 0
    buffer_load_dwordx4 v217, s[8:11], s21 offen lds
    v_mov_b32 v89, 0
    v_mov_b32 v90, 0
    v_mov_b32 v91, 0
    v_mov_b32 v92, 0
    v_mov_b32 v93, 0
    v_mov_b32 v94, 0
    v_mov_b32 v95, 0
    v_mov_b32 v96, 0
    v_mov_b32 v97, 0
    v_mov_b32 v98, 0
    v_mov_b32 v99, 0
    v_mov_b32 v100, 0
    v_mov_b32 v101, 0
    v_mov_b32 v102, 0
    s_add_u32 m0, s50, 10240
    s_nop 0
    buffer_load_dwordx4 v210, s[4:7], s20 offen lds
    v_mov_b32 v103, 0
    v_mov_b32 v104, 0
    v_mov_b32 v105, 0
    v_mov_b32 v106, 0
    v_mov_b32 v107, 0
    v_mov_b32 v108, 0
    v_mov_b32 v109, 0
    v_mov_b32 v110, 0
    v_mov_b32 v111, 0
    v_mov_b32 v112, 0
    v_mov_b32 v113, 0
    v_mov_b32 v114, 0
    v_mov_b32 v115, 0
    s_add_u32 m0, s50, 11264
    s_nop 0
    buffer_load_dwordx4 v211, s[4:7], s20 offen lds
    v_mov_b32 v116, 0
    v_mov_b32 v117, 0
    v_mov_b32 v118, 0
    v_mov_b32 v119, 0
    v_mov_b32 v120, 0
    v_mov_b32 v121, 0
    v_mov_b32 v122, 0
    v_mov_b32 v123, 0
    v_mov_b32 v124, 0
    v_mov_b32 v125, 0
    v_mov_b32 v126, 0
    v_mov_b32 v127, 0
    v_mov_b32 v128, 0
    s_add_u32 m0, s24, 21504
    s_nop 0
    buffer_load_dwordx4 v218, s[12:15], s22 offen lds
    v_mov_b32 v129, 0
    v_mov_b32 v130, 0
    v_mov_b32 v131, 0
    v_mov_b32 v132, 0
    v_mov_b32 v133, 0
    v_mov_b32 v134, 0
    v_mov_b32 v135, 0
    v_mov_b32 v136, 0
    v_mov_b32 v137, 0
    v_mov_b32 v138, 0
    v_mov_b32 v139, 0
    v_mov_b32 v140, 0
    v_mov_b32 v141, 0
    s_add_u32 m0, s50, 12288
    s_nop 0
    buffer_load_dwordx4 v212, s[4:7], s20 offen lds
    v_mov_b32 v142, 0
    v_mov_b32 v143, 0
    v_mov_b32 v144, 0
    v_mov_b32 v145, 0
    v_mov_b32 v146, 0
    v_mov_b32 v147, 0
    v_mov_b32 v148, 0
    v_mov_b32 v149, 0
    v_mov_b32 v150, 0
    v_mov_b32 v151, 0
    v_mov_b32 v152, 0
    v_mov_b32 v153, 0
    v_mov_b32 v154, 0
    s_add_u32 m0, s50, 13312
    s_nop 0
    buffer_load_dwordx4 v213, s[4:7], s20 offen lds
    v_mov_b32 v155, 0
    v_mov_b32 v156, 0
    v_mov_b32 v157, 0
    v_mov_b32 v158, 0
    v_mov_b32 v159, 0
    v_mov_b32 v160, 0
    v_mov_b32 v161, 0
    v_mov_b32 v162, 0
    v_mov_b32 v163, 0
    v_mov_b32 v164, 0
    v_mov_b32 v165, 0
    v_mov_b32 v166, 0
    v_mov_b32 v167, 0
    s_mov_b32 m0, s41
    s_nop 0
    buffer_load_dwordx4 v219, s[12:15], s22 offen lds
    v_mov_b32 v168, 0
    v_mov_b32 v169, 0
    v_mov_b32 v170, 0
    v_mov_b32 v171, 0
    v_mov_b32 v172, 0
    v_mov_b32 v173, 0
    v_mov_b32 v174, 0
    v_mov_b32 v175, 0
    v_mov_b32 v176, 0
    v_mov_b32 v177, 0
    v_mov_b32 v178, 0
    v_mov_b32 v179, 0
    v_mov_b32 v180, 0
    s_add_u32 m0, s50, 14336
    s_nop 0
    buffer_load_dwordx4 v214, s[4:7], s20 offen lds
    v_mov_b32 v181, 0
    v_mov_b32 v182, 0
    v_mov_b32 v183, 0
    v_mov_b32 v184, 0
    v_mov_b32 v185, 0
    v_mov_b32 v186, 0
    v_mov_b32 v187, 0
    v_mov_b32 v188, 0
    v_mov_b32 v189, 0
    v_mov_b32 v190, 0
    v_mov_b32 v191, 0
    v_mov_b32 v192, 0
    v_mov_b32 v193, 0
    s_add_u32 m0, s50, 15360
    s_nop 0
    buffer_load_dwordx4 v215, s[4:7], s20 offen lds
    s_add_u32 s21, s21, 196608
    s_add_u32 s22, s22, 229376
    s_add_u32 s20, s20, 128
    v_mov_b32 v194, 0
    v_mov_b32 v195, 0
    v_mov_b32 v196, 0
    v_mov_b32 v197, 0
    v_mov_b32 v198, 0
    v_mov_b32 v199, 0
    v_mov_b32 v200, 0
    v_mov_b32 v201, 0
    v_mov_b32 v202, 0
    v_mov_b32 v203, 0
    v_mov_b32 v204, 0
    v_mov_b32 v205, 0
    v_mov_b32 v206, 0
    v_mov_b32 v207, 0
    s_waitcnt vmcnt(24)
    s_add_u32 m0, s24, 26624
    s_nop 0
    buffer_load_dwordx4 v216, s[8:11], s21 offen lds
    v_mov_b32 v21, 0x3f803f80
    v_dot2_f32_bf16 v16, v0, v21, 0
    v_dot2_f32_bf16 v18, v0, v0, 0
    v_dot2_f32_bf16 v17, v1, v21, 0
    v_dot2_f32_bf16 v19, v1, v1, 0
    v_dot2_f32_bf16 v16, v2, v21, v16
    v_dot2_f32_bf16 v18, v2, v2, v18
    v_dot2_f32_bf16 v17, v3, v21, v17
    v_dot2_f32_bf16 v19, v3, v3, v19
    v_dot2_f32_bf16 v16, v4, v21, v16
    s_add_u32 m0, s50, 16384
    s_nop 0
    buffer_load_dwordx4 v208, s[4:7], s20 offen lds
    v_dot2_f32_bf16 v18, v4, v4, v18
    v_dot2_f32_bf16 v17, v5, v21, v17
    v_dot2_f32_bf16 v19, v5, v5, v19
    v_dot2_f32_bf16 v16, v6, v21, v16
    v_dot2_f32_bf16 v18, v6, v6, v18
    v_dot2_f32_bf16 v17, v7, v21, v17
    v_dot2_f32_bf16 v19, v7, v7, v19
    v_dot2_f32_bf16 v16, v8, v21, v16
    v_dot2_f32_bf16 v18, v8, v8, v18
    v_dot2_f32_bf16 v17, v9, v21, v17
    s_add_u32 m0, s24, 30720
    s_nop 0
    buffer_load_dwordx4 v217, s[8:11], s21 offen lds
    v_dot2_f32_bf16 v19, v9, v9, v19
    v_dot2_f32_bf16 v16, v10, v21, v16
    v_dot2_f32_bf16 v18, v10, v10, v18
    v_dot2_f32_bf16 v17, v11, v21, v17
    v_dot2_f32_bf16 v19, v11, v11, v19
    v_dot2_f32_bf16 v16, v12, v21, v16
    v_dot2_f32_bf16 v18, v12, v12, v18
    v_dot2_f32_bf16 v17, v13, v21, v17
    v_dot2_f32_bf16 v19, v13, v13, v19
    v_dot2_f32_bf16 v16, v14, v21, v16
    s_add_u32 m0, s50, 17408
    s_nop 0
    buffer_load_dwordx4 v209, s[4:7], s20 offen lds
    v_dot2_f32_bf16 v18, v14, v14, v18
    v_dot2_f32_bf16 v17, v15, v21, v17
    v_dot2_f32_bf16 v19, v15, v15, v19
    v_mov_b32 v0, -1
    v_mov_b32 v1, -1
    v_and_b32 v8, 48, v255
    v_mov_b32 v2, -1
    v_mov_b32 v3, -1
    v_mov_b32 v4, 0
    v_add_f32 v16, v16, v17
    v_add_f32 v17, v18, v19
    s_add_u32 m0, s24, 34816
    s_nop 0
    buffer_load_dwordx4 v218, s[12:15], s22 offen lds
    v_lshlrev_b32 v5, 3, v255
    v_lshlrev_b32 v6, 2, v255
    v_add_f32_dpp v16, v16, v16 row_ror:8 row_mask:0xf bank_mask:0xf
    v_add_f32_dpp v17, v17, v17 row_ror:8 row_mask:0xf bank_mask:0xf
    s_nop 0
    v_add_f32_dpp v16, v16, v16 row_ror:4 row_mask:0xf bank_mask:0xf
    v_add_f32_dpp v17, v17, v17 row_ror:4 row_mask:0xf bank_mask:0xf
    s_nop 0
    v_add_f32_dpp v16, v16, v16 row_ror:2 row_mask:0xf bank_mask:0xf
    v_add_f32_dpp v17, v17, v17 row_ror:2 row_mask:0xf bank_mask:0xf
    s_add_u32 m0, s50, 18432
    s_nop 0
    buffer_load_dwordx4 v210, s[4:7], s20 offen lds
    s_nop 0
    v_add_f32_dpp v16, v16, v16 row_ror:1 row_mask:0xf bank_mask:0xf
    v_add_f32_dpp v17, v17, v17 row_ror:1 row_mask:0xf bank_mask:0xf
    s_nop 0
    v_mov_b32 v18, v16
    v_mov_b32 v19, v17
    v_lshrrev_b32 v7, 5, v255
    v_lshlrev_b32 v7, 3, v7
    v_permlane16_swap_b32 v18, v16
    v_permlane16_swap_b32 v19, v17
    s_mov_b32 m0, s42
    s_nop 0
    buffer_load_dwordx4 v219, s[12:15], s22 offen lds
    v_add_f32 v16, v16, v18
    v_add_f32 v17, v17, v19
    v_mul_f32 v16, 0x3a800000, v16
    v_mul_f32 v17, 0x3a800000, v17
    v_fma_f32 v17, -v16, v16, v17
    v_max_f32 v17, 0, v17
    v_cvt_pk_bf16_f32 v17, v17, v17
    v_lshlrev_b32 v17, 16, v17
    v_add_f32 v17, 0x3727c5ac, v17
    v_cvt_pk_bf16_f32 v17, v17, v17
    s_add_u32 m0, s50, 19456
    s_nop 0
    buffer_load_dwordx4 v211, s[4:7], s20 offen lds
    s_add_u32 s21, s21, 196608
    s_add_u32 s22, s22, 229376
    v_lshlrev_b32 v17, 16, v17
    v_sqrt_f32 v17, v17
    v_cvt_pk_bf16_f32 v16, v16, v16
    v_lshlrev_b32 v16, 16, v16
    v_cvt_pk_bf16_f32 v17, v17, v17
    v_lshlrev_b32 v17, 16, v17
    v_rcp_f32 v17, v17
    s_nop 0
    v_sub_f32 v18, 0, v16
    v_mov_b32 v16, v17
    v_mov_b32 v17, v18
    s_mov_b32 exec_lo, 1
    s_mov_b32 exec_hi, 1
    buffer_store_dwordx2 v[16:17], v7, s[16:19], s57 offen sc1
    s_mov_b64 exec, s[84:85]
    buffer_store_dwordx4 v[0:3], v8, s[16:19], s86 offen sc1
    s_mov_b64 exec, -1
    s_cmp_lt_u32 s32, 8
    s_cbranch_scc1 k1_kernel_E_nost
    buffer_store_dwordx2 v[2:3], v5, s[16:19], s58 offen sc1
k1_kernel_E_nost:
    s_cmp_lg_u32 s29, 0
    s_cbranch_scc1 k1_kernel_E_nofl
    buffer_store_dword v4, v6, s[16:19], s59 offen
k1_kernel_E_nofl:
    s_nop 1
    v_mov_b32 v0, 0
    v_mov_b32 v1, 0
    v_mov_b32 v2, 0
    v_mov_b32 v3, 0
    v_mov_b32 v4, 0
    v_mov_b32 v5, 0
    v_mov_b32 v6, 0
    v_mov_b32 v7, 0
    v_mov_b32 v8, 0
    v_mov_b32 v9, 0
    v_mov_b32 v10, 0
    v_mov_b32 v11, 0
    v_mov_b32 v12, 0
    v_mov_b32 v13, 0
    v_mov_b32 v14, 0
    v_mov_b32 v15, 0
    v_mov_b32 v16, 0
    v_mov_b32 v17, 0
    v_mov_b32 v18, 0
    v_mov_b32 v19, 0
    v_mov_b32 v20, 0
    v_mov_b32 v21, 0
    v_mov_b32 v22, 0
    v_mov_b32 v23, 0
    s_waitcnt vmcnt(20)
    s_barrier
    ds_read_b128 a[52:55], v240 offset:0
    ds_read_b128 a[56:59], v240 offset:2048
    ds_read_b128 a[60:63], v240 offset:4096
    ds_read_b128 a[64:67], v240 offset:6144
    ds_read_b64_tr_b16 a[0:1], v222 offset:0
    ds_read_b64_tr_b16 a[2:3], v222 offset:512
    ds_read_b64_tr_b16 a[4:5], v223 offset:0
    ds_read_b64_tr_b16 a[6:7], v223 offset:512
    ds_read_b64_tr_b16 a[8:9], v224 offset:0
    ds_read_b64_tr_b16 a[10:11], v224 offset:512
    ds_read_b64_tr_b16 a[12:13], v225 offset:0
    ds_read_b64_tr_b16 a[14:15], v225 offset:512
    s_mov_b32 s33, 7
    .p2align 4
k1_kernel_loop_1:
    s_waitcnt lgkmcnt(6)
    v_mfma_f32_16x16x32_bf16 v[0:3], a[52:55], a[0:3], v[0:3]
    ds_read_b64_tr_b16 a[16:17], v222 offset:4096
    v_mfma_f32_16x16x32_bf16 v[4:7], a[56:59], a[0:3], v[4:7]
    ds_read_b64_tr_b16 a[18:19], v222 offset:4608
    ds_read_b64_tr_b16 a[84:85], v234 offset:0
    v_mfma_f32_16x16x32_bf16 v[8:11], a[60:63], a[0:3], v[8:11]
    ds_read_b128 a[68:71], v241 offset:0
    s_add_u32 m0, s24, 39936
    v_mfma_f32_16x16x32_bf16 v[12:15], a[64:67], a[0:3], v[12:15]
    buffer_load_dwordx4 v216, s[8:11], s21 offen lds
    s_waitcnt lgkmcnt(8)
    v_mfma_f32_16x16x32_bf16 v[28:31], a[64:67], a[4:7], v[28:31]
    ds_read_b64_tr_b16 a[20:21], v223 offset:4096
    v_mfma_f32_16x16x32_bf16 v[24:27], a[60:63], a[4:7], v[24:27]
    ds_read_b64_tr_b16 a[22:23], v223 offset:4608
    ds_read_b64_tr_b16 a[86:87], v235 offset:0
    v_mfma_f32_16x16x32_bf16 v[20:23], a[56:59], a[4:7], v[20:23]
    s_add_u32 m0, s48, 4096
    v_mfma_f32_16x16x32_bf16 v[16:19], a[52:55], a[4:7], v[16:19]
    buffer_load_dwordx4 v212, s[4:7], s20 offen lds
    s_waitcnt lgkmcnt(9)
    v_mfma_f32_16x16x32_bf16 v[32:35], a[52:55], a[8:11], v[32:35]
    ds_read_b64_tr_b16 a[24:25], v224 offset:4096
    v_mfma_f32_16x16x32_bf16 v[36:39], a[56:59], a[8:11], v[36:39]
    ds_read_b64_tr_b16 a[26:27], v224 offset:4608
    v_mfma_f32_16x16x32_bf16 v[40:43], a[60:63], a[8:11], v[40:43]
    ds_read_b128 a[72:75], v241 offset:2048
    s_add_u32 m0, s24, 44032
    v_mfma_f32_16x16x32_bf16 v[44:47], a[64:67], a[8:11], v[44:47]
    buffer_load_dwordx4 v217, s[8:11], s21 offen lds
    s_waitcnt lgkmcnt(10)
    v_mfma_f32_16x16x32_bf16 v[60:63], a[64:67], a[12:15], v[60:63]
    ds_read_b64_tr_b16 a[28:29], v225 offset:4096
    v_mfma_f32_16x16x32_bf16 v[56:59], a[60:63], a[12:15], v[56:59]
    ds_read_b64_tr_b16 a[30:31], v225 offset:4608
    v_mfma_f32_16x16x32_bf16 v[52:55], a[56:59], a[12:15], v[52:55]
    s_add_u32 m0, s48, 5120
    v_mfma_f32_16x16x32_bf16 v[48:51], a[52:55], a[12:15], v[48:51]
    buffer_load_dwordx4 v213, s[4:7], s20 offen lds
    s_waitcnt lgkmcnt(10)
    v_mfma_f32_16x16x32_bf16 v[64:67], a[52:55], a[16:19], v[64:67]
    ds_read_b64_tr_b16 a[32:33], v226 offset:8192
    v_mfma_f32_16x16x32_bf16 v[68:71], a[56:59], a[16:19], v[68:71]
    ds_read_b64_tr_b16 a[34:35], v230 offset:8704
    v_mfma_f32_16x16x32_bf16 v[72:75], a[60:63], a[16:19], v[72:75]
    ds_read_b128 a[76:79], v241 offset:4096
    s_add_u32 m0, s24, 48128
    v_mfma_f32_16x16x32_bf16 v[76:79], a[64:67], a[16:19], v[76:79]
    buffer_load_dwordx4 v218, s[12:15], s22 offen lds
    s_waitcnt lgkmcnt(9)
    v_mfma_f32_16x16x32_bf16 v[92:95], a[64:67], a[20:23], v[92:95]
    ds_read_b64_tr_b16 a[36:37], v227 offset:8192
    v_mfma_f32_16x16x32_bf16 v[88:91], a[60:63], a[20:23], v[88:91]
    ds_read_b64_tr_b16 a[38:39], v231 offset:8704
    v_mfma_f32_16x16x32_bf16 v[84:87], a[56:59], a[20:23], v[84:87]
    s_add_u32 m0, s48, 6144
    v_mfma_f32_16x16x32_bf16 v[80:83], a[52:55], a[20:23], v[80:83]
    buffer_load_dwordx4 v214, s[4:7], s20 offen lds
    s_waitcnt lgkmcnt(8)
    v_mfma_f32_16x16x32_bf16 v[96:99], a[52:55], a[24:27], v[96:99]
    ds_read_b64_tr_b16 a[40:41], v228 offset:8192
    v_mfma_f32_16x16x32_bf16 v[100:103], a[56:59], a[24:27], v[100:103]
    ds_read_b64_tr_b16 a[42:43], v232 offset:8704
    v_mfma_f32_16x16x32_bf16 v[104:107], a[60:63], a[24:27], v[104:107]
    ds_read_b128 a[80:83], v241 offset:6144
    s_mov_b32 m0, s43
    v_mfma_f32_16x16x32_bf16 v[108:111], a[64:67], a[24:27], v[108:111]
    buffer_load_dwordx4 v219, s[12:15], s22 offen lds
    s_waitcnt lgkmcnt(8)
    v_mfma_f32_16x16x32_bf16 v[124:127], a[64:67], a[28:31], v[124:127]
    ds_read_b64_tr_b16 a[44:45], v229 offset:8192
    v_mfma_f32_16x16x32_bf16 v[120:123], a[60:63], a[28:31], v[120:123]
    ds_read_b64_tr_b16 a[46:47], v233 offset:8704
    v_mfma_f32_16x16x32_bf16 v[116:119], a[56:59], a[28:31], v[116:119]
    s_add_u32 m0, s48, 7168
    v_mfma_f32_16x16x32_bf16 v[112:115], a[52:55], a[28:31], v[112:115]
    buffer_load_dwordx4 v215, s[4:7], s20 offen lds
    s_waitcnt lgkmcnt(8)
    v_mfma_f32_16x16x32_bf16 v[128:131], a[32:35], a[52:55], v[128:131]
    ds_read_b64_tr_b16 a[48:49], v230 offset:8192
    v_mfma_f32_16x16x32_bf16 v[132:135], a[32:35], a[56:59], v[132:135]
    ds_read_b64_tr_b16 a[50:51], v226 offset:8960
    v_mfma_f32_16x16x32_bf16 v[136:139], a[32:35], a[60:63], v[136:139]
    s_add_u32 s21, s21, 196608
    v_mfma_f32_16x16x32_bf16 v[140:143], a[32:35], a[64:67], v[140:143]
    s_add_u32 s22, s22, 229376
    s_waitcnt lgkmcnt(7)
    v_mfma_f32_16x16x32_bf16 v[156:159], a[36:39], a[64:67], v[156:159]
    v_mfma_f32_16x16x32_bf16 a[116:119], a[84:87], a[112:115], a[116:119]
    v_mfma_f32_16x16x32_bf16 v[152:155], a[36:39], a[60:63], v[152:155]
    v_mfma_f32_16x16x32_bf16 v[148:151], a[36:39], a[56:59], v[148:151]
    s_add_u32 s20, s20, 128
    v_mfma_f32_16x16x32_bf16 v[144:147], a[36:39], a[52:55], v[144:147]
    s_waitcnt vmcnt(16) lgkmcnt(0)
    s_barrier
    v_mfma_f32_16x16x32_bf16 v[160:163], a[40:43], a[52:55], v[160:163]
    ds_read_b64_tr_b16 a[0:1], v222 offset:13312
    v_mfma_f32_16x16x32_bf16 v[164:167], a[40:43], a[56:59], v[164:167]
    ds_read_b64_tr_b16 a[2:3], v222 offset:13824
    v_mfma_f32_16x16x32_bf16 v[168:171], a[40:43], a[60:63], v[168:171]
    ds_read_b64_tr_b16 a[4:5], v223 offset:13312
    v_mfma_f32_16x16x32_bf16 v[172:175], a[40:43], a[64:67], v[172:175]
    ds_read_b64_tr_b16 a[6:7], v223 offset:13824
    v_mfma_f32_16x16x32_bf16 v[188:191], a[44:47], a[64:67], v[188:191]
    ds_read_b64_tr_b16 a[8:9], v224 offset:13312
    v_mfma_f32_16x16x32_bf16 v[184:187], a[44:47], a[60:63], v[184:187]
    ds_read_b64_tr_b16 a[10:11], v224 offset:13824
    v_mfma_f32_16x16x32_bf16 v[180:183], a[44:47], a[56:59], v[180:183]
    ds_read_b64_tr_b16 a[12:13], v225 offset:13312
    v_mfma_f32_16x16x32_bf16 v[176:179], a[44:47], a[52:55], v[176:179]
    ds_read_b64_tr_b16 a[14:15], v225 offset:13824
    v_mfma_f32_16x16x32_bf16 v[192:195], a[48:51], a[52:55], v[192:195]
    s_mov_b32 s48, s49
    s_add_u32 s49, s49, 8192
    v_mfma_f32_16x16x32_bf16 v[196:199], a[48:51], a[56:59], v[196:199]
    v_mfma_f32_16x16x32_bf16 v[200:203], a[48:51], a[60:63], v[200:203]
    s_cmp_eq_u32 s49, s51
    s_cselect_b32 s49, s50, s49
    v_mfma_f32_16x16x32_bf16 v[204:207], a[48:51], a[64:67], v[204:207]
    v_add_u32 v240, s49, v238
    v_add_u32 v241, s49, v239
    s_waitcnt lgkmcnt(6)
    v_mfma_f32_16x16x32_bf16 v[12:15], a[80:83], a[0:3], v[12:15]
    ds_read_b64_tr_b16 a[16:17], v222 offset:17408
    v_mfma_f32_16x16x32_bf16 v[8:11], a[76:79], a[0:3], v[8:11]
    ds_read_b64_tr_b16 a[18:19], v222 offset:17920
    ds_read_b64_tr_b16 a[84:85], v234 offset:13312
    v_mfma_f32_16x16x32_bf16 v[4:7], a[72:75], a[0:3], v[4:7]
    ds_read_b128 a[52:55], v240 offset:0
    s_add_u32 m0, s24, 0
    v_mfma_f32_16x16x32_bf16 v[0:3], a[68:71], a[0:3], v[0:3]
    buffer_load_dwordx4 v216, s[8:11], s21 offen lds
    s_waitcnt lgkmcnt(8)
    v_mfma_f32_16x16x32_bf16 v[16:19], a[68:71], a[4:7], v[16:19]
    ds_read_b64_tr_b16 a[20:21], v223 offset:17408
    v_mfma_f32_16x16x32_bf16 v[20:23], a[72:75], a[4:7], v[20:23]
    ds_read_b64_tr_b16 a[22:23], v223 offset:17920
    ds_read_b64_tr_b16 a[86:87], v235 offset:13312
    v_mfma_f32_16x16x32_bf16 v[24:27], a[76:79], a[4:7], v[24:27]
    s_add_u32 m0, s48, 0
    v_mfma_f32_16x16x32_bf16 v[28:31], a[80:83], a[4:7], v[28:31]
    buffer_load_dwordx4 v208, s[4:7], s20 offen lds
    s_waitcnt lgkmcnt(9)
    v_mfma_f32_16x16x32_bf16 v[44:47], a[80:83], a[8:11], v[44:47]
    ds_read_b64_tr_b16 a[24:25], v224 offset:17408
    v_mfma_f32_16x16x32_bf16 v[40:43], a[76:79], a[8:11], v[40:43]
    ds_read_b64_tr_b16 a[26:27], v224 offset:17920
    v_mfma_f32_16x16x32_bf16 v[36:39], a[72:75], a[8:11], v[36:39]
    ds_read_b128 a[56:59], v240 offset:2048
    s_add_u32 m0, s24, 4096
    v_mfma_f32_16x16x32_bf16 v[32:35], a[68:71], a[8:11], v[32:35]
    buffer_load_dwordx4 v217, s[8:11], s21 offen lds
    s_waitcnt lgkmcnt(10)
    v_mfma_f32_16x16x32_bf16 v[48:51], a[68:71], a[12:15], v[48:51]
    ds_read_b64_tr_b16 a[28:29], v225 offset:17408
    v_mfma_f32_16x16x32_bf16 v[52:55], a[72:75], a[12:15], v[52:55]
    ds_read_b64_tr_b16 a[30:31], v225 offset:17920
    v_mfma_f32_16x16x32_bf16 v[56:59], a[76:79], a[12:15], v[56:59]
    s_add_u32 m0, s48, 1024
    v_mfma_f32_16x16x32_bf16 v[60:63], a[80:83], a[12:15], v[60:63]
    buffer_load_dwordx4 v209, s[4:7], s20 offen lds
    s_waitcnt lgkmcnt(10)
    v_mfma_f32_16x16x32_bf16 v[76:79], a[80:83], a[16:19], v[76:79]
    ds_read_b64_tr_b16 a[32:33], v226 offset:21504
    v_mfma_f32_16x16x32_bf16 v[72:75], a[76:79], a[16:19], v[72:75]
    ds_read_b64_tr_b16 a[34:35], v230 offset:22016
    v_mfma_f32_16x16x32_bf16 v[68:71], a[72:75], a[16:19], v[68:71]
    ds_read_b128 a[60:63], v240 offset:4096
    s_add_u32 m0, s24, 8192
    v_mfma_f32_16x16x32_bf16 v[64:67], a[68:71], a[16:19], v[64:67]
    buffer_load_dwordx4 v218, s[12:15], s22 offen lds
    s_waitcnt lgkmcnt(9)
    v_mfma_f32_16x16x32_bf16 v[80:83], a[68:71], a[20:23], v[80:83]
    ds_read_b64_tr_b16 a[36:37], v227 offset:21504
    v_mfma_f32_16x16x32_bf16 v[84:87], a[72:75], a[20:23], v[84:87]
    ds_read_b64_tr_b16 a[38:39], v231 offset:22016
    v_mfma_f32_16x16x32_bf16 v[88:91], a[76:79], a[20:23], v[88:91]
    s_add_u32 m0, s48, 2048
    v_mfma_f32_16x16x32_bf16 v[92:95], a[80:83], a[20:23], v[92:95]
    buffer_load_dwordx4 v210, s[4:7], s20 offen lds
    s_waitcnt lgkmcnt(8)
    v_mfma_f32_16x16x32_bf16 v[108:111], a[80:83], a[24:27], v[108:111]
    ds_read_b64_tr_b16 a[40:41], v228 offset:21504
    v_mfma_f32_16x16x32_bf16 v[104:107], a[76:79], a[24:27], v[104:107]
    ds_read_b64_tr_b16 a[42:43], v232 offset:22016
    v_mfma_f32_16x16x32_bf16 v[100:103], a[72:75], a[24:27], v[100:103]
    ds_read_b128 a[64:67], v240 offset:6144
    s_mov_b32 m0, s40
    v_mfma_f32_16x16x32_bf16 v[96:99], a[68:71], a[24:27], v[96:99]
    buffer_load_dwordx4 v219, s[12:15], s22 offen lds
    s_waitcnt lgkmcnt(8)
    v_mfma_f32_16x16x32_bf16 v[112:115], a[68:71], a[28:31], v[112:115]
    ds_read_b64_tr_b16 a[44:45], v229 offset:21504
    v_mfma_f32_16x16x32_bf16 v[116:119], a[72:75], a[28:31], v[116:119]
    ds_read_b64_tr_b16 a[46:47], v233 offset:22016
    v_mfma_f32_16x16x32_bf16 v[120:123], a[76:79], a[28:31], v[120:123]
    s_add_u32 m0, s48, 3072
    v_mfma_f32_16x16x32_bf16 v[124:127], a[80:83], a[28:31], v[124:127]
    buffer_load_dwordx4 v211, s[4:7], s20 offen lds
    s_waitcnt lgkmcnt(8)
    v_mfma_f32_16x16x32_bf16 v[140:143], a[32:35], a[80:83], v[140:143]
    ds_read_b64_tr_b16 a[48:49], v230 offset:21504
    v_mfma_f32_16x16x32_bf16 v[136:139], a[32:35], a[76:79], v[136:139]
    ds_read_b64_tr_b16 a[50:51], v226 offset:22272
    v_mfma_f32_16x16x32_bf16 v[132:135], a[32:35], a[72:75], v[132:135]
    s_add_u32 s21, s21, 196608
    v_mfma_f32_16x16x32_bf16 v[128:131], a[32:35], a[68:71], v[128:131]
    s_add_u32 s22, s22, 229376
    s_waitcnt lgkmcnt(7)
    v_mfma_f32_16x16x32_bf16 v[144:147], a[36:39], a[68:71], v[144:147]
    v_mfma_f32_16x16x32_bf16 a[116:119], a[84:87], a[112:115], a[116:119]
    v_mfma_f32_16x16x32_bf16 v[148:151], a[36:39], a[72:75], v[148:151]
    v_mfma_f32_16x16x32_bf16 v[152:155], a[36:39], a[76:79], v[152:155]
    v_mfma_f32_16x16x32_bf16 v[156:159], a[36:39], a[80:83], v[156:159]
    s_waitcnt vmcnt(17) lgkmcnt(0)
    s_barrier
    v_mfma_f32_16x16x32_bf16 v[172:175], a[40:43], a[80:83], v[172:175]
    ds_read_b64_tr_b16 a[0:1], v222 offset:26624
    v_mfma_f32_16x16x32_bf16 v[168:171], a[40:43], a[76:79], v[168:171]
    ds_read_b64_tr_b16 a[2:3], v222 offset:27136
    v_mfma_f32_16x16x32_bf16 v[164:167], a[40:43], a[72:75], v[164:167]
    ds_read_b64_tr_b16 a[4:5], v223 offset:26624
    v_mfma_f32_16x16x32_bf16 v[160:163], a[40:43], a[68:71], v[160:163]
    ds_read_b64_tr_b16 a[6:7], v223 offset:27136
    v_mfma_f32_16x16x32_bf16 v[176:179], a[44:47], a[68:71], v[176:179]
    ds_read_b64_tr_b16 a[8:9], v224 offset:26624
    v_mfma_f32_16x16x32_bf16 v[180:183], a[44:47], a[72:75], v[180:183]
    ds_read_b64_tr_b16 a[10:11], v224 offset:27136
    v_mfma_f32_16x16x32_bf16 v[184:187], a[44:47], a[76:79], v[184:187]
    ds_read_b64_tr_b16 a[12:13], v225 offset:26624
    v_mfma_f32_16x16x32_bf16 v[188:191], a[44:47], a[80:83], v[188:191]
    ds_read_b64_tr_b16 a[14:15], v225 offset:27136
    v_mfma_f32_16x16x32_bf16 v[204:207], a[48:51], a[80:83], v[204:207]
    v_mfma_f32_16x16x32_bf16 v[200:203], a[48:51], a[76:79], v[200:203]
    v_mfma_f32_16x16x32_bf16 v[196:199], a[48:51], a[72:75], v[196:199]
    v_mfma_f32_16x16x32_bf16 v[192:195], a[48:51], a[68:71], v[192:195]
    s_waitcnt lgkmcnt(6)
    v_mfma_f32_16x16x32_bf16 v[0:3], a[52:55], a[0:3], v[0:3]
    ds_read_b64_tr_b16 a[16:17], v222 offset:30720
    v_mfma_f32_16x16x32_bf16 v[4:7], a[56:59], a[0:3], v[4:7]
    ds_read_b64_tr_b16 a[18:19], v222 offset:31232
    ds_read_b64_tr_b16 a[84:85], v234 offset:26624
    v_mfma_f32_16x16x32_bf16 v[8:11], a[60:63], a[0:3], v[8:11]
    ds_read_b128 a[68:71], v241 offset:0
    s_add_u32 m0, s24, 13312
    v_mfma_f32_16x16x32_bf16 v[12:15], a[64:67], a[0:3], v[12:15]
    buffer_load_dwordx4 v216, s[8:11], s21 offen lds
    s_waitcnt lgkmcnt(8)
    v_mfma_f32_16x16x32_bf16 v[28:31], a[64:67], a[4:7], v[28:31]
    ds_read_b64_tr_b16 a[20:21], v223 offset:30720
    v_mfma_f32_16x16x32_bf16 v[24:27], a[60:63], a[4:7], v[24:27]
    ds_read_b64_tr_b16 a[22:23], v223 offset:31232
    ds_read_b64_tr_b16 a[86:87], v235 offset:26624
    v_mfma_f32_16x16x32_bf16 v[20:23], a[56:59], a[4:7], v[20:23]
    s_add_u32 m0, s48, 4096
    v_mfma_f32_16x16x32_bf16 v[16:19], a[52:55], a[4:7], v[16:19]
    buffer_load_dwordx4 v212, s[4:7], s20 offen lds
    s_waitcnt lgkmcnt(9)
    v_mfma_f32_16x16x32_bf16 v[32:35], a[52:55], a[8:11], v[32:35]
    ds_read_b64_tr_b16 a[24:25], v224 offset:30720
    v_mfma_f32_16x16x32_bf16 v[36:39], a[56:59], a[8:11], v[36:39]
    ds_read_b64_tr_b16 a[26:27], v224 offset:31232
    v_mfma_f32_16x16x32_bf16 v[40:43], a[60:63], a[8:11], v[40:43]
    ds_read_b128 a[72:75], v241 offset:2048
    s_add_u32 m0, s24, 17408
    v_mfma_f32_16x16x32_bf16 v[44:47], a[64:67], a[8:11], v[44:47]
    buffer_load_dwordx4 v217, s[8:11], s21 offen lds
    s_waitcnt lgkmcnt(10)
    v_mfma_f32_16x16x32_bf16 v[60:63], a[64:67], a[12:15], v[60:63]
    ds_read_b64_tr_b16 a[28:29], v225 offset:30720
    v_mfma_f32_16x16x32_bf16 v[56:59], a[60:63], a[12:15], v[56:59]
    ds_read_b64_tr_b16 a[30:31], v225 offset:31232
    v_mfma_f32_16x16x32_bf16 v[52:55], a[56:59], a[12:15], v[52:55]
    s_add_u32 m0, s48, 5120
    v_mfma_f32_16x16x32_bf16 v[48:51], a[52:55], a[12:15], v[48:51]
    buffer_load_dwordx4 v213, s[4:7], s20 offen lds
    s_waitcnt lgkmcnt(10)
    v_mfma_f32_16x16x32_bf16 v[64:67], a[52:55], a[16:19], v[64:67]
    ds_read_b64_tr_b16 a[32:33], v226 offset:34816
    v_mfma_f32_16x16x32_bf16 v[68:71], a[56:59], a[16:19], v[68:71]
    ds_read_b64_tr_b16 a[34:35], v230 offset:35328
    v_mfma_f32_16x16x32_bf16 v[72:75], a[60:63], a[16:19], v[72:75]
    ds_read_b128 a[76:79], v241 offset:4096
    s_add_u32 m0, s24, 21504
    v_mfma_f32_16x16x32_bf16 v[76:79], a[64:67], a[16:19], v[76:79]
    buffer_load_dwordx4 v218, s[12:15], s22 offen lds
    s_waitcnt lgkmcnt(9)
    v_mfma_f32_16x16x32_bf16 v[92:95], a[64:67], a[20:23], v[92:95]
    ds_read_b64_tr_b16 a[36:37], v227 offset:34816
    v_mfma_f32_16x16x32_bf16 v[88:91], a[60:63], a[20:23], v[88:91]
    ds_read_b64_tr_b16 a[38:39], v231 offset:35328
    v_mfma_f32_16x16x32_bf16 v[84:87], a[56:59], a[20:23], v[84:87]
    s_add_u32 m0, s48, 6144
    v_mfma_f32_16x16x32_bf16 v[80:83], a[52:55], a[20:23], v[80:83]
    buffer_load_dwordx4 v214, s[4:7], s20 offen lds
    s_waitcnt lgkmcnt(8)
    v_mfma_f32_16x16x32_bf16 v[96:99], a[52:55], a[24:27], v[96:99]
    ds_read_b64_tr_b16 a[40:41], v228 offset:34816
    v_mfma_f32_16x16x32_bf16 v[100:103], a[56:59], a[24:27], v[100:103]
    ds_read_b64_tr_b16 a[42:43], v232 offset:35328
    v_mfma_f32_16x16x32_bf16 v[104:107], a[60:63], a[24:27], v[104:107]
    ds_read_b128 a[80:83], v241 offset:6144
    s_mov_b32 m0, s41
    v_mfma_f32_16x16x32_bf16 v[108:111], a[64:67], a[24:27], v[108:111]
    buffer_load_dwordx4 v219, s[12:15], s22 offen lds
    s_waitcnt lgkmcnt(8)
    v_mfma_f32_16x16x32_bf16 v[124:127], a[64:67], a[28:31], v[124:127]
    ds_read_b64_tr_b16 a[44:45], v229 offset:34816
    v_mfma_f32_16x16x32_bf16 v[120:123], a[60:63], a[28:31], v[120:123]
    ds_read_b64_tr_b16 a[46:47], v233 offset:35328
    v_mfma_f32_16x16x32_bf16 v[116:119], a[56:59], a[28:31], v[116:119]
    s_add_u32 m0, s48, 7168
    v_mfma_f32_16x16x32_bf16 v[112:115], a[52:55], a[28:31], v[112:115]
    buffer_load_dwordx4 v215, s[4:7], s20 offen lds
    s_waitcnt lgkmcnt(8)
    v_mfma_f32_16x16x32_bf16 v[128:131], a[32:35], a[52:55], v[128:131]
    ds_read_b64_tr_b16 a[48:49], v230 offset:34816
    v_mfma_f32_16x16x32_bf16 v[132:135], a[32:35], a[56:59], v[132:135]
    ds_read_b64_tr_b16 a[50:51], v226 offset:35584
    v_mfma_f32_16x16x32_bf16 v[136:139], a[32:35], a[60:63], v[136:139]
    s_add_u32 s21, s21, 196608
    v_mfma_f32_16x16x32_bf16 v[140:143], a[32:35], a[64:67], v[140:143]
    s_add_u32 s22, s22, 229376
    s_waitcnt lgkmcnt(7)
    v_mfma_f32_16x16x32_bf16 v[156:159], a[36:39], a[64:67], v[156:159]
    v_mfma_f32_16x16x32_bf16 a[116:119], a[84:87], a[112:115], a[116:119]
    v_mfma_f32_16x16x32_bf16 v[152:155], a[36:39], a[60:63], v[152:155]
    v_mfma_f32_16x16x32_bf16 v[148:151], a[36:39], a[56:59], v[148:151]
    s_add_u32 s20, s20, 128
    v_mfma_f32_16x16x32_bf16 v[144:147], a[36:39], a[52:55], v[144:147]
    s_waitcnt vmcnt(16) lgkmcnt(0)
    s_barrier
    v_mfma_f32_16x16x32_bf16 v[160:163], a[40:43], a[52:55], v[160:163]
    ds_read_b64_tr_b16 a[0:1], v222 offset:39936
    v_mfma_f32_16x16x32_bf16 v[164:167], a[40:43], a[56:59], v[164:167]
    ds_read_b64_tr_b16 a[2:3], v222 offset:40448
    v_mfma_f32_16x16x32_bf16 v[168:171], a[40:43], a[60:63], v[168:171]
    ds_read_b64_tr_b16 a[4:5], v223 offset:39936
    v_mfma_f32_16x16x32_bf16 v[172:175], a[40:43], a[64:67], v[172:175]
    ds_read_b64_tr_b16 a[6:7], v223 offset:40448
    v_mfma_f32_16x16x32_bf16 v[188:191], a[44:47], a[64:67], v[188:191]
    ds_read_b64_tr_b16 a[8:9], v224 offset:39936
    v_mfma_f32_16x16x32_bf16 v[184:187], a[44:47], a[60:63], v[184:187]
    ds_read_b64_tr_b16 a[10:11], v224 offset:40448
    v_mfma_f32_16x16x32_bf16 v[180:183], a[44:47], a[56:59], v[180:183]
    ds_read_b64_tr_b16 a[12:13], v225 offset:39936
    v_mfma_f32_16x16x32_bf16 v[176:179], a[44:47], a[52:55], v[176:179]
    ds_read_b64_tr_b16 a[14:15], v225 offset:40448
    v_mfma_f32_16x16x32_bf16 v[192:195], a[48:51], a[52:55], v[192:195]
    s_mov_b32 s48, s49
    s_add_u32 s49, s49, 8192
    v_mfma_f32_16x16x32_bf16 v[196:199], a[48:51], a[56:59], v[196:199]
    v_mfma_f32_16x16x32_bf16 v[200:203], a[48:51], a[60:63], v[200:203]
    s_cmp_eq_u32 s49, s51
    s_cselect_b32 s49, s50, s49
    v_mfma_f32_16x16x32_bf16 v[204:207], a[48:51], a[64:67], v[204:207]
    v_add_u32 v240, s49, v238
    v_add_u32 v241, s49, v239
    s_waitcnt lgkmcnt(6)
    v_mfma_f32_16x16x32_bf16 v[12:15], a[80:83], a[0:3], v[12:15]
    ds_read_b64_tr_b16 a[16:17], v222 offset:44032
    v_mfma_f32_16x16x32_bf16 v[8:11], a[76:79], a[0:3], v[8:11]
    ds_read_b64_tr_b16 a[18:19], v222 offset:44544
    ds_read_b64_tr_b16 a[84:85], v234 offset:39936
    v_mfma_f32_16x16x32_bf16 v[4:7], a[72:75], a[0:3], v[4:7]
    ds_read_b128 a[52:55], v240 offset:0
    s_add_u32 m0, s24, 26624
    v_mfma_f32_16x16x32_bf16 v[0:3], a[68:71], a[0:3], v[0:3]
    buffer_load_dwordx4 v216, s[8:11], s21 offen lds
    s_waitcnt lgkmcnt(8)
    v_mfma_f32_16x16x32_bf16 v[16:19], a[68:71], a[4:7], v[16:19]
    ds_read_b64_tr_b16 a[20:21], v223 offset:44032
    v_mfma_f32_16x16x32_bf16 v[20:23], a[72:75], a[4:7], v[20:23]
    ds_read_b64_tr_b16 a[22:23], v223 offset:44544
    ds_read_b64_tr_b16 a[86:87], v235 offset:39936
    v_mfma_f32_16x16x32_bf16 v[24:27], a[76:79], a[4:7], v[24:27]
    s_add_u32 m0, s48, 0
    v_mfma_f32_16x16x32_bf16 v[28:31], a[80:83], a[4:7], v[28:31]
    buffer_load_dwordx4 v208, s[4:7], s20 offen lds
    s_waitcnt lgkmcnt(9)
    v_mfma_f32_16x16x32_bf16 v[44:47], a[80:83], a[8:11], v[44:47]
    ds_read_b64_tr_b16 a[24:25], v224 offset:44032
    v_mfma_f32_16x16x32_bf16 v[40:43], a[76:79], a[8:11], v[40:43]
    ds_read_b64_tr_b16 a[26:27], v224 offset:44544
    v_mfma_f32_16x16x32_bf16 v[36:39], a[72:75], a[8:11], v[36:39]
    ds_read_b128 a[56:59], v240 offset:2048
    s_add_u32 m0, s24, 30720
    v_mfma_f32_16x16x32_bf16 v[32:35], a[68:71], a[8:11], v[32:35]
    buffer_load_dwordx4 v217, s[8:11], s21 offen lds
    s_waitcnt lgkmcnt(10)
    v_mfma_f32_16x16x32_bf16 v[48:51], a[68:71], a[12:15], v[48:51]
    ds_read_b64_tr_b16 a[28:29], v225 offset:44032
    v_mfma_f32_16x16x32_bf16 v[52:55], a[72:75], a[12:15], v[52:55]
    ds_read_b64_tr_b16 a[30:31], v225 offset:44544
    v_mfma_f32_16x16x32_bf16 v[56:59], a[76:79], a[12:15], v[56:59]
    s_add_u32 m0, s48, 1024
    v_mfma_f32_16x16x32_bf16 v[60:63], a[80:83], a[12:15], v[60:63]
    buffer_load_dwordx4 v209, s[4:7], s20 offen lds
    s_waitcnt lgkmcnt(10)
    v_mfma_f32_16x16x32_bf16 v[76:79], a[80:83], a[16:19], v[76:79]
    ds_read_b64_tr_b16 a[32:33], v226 offset:48128
    v_mfma_f32_16x16x32_bf16 v[72:75], a[76:79], a[16:19], v[72:75]
    ds_read_b64_tr_b16 a[34:35], v230 offset:48640
    v_mfma_f32_16x16x32_bf16 v[68:71], a[72:75], a[16:19], v[68:71]
    ds_read_b128 a[60:63], v240 offset:4096
    s_add_u32 m0, s24, 34816
    v_mfma_f32_16x16x32_bf16 v[64:67], a[68:71], a[16:19], v[64:67]
    buffer_load_dwordx4 v218, s[12:15], s22 offen lds
    s_waitcnt lgkmcnt(9)
    v_mfma_f32_16x16x32_bf16 v[80:83], a[68:71], a[20:23], v[80:83]
    ds_read_b64_tr_b16 a[36:37], v227 offset:48128
    v_mfma_f32_16x16x32_bf16 v[84:87], a[72:75], a[20:23], v[84:87]
    ds_read_b64_tr_b16 a[38:39], v231 offset:48640
    v_mfma_f32_16x16x32_bf16 v[88:91], a[76:79], a[20:23], v[88:91]
    s_add_u32 m0, s48, 2048
    v_mfma_f32_16x16x32_bf16 v[92:95], a[80:83], a[20:23], v[92:95]
    buffer_load_dwordx4 v210, s[4:7], s20 offen lds
    s_waitcnt lgkmcnt(8)
    v_mfma_f32_16x16x32_bf16 v[108:111], a[80:83], a[24:27], v[108:111]
    ds_read_b64_tr_b16 a[40:41], v228 offset:48128
    v_mfma_f32_16x16x32_bf16 v[104:107], a[76:79], a[24:27], v[104:107]
    ds_read_b64_tr_b16 a[42:43], v232 offset:48640
    v_mfma_f32_16x16x32_bf16 v[100:103], a[72:75], a[24:27], v[100:103]
    ds_read_b128 a[64:67], v240 offset:6144
    s_mov_b32 m0, s42
    v_mfma_f32_16x16x32_bf16 v[96:99], a[68:71], a[24:27], v[96:99]
    buffer_load_dwordx4 v219, s[12:15], s22 offen lds
    s_waitcnt lgkmcnt(8)
    v_mfma_f32_16x16x32_bf16 v[112:115], a[68:71], a[28:31], v[112:115]
    ds_read_b64_tr_b16 a[44:45], v229 offset:48128
    v_mfma_f32_16x16x32_bf16 v[116:119], a[72:75], a[28:31], v[116:119]
    ds_read_b64_tr_b16 a[46:47], v233 offset:48640
    v_mfma_f32_16x16x32_bf16 v[120:123], a[76:79], a[28:31], v[120:123]
    s_add_u32 m0, s48, 3072
    v_mfma_f32_16x16x32_bf16 v[124:127], a[80:83], a[28:31], v[124:127]
    buffer_load_dwordx4 v211, s[4:7], s20 offen lds
    s_waitcnt lgkmcnt(8)
    v_mfma_f32_16x16x32_bf16 v[140:143], a[32:35], a[80:83], v[140:143]
    ds_read_b64_tr_b16 a[48:49], v230 offset:48128
    v_mfma_f32_16x16x32_bf16 v[136:139], a[32:35], a[76:79], v[136:139]
    ds_read_b64_tr_b16 a[50:51], v226 offset:48896
    v_mfma_f32_16x16x32_bf16 v[132:135], a[32:35], a[72:75], v[132:135]
    s_add_u32 s21, s21, 196608
    v_mfma_f32_16x16x32_bf16 v[128:131], a[32:35], a[68:71], v[128:131]
    s_add_u32 s22, s22, 229376
    s_waitcnt lgkmcnt(7)
    v_mfma_f32_16x16x32_bf16 v[144:147], a[36:39], a[68:71], v[144:147]
    v_mfma_f32_16x16x32_bf16 a[116:119], a[84:87], a[112:115], a[116:119]
    v_mfma_f32_16x16x32_bf16 v[148:151], a[36:39], a[72:75], v[148:151]
    v_mfma_f32_16x16x32_bf16 v[152:155], a[36:39], a[76:79], v[152:155]
    v_mfma_f32_16x16x32_bf16 v[156:159], a[36:39], a[80:83], v[156:159]
    s_waitcnt vmcnt(17) lgkmcnt(0)
    s_barrier
    v_mfma_f32_16x16x32_bf16 v[172:175], a[40:43], a[80:83], v[172:175]
    ds_read_b64_tr_b16 a[0:1], v222 offset:0
    v_mfma_f32_16x16x32_bf16 v[168:171], a[40:43], a[76:79], v[168:171]
    ds_read_b64_tr_b16 a[2:3], v222 offset:512
    v_mfma_f32_16x16x32_bf16 v[164:167], a[40:43], a[72:75], v[164:167]
    ds_read_b64_tr_b16 a[4:5], v223 offset:0
    v_mfma_f32_16x16x32_bf16 v[160:163], a[40:43], a[68:71], v[160:163]
    ds_read_b64_tr_b16 a[6:7], v223 offset:512
    v_mfma_f32_16x16x32_bf16 v[176:179], a[44:47], a[68:71], v[176:179]
    ds_read_b64_tr_b16 a[8:9], v224 offset:0
    v_mfma_f32_16x16x32_bf16 v[180:183], a[44:47], a[72:75], v[180:183]
    ds_read_b64_tr_b16 a[10:11], v224 offset:512
    v_mfma_f32_16x16x32_bf16 v[184:187], a[44:47], a[76:79], v[184:187]
    ds_read_b64_tr_b16 a[12:13], v225 offset:0
    v_mfma_f32_16x16x32_bf16 v[188:191], a[44:47], a[80:83], v[188:191]
    ds_read_b64_tr_b16 a[14:15], v225 offset:512
    v_mfma_f32_16x16x32_bf16 v[204:207], a[48:51], a[80:83], v[204:207]
    v_mfma_f32_16x16x32_bf16 v[200:203], a[48:51], a[76:79], v[200:203]
    v_mfma_f32_16x16x32_bf16 v[196:199], a[48:51], a[72:75], v[196:199]
    v_mfma_f32_16x16x32_bf16 v[192:195], a[48:51], a[68:71], v[192:195]
    s_cmp_eq_u32 s33, s56
    s_cbranch_scc1 k1_kernel_E_sig
k1_kernel_E_sigd:
    s_sub_u32 s33, s33, 1
    s_cmp_lg_u32 s33, 0
    s_cbranch_scc1 k1_kernel_loop_1
    s_waitcnt lgkmcnt(6)
    v_mfma_f32_16x16x32_bf16 v[0:3], a[52:55], a[0:3], v[0:3]
    ds_read_b64_tr_b16 a[16:17], v222 offset:4096
    v_cmp_gt_u32 vcc, 32, v253
    v_mfma_f32_16x16x32_bf16 v[4:7], a[56:59], a[0:3], v[4:7]
    ds_read_b64_tr_b16 a[18:19], v222 offset:4608
    ds_read_b64_tr_b16 a[84:85], v242 offset:0
    v_mfma_f32_16x16x32_bf16 v[8:11], a[60:63], a[0:3], v[8:11]
    ds_read_b128 a[68:71], v241 offset:0
    s_add_u32 m0, s24, 39936
    v_mfma_f32_16x16x32_bf16 v[12:15], a[64:67], a[0:3], v[12:15]
    buffer_load_dwordx4 v216, s[8:11], s21 offen lds
    s_waitcnt lgkmcnt(8)
    v_mfma_f32_16x16x32_bf16 v[28:31], a[64:67], a[4:7], v[28:31]
    ds_read_b64_tr_b16 a[20:21], v223 offset:4096
    s_cbranch_vccnz k1_kernel_E_spin
k1_kernel_E_spun:
    v_mfma_f32_16x16x32_bf16 v[24:27], a[60:63], a[4:7], v[24:27]
    ds_read_b64_tr_b16 a[22:23], v223 offset:4608
    ds_read_b64_tr_b16 a[86:87], v243 offset:0
    v_mfma_f32_16x16x32_bf16 v[20:23], a[56:59], a[4:7], v[20:23]
    v_mfma_f32_16x16x32_bf16 v[16:19], a[52:55], a[4:7], v[16:19]
    v_and_b32 v253, 48, v255
    s_waitcnt lgkmcnt(9)
    v_mfma_f32_16x16x32_bf16 v[32:35], a[52:55], a[8:11], v[32:35]
    ds_read_b64_tr_b16 a[24:25], v224 offset:4096
    v_mfma_f32_16x16x32_bf16 v[36:39], a[56:59], a[8:11], v[36:39]
    ds_read_b64_tr_b16 a[26:27], v224 offset:4608
    ds_read_b64_tr_b16 a[88:89], v244 offset:0
    v_mfma_f32_16x16x32_bf16 v[40:43], a[60:63], a[8:11], v[40:43]
    ds_read_b128 a[72:75], v241 offset:2048
    s_add_u32 m0, s24, 44032
    v_mfma_f32_16x16x32_bf16 v[44:47], a[64:67], a[8:11], v[44:47]
    buffer_load_dwordx4 v217, s[8:11], s21 offen lds
    s_waitcnt lgkmcnt(11)
    v_mfma_f32_16x16x32_bf16 v[60:63], a[64:67], a[12:15], v[60:63]
    ds_read_b64_tr_b16 a[28:29], v225 offset:4096
    v_mfma_f32_16x16x32_bf16 v[56:59], a[60:63], a[12:15], v[56:59]
    ds_read_b64_tr_b16 a[30:31], v225 offset:4608
    ds_read_b64_tr_b16 a[90:91], v245 offset:0
    v_mfma_f32_16x16x32_bf16 v[52:55], a[56:59], a[12:15], v[52:55]
    s_mov_b64 exec, s[84:85]
    buffer_store_dwordx4 a[116:119], v253, s[16:19], s86 offen sc1
    s_mov_b64 exec, -1
    v_mfma_f32_16x16x32_bf16 v[48:51], a[52:55], a[12:15], v[48:51]
    v_lshlrev_b32 v215, 3, v255
    s_waitcnt lgkmcnt(12)
    v_mfma_f32_16x16x32_bf16 v[64:67], a[52:55], a[16:19], v[64:67]
    ds_read_b64_tr_b16 a[32:33], v226 offset:8192
    v_mfma_f32_16x16x32_bf16 v[68:71], a[56:59], a[16:19], v[68:71]
    ds_read_b64_tr_b16 a[34:35], v230 offset:8704
    ds_read_b64_tr_b16 a[92:93], v220 offset:0
    v_mfma_f32_16x16x32_bf16 v[72:75], a[60:63], a[16:19], v[72:75]
    ds_read_b128 a[76:79], v241 offset:4096
    s_add_u32 m0, s24, 48128
    v_mfma_f32_16x16x32_bf16 v[76:79], a[64:67], a[16:19], v[76:79]
    buffer_load_dwordx4 v218, s[12:15], s22 offen lds
    s_waitcnt lgkmcnt(12)
    v_mfma_f32_16x16x32_bf16 v[92:95], a[64:67], a[20:23], v[92:95]
    ds_read_b64_tr_b16 a[36:37], v227 offset:8192
    v_mfma_f32_16x16x32_bf16 v[88:91], a[60:63], a[20:23], v[88:91]
    ds_read_b64_tr_b16 a[38:39], v231 offset:8704
    ds_read_b64_tr_b16 a[94:95], v221 offset:0
    s_waitcnt lgkmcnt(14)
    v_mfma_f32_16x16x32_bf16 a[96:99], a[84:87], a[112:115], a[96:99]
    v_mfma_f32_16x16x32_bf16 v[84:87], a[56:59], a[20:23], v[84:87]
    v_lshlrev_b32 v212, 7, v255
    v_mfma_f32_16x16x32_bf16 v[80:83], a[52:55], a[20:23], v[80:83]
    v_min_u32 v213, 3456, v212
    s_waitcnt lgkmcnt(12)
    v_mfma_f32_16x16x32_bf16 v[96:99], a[52:55], a[24:27], v[96:99]
    ds_read_b64_tr_b16 a[40:41], v228 offset:8192
    v_mfma_f32_16x16x32_bf16 v[100:103], a[56:59], a[24:27], v[100:103]
    ds_read_b64_tr_b16 a[42:43], v232 offset:8704
    v_mfma_f32_16x16x32_bf16 v[104:107], a[60:63], a[24:27], v[104:107]
    ds_read_b128 a[80:83], v241 offset:6144
    s_mov_b32 m0, s43
    v_mfma_f32_16x16x32_bf16 v[108:111], a[64:67], a[24:27], v[108:111]
    buffer_load_dwordx4 v219, s[12:15], s22 offen lds
    s_waitcnt lgkmcnt(11)
    v_mfma_f32_16x16x32_bf16 v[124:127], a[64:67], a[28:31], v[124:127]
    ds_read_b64_tr_b16 a[44:45], v229 offset:8192
    v_mfma_f32_16x16x32_bf16 v[120:123], a[60:63], a[28:31], v[120:123]
    ds_read_b64_tr_b16 a[46:47], v233 offset:8704
    s_waitcnt lgkmcnt(12)
    v_mfma_f32_16x16x32_bf16 a[100:103], a[88:91], a[112:115], a[100:103]
    v_mfma_f32_16x16x32_bf16 v[116:119], a[56:59], a[28:31], v[116:119]
    v_min_u32 v214, 1920, v212
    v_mfma_f32_16x16x32_bf16 v[112:115], a[52:55], a[28:31], v[112:115]
    s_waitcnt lgkmcnt(10)
    v_mfma_f32_16x16x32_bf16 v[128:131], a[32:35], a[52:55], v[128:131]
    ds_read_b64_tr_b16 a[48:49], v230 offset:8192
    v_mfma_f32_16x16x32_bf16 v[132:135], a[32:35], a[56:59], v[132:135]
    ds_read_b64_tr_b16 a[50:51], v226 offset:8960
    v_mfma_f32_16x16x32_bf16 v[136:139], a[32:35], a[60:63], v[136:139]
    s_getpc_b64 s[94:95]
k1_kernel_E_pc:
    s_add_u32 s94, s94, k1_kernel_E_epi - k1_kernel_E_pc
    s_addc_u32 s95, s95, 0
    s_add_u32 s21, s21, 196608
    v_mfma_f32_16x16x32_bf16 v[140:143], a[32:35], a[64:67], v[140:143]
    v_lshlrev_b32 v210, 7, v255
    s_add_u32 s22, s22, 229376
    s_waitcnt lgkmcnt(8)
    v_mfma_f32_16x16x32_bf16 v[156:159], a[36:39], a[64:67], v[156:159]
    s_sub_u32 s34, s29, 1
    s_max_i32 s34, s34, 0
    v_mov_b32 v211, s34
    v_mfma_f32_16x16x32_bf16 v[152:155], a[36:39], a[60:63], v[152:155]
    s_waitcnt lgkmcnt(7)
    v_mfma_f32_16x16x32_bf16 a[104:107], a[92:95], a[112:115], a[104:107]
    v_lshl_add_u32 v210, v211, 13, v210
    v_mfma_f32_16x16x32_bf16 v[148:151], a[36:39], a[56:59], v[148:151]
    s_add_u32 s20, s20, 128
    v_mov_b32 v211, s95
    v_mfma_f32_16x16x32_bf16 v[144:147], a[36:39], a[52:55], v[144:147]
    s_waitcnt vmcnt(12) lgkmcnt(0)
    s_barrier
    v_mfma_f32_16x16x32_bf16 v[160:163], a[40:43], a[52:55], v[160:163]
    ds_read_b64_tr_b16 a[0:1], v222 offset:13312
    v_mfma_f32_16x16x32_bf16 v[164:167], a[40:43], a[56:59], v[164:167]
    ds_read_b64_tr_b16 a[2:3], v222 offset:13824
    v_mfma_f32_16x16x32_bf16 v[168:171], a[40:43], a[60:63], v[168:171]
    ds_read_b64_tr_b16 a[4:5], v223 offset:13312
    v_mfma_f32_16x16x32_bf16 v[172:175], a[40:43], a[64:67], v[172:175]
    ds_read_b64_tr_b16 a[6:7], v223 offset:13824
    v_mfma_f32_16x16x32_bf16 v[188:191], a[44:47], a[64:67], v[188:191]
    ds_read_b64_tr_b16 a[8:9], v224 offset:13312
    v_mfma_f32_16x16x32_bf16 v[184:187], a[44:47], a[60:63], v[184:187]
    ds_read_b64_tr_b16 a[10:11], v224 offset:13824
    v_mfma_f32_16x16x32_bf16 v[180:183], a[44:47], a[56:59], v[180:183]
    ds_read_b64_tr_b16 a[12:13], v225 offset:13312
    v_mfma_f32_16x16x32_bf16 v[176:179], a[44:47], a[52:55], v[176:179]
    ds_read_b64_tr_b16 a[14:15], v225 offset:13824
    v_mfma_f32_16x16x32_bf16 v[192:195], a[48:51], a[52:55], v[192:195]
    s_mov_b32 s48, s49
    s_add_u32 s49, s49, 8192
    buffer_load_dwordx2 v[236:237], v215, s[16:19], s52 offen sc1
    v_mfma_f32_16x16x32_bf16 v[196:199], a[48:51], a[56:59], v[196:199]
    v_mfma_f32_16x16x32_bf16 a[108:111], a[48:51], a[112:115], a[108:111]
    v_mfma_f32_16x16x32_bf16 v[200:203], a[48:51], a[60:63], v[200:203]
    s_cmp_eq_u32 s49, s51
    s_cselect_b32 s49, s50, s49
    v_add_co_u32 v210, vcc, s94, v210
    v_mfma_f32_16x16x32_bf16 v[204:207], a[48:51], a[64:67], v[204:207]
    v_add_u32 v240, s49, v238
    v_add_u32 v241, s49, v239
    v_addc_co_u32 v211, vcc, 0, v211, vcc
    s_waitcnt lgkmcnt(6)
    v_mfma_f32_16x16x32_bf16 v[12:15], a[80:83], a[0:3], v[12:15]
    ds_read_b64_tr_b16 a[16:17], v222 offset:17408
    s_not_b64 exec, s[92:93]
    global_load_dword v254, v[210:211], off
    s_mov_b64 exec, -1
    v_mfma_f32_16x16x32_bf16 v[8:11], a[76:79], a[0:3], v[8:11]
    ds_read_b64_tr_b16 a[18:19], v222 offset:17920
    ds_read_b64_tr_b16 a[84:85], v242 offset:13312
    v_mfma_f32_16x16x32_bf16 v[4:7], a[72:75], a[0:3], v[4:7]
    ds_read_b128 a[52:55], v240 offset:0
    s_not_b64 exec, s[92:93]
    buffer_load_dword v254, v212, s[68:71], s80 offen
    s_mov_b64 exec, -1
    v_mfma_f32_16x16x32_bf16 v[0:3], a[68:71], a[0:3], v[0:3]
    v_mov_b32 v248, 0
    s_waitcnt lgkmcnt(8)
    v_mfma_f32_16x16x32_bf16 v[16:19], a[68:71], a[4:7], v[16:19]
    ds_read_b64_tr_b16 a[20:21], v223 offset:17408
    v_mfma_f32_16x16x32_bf16 v[20:23], a[72:75], a[4:7], v[20:23]
    ds_read_b64_tr_b16 a[22:23], v223 offset:17920
    ds_read_b64_tr_b16 a[86:87], v243 offset:13312
    v_mfma_f32_16x16x32_bf16 v[24:27], a[76:79], a[4:7], v[24:27]
    v_mfma_f32_16x16x32_bf16 v[28:31], a[80:83], a[4:7], v[28:31]
    v_mov_b32 v249, 0
    s_waitcnt lgkmcnt(9)
    v_mfma_f32_16x16x32_bf16 v[44:47], a[80:83], a[8:11], v[44:47]
    ds_read_b64_tr_b16 a[24:25], v224 offset:17408
    v_mfma_f32_16x16x32_bf16 v[40:43], a[76:79], a[8:11], v[40:43]
    ds_read_b64_tr_b16 a[26:27], v224 offset:17920
    ds_read_b64_tr_b16 a[88:89], v244 offset:13312
    v_mfma_f32_16x16x32_bf16 v[36:39], a[72:75], a[8:11], v[36:39]
    ds_read_b128 a[56:59], v240 offset:2048
    s_not_b64 exec, s[92:93]
    buffer_load_dword v254, v213, s[72:75], s81 offen
    s_mov_b64 exec, -1
    v_mfma_f32_16x16x32_bf16 v[32:35], a[68:71], a[8:11], v[32:35]
    v_mov_b32 v250, 0
    s_waitcnt lgkmcnt(11)
    v_mfma_f32_16x16x32_bf16 v[48:51], a[68:71], a[12:15], v[48:51]
    ds_read_b64_tr_b16 a[28:29], v225 offset:17408
    v_mfma_f32_16x16x32_bf16 v[52:55], a[72:75], a[12:15], v[52:55]
    ds_read_b64_tr_b16 a[30:31], v225 offset:17920
    ds_read_b64_tr_b16 a[90:91], v245 offset:13312
    v_mfma_f32_16x16x32_bf16 v[56:59], a[76:79], a[12:15], v[56:59]
    v_mfma_f32_16x16x32_bf16 v[60:63], a[80:83], a[12:15], v[60:63]
    v_mov_b32 v251, 0
    s_waitcnt lgkmcnt(12)
    v_mfma_f32_16x16x32_bf16 v[76:79], a[80:83], a[16:19], v[76:79]
    ds_read_b64_tr_b16 a[32:33], v226 offset:21504
    v_mfma_f32_16x16x32_bf16 v[72:75], a[76:79], a[16:19], v[72:75]
    ds_read_b64_tr_b16 a[34:35], v230 offset:22016
    ds_read_b64_tr_b16 a[92:93], v220 offset:13312
    v_mfma_f32_16x16x32_bf16 v[68:71], a[72:75], a[16:19], v[68:71]
    ds_read_b128 a[60:63], v240 offset:4096
    s_not_b64 exec, s[92:93]
    buffer_load_dword v254, v214, s[76:79], s82 offen
    s_mov_b64 exec, -1
    v_mfma_f32_16x16x32_bf16 v[64:67], a[68:71], a[16:19], v[64:67]
    s_waitcnt lgkmcnt(12)
    v_mfma_f32_16x16x32_bf16 v[80:83], a[68:71], a[20:23], v[80:83]
    ds_read_b64_tr_b16 a[36:37], v227 offset:21504
    v_mfma_f32_16x16x32_bf16 v[84:87], a[72:75], a[20:23], v[84:87]
    ds_read_b64_tr_b16 a[38:39], v231 offset:22016
    ds_read_b64_tr_b16 a[94:95], v221 offset:13312
    s_waitcnt lgkmcnt(14)
    v_mfma_f32_16x16x32_bf16 a[96:99], a[84:87], a[112:115], a[96:99]
    v_mfma_f32_16x16x32_bf16 v[88:91], a[76:79], a[20:23], v[88:91]
    v_mfma_f32_16x16x32_bf16 v[92:95], a[80:83], a[20:23], v[92:95]
    s_waitcnt lgkmcnt(12)
    v_mfma_f32_16x16x32_bf16 v[108:111], a[80:83], a[24:27], v[108:111]
    ds_read_b64_tr_b16 a[40:41], v228 offset:21504
    v_mfma_f32_16x16x32_bf16 v[104:107], a[76:79], a[24:27], v[104:107]
    ds_read_b64_tr_b16 a[42:43], v232 offset:22016
    v_mfma_f32_16x16x32_bf16 v[100:103], a[72:75], a[24:27], v[100:103]
    ds_read_b128 a[64:67], v240 offset:6144
    v_mfma_f32_16x16x32_bf16 v[96:99], a[68:71], a[24:27], v[96:99]
    s_waitcnt lgkmcnt(11)
    v_mfma_f32_16x16x32_bf16 v[112:115], a[68:71], a[28:31], v[112:115]
    ds_read_b64_tr_b16 a[44:45], v229 offset:21504
    v_mfma_f32_16x16x32_bf16 v[116:119], a[72:75], a[28:31], v[116:119]
    ds_read_b64_tr_b16 a[46:47], v233 offset:22016
    s_waitcnt lgkmcnt(12)
    v_mfma_f32_16x16x32_bf16 a[100:103], a[88:91], a[112:115], a[100:103]
    v_mfma_f32_16x16x32_bf16 v[120:123], a[76:79], a[28:31], v[120:123]
    v_mfma_f32_16x16x32_bf16 v[124:127], a[80:83], a[28:31], v[124:127]
    s_waitcnt lgkmcnt(10)
    v_mfma_f32_16x16x32_bf16 v[140:143], a[32:35], a[80:83], v[140:143]
    ds_read_b64_tr_b16 a[48:49], v230 offset:21504
    v_mfma_f32_16x16x32_bf16 v[136:139], a[32:35], a[76:79], v[136:139]
    ds_read_b64_tr_b16 a[50:51], v226 offset:22272
    v_mfma_f32_16x16x32_bf16 v[132:135], a[32:35], a[72:75], v[132:135]
    v_mfma_f32_16x16x32_bf16 v[128:131], a[32:35], a[68:71], v[128:131]
    s_waitcnt lgkmcnt(8)
    v_mfma_f32_16x16x32_bf16 v[144:147], a[36:39], a[68:71], v[144:147]
    v_mfma_f32_16x16x32_bf16 v[148:151], a[36:39], a[72:75], v[148:151]
    s_waitcnt lgkmcnt(7)
    v_mfma_f32_16x16x32_bf16 a[104:107], a[92:95], a[112:115], a[104:107]
    v_mfma_f32_16x16x32_bf16 v[152:155], a[36:39], a[76:79], v[152:155]
    v_mfma_f32_16x16x32_bf16 v[156:159], a[36:39], a[80:83], v[156:159]
    s_waitcnt vmcnt(10) lgkmcnt(0)
    s_barrier
    v_mfma_f32_16x16x32_bf16 v[172:175], a[40:43], a[80:83], v[172:175]
    ds_read_b64_tr_b16 a[0:1], v222 offset:26624
    v_mfma_f32_16x16x32_bf16 v[168:171], a[40:43], a[76:79], v[168:171]
    ds_read_b64_tr_b16 a[2:3], v222 offset:27136
    v_mfma_f32_16x16x32_bf16 v[164:167], a[40:43], a[72:75], v[164:167]
    ds_read_b64_tr_b16 a[4:5], v223 offset:26624
    v_mfma_f32_16x16x32_bf16 v[160:163], a[40:43], a[68:71], v[160:163]
    ds_read_b64_tr_b16 a[6:7], v223 offset:27136
    v_mfma_f32_16x16x32_bf16 v[176:179], a[44:47], a[68:71], v[176:179]
    ds_read_b64_tr_b16 a[8:9], v224 offset:26624
    v_mfma_f32_16x16x32_bf16 v[180:183], a[44:47], a[72:75], v[180:183]
    ds_read_b64_tr_b16 a[10:11], v224 offset:27136
    v_mfma_f32_16x16x32_bf16 v[184:187], a[44:47], a[76:79], v[184:187]
    ds_read_b64_tr_b16 a[12:13], v225 offset:26624
    v_mfma_f32_16x16x32_bf16 v[188:191], a[44:47], a[80:83], v[188:191]
    ds_read_b64_tr_b16 a[14:15], v225 offset:27136
    v_mfma_f32_16x16x32_bf16 v[204:207], a[48:51], a[80:83], v[204:207]
    v_mfma_f32_16x16x32_bf16 v[200:203], a[48:51], a[76:79], v[200:203]
    v_mfma_f32_16x16x32_bf16 a[108:111], a[48:51], a[112:115], a[108:111]
    v_mfma_f32_16x16x32_bf16 v[196:199], a[48:51], a[72:75], v[196:199]
    v_min_u32 v252, 51, v255
    v_mfma_f32_16x16x32_bf16 v[192:195], a[48:51], a[68:71], v[192:195]
    v_lshlrev_b32 v252, 4, v252
    s_waitcnt lgkmcnt(6)
    v_mfma_f32_16x16x32_bf16 v[0:3], a[52:55], a[0:3], v[0:3]
    ds_read_b64_tr_b16 a[16:17], v222 offset:30720
    v_mfma_f32_16x16x32_bf16 v[4:7], a[56:59], a[0:3], v[4:7]
    ds_read_b64_tr_b16 a[18:19], v222 offset:31232
    ds_read_b64_tr_b16 a[84:85], v242 offset:26624
    v_mfma_f32_16x16x32_bf16 v[8:11], a[60:63], a[0:3], v[8:11]
    ds_read_b128 a[68:71], v241 offset:0
    v_mfma_f32_16x16x32_bf16 v[12:15], a[64:67], a[0:3], v[12:15]
    s_waitcnt lgkmcnt(8)
    v_mfma_f32_16x16x32_bf16 v[28:31], a[64:67], a[4:7], v[28:31]
    ds_read_b64_tr_b16 a[20:21], v223 offset:30720
    v_mfma_f32_16x16x32_bf16 v[24:27], a[60:63], a[4:7], v[24:27]
    ds_read_b64_tr_b16 a[22:23], v223 offset:31232
    ds_read_b64_tr_b16 a[86:87], v243 offset:26624
    v_mfma_f32_16x16x32_bf16 v[20:23], a[56:59], a[4:7], v[20:23]
    v_mfma_f32_16x16x32_bf16 v[16:19], a[52:55], a[4:7], v[16:19]
    s_waitcnt lgkmcnt(9)
    v_mfma_f32_16x16x32_bf16 v[32:35], a[52:55], a[8:11], v[32:35]
    ds_read_b64_tr_b16 a[24:25], v224 offset:30720
    v_mfma_f32_16x16x32_bf16 v[36:39], a[56:59], a[8:11], v[36:39]
    ds_read_b64_tr_b16 a[26:27], v224 offset:31232
    ds_read_b64_tr_b16 a[88:89], v244 offset:26624
    v_mfma_f32_16x16x32_bf16 v[40:43], a[60:63], a[8:11], v[40:43]
    ds_read_b128 a[72:75], v241 offset:2048
    v_mfma_f32_16x16x32_bf16 v[44:47], a[64:67], a[8:11], v[44:47]
    s_waitcnt lgkmcnt(11)
    v_mfma_f32_16x16x32_bf16 v[60:63], a[64:67], a[12:15], v[60:63]
    ds_read_b64_tr_b16 a[28:29], v225 offset:30720
    v_mfma_f32_16x16x32_bf16 v[56:59], a[60:63], a[12:15], v[56:59]
    ds_read_b64_tr_b16 a[30:31], v225 offset:31232
    ds_read_b64_tr_b16 a[90:91], v245 offset:26624
    v_mfma_f32_16x16x32_bf16 v[52:55], a[56:59], a[12:15], v[52:55]
    v_mfma_f32_16x16x32_bf16 v[48:51], a[52:55], a[12:15], v[48:51]
    s_waitcnt lgkmcnt(12)
    v_mfma_f32_16x16x32_bf16 v[64:67], a[52:55], a[16:19], v[64:67]
    ds_read_b64_tr_b16 a[32:33], v226 offset:34816
    v_mfma_f32_16x16x32_bf16 v[68:71], a[56:59], a[16:19], v[68:71]
    ds_read_b64_tr_b16 a[34:35], v230 offset:35328
    ds_read_b64_tr_b16 a[92:93], v220 offset:26624
    v_mfma_f32_16x16x32_bf16 v[72:75], a[60:63], a[16:19], v[72:75]
    ds_read_b128 a[76:79], v241 offset:4096
    v_mfma_f32_16x16x32_bf16 v[76:79], a[64:67], a[16:19], v[76:79]
    s_waitcnt lgkmcnt(12)
    v_mfma_f32_16x16x32_bf16 v[92:95], a[64:67], a[20:23], v[92:95]
    ds_read_b64_tr_b16 a[36:37], v227 offset:34816
    v_mfma_f32_16x16x32_bf16 v[88:91], a[60:63], a[20:23], v[88:91]
    ds_read_b64_tr_b16 a[38:39], v231 offset:35328
    ds_read_b64_tr_b16 a[94:95], v221 offset:26624
    s_waitcnt lgkmcnt(14)
    v_mfma_f32_16x16x32_bf16 a[96:99], a[84:87], a[112:115], a[96:99]
    v_mfma_f32_16x16x32_bf16 v[84:87], a[56:59], a[20:23], v[84:87]
    v_mfma_f32_16x16x32_bf16 v[80:83], a[52:55], a[20:23], v[80:83]
    s_waitcnt lgkmcnt(12)
    v_mfma_f32_16x16x32_bf16 v[96:99], a[52:55], a[24:27], v[96:99]
    ds_read_b64_tr_b16 a[40:41], v228 offset:34816
    v_mfma_f32_16x16x32_bf16 v[100:103], a[56:59], a[24:27], v[100:103]
    ds_read_b64_tr_b16 a[42:43], v232 offset:35328
    v_mfma_f32_16x16x32_bf16 v[104:107], a[60:63], a[24:27], v[104:107]
    ds_read_b128 a[80:83], v241 offset:6144
    v_mfma_f32_16x16x32_bf16 v[108:111], a[64:67], a[24:27], v[108:111]
    s_waitcnt lgkmcnt(11)
    v_mfma_f32_16x16x32_bf16 v[124:127], a[64:67], a[28:31], v[124:127]
    ds_read_b64_tr_b16 a[44:45], v229 offset:34816
    v_mfma_f32_16x16x32_bf16 v[120:123], a[60:63], a[28:31], v[120:123]
    ds_read_b64_tr_b16 a[46:47], v233 offset:35328
    s_waitcnt lgkmcnt(12)
    v_mfma_f32_16x16x32_bf16 a[100:103], a[88:91], a[112:115], a[100:103]
    v_mfma_f32_16x16x32_bf16 v[116:119], a[56:59], a[28:31], v[116:119]
    v_mfma_f32_16x16x32_bf16 v[112:115], a[52:55], a[28:31], v[112:115]
    s_waitcnt lgkmcnt(10)
    v_mfma_f32_16x16x32_bf16 v[128:131], a[32:35], a[52:55], v[128:131]
    ds_read_b64_tr_b16 a[48:49], v230 offset:34816
    v_mfma_f32_16x16x32_bf16 v[132:135], a[32:35], a[56:59], v[132:135]
    ds_read_b64_tr_b16 a[50:51], v226 offset:35584
    v_mfma_f32_16x16x32_bf16 v[136:139], a[32:35], a[60:63], v[136:139]
    s_mov_b64 exec, s[92:93]
    buffer_load_dwordx4 v[248:251], v252, s[16:19], s87 offen sc1
    s_mov_b64 exec, -1
    v_mfma_f32_16x16x32_bf16 v[140:143], a[32:35], a[64:67], v[140:143]
    s_waitcnt lgkmcnt(8)
    v_mfma_f32_16x16x32_bf16 v[156:159], a[36:39], a[64:67], v[156:159]
    v_mfma_f32_16x16x32_bf16 v[152:155], a[36:39], a[60:63], v[152:155]
    s_waitcnt lgkmcnt(7)
    v_mfma_f32_16x16x32_bf16 a[104:107], a[92:95], a[112:115], a[104:107]
    v_mfma_f32_16x16x32_bf16 v[148:151], a[36:39], a[56:59], v[148:151]
    s_add_u32 s20, s20, 128
    v_mfma_f32_16x16x32_bf16 v[144:147], a[36:39], a[52:55], v[144:147]
    s_waitcnt vmcnt(6) lgkmcnt(0)
    s_barrier
    v_mfma_f32_16x16x32_bf16 v[160:163], a[40:43], a[52:55], v[160:163]
    ds_read_b64_tr_b16 a[0:1], v222 offset:39936
    v_mfma_f32_16x16x32_bf16 v[164:167], a[40:43], a[56:59], v[164:167]
    ds_read_b64_tr_b16 a[2:3], v222 offset:40448
    v_mfma_f32_16x16x32_bf16 v[168:171], a[40:43], a[60:63], v[168:171]
    ds_read_b64_tr_b16 a[4:5], v223 offset:39936
    v_mfma_f32_16x16x32_bf16 v[172:175], a[40:43], a[64:67], v[172:175]
    ds_read_b64_tr_b16 a[6:7], v223 offset:40448
    v_mfma_f32_16x16x32_bf16 v[188:191], a[44:47], a[64:67], v[188:191]
    ds_read_b64_tr_b16 a[8:9], v224 offset:39936
    v_mfma_f32_16x16x32_bf16 v[184:187], a[44:47], a[60:63], v[184:187]
    ds_read_b64_tr_b16 a[10:11], v224 offset:40448
    v_mfma_f32_16x16x32_bf16 v[180:183], a[44:47], a[56:59], v[180:183]
    ds_read_b64_tr_b16 a[12:13], v225 offset:39936
    v_mfma_f32_16x16x32_bf16 v[176:179], a[44:47], a[52:55], v[176:179]
    ds_read_b64_tr_b16 a[14:15], v225 offset:40448
    v_mfma_f32_16x16x32_bf16 v[192:195], a[48:51], a[52:55], v[192:195]
    s_mov_b32 s48, s49
    s_add_u32 s49, s49, 8192
    v_mfma_f32_16x16x32_bf16 v[196:199], a[48:51], a[56:59], v[196:199]
    v_mfma_f32_16x16x32_bf16 a[108:111], a[48:51], a[112:115], a[108:111]
    v_mfma_f32_16x16x32_bf16 v[200:203], a[48:51], a[60:63], v[200:203]
    s_cmp_eq_u32 s49, s51
    s_cselect_b32 s49, s50, s49
    v_mfma_f32_16x16x32_bf16 v[204:207], a[48:51], a[64:67], v[204:207]
    v_add_u32 v240, s49, v238
    v_add_u32 v241, s49, v239
    s_waitcnt lgkmcnt(6)
    v_mfma_f32_16x16x32_bf16 v[12:15], a[80:83], a[0:3], v[12:15]
    ds_read_b64_tr_b16 a[16:17], v222 offset:44032
    v_mfma_f32_16x16x32_bf16 v[8:11], a[76:79], a[0:3], v[8:11]
    ds_read_b64_tr_b16 a[18:19], v222 offset:44544
    ds_read_b64_tr_b16 a[84:85], v242 offset:39936
    v_mfma_f32_16x16x32_bf16 v[4:7], a[72:75], a[0:3], v[4:7]
    s_mov_b64 exec, s[92:93]
    buffer_load_dword v254, v212, s[68:71], s80 offen
    s_mov_b64 exec, -1
    v_mfma_f32_16x16x32_bf16 v[0:3], a[68:71], a[0:3], v[0:3]
    s_waitcnt lgkmcnt(7)
    v_mfma_f32_16x16x32_bf16 v[16:19], a[68:71], a[4:7], v[16:19]
    ds_read_b64_tr_b16 a[20:21], v223 offset:44032
    v_mfma_f32_16x16x32_bf16 v[20:23], a[72:75], a[4:7], v[20:23]
    ds_read_b64_tr_b16 a[22:23], v223 offset:44544
    ds_read_b64_tr_b16 a[86:87], v243 offset:39936
    v_mfma_f32_16x16x32_bf16 v[24:27], a[76:79], a[4:7], v[24:27]
    s_lshl_b32 s34, s29, 9
    v_mfma_f32_16x16x32_bf16 v[28:31], a[80:83], a[4:7], v[28:31]
    s_add_u32 s34, s34, 154624
    s_waitcnt lgkmcnt(8)
    v_mfma_f32_16x16x32_bf16 v[44:47], a[80:83], a[8:11], v[44:47]
    ds_read_b64_tr_b16 a[24:25], v224 offset:44032
    v_mfma_f32_16x16x32_bf16 v[40:43], a[76:79], a[8:11], v[40:43]
    ds_read_b64_tr_b16 a[26:27], v224 offset:44544
    ds_read_b64_tr_b16 a[88:89], v244 offset:39936
    v_mfma_f32_16x16x32_bf16 v[36:39], a[72:75], a[8:11], v[36:39]
    s_mov_b64 exec, s[92:93]
    buffer_load_dword v254, v213, s[72:75], s81 offen
    s_mov_b64 exec, -1
    v_mfma_f32_16x16x32_bf16 v[32:35], a[68:71], a[8:11], v[32:35]
    s_waitcnt lgkmcnt(9)
    v_mfma_f32_16x16x32_bf16 v[48:51], a[68:71], a[12:15], v[48:51]
    ds_read_b64_tr_b16 a[28:29], v225 offset:44032
    v_mfma_f32_16x16x32_bf16 v[52:55], a[72:75], a[12:15], v[52:55]
    ds_read_b64_tr_b16 a[30:31], v225 offset:44544
    ds_read_b64_tr_b16 a[90:91], v245 offset:39936
    v_mfma_f32_16x16x32_bf16 v[56:59], a[76:79], a[12:15], v[56:59]
    v_lshl_add_u32 v246, v255, 2, s34
    v_mfma_f32_16x16x32_bf16 v[60:63], a[80:83], a[12:15], v[60:63]
    s_lshl_b32 s34, s29, 6
    s_waitcnt lgkmcnt(10)
    v_mfma_f32_16x16x32_bf16 v[76:79], a[80:83], a[16:19], v[76:79]
    ds_read_b64_tr_b16 a[32:33], v226 offset:48128
    v_mfma_f32_16x16x32_bf16 v[72:75], a[76:79], a[16:19], v[72:75]
    ds_read_b64_tr_b16 a[34:35], v230 offset:48640
    ds_read_b64_tr_b16 a[92:93], v220 offset:39936
    v_mfma_f32_16x16x32_bf16 v[68:71], a[72:75], a[16:19], v[68:71]
    s_mov_b64 exec, s[92:93]
    buffer_load_dword v254, v214, s[76:79], s82 offen
    s_mov_b64 exec, -1
    v_mfma_f32_16x16x32_bf16 v[64:67], a[68:71], a[16:19], v[64:67]
    s_waitcnt lgkmcnt(10)
    v_mfma_f32_16x16x32_bf16 v[80:83], a[68:71], a[20:23], v[80:83]
    ds_read_b64_tr_b16 a[36:37], v227 offset:48128
    v_mfma_f32_16x16x32_bf16 v[84:87], a[72:75], a[20:23], v[84:87]
    ds_read_b64_tr_b16 a[38:39], v231 offset:48640
    ds_read_b64_tr_b16 a[94:95], v221 offset:39936
    s_waitcnt lgkmcnt(12)
    v_mfma_f32_16x16x32_bf16 a[96:99], a[84:87], a[112:115], a[96:99]
    v_mfma_f32_16x16x32_bf16 v[88:91], a[76:79], a[20:23], v[88:91]
    s_add_u32 s34, s34, 152576
    v_mfma_f32_16x16x32_bf16 v[92:95], a[80:83], a[20:23], v[92:95]
    v_and_b32 v247, 48, v255
    s_waitcnt lgkmcnt(10)
    v_mfma_f32_16x16x32_bf16 v[108:111], a[80:83], a[24:27], v[108:111]
    ds_read_b64_tr_b16 a[40:41], v228 offset:48128
    v_mfma_f32_16x16x32_bf16 v[104:107], a[76:79], a[24:27], v[104:107]
    ds_read_b64_tr_b16 a[42:43], v232 offset:48640
    v_mfma_f32_16x16x32_bf16 v[100:103], a[72:75], a[24:27], v[100:103]
    v_mfma_f32_16x16x32_bf16 v[96:99], a[68:71], a[24:27], v[96:99]
    s_waitcnt lgkmcnt(9)
    v_mfma_f32_16x16x32_bf16 v[112:115], a[68:71], a[28:31], v[112:115]
    ds_read_b64_tr_b16 a[44:45], v229 offset:48128
    v_mfma_f32_16x16x32_bf16 v[116:119], a[72:75], a[28:31], v[116:119]
    ds_read_b64_tr_b16 a[46:47], v233 offset:48640
    s_waitcnt lgkmcnt(10)
    v_mfma_f32_16x16x32_bf16 a[100:103], a[88:91], a[112:115], a[100:103]
    v_mfma_f32_16x16x32_bf16 v[120:123], a[76:79], a[28:31], v[120:123]
    v_add_u32 v208, 153344, v247
    v_mfma_f32_16x16x32_bf16 v[124:127], a[80:83], a[28:31], v[124:127]
    v_add_u32 v247, s34, v247
    s_waitcnt lgkmcnt(8)
    v_mfma_f32_16x16x32_bf16 v[140:143], a[32:35], a[80:83], v[140:143]
    ds_read_b64_tr_b16 a[48:49], v230 offset:48128
    v_mfma_f32_16x16x32_bf16 v[136:139], a[32:35], a[76:79], v[136:139]
    ds_read_b64_tr_b16 a[50:51], v226 offset:48896
    v_mfma_f32_16x16x32_bf16 v[132:135], a[32:35], a[72:75], v[132:135]
    v_mfma_f32_16x16x32_bf16 v[128:131], a[32:35], a[68:71], v[128:131]
    s_waitcnt lgkmcnt(7)
    v_mfma_f32_16x16x32_bf16 v[144:147], a[36:39], a[68:71], v[144:147]
    v_mfma_f32_16x16x32_bf16 v[148:151], a[36:39], a[72:75], v[148:151]
    s_waitcnt lgkmcnt(6)
    v_mfma_f32_16x16x32_bf16 a[104:107], a[92:95], a[112:115], a[104:107]
    v_mfma_f32_16x16x32_bf16 v[152:155], a[36:39], a[76:79], v[152:155]
    v_mfma_f32_16x16x32_bf16 v[156:159], a[36:39], a[80:83], v[156:159]
    s_waitcnt lgkmcnt(4)
    v_mfma_f32_16x16x32_bf16 v[172:175], a[40:43], a[80:83], v[172:175]
    s_waitcnt vmcnt(8)
    ds_write_b32 v246, v236
    v_mfma_f32_16x16x32_bf16 v[168:171], a[40:43], a[76:79], v[168:171]
    ds_write_b32 v246, v237 offset:256
    v_mfma_f32_16x16x32_bf16 v[164:167], a[40:43], a[72:75], v[164:167]
    v_mfma_f32_16x16x32_bf16 v[160:163], a[40:43], a[68:71], v[160:163]
    s_mov_b32 exec_lo, 0x10001
    s_mov_b32 exec_hi, 0x10001
    ds_write_b128 v247, a[96:99] offset:0
    ds_write_b128 v247, a[100:103] offset:256
    ds_write_b128 v247, a[104:107] offset:512
    s_mov_b64 exec, -1
    s_waitcnt lgkmcnt(7)
    v_mfma_f32_16x16x32_bf16 v[176:179], a[44:47], a[68:71], v[176:179]
    v_mfma_f32_16x16x32_bf16 v[180:183], a[44:47], a[72:75], v[180:183]
    v_mfma_f32_16x16x32_bf16 v[184:187], a[44:47], a[76:79], v[184:187]
    s_waitcnt vmcnt(3)
    v_max3_u32 v253, v248, v249, v250
    v_mfma_f32_16x16x32_bf16 v[188:191], a[44:47], a[80:83], v[188:191]
    v_max_u32 v253, v253, v251
    v_cmp_eq_u32 vcc, -1, v253
    s_waitcnt lgkmcnt(5)
    v_mfma_f32_16x16x32_bf16 v[204:207], a[48:51], a[80:83], v[204:207]
    v_add_u32 v253, 153600, v252
    v_mfma_f32_16x16x32_bf16 v[200:203], a[48:51], a[76:79], v[200:203]
    v_mfma_f32_16x16x32_bf16 a[108:111], a[48:51], a[112:115], a[108:111]
    v_mfma_f32_16x16x32_bf16 v[196:199], a[48:51], a[72:75], v[196:199]
    s_cbranch_vccnz k1_kernel_E_cx
k1_kernel_E_cxd:
    s_mov_b64 exec, s[92:93]
    ds_write_b128 v253, v[248:251]
    s_mov_b64 exec, -1
    v_mfma_f32_16x16x32_bf16 v[192:195], a[48:51], a[68:71], v[192:195]
k1_kernel_E_epi:
    s_nop 4
    s_mov_b32 exec_lo, 0x10001
    s_mov_b32 exec_hi, 0x10001
    ds_write_b128 v208, a[108:111]
    s_mov_b64 exec, -1
    s_waitcnt lgkmcnt(0)
    s_barrier
    v_mov_b32 v210, 0x3fb8aa3b
    v_mov_b32 v211, 0x358637bd
    v_lshlrev_b32 v244, 4, v255
    s_and_b32 s36, s32, 7
    s_mul_i32 s36, s36, 7
    s_lshl_b32 s34, s29, 9
    s_add_u32 s34, s34, 154624
    v_and_b32 v250, 15, v255
    v_lshl_add_u32 v250, v250, 2, s34
    v_and_b32 v251, 48, v255
    v_add_u32 v251, 152576, v251
    ds_read2_b32 v[212:213], v250 offset0:64 offset1:80
    ds_read2_b32 v[214:215], v250 offset0:96 offset1:112
    ds_read2_b32 v[216:217], v250 offset0:0 offset1:16
    ds_read2_b32 v[218:219], v250 offset0:32 offset1:48
    ds_read_b128 v[220:223], v251 offset:512
    ds_read_b128 v[224:227], v251 offset:1536
    ds_read_b128 v[228:231], v251 offset:576
    ds_read_b128 v[232:235], v251 offset:1600
    ds_read_b128 v[236:239], v251 offset:640
    ds_read_b128 v[240:243], v251 offset:1664
    s_waitcnt lgkmcnt(4)
    v_pk_add_f32 v[220:221], v[220:221], v[224:225]
    v_pk_add_f32 v[222:223], v[222:223], v[226:227]
    v_pk_fma_f32 v[128:129], v[220:221], v[212:213], v[128:129] op_sel:[0,0,0] op_sel_hi:[1,0,1]
    v_pk_fma_f32 v[130:131], v[222:223], v[212:213], v[130:131] op_sel:[0,0,0] op_sel_hi:[1,0,1]
    v_pk_fma_f32 v[132:133], v[220:221], v[212:213], v[132:133] op_sel:[0,1,0] op_sel_hi:[1,1,1]
    v_pk_fma_f32 v[134:135], v[222:223], v[212:213], v[134:135] op_sel:[0,1,0] op_sel_hi:[1,1,1]
    v_pk_fma_f32 v[136:137], v[220:221], v[214:215], v[136:137] op_sel:[0,0,0] op_sel_hi:[1,0,1]
    v_pk_fma_f32 v[138:139], v[222:223], v[214:215], v[138:139] op_sel:[0,0,0] op_sel_hi:[1,0,1]
    v_pk_fma_f32 v[140:141], v[220:221], v[214:215], v[140:141] op_sel:[0,1,0] op_sel_hi:[1,1,1]
    v_pk_fma_f32 v[142:143], v[222:223], v[214:215], v[142:143] op_sel:[0,1,0] op_sel_hi:[1,1,1]
    ds_read_b128 v[220:223], v251 offset:704
    ds_read_b128 v[224:227], v251 offset:1728
    s_waitcnt lgkmcnt(4)
    v_pk_add_f32 v[228:229], v[228:229], v[232:233]
    v_pk_add_f32 v[230:231], v[230:231], v[234:235]
    v_pk_fma_f32 v[144:145], v[228:229], v[212:213], v[144:145] op_sel:[0,0,0] op_sel_hi:[1,0,1]
    v_pk_fma_f32 v[146:147], v[230:231], v[212:213], v[146:147] op_sel:[0,0,0] op_sel_hi:[1,0,1]
    v_pk_fma_f32 v[148:149], v[228:229], v[212:213], v[148:149] op_sel:[0,1,0] op_sel_hi:[1,1,1]
    v_pk_fma_f32 v[150:151], v[230:231], v[212:213], v[150:151] op_sel:[0,1,0] op_sel_hi:[1,1,1]
    v_pk_fma_f32 v[152:153], v[228:229], v[214:215], v[152:153] op_sel:[0,0,0] op_sel_hi:[1,0,1]
    v_pk_fma_f32 v[154:155], v[230:231], v[214:215], v[154:155] op_sel:[0,0,0] op_sel_hi:[1,0,1]
    v_pk_fma_f32 v[156:157], v[228:229], v[214:215], v[156:157] op_sel:[0,1,0] op_sel_hi:[1,1,1]
    v_pk_fma_f32 v[158:159], v[230:231], v[214:215], v[158:159] op_sel:[0,1,0] op_sel_hi:[1,1,1]
    ds_read_b128 v[228:231], v251 offset:768
    ds_read_b128 v[232:235], v251 offset:1792
    s_waitcnt lgkmcnt(4)
    v_pk_add_f32 v[236:237], v[236:237], v[240:241]
    v_pk_add_f32 v[238:239], v[238:239], v[242:243]
    v_pk_fma_f32 v[160:161], v[236:237], v[212:213], v[160:161] op_sel:[0,0,0] op_sel_hi:[1,0,1]
    v_pk_fma_f32 v[162:163], v[238:239], v[212:213], v[162:163] op_sel:[0,0,0] op_sel_hi:[1,0,1]
    v_pk_fma_f32 v[164:165], v[236:237], v[212:213], v[164:165] op_sel:[0,1,0] op_sel_hi:[1,1,1]
    v_pk_fma_f32 v[166:167], v[238:239], v[212:213], v[166:167] op_sel:[0,1,0] op_sel_hi:[1,1,1]
    v_pk_fma_f32 v[168:169], v[236:237], v[214:215], v[168:169] op_sel:[0,0,0] op_sel_hi:[1,0,1]
    v_pk_fma_f32 v[170:171], v[238:239], v[214:215], v[170:171] op_sel:[0,0,0] op_sel_hi:[1,0,1]
    v_pk_fma_f32 v[172:173], v[236:237], v[214:215], v[172:173] op_sel:[0,1,0] op_sel_hi:[1,1,1]
    v_pk_fma_f32 v[174:175], v[238:239], v[214:215], v[174:175] op_sel:[0,1,0] op_sel_hi:[1,1,1]
    s_waitcnt lgkmcnt(2)
    v_pk_add_f32 v[220:221], v[220:221], v[224:225]
    v_pk_add_f32 v[222:223], v[222:223], v[226:227]
    v_pk_fma_f32 v[176:177], v[220:221], v[212:213], v[176:177] op_sel:[0,0,0] op_sel_hi:[1,0,1]
    v_pk_fma_f32 v[178:179], v[222:223], v[212:213], v[178:179] op_sel:[0,0,0] op_sel_hi:[1,0,1]
    v_pk_fma_f32 v[180:181], v[220:221], v[212:213], v[180:181] op_sel:[0,1,0] op_sel_hi:[1,1,1]
    v_pk_fma_f32 v[182:183], v[222:223], v[212:213], v[182:183] op_sel:[0,1,0] op_sel_hi:[1,1,1]
    v_pk_fma_f32 v[184:185], v[220:221], v[214:215], v[184:185] op_sel:[0,0,0] op_sel_hi:[1,0,1]
    v_pk_fma_f32 v[186:187], v[222:223], v[214:215], v[186:187] op_sel:[0,0,0] op_sel_hi:[1,0,1]
    v_pk_fma_f32 v[188:189], v[220:221], v[214:215], v[188:189] op_sel:[0,1,0] op_sel_hi:[1,1,1]
    v_pk_fma_f32 v[190:191], v[222:223], v[214:215], v[190:191] op_sel:[0,1,0] op_sel_hi:[1,1,1]
    s_waitcnt lgkmcnt(0)
    v_pk_add_f32 v[228:229], v[228:229], v[232:233]
    v_pk_add_f32 v[230:231], v[230:231], v[234:235]
    v_pk_fma_f32 v[192:193], v[228:229], v[212:213], v[192:193] op_sel:[0,0,0] op_sel_hi:[1,0,1]
    v_pk_fma_f32 v[194:195], v[230:231], v[212:213], v[194:195] op_sel:[0,0,0] op_sel_hi:[1,0,1]
    v_pk_fma_f32 v[196:197], v[228:229], v[212:213], v[196:197] op_sel:[0,1,0] op_sel_hi:[1,1,1]
    v_pk_fma_f32 v[198:199], v[230:231], v[212:213], v[198:199] op_sel:[0,1,0] op_sel_hi:[1,1,1]
    v_pk_fma_f32 v[200:201], v[228:229], v[214:215], v[200:201] op_sel:[0,0,0] op_sel_hi:[1,0,1]
    v_pk_fma_f32 v[202:203], v[230:231], v[214:215], v[202:203] op_sel:[0,0,0] op_sel_hi:[1,0,1]
    v_pk_fma_f32 v[204:205], v[228:229], v[214:215], v[204:205] op_sel:[0,1,0] op_sel_hi:[1,1,1]
    v_pk_fma_f32 v[206:207], v[230:231], v[214:215], v[206:207] op_sel:[0,1,0] op_sel_hi:[1,1,1]
    v_mul_f32 v212, v216, v216
    v_mul_f32 v213, v217, v217
    v_mul_f32 v214, v218, v218
    v_mul_f32 v215, v219, v219
    v_mul_f32 v220, 0xbdd2d3e8, v216
    v_mul_f32 v221, 0xc0135761, v216
    v_mul_f32 v222, 0xbdd2d3e8, v217
    v_mul_f32 v223, 0xc0135761, v217
    v_mul_f32 v224, 0xbdd2d3e8, v218
    v_mul_f32 v225, 0xc0135761, v218
    v_mul_f32 v226, 0xbdd2d3e8, v219
    v_mul_f32 v227, 0xc0135761, v219
    v_mul_f32 v220, v220, v212
    v_rcp_f32 v208, v216
    v_mul_f32 v222, v222, v213
    v_rcp_f32 v209, v217
    v_mul_f32 v224, v224, v214
    v_rcp_f32 v252, v218
    v_mul_f32 v226, v226, v215
    v_rcp_f32 v253, v219
    s_cmp_ge_u32 s32, 8
    s_cbranch_scc1 k1_kernel_E_z2
    s_lshl_b32 s34, s30, 4
    s_lshl_b32 s35, s29, 2
    s_add_u32 s34, s34, s35
    s_mul_i32 s34, s34, 56
    s_add_u32 s34, s34, s36
    s_lshl_b32 s34, s34, 10
    s_add_u32 s60, s34, 12582912
    s_add_u32 s61, s60, 57344
    s_add_u32 s62, s60, 114688
    s_add_u32 s63, s60, 172032
    v_add_u32 v245, 0, v244
    v_pk_mul_f32 v[212:213], v[128:129], v[128:129]
    v_pk_mul_f32 v[214:215], v[130:131], v[130:131]
    v_pk_mul_f32 v[216:217], v[144:145], v[144:145]
    v_pk_mul_f32 v[218:219], v[146:147], v[146:147]
    v_pk_fma_f32 v[212:213], v[212:213], v[220:221], v[220:221] op_sel:[0,0,1] op_sel_hi:[1,0,1]
    v_pk_fma_f32 v[214:215], v[214:215], v[220:221], v[220:221] op_sel:[0,0,1] op_sel_hi:[1,0,1]
    v_pk_fma_f32 v[216:217], v[216:217], v[220:221], v[220:221] op_sel:[0,0,1] op_sel_hi:[1,0,1]
    v_pk_fma_f32 v[218:219], v[218:219], v[220:221], v[220:221] op_sel:[0,0,1] op_sel_hi:[1,0,1]
    v_pk_mul_f32 v[212:213], v[212:213], v[128:129]
    v_pk_mul_f32 v[214:215], v[214:215], v[130:131]
    v_pk_mul_f32 v[216:217], v[216:217], v[144:145]
    v_pk_mul_f32 v[218:219], v[218:219], v[146:147]
    v_exp_f32 v212, v212
    v_exp_f32 v213, v213
    v_exp_f32 v214, v214
    v_exp_f32 v215, v215
    v_exp_f32 v216, v216
    v_exp_f32 v217, v217
    v_exp_f32 v218, v218
    v_exp_f32 v219, v219
    v_pk_fma_f32 v[212:213], v[212:213], v[208:209], v[208:209] op_sel:[0,0,0] op_sel_hi:[1,0,0]
    v_pk_fma_f32 v[214:215], v[214:215], v[208:209], v[208:209] op_sel:[0,0,0] op_sel_hi:[1,0,0]
    v_pk_fma_f32 v[216:217], v[216:217], v[208:209], v[208:209] op_sel:[0,0,0] op_sel_hi:[1,0,0]
    v_pk_fma_f32 v[218:219], v[218:219], v[208:209], v[208:209] op_sel:[0,0,0] op_sel_hi:[1,0,0]
    v_rcp_f32 v212, v212
    v_rcp_f32 v213, v213
    v_rcp_f32 v214, v214
    v_rcp_f32 v215, v215
    v_rcp_f32 v216, v216
    v_rcp_f32 v217, v217
    v_rcp_f32 v218, v218
    v_rcp_f32 v219, v219
    v_pk_mul_f32 v[128:129], v[128:129], v[212:213]
    v_pk_mul_f32 v[130:131], v[130:131], v[214:215]
    v_pk_mul_f32 v[144:145], v[144:145], v[216:217]
    v_pk_mul_f32 v[146:147], v[146:147], v[218:219]
    v_cvt_pk_bf16_f32 v128, v128, v129
    v_cvt_pk_bf16_f32 v129, v130, v131
    v_cvt_pk_bf16_f32 v130, v144, v145
    v_cvt_pk_bf16_f32 v131, v146, v147
    buffer_store_dwordx4 v[128:131], v245, s[16:19], s60 offen offset:0
    v_pk_mul_f32 v[212:213], v[132:133], v[132:133]
    v_pk_mul_f32 v[214:215], v[134:135], v[134:135]
    v_pk_mul_f32 v[216:217], v[148:149], v[148:149]
    v_pk_mul_f32 v[218:219], v[150:151], v[150:151]
    v_pk_fma_f32 v[212:213], v[212:213], v[222:223], v[222:223] op_sel:[0,0,1] op_sel_hi:[1,0,1]
    v_pk_fma_f32 v[214:215], v[214:215], v[222:223], v[222:223] op_sel:[0,0,1] op_sel_hi:[1,0,1]
    v_pk_fma_f32 v[216:217], v[216:217], v[222:223], v[222:223] op_sel:[0,0,1] op_sel_hi:[1,0,1]
    v_pk_fma_f32 v[218:219], v[218:219], v[222:223], v[222:223] op_sel:[0,0,1] op_sel_hi:[1,0,1]
    v_pk_mul_f32 v[212:213], v[212:213], v[132:133]
    v_pk_mul_f32 v[214:215], v[214:215], v[134:135]
    v_pk_mul_f32 v[216:217], v[216:217], v[148:149]
    v_pk_mul_f32 v[218:219], v[218:219], v[150:151]
    v_exp_f32 v212, v212
    v_exp_f32 v213, v213
    v_exp_f32 v214, v214
    v_exp_f32 v215, v215
    v_exp_f32 v216, v216
    v_exp_f32 v217, v217
    v_exp_f32 v218, v218
    v_exp_f32 v219, v219
    v_pk_fma_f32 v[212:213], v[212:213], v[208:209], v[208:209] op_sel:[0,1,1] op_sel_hi:[1,1,1]
    v_pk_fma_f32 v[214:215], v[214:215], v[208:209], v[208:209] op_sel:[0,1,1] op_sel_hi:[1,1,1]
    v_pk_fma_f32 v[216:217], v[216:217], v[208:209], v[208:209] op_sel:[0,1,1] op_sel_hi:[1,1,1]
    v_pk_fma_f32 v[218:219], v[218:219], v[208:209], v[208:209] op_sel:[0,1,1] op_sel_hi:[1,1,1]
    v_rcp_f32 v212, v212
    v_rcp_f32 v213, v213
    v_rcp_f32 v214, v214
    v_rcp_f32 v215, v215
    v_rcp_f32 v216, v216
    v_rcp_f32 v217, v217
    v_rcp_f32 v218, v218
    v_rcp_f32 v219, v219
    v_pk_mul_f32 v[132:133], v[132:133], v[212:213]
    v_pk_mul_f32 v[134:135], v[134:135], v[214:215]
    v_pk_mul_f32 v[148:149], v[148:149], v[216:217]
    v_pk_mul_f32 v[150:151], v[150:151], v[218:219]
    v_cvt_pk_bf16_f32 v132, v132, v133
    v_cvt_pk_bf16_f32 v133, v134, v135
    v_cvt_pk_bf16_f32 v134, v148, v149
    v_cvt_pk_bf16_f32 v135, v150, v151
    buffer_store_dwordx4 v[132:135], v245, s[16:19], s61 offen offset:0
    v_pk_mul_f32 v[212:213], v[136:137], v[136:137]
    v_pk_mul_f32 v[214:215], v[138:139], v[138:139]
    v_pk_mul_f32 v[216:217], v[152:153], v[152:153]
    v_pk_mul_f32 v[218:219], v[154:155], v[154:155]
    v_pk_fma_f32 v[212:213], v[212:213], v[224:225], v[224:225] op_sel:[0,0,1] op_sel_hi:[1,0,1]
    v_pk_fma_f32 v[214:215], v[214:215], v[224:225], v[224:225] op_sel:[0,0,1] op_sel_hi:[1,0,1]
    v_pk_fma_f32 v[216:217], v[216:217], v[224:225], v[224:225] op_sel:[0,0,1] op_sel_hi:[1,0,1]
    v_pk_fma_f32 v[218:219], v[218:219], v[224:225], v[224:225] op_sel:[0,0,1] op_sel_hi:[1,0,1]
    v_pk_mul_f32 v[212:213], v[212:213], v[136:137]
    v_pk_mul_f32 v[214:215], v[214:215], v[138:139]
    v_pk_mul_f32 v[216:217], v[216:217], v[152:153]
    v_pk_mul_f32 v[218:219], v[218:219], v[154:155]
    v_exp_f32 v212, v212
    v_exp_f32 v213, v213
    v_exp_f32 v214, v214
    v_exp_f32 v215, v215
    v_exp_f32 v216, v216
    v_exp_f32 v217, v217
    v_exp_f32 v218, v218
    v_exp_f32 v219, v219
    v_pk_fma_f32 v[212:213], v[212:213], v[252:253], v[252:253] op_sel:[0,0,0] op_sel_hi:[1,0,0]
    v_pk_fma_f32 v[214:215], v[214:215], v[252:253], v[252:253] op_sel:[0,0,0] op_sel_hi:[1,0,0]
    v_pk_fma_f32 v[216:217], v[216:217], v[252:253], v[252:253] op_sel:[0,0,0] op_sel_hi:[1,0,0]
    v_pk_fma_f32 v[218:219], v[218:219], v[252:253], v[252:253] op_sel:[0,0,0] op_sel_hi:[1,0,0]
    v_rcp_f32 v212, v212
    v_rcp_f32 v213, v213
    v_rcp_f32 v214, v214
    v_rcp_f32 v215, v215
    v_rcp_f32 v216, v216
    v_rcp_f32 v217, v217
    v_rcp_f32 v218, v218
    v_rcp_f32 v219, v219
    v_pk_mul_f32 v[136:137], v[136:137], v[212:213]
    v_pk_mul_f32 v[138:139], v[138:139], v[214:215]
    v_pk_mul_f32 v[152:153], v[152:153], v[216:217]
    v_pk_mul_f32 v[154:155], v[154:155], v[218:219]
    v_cvt_pk_bf16_f32 v136, v136, v137
    v_cvt_pk_bf16_f32 v137, v138, v139
    v_cvt_pk_bf16_f32 v138, v152, v153
    v_cvt_pk_bf16_f32 v139, v154, v155
    buffer_store_dwordx4 v[136:139], v245, s[16:19], s62 offen offset:0
    v_pk_mul_f32 v[212:213], v[140:141], v[140:141]
    v_pk_mul_f32 v[214:215], v[142:143], v[142:143]
    v_pk_mul_f32 v[216:217], v[156:157], v[156:157]
    v_pk_mul_f32 v[218:219], v[158:159], v[158:159]
    v_pk_fma_f32 v[212:213], v[212:213], v[226:227], v[226:227] op_sel:[0,0,1] op_sel_hi:[1,0,1]
    v_pk_fma_f32 v[214:215], v[214:215], v[226:227], v[226:227] op_sel:[0,0,1] op_sel_hi:[1,0,1]
    v_pk_fma_f32 v[216:217], v[216:217], v[226:227], v[226:227] op_sel:[0,0,1] op_sel_hi:[1,0,1]
    v_pk_fma_f32 v[218:219], v[218:219], v[226:227], v[226:227] op_sel:[0,0,1] op_sel_hi:[1,0,1]
    v_pk_mul_f32 v[212:213], v[212:213], v[140:141]
    v_pk_mul_f32 v[214:215], v[214:215], v[142:143]
    v_pk_mul_f32 v[216:217], v[216:217], v[156:157]
    v_pk_mul_f32 v[218:219], v[218:219], v[158:159]
    v_exp_f32 v212, v212
    v_exp_f32 v213, v213
    v_exp_f32 v214, v214
    v_exp_f32 v215, v215
    v_exp_f32 v216, v216
    v_exp_f32 v217, v217
    v_exp_f32 v218, v218
    v_exp_f32 v219, v219
    v_pk_fma_f32 v[212:213], v[212:213], v[252:253], v[252:253] op_sel:[0,1,1] op_sel_hi:[1,1,1]
    v_pk_fma_f32 v[214:215], v[214:215], v[252:253], v[252:253] op_sel:[0,1,1] op_sel_hi:[1,1,1]
    v_pk_fma_f32 v[216:217], v[216:217], v[252:253], v[252:253] op_sel:[0,1,1] op_sel_hi:[1,1,1]
    v_pk_fma_f32 v[218:219], v[218:219], v[252:253], v[252:253] op_sel:[0,1,1] op_sel_hi:[1,1,1]
    v_rcp_f32 v212, v212
    v_rcp_f32 v213, v213
    v_rcp_f32 v214, v214
    v_rcp_f32 v215, v215
    v_rcp_f32 v216, v216
    v_rcp_f32 v217, v217
    v_rcp_f32 v218, v218
    v_rcp_f32 v219, v219
    v_pk_mul_f32 v[140:141], v[140:141], v[212:213]
    v_pk_mul_f32 v[142:143], v[142:143], v[214:215]
    v_pk_mul_f32 v[156:157], v[156:157], v[216:217]
    v_pk_mul_f32 v[158:159], v[158:159], v[218:219]
    v_cvt_pk_bf16_f32 v140, v140, v141
    v_cvt_pk_bf16_f32 v141, v142, v143
    v_cvt_pk_bf16_f32 v142, v156, v157
    v_cvt_pk_bf16_f32 v143, v158, v159
    buffer_store_dwordx4 v[140:143], v245, s[16:19], s63 offen offset:0
    v_pk_mul_f32 v[212:213], v[160:161], v[160:161]
    v_pk_mul_f32 v[214:215], v[162:163], v[162:163]
    v_pk_mul_f32 v[216:217], v[176:177], v[176:177]
    v_pk_mul_f32 v[218:219], v[178:179], v[178:179]
    v_pk_fma_f32 v[212:213], v[212:213], v[220:221], v[220:221] op_sel:[0,0,1] op_sel_hi:[1,0,1]
    v_pk_fma_f32 v[214:215], v[214:215], v[220:221], v[220:221] op_sel:[0,0,1] op_sel_hi:[1,0,1]
    v_pk_fma_f32 v[216:217], v[216:217], v[220:221], v[220:221] op_sel:[0,0,1] op_sel_hi:[1,0,1]
    v_pk_fma_f32 v[218:219], v[218:219], v[220:221], v[220:221] op_sel:[0,0,1] op_sel_hi:[1,0,1]
    v_pk_mul_f32 v[212:213], v[212:213], v[160:161]
    v_pk_mul_f32 v[214:215], v[214:215], v[162:163]
    v_pk_mul_f32 v[216:217], v[216:217], v[176:177]
    v_pk_mul_f32 v[218:219], v[218:219], v[178:179]
    v_exp_f32 v212, v212
    v_exp_f32 v213, v213
    v_exp_f32 v214, v214
    v_exp_f32 v215, v215
    v_exp_f32 v216, v216
    v_exp_f32 v217, v217
    v_exp_f32 v218, v218
    v_exp_f32 v219, v219
    v_pk_fma_f32 v[212:213], v[212:213], v[208:209], v[208:209] op_sel:[0,0,0] op_sel_hi:[1,0,0]
    v_pk_fma_f32 v[214:215], v[214:215], v[208:209], v[208:209] op_sel:[0,0,0] op_sel_hi:[1,0,0]
    v_pk_fma_f32 v[216:217], v[216:217], v[208:209], v[208:209] op_sel:[0,0,0] op_sel_hi:[1,0,0]
    v_pk_fma_f32 v[218:219], v[218:219], v[208:209], v[208:209] op_sel:[0,0,0] op_sel_hi:[1,0,0]
    v_rcp_f32 v212, v212
    v_rcp_f32 v213, v213
    v_rcp_f32 v214, v214
    v_rcp_f32 v215, v215
    v_rcp_f32 v216, v216
    v_rcp_f32 v217, v217
    v_rcp_f32 v218, v218
    v_rcp_f32 v219, v219
    v_pk_mul_f32 v[160:161], v[160:161], v[212:213]
    v_pk_mul_f32 v[162:163], v[162:163], v[214:215]
    v_pk_mul_f32 v[176:177], v[176:177], v[216:217]
    v_pk_mul_f32 v[178:179], v[178:179], v[218:219]
    v_cvt_pk_bf16_f32 v160, v160, v161
    v_cvt_pk_bf16_f32 v161, v162, v163
    v_cvt_pk_bf16_f32 v162, v176, v177
    v_cvt_pk_bf16_f32 v163, v178, v179
    buffer_store_dwordx4 v[160:163], v245, s[16:19], s60 offen offset:1024
    v_pk_mul_f32 v[212:213], v[164:165], v[164:165]
    v_pk_mul_f32 v[214:215], v[166:167], v[166:167]
    v_pk_mul_f32 v[216:217], v[180:181], v[180:181]
    v_pk_mul_f32 v[218:219], v[182:183], v[182:183]
    v_pk_fma_f32 v[212:213], v[212:213], v[222:223], v[222:223] op_sel:[0,0,1] op_sel_hi:[1,0,1]
    v_pk_fma_f32 v[214:215], v[214:215], v[222:223], v[222:223] op_sel:[0,0,1] op_sel_hi:[1,0,1]
    v_pk_fma_f32 v[216:217], v[216:217], v[222:223], v[222:223] op_sel:[0,0,1] op_sel_hi:[1,0,1]
    v_pk_fma_f32 v[218:219], v[218:219], v[222:223], v[222:223] op_sel:[0,0,1] op_sel_hi:[1,0,1]
    v_pk_mul_f32 v[212:213], v[212:213], v[164:165]
    v_pk_mul_f32 v[214:215], v[214:215], v[166:167]
    v_pk_mul_f32 v[216:217], v[216:217], v[180:181]
    v_pk_mul_f32 v[218:219], v[218:219], v[182:183]
    v_exp_f32 v212, v212
    v_exp_f32 v213, v213
    v_exp_f32 v214, v214
    v_exp_f32 v215, v215
    v_exp_f32 v216, v216
    v_exp_f32 v217, v217
    v_exp_f32 v218, v218
    v_exp_f32 v219, v219
    v_pk_fma_f32 v[212:213], v[212:213], v[208:209], v[208:209] op_sel:[0,1,1] op_sel_hi:[1,1,1]
    v_pk_fma_f32 v[214:215], v[214:215], v[208:209], v[208:209] op_sel:[0,1,1] op_sel_hi:[1,1,1]
    v_pk_fma_f32 v[216:217], v[216:217], v[208:209], v[208:209] op_sel:[0,1,1] op_sel_hi:[1,1,1]
    v_pk_fma_f32 v[218:219], v[218:219], v[208:209], v[208:209] op_sel:[0,1,1] op_sel_hi:[1,1,1]
    v_rcp_f32 v212, v212
    v_rcp_f32 v213, v213
    v_rcp_f32 v214, v214
    v_rcp_f32 v215, v215
    v_rcp_f32 v216, v216
    v_rcp_f32 v217, v217
    v_rcp_f32 v218, v218
    v_rcp_f32 v219, v219
    v_pk_mul_f32 v[164:165], v[164:165], v[212:213]
    v_pk_mul_f32 v[166:167], v[166:167], v[214:215]
    v_pk_mul_f32 v[180:181], v[180:181], v[216:217]
    v_pk_mul_f32 v[182:183], v[182:183], v[218:219]
    v_cvt_pk_bf16_f32 v164, v164, v165
    v_cvt_pk_bf16_f32 v165, v166, v167
    v_cvt_pk_bf16_f32 v166, v180, v181
    v_cvt_pk_bf16_f32 v167, v182, v183
    buffer_store_dwordx4 v[164:167], v245, s[16:19], s61 offen offset:1024
    v_pk_mul_f32 v[212:213], v[168:169], v[168:169]
    v_pk_mul_f32 v[214:215], v[170:171], v[170:171]
    v_pk_mul_f32 v[216:217], v[184:185], v[184:185]
    v_pk_mul_f32 v[218:219], v[186:187], v[186:187]
    v_pk_fma_f32 v[212:213], v[212:213], v[224:225], v[224:225] op_sel:[0,0,1] op_sel_hi:[1,0,1]
    v_pk_fma_f32 v[214:215], v[214:215], v[224:225], v[224:225] op_sel:[0,0,1] op_sel_hi:[1,0,1]
    v_pk_fma_f32 v[216:217], v[216:217], v[224:225], v[224:225] op_sel:[0,0,1] op_sel_hi:[1,0,1]
    v_pk_fma_f32 v[218:219], v[218:219], v[224:225], v[224:225] op_sel:[0,0,1] op_sel_hi:[1,0,1]
    v_pk_mul_f32 v[212:213], v[212:213], v[168:169]
    v_pk_mul_f32 v[214:215], v[214:215], v[170:171]
    v_pk_mul_f32 v[216:217], v[216:217], v[184:185]
    v_pk_mul_f32 v[218:219], v[218:219], v[186:187]
    v_exp_f32 v212, v212
    v_exp_f32 v213, v213
    v_exp_f32 v214, v214
    v_exp_f32 v215, v215
    v_exp_f32 v216, v216
    v_exp_f32 v217, v217
    v_exp_f32 v218, v218
    v_exp_f32 v219, v219
    v_pk_fma_f32 v[212:213], v[212:213], v[252:253], v[252:253] op_sel:[0,0,0] op_sel_hi:[1,0,0]
    v_pk_fma_f32 v[214:215], v[214:215], v[252:253], v[252:253] op_sel:[0,0,0] op_sel_hi:[1,0,0]
    v_pk_fma_f32 v[216:217], v[216:217], v[252:253], v[252:253] op_sel:[0,0,0] op_sel_hi:[1,0,0]
    v_pk_fma_f32 v[218:219], v[218:219], v[252:253], v[252:253] op_sel:[0,0,0] op_sel_hi:[1,0,0]
    v_rcp_f32 v212, v212
    v_rcp_f32 v213, v213
    v_rcp_f32 v214, v214
    v_rcp_f32 v215, v215
    v_rcp_f32 v216, v216
    v_rcp_f32 v217, v217
    v_rcp_f32 v218, v218
    v_rcp_f32 v219, v219
    v_pk_mul_f32 v[168:169], v[168:169], v[212:213]
    v_pk_mul_f32 v[170:171], v[170:171], v[214:215]
    v_pk_mul_f32 v[184:185], v[184:185], v[216:217]
    v_pk_mul_f32 v[186:187], v[186:187], v[218:219]
    v_cvt_pk_bf16_f32 v168, v168, v169
    v_cvt_pk_bf16_f32 v169, v170, v171
    v_cvt_pk_bf16_f32 v170, v184, v185
    v_cvt_pk_bf16_f32 v171, v186, v187
    buffer_store_dwordx4 v[168:171], v245, s[16:19], s62 offen offset:1024
    v_pk_mul_f32 v[212:213], v[172:173], v[172:173]
    v_pk_mul_f32 v[214:215], v[174:175], v[174:175]
    v_pk_mul_f32 v[216:217], v[188:189], v[188:189]
    v_pk_mul_f32 v[218:219], v[190:191], v[190:191]
    v_pk_fma_f32 v[212:213], v[212:213], v[226:227], v[226:227] op_sel:[0,0,1] op_sel_hi:[1,0,1]
    v_pk_fma_f32 v[214:215], v[214:215], v[226:227], v[226:227] op_sel:[0,0,1] op_sel_hi:[1,0,1]
    v_pk_fma_f32 v[216:217], v[216:217], v[226:227], v[226:227] op_sel:[0,0,1] op_sel_hi:[1,0,1]
    v_pk_fma_f32 v[218:219], v[218:219], v[226:227], v[226:227] op_sel:[0,0,1] op_sel_hi:[1,0,1]
    v_pk_mul_f32 v[212:213], v[212:213], v[172:173]
    v_pk_mul_f32 v[214:215], v[214:215], v[174:175]
    v_pk_mul_f32 v[216:217], v[216:217], v[188:189]
    v_pk_mul_f32 v[218:219], v[218:219], v[190:191]
    v_exp_f32 v212, v212
    v_exp_f32 v213, v213
    v_exp_f32 v214, v214
    v_exp_f32 v215, v215
    v_exp_f32 v216, v216
    v_exp_f32 v217, v217
    v_exp_f32 v218, v218
    v_exp_f32 v219, v219
    v_pk_fma_f32 v[212:213], v[212:213], v[252:253], v[252:253] op_sel:[0,1,1] op_sel_hi:[1,1,1]
    v_pk_fma_f32 v[214:215], v[214:215], v[252:253], v[252:253] op_sel:[0,1,1] op_sel_hi:[1,1,1]
    v_pk_fma_f32 v[216:217], v[216:217], v[252:253], v[252:253] op_sel:[0,1,1] op_sel_hi:[1,1,1]
    v_pk_fma_f32 v[218:219], v[218:219], v[252:253], v[252:253] op_sel:[0,1,1] op_sel_hi:[1,1,1]
    v_rcp_f32 v212, v212
    v_rcp_f32 v213, v213
    v_rcp_f32 v214, v214
    v_rcp_f32 v215, v215
    v_rcp_f32 v216, v216
    v_rcp_f32 v217, v217
    v_rcp_f32 v218, v218
    v_rcp_f32 v219, v219
    v_pk_mul_f32 v[172:173], v[172:173], v[212:213]
    v_pk_mul_f32 v[174:175], v[174:175], v[214:215]
    v_pk_mul_f32 v[188:189], v[188:189], v[216:217]
    v_pk_mul_f32 v[190:191], v[190:191], v[218:219]
    v_cvt_pk_bf16_f32 v172, v172, v173
    v_cvt_pk_bf16_f32 v173, v174, v175
    v_cvt_pk_bf16_f32 v174, v188, v189
    v_cvt_pk_bf16_f32 v175, v190, v191
    buffer_store_dwordx4 v[172:175], v245, s[16:19], s63 offen offset:1024
    v_pk_mul_f32 v[212:213], v[192:193], v[192:193]
    v_pk_mul_f32 v[214:215], v[194:195], v[194:195]
    v_pk_mul_f32 v[216:217], v[196:197], v[196:197]
    v_pk_mul_f32 v[218:219], v[198:199], v[198:199]
    v_pk_fma_f32 v[212:213], v[212:213], v[220:221], v[220:221] op_sel:[0,0,1] op_sel_hi:[1,0,1]
    v_pk_fma_f32 v[214:215], v[214:215], v[220:221], v[220:221] op_sel:[0,0,1] op_sel_hi:[1,0,1]
    v_pk_fma_f32 v[216:217], v[216:217], v[222:223], v[222:223] op_sel:[0,0,1] op_sel_hi:[1,0,1]
    v_pk_fma_f32 v[218:219], v[218:219], v[222:223], v[222:223] op_sel:[0,0,1] op_sel_hi:[1,0,1]
    v_pk_mul_f32 v[212:213], v[212:213], v[192:193]
    v_pk_mul_f32 v[214:215], v[214:215], v[194:195]
    v_pk_mul_f32 v[216:217], v[216:217], v[196:197]
    v_pk_mul_f32 v[218:219], v[218:219], v[198:199]
    v_exp_f32 v212, v212
    v_exp_f32 v213, v213
    v_exp_f32 v214, v214
    v_exp_f32 v215, v215
    v_exp_f32 v216, v216
    v_exp_f32 v217, v217
    v_exp_f32 v218, v218
    v_exp_f32 v219, v219
    v_pk_fma_f32 v[212:213], v[212:213], v[208:209], v[208:209] op_sel:[0,0,0] op_sel_hi:[1,0,0]
    v_pk_fma_f32 v[214:215], v[214:215], v[208:209], v[208:209] op_sel:[0,0,0] op_sel_hi:[1,0,0]
    v_pk_fma_f32 v[216:217], v[216:217], v[208:209], v[208:209] op_sel:[0,1,1] op_sel_hi:[1,1,1]
    v_pk_fma_f32 v[218:219], v[218:219], v[208:209], v[208:209] op_sel:[0,1,1] op_sel_hi:[1,1,1]
    v_rcp_f32 v212, v212
    v_rcp_f32 v213, v213
    v_rcp_f32 v214, v214
    v_rcp_f32 v215, v215
    v_rcp_f32 v216, v216
    v_rcp_f32 v217, v217
    v_rcp_f32 v218, v218
    v_rcp_f32 v219, v219
    v_pk_mul_f32 v[192:193], v[192:193], v[212:213]
    v_pk_mul_f32 v[194:195], v[194:195], v[214:215]
    v_pk_mul_f32 v[196:197], v[196:197], v[216:217]
    v_pk_mul_f32 v[198:199], v[198:199], v[218:219]
    v_cvt_pk_bf16_f32 v192, v192, v193
    v_cvt_pk_bf16_f32 v193, v194, v195
    v_cvt_pk_bf16_f32 v196, v196, v197
    v_cvt_pk_bf16_f32 v197, v198, v199
    buffer_store_dwordx2 v[192:193], v244, s[16:19], s60 offen offset:2048
    buffer_store_dwordx2 v[196:197], v244, s[16:19], s61 offen offset:2048
    v_pk_mul_f32 v[212:213], v[200:201], v[200:201]
    v_pk_mul_f32 v[214:215], v[202:203], v[202:203]
    v_pk_mul_f32 v[216:217], v[204:205], v[204:205]
    v_pk_mul_f32 v[218:219], v[206:207], v[206:207]
    v_pk_fma_f32 v[212:213], v[212:213], v[224:225], v[224:225] op_sel:[0,0,1] op_sel_hi:[1,0,1]
    v_pk_fma_f32 v[214:215], v[214:215], v[224:225], v[224:225] op_sel:[0,0,1] op_sel_hi:[1,0,1]
    v_pk_fma_f32 v[216:217], v[216:217], v[226:227], v[226:227] op_sel:[0,0,1] op_sel_hi:[1,0,1]
    v_pk_fma_f32 v[218:219], v[218:219], v[226:227], v[226:227] op_sel:[0,0,1] op_sel_hi:[1,0,1]
    v_pk_mul_f32 v[212:213], v[212:213], v[200:201]
    v_pk_mul_f32 v[214:215], v[214:215], v[202:203]
    v_pk_mul_f32 v[216:217], v[216:217], v[204:205]
    v_pk_mul_f32 v[218:219], v[218:219], v[206:207]
    v_exp_f32 v212, v212
    v_exp_f32 v213, v213
    v_exp_f32 v214, v214
    v_exp_f32 v215, v215
    v_exp_f32 v216, v216
    v_exp_f32 v217, v217
    v_exp_f32 v218, v218
    v_exp_f32 v219, v219
    v_pk_fma_f32 v[212:213], v[212:213], v[252:253], v[252:253] op_sel:[0,0,0] op_sel_hi:[1,0,0]
    v_pk_fma_f32 v[214:215], v[214:215], v[252:253], v[252:253] op_sel:[0,0,0] op_sel_hi:[1,0,0]
    v_pk_fma_f32 v[216:217], v[216:217], v[252:253], v[252:253] op_sel:[0,1,1] op_sel_hi:[1,1,1]
    v_pk_fma_f32 v[218:219], v[218:219], v[252:253], v[252:253] op_sel:[0,1,1] op_sel_hi:[1,1,1]
    v_rcp_f32 v212, v212
    v_rcp_f32 v213, v213
    v_rcp_f32 v214, v214
    v_rcp_f32 v215, v215
    v_rcp_f32 v216, v216
    v_rcp_f32 v217, v217
    v_rcp_f32 v218, v218
    v_rcp_f32 v219, v219
    v_pk_mul_f32 v[200:201], v[200:201], v[212:213]
    v_pk_mul_f32 v[202:203], v[202:203], v[214:215]
    v_pk_mul_f32 v[204:205], v[204:205], v[216:217]
    v_pk_mul_f32 v[206:207], v[206:207], v[218:219]
    v_cvt_pk_bf16_f32 v200, v200, v201
    v_cvt_pk_bf16_f32 v201, v202, v203
    v_cvt_pk_bf16_f32 v204, v204, v205
    v_cvt_pk_bf16_f32 v205, v206, v207
    buffer_store_dwordx2 v[200:201], v244, s[16:19], s62 offen offset:2048
    buffer_store_dwordx2 v[204:205], v244, s[16:19], s63 offen offset:2048
    s_lshl_b32 s34, s29, 9
    s_add_u32 s34, s34, 154624
    v_and_b32 v250, 48, v255
    v_add_u32 v250, s34, v250
    v_and_b32 v251, 15, v255
    v_lshlrev_b32 v251, 2, v251
    v_add_u32 v251, 152576, v251
    ds_read2_b32 v[220:221], v251 offset0:0 offset1:16
    ds_read2_b32 v[222:223], v251 offset0:32 offset1:48
    ds_read2_b32 v[224:225], v251 offset0:64 offset1:80
    ds_read2_b32 v[226:227], v251 offset0:96 offset1:112
    v_add_u32 v251, 1024, v251
    ds_read2_b32 v[212:213], v251 offset0:0 offset1:16
    ds_read2_b32 v[214:215], v251 offset0:32 offset1:48
    ds_read2_b32 v[216:217], v251 offset0:64 offset1:80
    ds_read2_b32 v[218:219], v251 offset0:96 offset1:112
    ds_read_b128 v[228:231], v250 offset:256
    ds_read_b128 v[232:235], v250 offset:320
    ds_read_b128 v[236:239], v250 offset:384
    ds_read_b128 v[240:243], v250 offset:448
    s_waitcnt lgkmcnt(3)
    v_pk_add_f32 v[220:221], v[220:221], v[212:213]
    v_pk_add_f32 v[222:223], v[222:223], v[214:215]
    v_pk_add_f32 v[224:225], v[224:225], v[216:217]
    v_pk_add_f32 v[226:227], v[226:227], v[218:219]
    v_pk_fma_f32 v[0:1], v[228:229], v[220:221], v[0:1] op_sel:[0,0,0] op_sel_hi:[1,0,1]
    v_pk_fma_f32 v[2:3], v[230:231], v[220:221], v[2:3] op_sel:[0,0,0] op_sel_hi:[1,0,1]
    v_pk_fma_f32 v[16:17], v[228:229], v[220:221], v[16:17] op_sel:[0,1,0] op_sel_hi:[1,1,1]
    v_pk_fma_f32 v[18:19], v[230:231], v[220:221], v[18:19] op_sel:[0,1,0] op_sel_hi:[1,1,1]
    v_pk_fma_f32 v[32:33], v[228:229], v[222:223], v[32:33] op_sel:[0,0,0] op_sel_hi:[1,0,1]
    v_pk_fma_f32 v[34:35], v[230:231], v[222:223], v[34:35] op_sel:[0,0,0] op_sel_hi:[1,0,1]
    v_pk_fma_f32 v[48:49], v[228:229], v[222:223], v[48:49] op_sel:[0,1,0] op_sel_hi:[1,1,1]
    v_pk_fma_f32 v[50:51], v[230:231], v[222:223], v[50:51] op_sel:[0,1,0] op_sel_hi:[1,1,1]
    v_pk_fma_f32 v[64:65], v[228:229], v[224:225], v[64:65] op_sel:[0,0,0] op_sel_hi:[1,0,1]
    v_pk_fma_f32 v[66:67], v[230:231], v[224:225], v[66:67] op_sel:[0,0,0] op_sel_hi:[1,0,1]
    v_pk_fma_f32 v[80:81], v[228:229], v[224:225], v[80:81] op_sel:[0,1,0] op_sel_hi:[1,1,1]
    v_pk_fma_f32 v[82:83], v[230:231], v[224:225], v[82:83] op_sel:[0,1,0] op_sel_hi:[1,1,1]
    v_pk_fma_f32 v[96:97], v[228:229], v[226:227], v[96:97] op_sel:[0,0,0] op_sel_hi:[1,0,1]
    v_pk_fma_f32 v[98:99], v[230:231], v[226:227], v[98:99] op_sel:[0,0,0] op_sel_hi:[1,0,1]
    v_pk_fma_f32 v[112:113], v[228:229], v[226:227], v[112:113] op_sel:[0,1,0] op_sel_hi:[1,1,1]
    v_pk_fma_f32 v[114:115], v[230:231], v[226:227], v[114:115] op_sel:[0,1,0] op_sel_hi:[1,1,1]
    ds_read_b128 v[228:231], v250 offset:0
    s_waitcnt lgkmcnt(3)
    v_pk_fma_f32 v[4:5], v[232:233], v[220:221], v[4:5] op_sel:[0,0,0] op_sel_hi:[1,0,1]
    v_pk_fma_f32 v[6:7], v[234:235], v[220:221], v[6:7] op_sel:[0,0,0] op_sel_hi:[1,0,1]
    v_pk_fma_f32 v[20:21], v[232:233], v[220:221], v[20:21] op_sel:[0,1,0] op_sel_hi:[1,1,1]
    v_pk_fma_f32 v[22:23], v[234:235], v[220:221], v[22:23] op_sel:[0,1,0] op_sel_hi:[1,1,1]
    v_pk_fma_f32 v[36:37], v[232:233], v[222:223], v[36:37] op_sel:[0,0,0] op_sel_hi:[1,0,1]
    v_pk_fma_f32 v[38:39], v[234:235], v[222:223], v[38:39] op_sel:[0,0,0] op_sel_hi:[1,0,1]
    v_pk_fma_f32 v[52:53], v[232:233], v[222:223], v[52:53] op_sel:[0,1,0] op_sel_hi:[1,1,1]
    v_pk_fma_f32 v[54:55], v[234:235], v[222:223], v[54:55] op_sel:[0,1,0] op_sel_hi:[1,1,1]
    v_pk_fma_f32 v[68:69], v[232:233], v[224:225], v[68:69] op_sel:[0,0,0] op_sel_hi:[1,0,1]
    v_pk_fma_f32 v[70:71], v[234:235], v[224:225], v[70:71] op_sel:[0,0,0] op_sel_hi:[1,0,1]
    v_pk_fma_f32 v[84:85], v[232:233], v[224:225], v[84:85] op_sel:[0,1,0] op_sel_hi:[1,1,1]
    v_pk_fma_f32 v[86:87], v[234:235], v[224:225], v[86:87] op_sel:[0,1,0] op_sel_hi:[1,1,1]
    v_pk_fma_f32 v[100:101], v[232:233], v[226:227], v[100:101] op_sel:[0,0,0] op_sel_hi:[1,0,1]
    v_pk_fma_f32 v[102:103], v[234:235], v[226:227], v[102:103] op_sel:[0,0,0] op_sel_hi:[1,0,1]
    v_pk_fma_f32 v[116:117], v[232:233], v[226:227], v[116:117] op_sel:[0,1,0] op_sel_hi:[1,1,1]
    v_pk_fma_f32 v[118:119], v[234:235], v[226:227], v[118:119] op_sel:[0,1,0] op_sel_hi:[1,1,1]
    ds_read_b128 v[232:235], v250 offset:64
    s_waitcnt lgkmcnt(3)
    v_pk_fma_f32 v[8:9], v[236:237], v[220:221], v[8:9] op_sel:[0,0,0] op_sel_hi:[1,0,1]
    v_pk_fma_f32 v[10:11], v[238:239], v[220:221], v[10:11] op_sel:[0,0,0] op_sel_hi:[1,0,1]
    v_pk_fma_f32 v[24:25], v[236:237], v[220:221], v[24:25] op_sel:[0,1,0] op_sel_hi:[1,1,1]
    v_pk_fma_f32 v[26:27], v[238:239], v[220:221], v[26:27] op_sel:[0,1,0] op_sel_hi:[1,1,1]
    v_pk_fma_f32 v[40:41], v[236:237], v[222:223], v[40:41] op_sel:[0,0,0] op_sel_hi:[1,0,1]
    v_pk_fma_f32 v[42:43], v[238:239], v[222:223], v[42:43] op_sel:[0,0,0] op_sel_hi:[1,0,1]
    v_pk_fma_f32 v[56:57], v[236:237], v[222:223], v[56:57] op_sel:[0,1,0] op_sel_hi:[1,1,1]
    v_pk_fma_f32 v[58:59], v[238:239], v[222:223], v[58:59] op_sel:[0,1,0] op_sel_hi:[1,1,1]
    v_pk_fma_f32 v[72:73], v[236:237], v[224:225], v[72:73] op_sel:[0,0,0] op_sel_hi:[1,0,1]
    v_pk_fma_f32 v[74:75], v[238:239], v[224:225], v[74:75] op_sel:[0,0,0] op_sel_hi:[1,0,1]
    v_pk_fma_f32 v[88:89], v[236:237], v[224:225], v[88:89] op_sel:[0,1,0] op_sel_hi:[1,1,1]
    v_pk_fma_f32 v[90:91], v[238:239], v[224:225], v[90:91] op_sel:[0,1,0] op_sel_hi:[1,1,1]
    v_pk_fma_f32 v[104:105], v[236:237], v[226:227], v[104:105] op_sel:[0,0,0] op_sel_hi:[1,0,1]
    v_pk_fma_f32 v[106:107], v[238:239], v[226:227], v[106:107] op_sel:[0,0,0] op_sel_hi:[1,0,1]
    v_pk_fma_f32 v[120:121], v[236:237], v[226:227], v[120:121] op_sel:[0,1,0] op_sel_hi:[1,1,1]
    v_pk_fma_f32 v[122:123], v[238:239], v[226:227], v[122:123] op_sel:[0,1,0] op_sel_hi:[1,1,1]
    ds_read_b128 v[236:239], v250 offset:128
    s_waitcnt lgkmcnt(2)
    v_pk_fma_f32 v[12:13], v[240:241], v[220:221], v[12:13] op_sel:[0,0,0] op_sel_hi:[1,0,1]
    v_pk_fma_f32 v[14:15], v[242:243], v[220:221], v[14:15] op_sel:[0,0,0] op_sel_hi:[1,0,1]
    v_pk_fma_f32 v[28:29], v[240:241], v[220:221], v[28:29] op_sel:[0,1,0] op_sel_hi:[1,1,1]
    v_pk_fma_f32 v[30:31], v[242:243], v[220:221], v[30:31] op_sel:[0,1,0] op_sel_hi:[1,1,1]
    v_pk_fma_f32 v[44:45], v[240:241], v[222:223], v[44:45] op_sel:[0,0,0] op_sel_hi:[1,0,1]
    v_pk_fma_f32 v[46:47], v[242:243], v[222:223], v[46:47] op_sel:[0,0,0] op_sel_hi:[1,0,1]
    v_pk_fma_f32 v[60:61], v[240:241], v[222:223], v[60:61] op_sel:[0,1,0] op_sel_hi:[1,1,1]
    v_pk_fma_f32 v[62:63], v[242:243], v[222:223], v[62:63] op_sel:[0,1,0] op_sel_hi:[1,1,1]
    v_pk_fma_f32 v[76:77], v[240:241], v[224:225], v[76:77] op_sel:[0,0,0] op_sel_hi:[1,0,1]
    v_pk_fma_f32 v[78:79], v[242:243], v[224:225], v[78:79] op_sel:[0,0,0] op_sel_hi:[1,0,1]
    v_pk_fma_f32 v[92:93], v[240:241], v[224:225], v[92:93] op_sel:[0,1,0] op_sel_hi:[1,1,1]
    v_pk_fma_f32 v[94:95], v[242:243], v[224:225], v[94:95] op_sel:[0,1,0] op_sel_hi:[1,1,1]
    v_pk_fma_f32 v[108:109], v[240:241], v[226:227], v[108:109] op_sel:[0,0,0] op_sel_hi:[1,0,1]
    v_pk_fma_f32 v[110:111], v[242:243], v[226:227], v[110:111] op_sel:[0,0,0] op_sel_hi:[1,0,1]
    v_pk_fma_f32 v[124:125], v[240:241], v[226:227], v[124:125] op_sel:[0,1,0] op_sel_hi:[1,1,1]
    v_pk_fma_f32 v[126:127], v[242:243], v[226:227], v[126:127] op_sel:[0,1,0] op_sel_hi:[1,1,1]
    ds_read_b128 v[240:243], v250 offset:192
    s_waitcnt lgkmcnt(0)
    v_pk_mul_f32 v[220:221], v[228:229], v[210:211] op_sel_hi:[1,0]
    v_pk_mul_f32 v[222:223], v[230:231], v[210:211] op_sel_hi:[1,0]
    v_pk_mul_f32 v[224:225], v[232:233], v[210:211] op_sel_hi:[1,0]
    v_pk_mul_f32 v[226:227], v[234:235], v[210:211] op_sel_hi:[1,0]
    v_pk_mul_f32 v[64:65], v[64:65], v[228:229]
    v_pk_mul_f32 v[66:67], v[66:67], v[230:231]
    v_pk_mul_f32 v[68:69], v[68:69], v[232:233]
    v_pk_mul_f32 v[70:71], v[70:71], v[234:235]
    v_cvt_pk_bf16_f32 v64, v64, v65
    v_cvt_pk_bf16_f32 v65, v66, v67
    v_cvt_pk_bf16_f32 v66, v68, v69
    v_cvt_pk_bf16_f32 v67, v70, v71
    v_pk_mul_f32 v[80:81], v[80:81], v[228:229]
    v_pk_mul_f32 v[82:83], v[82:83], v[230:231]
    v_pk_mul_f32 v[84:85], v[84:85], v[232:233]
    v_pk_mul_f32 v[86:87], v[86:87], v[234:235]
    v_cvt_pk_bf16_f32 v80, v80, v81
    v_cvt_pk_bf16_f32 v81, v82, v83
    v_cvt_pk_bf16_f32 v82, v84, v85
    v_cvt_pk_bf16_f32 v83, v86, v87
    v_pk_mul_f32 v[96:97], v[96:97], v[228:229]
    v_pk_mul_f32 v[98:99], v[98:99], v[230:231]
    v_pk_mul_f32 v[100:101], v[100:101], v[232:233]
    v_pk_mul_f32 v[102:103], v[102:103], v[234:235]
    v_cvt_pk_bf16_f32 v96, v96, v97
    v_cvt_pk_bf16_f32 v97, v98, v99
    v_cvt_pk_bf16_f32 v98, v100, v101
    v_cvt_pk_bf16_f32 v99, v102, v103
    v_pk_mul_f32 v[112:113], v[112:113], v[228:229]
    v_pk_mul_f32 v[114:115], v[114:115], v[230:231]
    v_pk_mul_f32 v[116:117], v[116:117], v[232:233]
    v_pk_mul_f32 v[118:119], v[118:119], v[234:235]
    v_cvt_pk_bf16_f32 v112, v112, v113
    v_cvt_pk_bf16_f32 v113, v114, v115
    v_cvt_pk_bf16_f32 v114, v116, v117
    v_cvt_pk_bf16_f32 v115, v118, v119
    v_pk_mul_f32 v[212:213], v[0:1], v[220:221]
    v_pk_mul_f32 v[214:215], v[2:3], v[222:223]
    v_pk_mul_f32 v[216:217], v[4:5], v[224:225]
    v_pk_mul_f32 v[218:219], v[6:7], v[226:227]
    v_pk_fma_f32 v[0:1], v[0:1], v[228:229], 1.0 op_sel_hi:[1,1,0]
    v_pk_fma_f32 v[2:3], v[2:3], v[230:231], 1.0 op_sel_hi:[1,1,0]
    v_pk_fma_f32 v[4:5], v[4:5], v[232:233], 1.0 op_sel_hi:[1,1,0]
    v_pk_fma_f32 v[6:7], v[6:7], v[234:235], 1.0 op_sel_hi:[1,1,0]
    v_exp_f32 v212, v212 clamp
    v_exp_f32 v213, v213 clamp
    v_exp_f32 v214, v214 clamp
    v_exp_f32 v215, v215 clamp
    v_exp_f32 v216, v216 clamp
    v_exp_f32 v217, v217 clamp
    v_exp_f32 v218, v218 clamp
    v_exp_f32 v219, v219 clamp
    v_max_f32 v0, v0, v212
    v_max_f32 v1, v1, v213
    v_max_f32 v2, v2, v214
    v_max_f32 v3, v3, v215
    v_max_f32 v4, v4, v216
    v_max_f32 v5, v5, v217
    v_max_f32 v6, v6, v218
    v_max_f32 v7, v7, v219
    v_pk_add_f32 v[0:1], v[0:1], v[210:211] op_sel:[0,1] op_sel_hi:[1,1]
    v_pk_add_f32 v[2:3], v[2:3], v[210:211] op_sel:[0,1] op_sel_hi:[1,1]
    v_pk_add_f32 v[4:5], v[4:5], v[210:211] op_sel:[0,1] op_sel_hi:[1,1]
    v_pk_add_f32 v[6:7], v[6:7], v[210:211] op_sel:[0,1] op_sel_hi:[1,1]
    v_cvt_pk_bf16_f32 v0, v0, v1
    v_cvt_pk_bf16_f32 v1, v2, v3
    v_cvt_pk_bf16_f32 v2, v4, v5
    v_cvt_pk_bf16_f32 v3, v6, v7
    v_pk_mul_f32 v[212:213], v[16:17], v[220:221]
    v_pk_mul_f32 v[214:215], v[18:19], v[222:223]
    v_pk_mul_f32 v[216:217], v[20:21], v[224:225]
    v_pk_mul_f32 v[218:219], v[22:23], v[226:227]
    v_pk_fma_f32 v[16:17], v[16:17], v[228:229], 1.0 op_sel_hi:[1,1,0]
    v_pk_fma_f32 v[18:19], v[18:19], v[230:231], 1.0 op_sel_hi:[1,1,0]
    v_pk_fma_f32 v[20:21], v[20:21], v[232:233], 1.0 op_sel_hi:[1,1,0]
    v_pk_fma_f32 v[22:23], v[22:23], v[234:235], 1.0 op_sel_hi:[1,1,0]
    v_exp_f32 v212, v212 clamp
    v_exp_f32 v213, v213 clamp
    v_exp_f32 v214, v214 clamp
    v_exp_f32 v215, v215 clamp
    v_exp_f32 v216, v216 clamp
    v_exp_f32 v217, v217 clamp
    v_exp_f32 v218, v218 clamp
    v_exp_f32 v219, v219 clamp
    v_max_f32 v16, v16, v212
    v_max_f32 v17, v17, v213
    v_max_f32 v18, v18, v214
    v_max_f32 v19, v19, v215
    v_max_f32 v20, v20, v216
    v_max_f32 v21, v21, v217
    v_max_f32 v22, v22, v218
    v_max_f32 v23, v23, v219
    v_pk_add_f32 v[16:17], v[16:17], v[210:211] op_sel:[0,1] op_sel_hi:[1,1]
    v_pk_add_f32 v[18:19], v[18:19], v[210:211] op_sel:[0,1] op_sel_hi:[1,1]
    v_pk_add_f32 v[20:21], v[20:21], v[210:211] op_sel:[0,1] op_sel_hi:[1,1]
    v_pk_add_f32 v[22:23], v[22:23], v[210:211] op_sel:[0,1] op_sel_hi:[1,1]
    v_cvt_pk_bf16_f32 v16, v16, v17
    v_cvt_pk_bf16_f32 v17, v18, v19
    v_cvt_pk_bf16_f32 v18, v20, v21
    v_cvt_pk_bf16_f32 v19, v22, v23
    v_pk_mul_f32 v[212:213], v[32:33], v[220:221]
    v_pk_mul_f32 v[214:215], v[34:35], v[222:223]
    v_pk_mul_f32 v[216:217], v[36:37], v[224:225]
    v_pk_mul_f32 v[218:219], v[38:39], v[226:227]
    v_pk_fma_f32 v[32:33], v[32:33], v[228:229], 1.0 op_sel_hi:[1,1,0]
    v_pk_fma_f32 v[34:35], v[34:35], v[230:231], 1.0 op_sel_hi:[1,1,0]
    v_pk_fma_f32 v[36:37], v[36:37], v[232:233], 1.0 op_sel_hi:[1,1,0]
    v_pk_fma_f32 v[38:39], v[38:39], v[234:235], 1.0 op_sel_hi:[1,1,0]
    v_exp_f32 v212, v212 clamp
    v_exp_f32 v213, v213 clamp
    v_exp_f32 v214, v214 clamp
    v_exp_f32 v215, v215 clamp
    v_exp_f32 v216, v216 clamp
    v_exp_f32 v217, v217 clamp
    v_exp_f32 v218, v218 clamp
    v_exp_f32 v219, v219 clamp
    v_max_f32 v32, v32, v212
    v_max_f32 v33, v33, v213
    v_max_f32 v34, v34, v214
    v_max_f32 v35, v35, v215
    v_max_f32 v36, v36, v216
    v_max_f32 v37, v37, v217
    v_max_f32 v38, v38, v218
    v_max_f32 v39, v39, v219
    v_pk_add_f32 v[32:33], v[32:33], v[210:211] op_sel:[0,1] op_sel_hi:[1,1]
    v_pk_add_f32 v[34:35], v[34:35], v[210:211] op_sel:[0,1] op_sel_hi:[1,1]
    v_pk_add_f32 v[36:37], v[36:37], v[210:211] op_sel:[0,1] op_sel_hi:[1,1]
    v_pk_add_f32 v[38:39], v[38:39], v[210:211] op_sel:[0,1] op_sel_hi:[1,1]
    v_cvt_pk_bf16_f32 v32, v32, v33
    v_cvt_pk_bf16_f32 v33, v34, v35
    v_cvt_pk_bf16_f32 v34, v36, v37
    v_cvt_pk_bf16_f32 v35, v38, v39
    v_pk_mul_f32 v[212:213], v[48:49], v[220:221]
    v_pk_mul_f32 v[214:215], v[50:51], v[222:223]
    v_pk_mul_f32 v[216:217], v[52:53], v[224:225]
    v_pk_mul_f32 v[218:219], v[54:55], v[226:227]
    v_pk_fma_f32 v[48:49], v[48:49], v[228:229], 1.0 op_sel_hi:[1,1,0]
    v_pk_fma_f32 v[50:51], v[50:51], v[230:231], 1.0 op_sel_hi:[1,1,0]
    v_pk_fma_f32 v[52:53], v[52:53], v[232:233], 1.0 op_sel_hi:[1,1,0]
    v_pk_fma_f32 v[54:55], v[54:55], v[234:235], 1.0 op_sel_hi:[1,1,0]
    v_exp_f32 v212, v212 clamp
    v_exp_f32 v213, v213 clamp
    v_exp_f32 v214, v214 clamp
    v_exp_f32 v215, v215 clamp
    v_exp_f32 v216, v216 clamp
    v_exp_f32 v217, v217 clamp
    v_exp_f32 v218, v218 clamp
    v_exp_f32 v219, v219 clamp
    v_max_f32 v48, v48, v212
    v_max_f32 v49, v49, v213
    v_max_f32 v50, v50, v214
    v_max_f32 v51, v51, v215
    v_max_f32 v52, v52, v216
    v_max_f32 v53, v53, v217
    v_max_f32 v54, v54, v218
    v_max_f32 v55, v55, v219
    v_pk_add_f32 v[48:49], v[48:49], v[210:211] op_sel:[0,1] op_sel_hi:[1,1]
    v_pk_add_f32 v[50:51], v[50:51], v[210:211] op_sel:[0,1] op_sel_hi:[1,1]
    v_pk_add_f32 v[52:53], v[52:53], v[210:211] op_sel:[0,1] op_sel_hi:[1,1]
    v_pk_add_f32 v[54:55], v[54:55], v[210:211] op_sel:[0,1] op_sel_hi:[1,1]
    v_cvt_pk_bf16_f32 v48, v48, v49
    v_cvt_pk_bf16_f32 v49, v50, v51
    v_cvt_pk_bf16_f32 v50, v52, v53
    v_cvt_pk_bf16_f32 v51, v54, v55
    v_pk_mul_f32 v[220:221], v[236:237], v[210:211] op_sel_hi:[1,0]
    v_pk_mul_f32 v[222:223], v[238:239], v[210:211] op_sel_hi:[1,0]
    v_pk_mul_f32 v[224:225], v[240:241], v[210:211] op_sel_hi:[1,0]
    v_pk_mul_f32 v[226:227], v[242:243], v[210:211] op_sel_hi:[1,0]
    v_pk_mul_f32 v[72:73], v[72:73], v[236:237]
    v_pk_mul_f32 v[74:75], v[74:75], v[238:239]
    v_pk_mul_f32 v[76:77], v[76:77], v[240:241]
    v_pk_mul_f32 v[78:79], v[78:79], v[242:243]
    v_cvt_pk_bf16_f32 v72, v72, v73
    v_cvt_pk_bf16_f32 v73, v74, v75
    v_cvt_pk_bf16_f32 v74, v76, v77
    v_cvt_pk_bf16_f32 v75, v78, v79
    v_pk_mul_f32 v[88:89], v[88:89], v[236:237]
    v_pk_mul_f32 v[90:91], v[90:91], v[238:239]
    v_pk_mul_f32 v[92:93], v[92:93], v[240:241]
    v_pk_mul_f32 v[94:95], v[94:95], v[242:243]
    v_cvt_pk_bf16_f32 v88, v88, v89
    v_cvt_pk_bf16_f32 v89, v90, v91
    v_cvt_pk_bf16_f32 v90, v92, v93
    v_cvt_pk_bf16_f32 v91, v94, v95
    v_pk_mul_f32 v[104:105], v[104:105], v[236:237]
    v_pk_mul_f32 v[106:107], v[106:107], v[238:239]
    v_pk_mul_f32 v[108:109], v[108:109], v[240:241]
    v_pk_mul_f32 v[110:111], v[110:111], v[242:243]
    v_cvt_pk_bf16_f32 v104, v104, v105
    v_cvt_pk_bf16_f32 v105, v106, v107
    v_cvt_pk_bf16_f32 v106, v108, v109
    v_cvt_pk_bf16_f32 v107, v110, v111
    v_pk_mul_f32 v[120:121], v[120:121], v[236:237]
    v_pk_mul_f32 v[122:123], v[122:123], v[238:239]
    v_pk_mul_f32 v[124:125], v[124:125], v[240:241]
    v_pk_mul_f32 v[126:127], v[126:127], v[242:243]
    v_cvt_pk_bf16_f32 v120, v120, v121
    v_cvt_pk_bf16_f32 v121, v122, v123
    v_cvt_pk_bf16_f32 v122, v124, v125
    v_cvt_pk_bf16_f32 v123, v126, v127
    v_pk_mul_f32 v[212:213], v[8:9], v[220:221]
    v_pk_mul_f32 v[214:215], v[10:11], v[222:223]
    v_pk_mul_f32 v[216:217], v[12:13], v[224:225]
    v_pk_mul_f32 v[218:219], v[14:15], v[226:227]
    v_pk_fma_f32 v[8:9], v[8:9], v[236:237], 1.0 op_sel_hi:[1,1,0]
    v_pk_fma_f32 v[10:11], v[10:11], v[238:239], 1.0 op_sel_hi:[1,1,0]
    v_pk_fma_f32 v[12:13], v[12:13], v[240:241], 1.0 op_sel_hi:[1,1,0]
    v_pk_fma_f32 v[14:15], v[14:15], v[242:243], 1.0 op_sel_hi:[1,1,0]
    v_exp_f32 v212, v212 clamp
    v_exp_f32 v213, v213 clamp
    v_exp_f32 v214, v214 clamp
    v_exp_f32 v215, v215 clamp
    v_exp_f32 v216, v216 clamp
    v_exp_f32 v217, v217 clamp
    v_exp_f32 v218, v218 clamp
    v_exp_f32 v219, v219 clamp
    v_max_f32 v8, v8, v212
    v_max_f32 v9, v9, v213
    v_max_f32 v10, v10, v214
    v_max_f32 v11, v11, v215
    v_max_f32 v12, v12, v216
    v_max_f32 v13, v13, v217
    v_max_f32 v14, v14, v218
    v_max_f32 v15, v15, v219
    v_pk_add_f32 v[8:9], v[8:9], v[210:211] op_sel:[0,1] op_sel_hi:[1,1]
    v_pk_add_f32 v[10:11], v[10:11], v[210:211] op_sel:[0,1] op_sel_hi:[1,1]
    v_pk_add_f32 v[12:13], v[12:13], v[210:211] op_sel:[0,1] op_sel_hi:[1,1]
    v_pk_add_f32 v[14:15], v[14:15], v[210:211] op_sel:[0,1] op_sel_hi:[1,1]
    v_cvt_pk_bf16_f32 v8, v8, v9
    v_cvt_pk_bf16_f32 v9, v10, v11
    v_cvt_pk_bf16_f32 v10, v12, v13
    v_cvt_pk_bf16_f32 v11, v14, v15
    v_pk_mul_f32 v[212:213], v[24:25], v[220:221]
    v_pk_mul_f32 v[214:215], v[26:27], v[222:223]
    v_pk_mul_f32 v[216:217], v[28:29], v[224:225]
    v_pk_mul_f32 v[218:219], v[30:31], v[226:227]
    v_pk_fma_f32 v[24:25], v[24:25], v[236:237], 1.0 op_sel_hi:[1,1,0]
    v_pk_fma_f32 v[26:27], v[26:27], v[238:239], 1.0 op_sel_hi:[1,1,0]
    v_pk_fma_f32 v[28:29], v[28:29], v[240:241], 1.0 op_sel_hi:[1,1,0]
    v_pk_fma_f32 v[30:31], v[30:31], v[242:243], 1.0 op_sel_hi:[1,1,0]
    v_exp_f32 v212, v212 clamp
    v_exp_f32 v213, v213 clamp
    v_exp_f32 v214, v214 clamp
    v_exp_f32 v215, v215 clamp
    v_exp_f32 v216, v216 clamp
    v_exp_f32 v217, v217 clamp
    v_exp_f32 v218, v218 clamp
    v_exp_f32 v219, v219 clamp
    v_max_f32 v24, v24, v212
    v_max_f32 v25, v25, v213
    v_max_f32 v26, v26, v214
    v_max_f32 v27, v27, v215
    v_max_f32 v28, v28, v216
    v_max_f32 v29, v29, v217
    v_max_f32 v30, v30, v218
    v_max_f32 v31, v31, v219
    v_pk_add_f32 v[24:25], v[24:25], v[210:211] op_sel:[0,1] op_sel_hi:[1,1]
    v_pk_add_f32 v[26:27], v[26:27], v[210:211] op_sel:[0,1] op_sel_hi:[1,1]
    v_pk_add_f32 v[28:29], v[28:29], v[210:211] op_sel:[0,1] op_sel_hi:[1,1]
    v_pk_add_f32 v[30:31], v[30:31], v[210:211] op_sel:[0,1] op_sel_hi:[1,1]
    v_cvt_pk_bf16_f32 v24, v24, v25
    v_cvt_pk_bf16_f32 v25, v26, v27
    v_cvt_pk_bf16_f32 v26, v28, v29
    v_cvt_pk_bf16_f32 v27, v30, v31
    v_pk_mul_f32 v[212:213], v[40:41], v[220:221]
    v_pk_mul_f32 v[214:215], v[42:43], v[222:223]
    v_pk_mul_f32 v[216:217], v[44:45], v[224:225]
    v_pk_mul_f32 v[218:219], v[46:47], v[226:227]
    v_pk_fma_f32 v[40:41], v[40:41], v[236:237], 1.0 op_sel_hi:[1,1,0]
    v_pk_fma_f32 v[42:43], v[42:43], v[238:239], 1.0 op_sel_hi:[1,1,0]
    v_pk_fma_f32 v[44:45], v[44:45], v[240:241], 1.0 op_sel_hi:[1,1,0]
    v_pk_fma_f32 v[46:47], v[46:47], v[242:243], 1.0 op_sel_hi:[1,1,0]
    v_exp_f32 v212, v212 clamp
    v_exp_f32 v213, v213 clamp
    v_exp_f32 v214, v214 clamp
    v_exp_f32 v215, v215 clamp
    v_exp_f32 v216, v216 clamp
    v_exp_f32 v217, v217 clamp
    v_exp_f32 v218, v218 clamp
    v_exp_f32 v219, v219 clamp
    v_max_f32 v40, v40, v212
    v_max_f32 v41, v41, v213
    v_max_f32 v42, v42, v214
    v_max_f32 v43, v43, v215
    v_max_f32 v44, v44, v216
    v_max_f32 v45, v45, v217
    v_max_f32 v46, v46, v218
    v_max_f32 v47, v47, v219
    v_pk_add_f32 v[40:41], v[40:41], v[210:211] op_sel:[0,1] op_sel_hi:[1,1]
    v_pk_add_f32 v[42:43], v[42:43], v[210:211] op_sel:[0,1] op_sel_hi:[1,1]
    v_pk_add_f32 v[44:45], v[44:45], v[210:211] op_sel:[0,1] op_sel_hi:[1,1]
    v_pk_add_f32 v[46:47], v[46:47], v[210:211] op_sel:[0,1] op_sel_hi:[1,1]
    v_cvt_pk_bf16_f32 v40, v40, v41
    v_cvt_pk_bf16_f32 v41, v42, v43
    v_cvt_pk_bf16_f32 v42, v44, v45
    v_cvt_pk_bf16_f32 v43, v46, v47
    v_pk_mul_f32 v[212:213], v[56:57], v[220:221]
    v_pk_mul_f32 v[214:215], v[58:59], v[222:223]
    v_pk_mul_f32 v[216:217], v[60:61], v[224:225]
    v_pk_mul_f32 v[218:219], v[62:63], v[226:227]
    v_pk_fma_f32 v[56:57], v[56:57], v[236:237], 1.0 op_sel_hi:[1,1,0]
    v_pk_fma_f32 v[58:59], v[58:59], v[238:239], 1.0 op_sel_hi:[1,1,0]
    v_pk_fma_f32 v[60:61], v[60:61], v[240:241], 1.0 op_sel_hi:[1,1,0]
    v_pk_fma_f32 v[62:63], v[62:63], v[242:243], 1.0 op_sel_hi:[1,1,0]
    v_exp_f32 v212, v212 clamp
    v_exp_f32 v213, v213 clamp
    v_exp_f32 v214, v214 clamp
    v_exp_f32 v215, v215 clamp
    v_exp_f32 v216, v216 clamp
    v_exp_f32 v217, v217 clamp
    v_exp_f32 v218, v218 clamp
    v_exp_f32 v219, v219 clamp
    v_max_f32 v56, v56, v212
    v_max_f32 v57, v57, v213
    v_max_f32 v58, v58, v214
    v_max_f32 v59, v59, v215
    v_max_f32 v60, v60, v216
    v_max_f32 v61, v61, v217
    v_max_f32 v62, v62, v218
    v_max_f32 v63, v63, v219
    v_pk_add_f32 v[56:57], v[56:57], v[210:211] op_sel:[0,1] op_sel_hi:[1,1]
    v_pk_add_f32 v[58:59], v[58:59], v[210:211] op_sel:[0,1] op_sel_hi:[1,1]
    v_pk_add_f32 v[60:61], v[60:61], v[210:211] op_sel:[0,1] op_sel_hi:[1,1]
    v_pk_add_f32 v[62:63], v[62:63], v[210:211] op_sel:[0,1] op_sel_hi:[1,1]
    v_cvt_pk_bf16_f32 v56, v56, v57
    v_cvt_pk_bf16_f32 v57, v58, v59
    v_cvt_pk_bf16_f32 v58, v60, v61
    v_cvt_pk_bf16_f32 v59, v62, v63
    v_mov_b32 v100, 0x3f803f80
    v_mov_b32 v101, 0x3f803f80
    v_mov_b32 v102, 0x3f803f80
    v_mov_b32 v103, 0x3f803f80
    s_nop 1
    v_mfma_f32_16x16x32_bf16 v[4:7], v[0:3], v[64:67], 0
    v_mfma_f32_16x16x32_bf16 v[12:15], v[0:3], v[80:83], 0
    v_mfma_f32_16x16x32_bf16 v[20:23], v[0:3], v[100:103], 0
    v_mfma_f32_16x16x32_bf16 v[28:31], v[16:19], v[64:67], 0
    v_mfma_f32_16x16x32_bf16 v[36:39], v[16:19], v[80:83], 0
    v_mfma_f32_16x16x32_bf16 v[44:47], v[16:19], v[100:103], 0
    v_mfma_f32_16x16x32_bf16 v[52:55], v[32:35], v[96:99], 0
    v_mfma_f32_16x16x32_bf16 v[60:63], v[32:35], v[112:115], 0
    v_mfma_f32_16x16x32_bf16 v[68:71], v[32:35], v[100:103], 0
    v_mfma_f32_16x16x32_bf16 v[76:79], v[48:51], v[96:99], 0
    v_mfma_f32_16x16x32_bf16 v[84:87], v[48:51], v[112:115], 0
    v_mfma_f32_16x16x32_bf16 v[92:95], v[48:51], v[100:103], 0
    v_mfma_f32_16x16x32_bf16 v[4:7], v[8:11], v[72:75], v[4:7]
    v_mfma_f32_16x16x32_bf16 v[12:15], v[8:11], v[88:91], v[12:15]
    v_mfma_f32_16x16x32_bf16 v[20:23], v[8:11], v[100:103], v[20:23]
    v_mfma_f32_16x16x32_bf16 v[28:31], v[24:27], v[72:75], v[28:31]
    v_mfma_f32_16x16x32_bf16 v[36:39], v[24:27], v[88:91], v[36:39]
    v_mfma_f32_16x16x32_bf16 v[44:47], v[24:27], v[100:103], v[44:47]
    v_mfma_f32_16x16x32_bf16 v[52:55], v[40:43], v[104:107], v[52:55]
    v_mfma_f32_16x16x32_bf16 v[60:63], v[40:43], v[120:123], v[60:63]
    v_mfma_f32_16x16x32_bf16 v[68:71], v[40:43], v[100:103], v[68:71]
    v_mfma_f32_16x16x32_bf16 v[76:79], v[56:59], v[104:107], v[76:79]
    v_mfma_f32_16x16x32_bf16 v[84:87], v[56:59], v[120:123], v[84:87]
    v_mfma_f32_16x16x32_bf16 v[92:95], v[56:59], v[100:103], v[92:95]
    s_mul_i32 s34, s29, 24576
    s_add_u32 s34, s34, 54272
    v_add_u32 v248, s34, v244
    s_mul_i32 s34, s29, 3072
    s_add_u32 s34, s34, 54272
    v_add_u32 v249, s34, v244
    v_add_u32 v250, 49152, v249
    s_nop 1
    ds_write_b128 v248, v[4:7] offset:0
    ds_write_b128 v248, v[12:15] offset:1024
    ds_write_b128 v248, v[20:23] offset:2048
    ds_write_b128 v248, v[28:31] offset:3072
    ds_write_b128 v248, v[36:39] offset:4096
    ds_write_b128 v248, v[44:47] offset:5120
    ds_write_b128 v248, v[52:55] offset:6144
    ds_write_b128 v248, v[60:63] offset:7168
    ds_write_b128 v248, v[68:71] offset:8192
    ds_write_b128 v248, v[76:79] offset:9216
    ds_write_b128 v248, v[84:87] offset:10240
    ds_write_b128 v248, v[92:95] offset:11264
    s_waitcnt lgkmcnt(0)
    s_barrier
    ds_read_b128 v[0:3], v249 offset:0
    ds_read_b128 v[16:19], v249 offset:24576
    ds_read_b128 v[32:35], v250 offset:0
    ds_read_b128 v[48:51], v250 offset:24576
    ds_read_b128 v[64:67], v249 offset:1024
    ds_read_b128 v[80:83], v249 offset:25600
    ds_read_b128 v[96:99], v250 offset:1024
    ds_read_b128 v[112:115], v250 offset:25600
    ds_read_b128 v[8:11], v249 offset:2048
    ds_read_b128 v[24:27], v249 offset:26624
    ds_read_b128 v[40:43], v250 offset:2048
    ds_read_b128 v[56:59], v250 offset:26624
    s_lshl_b32 s34, s30, 5
    s_lshl_b32 s35, s32, 1
    s_add_u32 s34, s34, s35
    s_mul_i32 s34, s34, 6
    s_mul_i32 s35, s29, 3
    s_add_u32 s34, s34, s35
    s_lshl_b32 s34, s34, 10
    s_add_u32 s34, s34, 37748736
    s_waitcnt lgkmcnt(8)
    v_pk_add_f32 v[0:1], v[0:1], v[16:17]
    v_pk_add_f32 v[32:33], v[32:33], v[48:49]
    v_pk_add_f32 v[2:3], v[2:3], v[18:19]
    v_pk_add_f32 v[34:35], v[34:35], v[50:51]
    v_pk_add_f32 v[0:1], v[0:1], v[32:33]
    v_pk_add_f32 v[2:3], v[2:3], v[34:35]
    buffer_store_dwordx4 v[0:3], v244, s[16:19], s34 offen offset:0
    s_waitcnt lgkmcnt(4)
    v_pk_add_f32 v[64:65], v[64:65], v[80:81]
    v_pk_add_f32 v[96:97], v[96:97], v[112:113]
    v_pk_add_f32 v[66:67], v[66:67], v[82:83]
    v_pk_add_f32 v[98:99], v[98:99], v[114:115]
    v_pk_add_f32 v[64:65], v[64:65], v[96:97]
    v_pk_add_f32 v[66:67], v[66:67], v[98:99]
    buffer_store_dwordx4 v[64:67], v244, s[16:19], s34 offen offset:1024
    s_waitcnt lgkmcnt(0)
    v_pk_add_f32 v[8:9], v[8:9], v[24:25]
    v_pk_add_f32 v[40:41], v[40:41], v[56:57]
    v_pk_add_f32 v[10:11], v[10:11], v[26:27]
    v_pk_add_f32 v[42:43], v[42:43], v[58:59]
    v_pk_add_f32 v[8:9], v[8:9], v[40:41]
    v_pk_add_f32 v[10:11], v[10:11], v[42:43]
    buffer_store_dwordx4 v[8:11], v244, s[16:19], s34 offen offset:2048
    s_branch k1_kernel_E_done
k1_kernel_E_z2:
    s_lshl_b32 s34, s30, 4
    s_lshl_b32 s35, s29, 2
    s_add_u32 s34, s34, s35
    s_mul_i32 s34, s34, 56
    s_add_u32 s34, s34, s36
    s_lshl_b32 s34, s34, 10
    s_add_u32 s60, s34, 20971520
    s_add_u32 s61, s60, 57344
    s_add_u32 s62, s60, 114688
    s_add_u32 s63, s60, 172032
    v_pk_mul_f32 v[212:213], v[128:129], v[128:129]
    v_pk_mul_f32 v[214:215], v[130:131], v[130:131]
    v_pk_mul_f32 v[216:217], v[144:145], v[144:145]
    v_pk_mul_f32 v[218:219], v[146:147], v[146:147]
    v_pk_fma_f32 v[212:213], v[212:213], v[220:221], v[220:221] op_sel:[0,0,1] op_sel_hi:[1,0,1]
    v_pk_fma_f32 v[214:215], v[214:215], v[220:221], v[220:221] op_sel:[0,0,1] op_sel_hi:[1,0,1]
    v_pk_fma_f32 v[216:217], v[216:217], v[220:221], v[220:221] op_sel:[0,0,1] op_sel_hi:[1,0,1]
    v_pk_fma_f32 v[218:219], v[218:219], v[220:221], v[220:221] op_sel:[0,0,1] op_sel_hi:[1,0,1]
    v_pk_mul_f32 v[212:213], v[212:213], v[128:129]
    v_pk_mul_f32 v[214:215], v[214:215], v[130:131]
    v_pk_mul_f32 v[216:217], v[216:217], v[144:145]
    v_pk_mul_f32 v[218:219], v[218:219], v[146:147]
    v_exp_f32 v212, v212
    v_exp_f32 v213, v213
    v_exp_f32 v214, v214
    v_exp_f32 v215, v215
    v_exp_f32 v216, v216
    v_exp_f32 v217, v217
    v_exp_f32 v218, v218
    v_exp_f32 v219, v219
    v_pk_fma_f32 v[212:213], v[212:213], v[208:209], v[208:209] op_sel:[0,0,0] op_sel_hi:[1,0,0]
    v_pk_fma_f32 v[214:215], v[214:215], v[208:209], v[208:209] op_sel:[0,0,0] op_sel_hi:[1,0,0]
    v_pk_fma_f32 v[216:217], v[216:217], v[208:209], v[208:209] op_sel:[0,0,0] op_sel_hi:[1,0,0]
    v_pk_fma_f32 v[218:219], v[218:219], v[208:209], v[208:209] op_sel:[0,0,0] op_sel_hi:[1,0,0]
    v_rcp_f32 v212, v212
    v_rcp_f32 v213, v213
    v_rcp_f32 v214, v214
    v_rcp_f32 v215, v215
    v_rcp_f32 v216, v216
    v_rcp_f32 v217, v217
    v_rcp_f32 v218, v218
    v_rcp_f32 v219, v219
    v_pk_mul_f32 v[128:129], v[128:129], v[212:213]
    v_pk_mul_f32 v[130:131], v[130:131], v[214:215]
    v_pk_mul_f32 v[144:145], v[144:145], v[216:217]
    v_pk_mul_f32 v[146:147], v[146:147], v[218:219]
    v_pk_mul_f32 v[236:237], v[128:129], v[128:129]
    v_pk_add_f32 v[228:229], v[128:129], v[130:131]
    v_pk_fma_f32 v[236:237], v[130:131], v[130:131], v[236:237]
    v_pk_add_f32 v[228:229], v[228:229], v[144:145]
    v_pk_fma_f32 v[236:237], v[144:145], v[144:145], v[236:237]
    v_pk_add_f32 v[228:229], v[228:229], v[146:147]
    v_pk_fma_f32 v[236:237], v[146:147], v[146:147], v[236:237]
    v_pk_mul_f32 v[212:213], v[132:133], v[132:133]
    v_pk_mul_f32 v[214:215], v[134:135], v[134:135]
    v_pk_mul_f32 v[216:217], v[148:149], v[148:149]
    v_pk_mul_f32 v[218:219], v[150:151], v[150:151]
    v_pk_fma_f32 v[212:213], v[212:213], v[222:223], v[222:223] op_sel:[0,0,1] op_sel_hi:[1,0,1]
    v_pk_fma_f32 v[214:215], v[214:215], v[222:223], v[222:223] op_sel:[0,0,1] op_sel_hi:[1,0,1]
    v_pk_fma_f32 v[216:217], v[216:217], v[222:223], v[222:223] op_sel:[0,0,1] op_sel_hi:[1,0,1]
    v_pk_fma_f32 v[218:219], v[218:219], v[222:223], v[222:223] op_sel:[0,0,1] op_sel_hi:[1,0,1]
    v_pk_mul_f32 v[212:213], v[212:213], v[132:133]
    v_pk_mul_f32 v[214:215], v[214:215], v[134:135]
    v_pk_mul_f32 v[216:217], v[216:217], v[148:149]
    v_pk_mul_f32 v[218:219], v[218:219], v[150:151]
    v_exp_f32 v212, v212
    v_exp_f32 v213, v213
    v_exp_f32 v214, v214
    v_exp_f32 v215, v215
    v_exp_f32 v216, v216
    v_exp_f32 v217, v217
    v_exp_f32 v218, v218
    v_exp_f32 v219, v219
    v_pk_fma_f32 v[212:213], v[212:213], v[208:209], v[208:209] op_sel:[0,1,1] op_sel_hi:[1,1,1]
    v_pk_fma_f32 v[214:215], v[214:215], v[208:209], v[208:209] op_sel:[0,1,1] op_sel_hi:[1,1,1]
    v_pk_fma_f32 v[216:217], v[216:217], v[208:209], v[208:209] op_sel:[0,1,1] op_sel_hi:[1,1,1]
    v_pk_fma_f32 v[218:219], v[218:219], v[208:209], v[208:209] op_sel:[0,1,1] op_sel_hi:[1,1,1]
    v_rcp_f32 v212, v212
    v_rcp_f32 v213, v213
    v_rcp_f32 v214, v214
    v_rcp_f32 v215, v215
    v_rcp_f32 v216, v216
    v_rcp_f32 v217, v217
    v_rcp_f32 v218, v218
    v_rcp_f32 v219, v219
    v_pk_mul_f32 v[132:133], v[132:133], v[212:213]
    v_pk_mul_f32 v[134:135], v[134:135], v[214:215]
    v_pk_mul_f32 v[148:149], v[148:149], v[216:217]
    v_pk_mul_f32 v[150:151], v[150:151], v[218:219]
    v_pk_mul_f32 v[238:239], v[132:133], v[132:133]
    v_pk_add_f32 v[230:231], v[132:133], v[134:135]
    v_pk_fma_f32 v[238:239], v[134:135], v[134:135], v[238:239]
    v_pk_add_f32 v[230:231], v[230:231], v[148:149]
    v_pk_fma_f32 v[238:239], v[148:149], v[148:149], v[238:239]
    v_pk_add_f32 v[230:231], v[230:231], v[150:151]
    v_pk_fma_f32 v[238:239], v[150:151], v[150:151], v[238:239]
    v_pk_mul_f32 v[212:213], v[136:137], v[136:137]
    v_pk_mul_f32 v[214:215], v[138:139], v[138:139]
    v_pk_mul_f32 v[216:217], v[152:153], v[152:153]
    v_pk_mul_f32 v[218:219], v[154:155], v[154:155]
    v_pk_fma_f32 v[212:213], v[212:213], v[224:225], v[224:225] op_sel:[0,0,1] op_sel_hi:[1,0,1]
    v_pk_fma_f32 v[214:215], v[214:215], v[224:225], v[224:225] op_sel:[0,0,1] op_sel_hi:[1,0,1]
    v_pk_fma_f32 v[216:217], v[216:217], v[224:225], v[224:225] op_sel:[0,0,1] op_sel_hi:[1,0,1]
    v_pk_fma_f32 v[218:219], v[218:219], v[224:225], v[224:225] op_sel:[0,0,1] op_sel_hi:[1,0,1]
    v_pk_mul_f32 v[212:213], v[212:213], v[136:137]
    v_pk_mul_f32 v[214:215], v[214:215], v[138:139]
    v_pk_mul_f32 v[216:217], v[216:217], v[152:153]
    v_pk_mul_f32 v[218:219], v[218:219], v[154:155]
    v_exp_f32 v212, v212
    v_exp_f32 v213, v213
    v_exp_f32 v214, v214
    v_exp_f32 v215, v215
    v_exp_f32 v216, v216
    v_exp_f32 v217, v217
    v_exp_f32 v218, v218
    v_exp_f32 v219, v219
    v_pk_fma_f32 v[212:213], v[212:213], v[252:253], v[252:253] op_sel:[0,0,0] op_sel_hi:[1,0,0]
    v_pk_fma_f32 v[214:215], v[214:215], v[252:253], v[252:253] op_sel:[0,0,0] op_sel_hi:[1,0,0]
    v_pk_fma_f32 v[216:217], v[216:217], v[252:253], v[252:253] op_sel:[0,0,0] op_sel_hi:[1,0,0]
    v_pk_fma_f32 v[218:219], v[218:219], v[252:253], v[252:253] op_sel:[0,0,0] op_sel_hi:[1,0,0]
    v_rcp_f32 v212, v212
    v_rcp_f32 v213, v213
    v_rcp_f32 v214, v214
    v_rcp_f32 v215, v215
    v_rcp_f32 v216, v216
    v_rcp_f32 v217, v217
    v_rcp_f32 v218, v218
    v_rcp_f32 v219, v219
    v_pk_mul_f32 v[136:137], v[136:137], v[212:213]
    v_pk_mul_f32 v[138:139], v[138:139], v[214:215]
    v_pk_mul_f32 v[152:153], v[152:153], v[216:217]
    v_pk_mul_f32 v[154:155], v[154:155], v[218:219]
    v_pk_mul_f32 v[240:241], v[136:137], v[136:137]
    v_pk_add_f32 v[232:233], v[136:137], v[138:139]
    v_pk_fma_f32 v[240:241], v[138:139], v[138:139], v[240:241]
    v_pk_add_f32 v[232:233], v[232:233], v[152:153]
    v_pk_fma_f32 v[240:241], v[152:153], v[152:153], v[240:241]
    v_pk_add_f32 v[232:233], v[232:233], v[154:155]
    v_pk_fma_f32 v[240:241], v[154:155], v[154:155], v[240:241]
    v_pk_mul_f32 v[212:213], v[140:141], v[140:141]
    v_pk_mul_f32 v[214:215], v[142:143], v[142:143]
    v_pk_mul_f32 v[216:217], v[156:157], v[156:157]
    v_pk_mul_f32 v[218:219], v[158:159], v[158:159]
    v_pk_fma_f32 v[212:213], v[212:213], v[226:227], v[226:227] op_sel:[0,0,1] op_sel_hi:[1,0,1]
    v_pk_fma_f32 v[214:215], v[214:215], v[226:227], v[226:227] op_sel:[0,0,1] op_sel_hi:[1,0,1]
    v_pk_fma_f32 v[216:217], v[216:217], v[226:227], v[226:227] op_sel:[0,0,1] op_sel_hi:[1,0,1]
    v_pk_fma_f32 v[218:219], v[218:219], v[226:227], v[226:227] op_sel:[0,0,1] op_sel_hi:[1,0,1]
    v_pk_mul_f32 v[212:213], v[212:213], v[140:141]
    v_pk_mul_f32 v[214:215], v[214:215], v[142:143]
    v_pk_mul_f32 v[216:217], v[216:217], v[156:157]
    v_pk_mul_f32 v[218:219], v[218:219], v[158:159]
    v_exp_f32 v212, v212
    v_exp_f32 v213, v213
    v_exp_f32 v214, v214
    v_exp_f32 v215, v215
    v_exp_f32 v216, v216
    v_exp_f32 v217, v217
    v_exp_f32 v218, v218
    v_exp_f32 v219, v219
    v_pk_fma_f32 v[212:213], v[212:213], v[252:253], v[252:253] op_sel:[0,1,1] op_sel_hi:[1,1,1]
    v_pk_fma_f32 v[214:215], v[214:215], v[252:253], v[252:253] op_sel:[0,1,1] op_sel_hi:[1,1,1]
    v_pk_fma_f32 v[216:217], v[216:217], v[252:253], v[252:253] op_sel:[0,1,1] op_sel_hi:[1,1,1]
    v_pk_fma_f32 v[218:219], v[218:219], v[252:253], v[252:253] op_sel:[0,1,1] op_sel_hi:[1,1,1]
    v_rcp_f32 v212, v212
    v_rcp_f32 v213, v213
    v_rcp_f32 v214, v214
    v_rcp_f32 v215, v215
    v_rcp_f32 v216, v216
    v_rcp_f32 v217, v217
    v_rcp_f32 v218, v218
    v_rcp_f32 v219, v219
    v_pk_mul_f32 v[140:141], v[140:141], v[212:213]
    v_pk_mul_f32 v[142:143], v[142:143], v[214:215]
    v_pk_mul_f32 v[156:157], v[156:157], v[216:217]
    v_pk_mul_f32 v[158:159], v[158:159], v[218:219]
    v_pk_mul_f32 v[242:243], v[140:141], v[140:141]
    v_pk_add_f32 v[234:235], v[140:141], v[142:143]
    v_pk_fma_f32 v[242:243], v[142:143], v[142:143], v[242:243]
    v_pk_add_f32 v[234:235], v[234:235], v[156:157]
    v_pk_fma_f32 v[242:243], v[156:157], v[156:157], v[242:243]
    v_pk_add_f32 v[234:235], v[234:235], v[158:159]
    v_pk_fma_f32 v[242:243], v[158:159], v[158:159], v[242:243]
    v_pk_mul_f32 v[212:213], v[160:161], v[160:161]
    v_pk_mul_f32 v[214:215], v[162:163], v[162:163]
    v_pk_mul_f32 v[216:217], v[176:177], v[176:177]
    v_pk_mul_f32 v[218:219], v[178:179], v[178:179]
    v_pk_fma_f32 v[212:213], v[212:213], v[220:221], v[220:221] op_sel:[0,0,1] op_sel_hi:[1,0,1]
    v_pk_fma_f32 v[214:215], v[214:215], v[220:221], v[220:221] op_sel:[0,0,1] op_sel_hi:[1,0,1]
    v_pk_fma_f32 v[216:217], v[216:217], v[220:221], v[220:221] op_sel:[0,0,1] op_sel_hi:[1,0,1]
    v_pk_fma_f32 v[218:219], v[218:219], v[220:221], v[220:221] op_sel:[0,0,1] op_sel_hi:[1,0,1]
    v_pk_mul_f32 v[212:213], v[212:213], v[160:161]
    v_pk_mul_f32 v[214:215], v[214:215], v[162:163]
    v_pk_mul_f32 v[216:217], v[216:217], v[176:177]
    v_pk_mul_f32 v[218:219], v[218:219], v[178:179]
    v_exp_f32 v212, v212
    v_exp_f32 v213, v213
    v_exp_f32 v214, v214
    v_exp_f32 v215, v215
    v_exp_f32 v216, v216
    v_exp_f32 v217, v217
    v_exp_f32 v218, v218
    v_exp_f32 v219, v219
    v_pk_fma_f32 v[212:213], v[212:213], v[208:209], v[208:209] op_sel:[0,0,0] op_sel_hi:[1,0,0]
    v_pk_fma_f32 v[214:215], v[214:215], v[208:209], v[208:209] op_sel:[0,0,0] op_sel_hi:[1,0,0]
    v_pk_fma_f32 v[216:217], v[216:217], v[208:209], v[208:209] op_sel:[0,0,0] op_sel_hi:[1,0,0]
    v_pk_fma_f32 v[218:219], v[218:219], v[208:209], v[208:209] op_sel:[0,0,0] op_sel_hi:[1,0,0]
    v_rcp_f32 v212, v212
    v_rcp_f32 v213, v213
    v_rcp_f32 v214, v214
    v_rcp_f32 v215, v215
    v_rcp_f32 v216, v216
    v_rcp_f32 v217, v217
    v_rcp_f32 v218, v218
    v_rcp_f32 v219, v219
    v_pk_mul_f32 v[160:161], v[160:161], v[212:213]
    v_pk_mul_f32 v[162:163], v[162:163], v[214:215]
    v_pk_mul_f32 v[176:177], v[176:177], v[216:217]
    v_pk_mul_f32 v[178:179], v[178:179], v[218:219]
    v_pk_add_f32 v[228:229], v[228:229], v[160:161]
    v_pk_fma_f32 v[236:237], v[160:161], v[160:161], v[236:237]
    v_pk_add_f32 v[228:229], v[228:229], v[162:163]
    v_pk_fma_f32 v[236:237], v[162:163], v[162:163], v[236:237]
    v_pk_add_f32 v[228:229], v[228:229], v[176:177]
    v_pk_fma_f32 v[236:237], v[176:177], v[176:177], v[236:237]
    v_pk_add_f32 v[228:229], v[228:229], v[178:179]
    v_pk_fma_f32 v[236:237], v[178:179], v[178:179], v[236:237]
    v_pk_mul_f32 v[212:213], v[164:165], v[164:165]
    v_pk_mul_f32 v[214:215], v[166:167], v[166:167]
    v_pk_mul_f32 v[216:217], v[180:181], v[180:181]
    v_pk_mul_f32 v[218:219], v[182:183], v[182:183]
    v_pk_fma_f32 v[212:213], v[212:213], v[222:223], v[222:223] op_sel:[0,0,1] op_sel_hi:[1,0,1]
    v_pk_fma_f32 v[214:215], v[214:215], v[222:223], v[222:223] op_sel:[0,0,1] op_sel_hi:[1,0,1]
    v_pk_fma_f32 v[216:217], v[216:217], v[222:223], v[222:223] op_sel:[0,0,1] op_sel_hi:[1,0,1]
    v_pk_fma_f32 v[218:219], v[218:219], v[222:223], v[222:223] op_sel:[0,0,1] op_sel_hi:[1,0,1]
    v_pk_mul_f32 v[212:213], v[212:213], v[164:165]
    v_pk_mul_f32 v[214:215], v[214:215], v[166:167]
    v_pk_mul_f32 v[216:217], v[216:217], v[180:181]
    v_pk_mul_f32 v[218:219], v[218:219], v[182:183]
    v_exp_f32 v212, v212
    v_exp_f32 v213, v213
    v_exp_f32 v214, v214
    v_exp_f32 v215, v215
    v_exp_f32 v216, v216
    v_exp_f32 v217, v217
    v_exp_f32 v218, v218
    v_exp_f32 v219, v219
    v_pk_fma_f32 v[212:213], v[212:213], v[208:209], v[208:209] op_sel:[0,1,1] op_sel_hi:[1,1,1]
    v_pk_fma_f32 v[214:215], v[214:215], v[208:209], v[208:209] op_sel:[0,1,1] op_sel_hi:[1,1,1]
    v_pk_fma_f32 v[216:217], v[216:217], v[208:209], v[208:209] op_sel:[0,1,1] op_sel_hi:[1,1,1]
    v_pk_fma_f32 v[218:219], v[218:219], v[208:209], v[208:209] op_sel:[0,1,1] op_sel_hi:[1,1,1]
    v_rcp_f32 v212, v212
    v_rcp_f32 v213, v213
    v_rcp_f32 v214, v214
    v_rcp_f32 v215, v215
    v_rcp_f32 v216, v216
    v_rcp_f32 v217, v217
    v_rcp_f32 v218, v218
    v_rcp_f32 v219, v219
    v_pk_mul_f32 v[164:165], v[164:165], v[212:213]
    v_pk_mul_f32 v[166:167], v[166:167], v[214:215]
    v_pk_mul_f32 v[180:181], v[180:181], v[216:217]
    v_pk_mul_f32 v[182:183], v[182:183], v[218:219]
    v_pk_add_f32 v[230:231], v[230:231], v[164:165]
    v_pk_fma_f32 v[238:239], v[164:165], v[164:165], v[238:239]
    v_pk_add_f32 v[230:231], v[230:231], v[166:167]
    v_pk_fma_f32 v[238:239], v[166:167], v[166:167], v[238:239]
    v_pk_add_f32 v[230:231], v[230:231], v[180:181]
    v_pk_fma_f32 v[238:239], v[180:181], v[180:181], v[238:239]
    v_pk_add_f32 v[230:231], v[230:231], v[182:183]
    v_pk_fma_f32 v[238:239], v[182:183], v[182:183], v[238:239]
    v_pk_mul_f32 v[212:213], v[168:169], v[168:169]
    v_pk_mul_f32 v[214:215], v[170:171], v[170:171]
    v_pk_mul_f32 v[216:217], v[184:185], v[184:185]
    v_pk_mul_f32 v[218:219], v[186:187], v[186:187]
    v_pk_fma_f32 v[212:213], v[212:213], v[224:225], v[224:225] op_sel:[0,0,1] op_sel_hi:[1,0,1]
    v_pk_fma_f32 v[214:215], v[214:215], v[224:225], v[224:225] op_sel:[0,0,1] op_sel_hi:[1,0,1]
    v_pk_fma_f32 v[216:217], v[216:217], v[224:225], v[224:225] op_sel:[0,0,1] op_sel_hi:[1,0,1]
    v_pk_fma_f32 v[218:219], v[218:219], v[224:225], v[224:225] op_sel:[0,0,1] op_sel_hi:[1,0,1]
    v_pk_mul_f32 v[212:213], v[212:213], v[168:169]
    v_pk_mul_f32 v[214:215], v[214:215], v[170:171]
    v_pk_mul_f32 v[216:217], v[216:217], v[184:185]
    v_pk_mul_f32 v[218:219], v[218:219], v[186:187]
    v_exp_f32 v212, v212
    v_exp_f32 v213, v213
    v_exp_f32 v214, v214
    v_exp_f32 v215, v215
    v_exp_f32 v216, v216
    v_exp_f32 v217, v217
    v_exp_f32 v218, v218
    v_exp_f32 v219, v219
    v_pk_fma_f32 v[212:213], v[212:213], v[252:253], v[252:253] op_sel:[0,0,0] op_sel_hi:[1,0,0]
    v_pk_fma_f32 v[214:215], v[214:215], v[252:253], v[252:253] op_sel:[0,0,0] op_sel_hi:[1,0,0]
    v_pk_fma_f32 v[216:217], v[216:217], v[252:253], v[252:253] op_sel:[0,0,0] op_sel_hi:[1,0,0]
    v_pk_fma_f32 v[218:219], v[218:219], v[252:253], v[252:253] op_sel:[0,0,0] op_sel_hi:[1,0,0]
    v_rcp_f32 v212, v212
    v_rcp_f32 v213, v213
    v_rcp_f32 v214, v214
    v_rcp_f32 v215, v215
    v_rcp_f32 v216, v216
    v_rcp_f32 v217, v217
    v_rcp_f32 v218, v218
    v_rcp_f32 v219, v219
    v_pk_mul_f32 v[168:169], v[168:169], v[212:213]
    v_pk_mul_f32 v[170:171], v[170:171], v[214:215]
    v_pk_mul_f32 v[184:185], v[184:185], v[216:217]
    v_pk_mul_f32 v[186:187], v[186:187], v[218:219]
    v_pk_add_f32 v[232:233], v[232:233], v[168:169]
    v_pk_fma_f32 v[240:241], v[168:169], v[168:169], v[240:241]
    v_pk_add_f32 v[232:233], v[232:233], v[170:171]
    v_pk_fma_f32 v[240:241], v[170:171], v[170:171], v[240:241]
    v_pk_add_f32 v[232:233], v[232:233], v[184:185]
    v_pk_fma_f32 v[240:241], v[184:185], v[184:185], v[240:241]
    v_pk_add_f32 v[232:233], v[232:233], v[186:187]
    v_pk_fma_f32 v[240:241], v[186:187], v[186:187], v[240:241]
    v_pk_mul_f32 v[212:213], v[172:173], v[172:173]
    v_pk_mul_f32 v[214:215], v[174:175], v[174:175]
    v_pk_mul_f32 v[216:217], v[188:189], v[188:189]
    v_pk_mul_f32 v[218:219], v[190:191], v[190:191]
    v_pk_fma_f32 v[212:213], v[212:213], v[226:227], v[226:227] op_sel:[0,0,1] op_sel_hi:[1,0,1]
    v_pk_fma_f32 v[214:215], v[214:215], v[226:227], v[226:227] op_sel:[0,0,1] op_sel_hi:[1,0,1]
    v_pk_fma_f32 v[216:217], v[216:217], v[226:227], v[226:227] op_sel:[0,0,1] op_sel_hi:[1,0,1]
    v_pk_fma_f32 v[218:219], v[218:219], v[226:227], v[226:227] op_sel:[0,0,1] op_sel_hi:[1,0,1]
    v_pk_mul_f32 v[212:213], v[212:213], v[172:173]
    v_pk_mul_f32 v[214:215], v[214:215], v[174:175]
    v_pk_mul_f32 v[216:217], v[216:217], v[188:189]
    v_pk_mul_f32 v[218:219], v[218:219], v[190:191]
    v_exp_f32 v212, v212
    v_exp_f32 v213, v213
    v_exp_f32 v214, v214
    v_exp_f32 v215, v215
    v_exp_f32 v216, v216
    v_exp_f32 v217, v217
    v_exp_f32 v218, v218
    v_exp_f32 v219, v219
    v_pk_fma_f32 v[212:213], v[212:213], v[252:253], v[252:253] op_sel:[0,1,1] op_sel_hi:[1,1,1]
    v_pk_fma_f32 v[214:215], v[214:215], v[252:253], v[252:253] op_sel:[0,1,1] op_sel_hi:[1,1,1]
    v_pk_fma_f32 v[216:217], v[216:217], v[252:253], v[252:253] op_sel:[0,1,1] op_sel_hi:[1,1,1]
    v_pk_fma_f32 v[218:219], v[218:219], v[252:253], v[252:253] op_sel:[0,1,1] op_sel_hi:[1,1,1]
    v_rcp_f32 v212, v212
    v_rcp_f32 v213, v213
    v_rcp_f32 v214, v214
    v_rcp_f32 v215, v215
    v_rcp_f32 v216, v216
    v_rcp_f32 v217, v217
    v_rcp_f32 v218, v218
    v_rcp_f32 v219, v219
    v_pk_mul_f32 v[172:173], v[172:173], v[212:213]
    v_pk_mul_f32 v[174:175], v[174:175], v[214:215]
    v_pk_mul_f32 v[188:189], v[188:189], v[216:217]
    v_pk_mul_f32 v[190:191], v[190:191], v[218:219]
    v_pk_add_f32 v[234:235], v[234:235], v[172:173]
    v_pk_fma_f32 v[242:243], v[172:173], v[172:173], v[242:243]
    v_pk_add_f32 v[234:235], v[234:235], v[174:175]
    v_pk_fma_f32 v[242:243], v[174:175], v[174:175], v[242:243]
    v_pk_add_f32 v[234:235], v[234:235], v[188:189]
    v_pk_fma_f32 v[242:243], v[188:189], v[188:189], v[242:243]
    v_pk_add_f32 v[234:235], v[234:235], v[190:191]
    v_pk_fma_f32 v[242:243], v[190:191], v[190:191], v[242:243]
    v_pk_mul_f32 v[212:213], v[192:193], v[192:193]
    v_pk_mul_f32 v[214:215], v[194:195], v[194:195]
    v_pk_fma_f32 v[212:213], v[212:213], v[220:221], v[220:221] op_sel:[0,0,1] op_sel_hi:[1,0,1]
    v_pk_fma_f32 v[214:215], v[214:215], v[220:221], v[220:221] op_sel:[0,0,1] op_sel_hi:[1,0,1]
    v_pk_mul_f32 v[212:213], v[212:213], v[192:193]
    v_pk_mul_f32 v[214:215], v[214:215], v[194:195]
    v_exp_f32 v212, v212
    v_exp_f32 v213, v213
    v_exp_f32 v214, v214
    v_exp_f32 v215, v215
    v_pk_fma_f32 v[212:213], v[212:213], v[208:209], v[208:209] op_sel:[0,0,0] op_sel_hi:[1,0,0]
    v_pk_fma_f32 v[214:215], v[214:215], v[208:209], v[208:209] op_sel:[0,0,0] op_sel_hi:[1,0,0]
    v_rcp_f32 v212, v212
    v_rcp_f32 v213, v213
    v_rcp_f32 v214, v214
    v_rcp_f32 v215, v215
    v_pk_mul_f32 v[192:193], v[192:193], v[212:213]
    v_pk_mul_f32 v[194:195], v[194:195], v[214:215]
    v_pk_add_f32 v[228:229], v[228:229], v[192:193]
    v_pk_fma_f32 v[236:237], v[192:193], v[192:193], v[236:237]
    v_pk_add_f32 v[228:229], v[228:229], v[194:195]
    v_pk_fma_f32 v[236:237], v[194:195], v[194:195], v[236:237]
    v_pk_mul_f32 v[212:213], v[196:197], v[196:197]
    v_pk_mul_f32 v[214:215], v[198:199], v[198:199]
    v_pk_fma_f32 v[212:213], v[212:213], v[222:223], v[222:223] op_sel:[0,0,1] op_sel_hi:[1,0,1]
    v_pk_fma_f32 v[214:215], v[214:215], v[222:223], v[222:223] op_sel:[0,0,1] op_sel_hi:[1,0,1]
    v_pk_mul_f32 v[212:213], v[212:213], v[196:197]
    v_pk_mul_f32 v[214:215], v[214:215], v[198:199]
    v_exp_f32 v212, v212
    v_exp_f32 v213, v213
    v_exp_f32 v214, v214
    v_exp_f32 v215, v215
    v_pk_fma_f32 v[212:213], v[212:213], v[208:209], v[208:209] op_sel:[0,1,1] op_sel_hi:[1,1,1]
    v_pk_fma_f32 v[214:215], v[214:215], v[208:209], v[208:209] op_sel:[0,1,1] op_sel_hi:[1,1,1]
    v_rcp_f32 v212, v212
    v_rcp_f32 v213, v213
    v_rcp_f32 v214, v214
    v_rcp_f32 v215, v215
    v_pk_mul_f32 v[196:197], v[196:197], v[212:213]
    v_pk_mul_f32 v[198:199], v[198:199], v[214:215]
    v_pk_add_f32 v[230:231], v[230:231], v[196:197]
    v_pk_fma_f32 v[238:239], v[196:197], v[196:197], v[238:239]
    v_pk_add_f32 v[230:231], v[230:231], v[198:199]
    v_pk_fma_f32 v[238:239], v[198:199], v[198:199], v[238:239]
    v_pk_mul_f32 v[212:213], v[200:201], v[200:201]
    v_pk_mul_f32 v[214:215], v[202:203], v[202:203]
    v_pk_fma_f32 v[212:213], v[212:213], v[224:225], v[224:225] op_sel:[0,0,1] op_sel_hi:[1,0,1]
    v_pk_fma_f32 v[214:215], v[214:215], v[224:225], v[224:225] op_sel:[0,0,1] op_sel_hi:[1,0,1]
    v_pk_mul_f32 v[212:213], v[212:213], v[200:201]
    v_pk_mul_f32 v[214:215], v[214:215], v[202:203]
    v_exp_f32 v212, v212
    v_exp_f32 v213, v213
    v_exp_f32 v214, v214
    v_exp_f32 v215, v215
    v_pk_fma_f32 v[212:213], v[212:213], v[252:253], v[252:253] op_sel:[0,0,0] op_sel_hi:[1,0,0]
    v_pk_fma_f32 v[214:215], v[214:215], v[252:253], v[252:253] op_sel:[0,0,0] op_sel_hi:[1,0,0]
    v_rcp_f32 v212, v212
    v_rcp_f32 v213, v213
    v_rcp_f32 v214, v214
    v_rcp_f32 v215, v215
    v_pk_mul_f32 v[200:201], v[200:201], v[212:213]
    v_pk_mul_f32 v[202:203], v[202:203], v[214:215]
    v_pk_add_f32 v[232:233], v[232:233], v[200:201]
    v_pk_fma_f32 v[240:241], v[200:201], v[200:201], v[240:241]
    v_pk_add_f32 v[232:233], v[232:233], v[202:203]
    v_pk_fma_f32 v[240:241], v[202:203], v[202:203], v[240:241]
    v_pk_mul_f32 v[212:213], v[204:205], v[204:205]
    v_pk_mul_f32 v[214:215], v[206:207], v[206:207]
    v_pk_fma_f32 v[212:213], v[212:213], v[226:227], v[226:227] op_sel:[0,0,1] op_sel_hi:[1,0,1]
    v_pk_fma_f32 v[214:215], v[214:215], v[226:227], v[226:227] op_sel:[0,0,1] op_sel_hi:[1,0,1]
    v_pk_mul_f32 v[212:213], v[212:213], v[204:205]
    v_pk_mul_f32 v[214:215], v[214:215], v[206:207]
    v_exp_f32 v212, v212
    v_exp_f32 v213, v213
    v_exp_f32 v214, v214
    v_exp_f32 v215, v215
    v_pk_fma_f32 v[212:213], v[212:213], v[252:253], v[252:253] op_sel:[0,1,1] op_sel_hi:[1,1,1]
    v_pk_fma_f32 v[214:215], v[214:215], v[252:253], v[252:253] op_sel:[0,1,1] op_sel_hi:[1,1,1]
    v_rcp_f32 v212, v212
    v_rcp_f32 v213, v213
    v_rcp_f32 v214, v214
    v_rcp_f32 v215, v215
    v_pk_mul_f32 v[204:205], v[204:205], v[212:213]
    v_pk_mul_f32 v[206:207], v[206:207], v[214:215]
    v_pk_add_f32 v[234:235], v[234:235], v[204:205]
    v_pk_fma_f32 v[242:243], v[204:205], v[204:205], v[242:243]
    v_pk_add_f32 v[234:235], v[234:235], v[206:207]
    v_pk_fma_f32 v[242:243], v[206:207], v[206:207], v[242:243]
    v_add_f32 v228, v228, v229
    v_add_f32 v230, v230, v231
    v_add_f32 v232, v232, v233
    v_add_f32 v234, v234, v235
    v_add_f32 v236, v236, v237
    v_add_f32 v238, v238, v239
    v_add_f32 v240, v240, v241
    v_add_f32 v242, v242, v243
    s_lshl_b32 s34, s30, 8
    s_lshl_b32 s35, s29, 6
    s_add_u32 s34, s34, s35
    s_lshl_b32 s34, s34, 3
    s_add_u32 s37, s34, 39845888
    s_and_b32 s35, s31, 15
    s_lshl_b32 s35, s35, 14
    s_add_u32 s38, s37, s35
    v_permlane32_swap_b32 v228, v232
    v_permlane32_swap_b32 v230, v234
    v_permlane32_swap_b32 v236, v240
    v_permlane32_swap_b32 v238, v242
    v_add_f32 v228, v228, v232
    v_add_f32 v230, v230, v234
    v_add_f32 v236, v236, v240
    v_add_f32 v238, v238, v242
    v_lshlrev_b32 v247, 3, v255
    s_nop 0
    v_permlane16_swap_b32 v228, v230
    v_permlane16_swap_b32 v236, v238
    v_add_f32 v228, v228, v230
    v_add_f32 v229, v236, v238
    buffer_store_dwordx2 v[228:229], v247, s[16:19], s38 offen sc1
    s_lshl_b32 s34, s29, 9
    s_add_u32 s34, s34, 154624
    v_and_b32 v250, 48, v255
    v_add_u32 v250, s34, v250
    v_and_b32 v251, 15, v255
    v_lshlrev_b32 v251, 2, v251
    v_add_u32 v251, 152576, v251
    ds_read2_b32 v[220:221], v251 offset0:0 offset1:16
    ds_read2_b32 v[222:223], v251 offset0:32 offset1:48
    ds_read2_b32 v[224:225], v251 offset0:64 offset1:80
    ds_read2_b32 v[226:227], v251 offset0:96 offset1:112
    v_add_u32 v251, 1024, v251
    ds_read2_b32 v[212:213], v251 offset0:0 offset1:16
    ds_read2_b32 v[214:215], v251 offset0:32 offset1:48
    ds_read2_b32 v[216:217], v251 offset0:64 offset1:80
    ds_read2_b32 v[218:219], v251 offset0:96 offset1:112
    ds_read_b128 v[228:231], v250 offset:256
    ds_read_b128 v[232:235], v250 offset:320
    ds_read_b128 v[236:239], v250 offset:384
    ds_read_b128 v[240:243], v250 offset:448
    s_waitcnt lgkmcnt(3)
    v_pk_add_f32 v[220:221], v[220:221], v[212:213]
    v_pk_add_f32 v[222:223], v[222:223], v[214:215]
    v_pk_add_f32 v[224:225], v[224:225], v[216:217]
    v_pk_add_f32 v[226:227], v[226:227], v[218:219]
    v_pk_fma_f32 v[0:1], v[228:229], v[220:221], v[0:1] op_sel:[0,0,0] op_sel_hi:[1,0,1]
    v_pk_fma_f32 v[2:3], v[230:231], v[220:221], v[2:3] op_sel:[0,0,0] op_sel_hi:[1,0,1]
    v_pk_fma_f32 v[16:17], v[228:229], v[220:221], v[16:17] op_sel:[0,1,0] op_sel_hi:[1,1,1]
    v_pk_fma_f32 v[18:19], v[230:231], v[220:221], v[18:19] op_sel:[0,1,0] op_sel_hi:[1,1,1]
    v_pk_fma_f32 v[32:33], v[228:229], v[222:223], v[32:33] op_sel:[0,0,0] op_sel_hi:[1,0,1]
    v_pk_fma_f32 v[34:35], v[230:231], v[222:223], v[34:35] op_sel:[0,0,0] op_sel_hi:[1,0,1]
    v_pk_fma_f32 v[48:49], v[228:229], v[222:223], v[48:49] op_sel:[0,1,0] op_sel_hi:[1,1,1]
    v_pk_fma_f32 v[50:51], v[230:231], v[222:223], v[50:51] op_sel:[0,1,0] op_sel_hi:[1,1,1]
    v_pk_fma_f32 v[64:65], v[228:229], v[224:225], v[64:65] op_sel:[0,0,0] op_sel_hi:[1,0,1]
    v_pk_fma_f32 v[66:67], v[230:231], v[224:225], v[66:67] op_sel:[0,0,0] op_sel_hi:[1,0,1]
    v_pk_fma_f32 v[80:81], v[228:229], v[224:225], v[80:81] op_sel:[0,1,0] op_sel_hi:[1,1,1]
    v_pk_fma_f32 v[82:83], v[230:231], v[224:225], v[82:83] op_sel:[0,1,0] op_sel_hi:[1,1,1]
    v_pk_fma_f32 v[96:97], v[228:229], v[226:227], v[96:97] op_sel:[0,0,0] op_sel_hi:[1,0,1]
    v_pk_fma_f32 v[98:99], v[230:231], v[226:227], v[98:99] op_sel:[0,0,0] op_sel_hi:[1,0,1]
    v_pk_fma_f32 v[112:113], v[228:229], v[226:227], v[112:113] op_sel:[0,1,0] op_sel_hi:[1,1,1]
    v_pk_fma_f32 v[114:115], v[230:231], v[226:227], v[114:115] op_sel:[0,1,0] op_sel_hi:[1,1,1]
    ds_read_b128 v[228:231], v250 offset:0
    s_waitcnt lgkmcnt(3)
    v_pk_fma_f32 v[4:5], v[232:233], v[220:221], v[4:5] op_sel:[0,0,0] op_sel_hi:[1,0,1]
    v_pk_fma_f32 v[6:7], v[234:235], v[220:221], v[6:7] op_sel:[0,0,0] op_sel_hi:[1,0,1]
    v_pk_fma_f32 v[20:21], v[232:233], v[220:221], v[20:21] op_sel:[0,1,0] op_sel_hi:[1,1,1]
    v_pk_fma_f32 v[22:23], v[234:235], v[220:221], v[22:23] op_sel:[0,1,0] op_sel_hi:[1,1,1]
    v_pk_fma_f32 v[36:37], v[232:233], v[222:223], v[36:37] op_sel:[0,0,0] op_sel_hi:[1,0,1]
    v_pk_fma_f32 v[38:39], v[234:235], v[222:223], v[38:39] op_sel:[0,0,0] op_sel_hi:[1,0,1]
    v_pk_fma_f32 v[52:53], v[232:233], v[222:223], v[52:53] op_sel:[0,1,0] op_sel_hi:[1,1,1]
    v_pk_fma_f32 v[54:55], v[234:235], v[222:223], v[54:55] op_sel:[0,1,0] op_sel_hi:[1,1,1]
    v_pk_fma_f32 v[68:69], v[232:233], v[224:225], v[68:69] op_sel:[0,0,0] op_sel_hi:[1,0,1]
    v_pk_fma_f32 v[70:71], v[234:235], v[224:225], v[70:71] op_sel:[0,0,0] op_sel_hi:[1,0,1]
    v_pk_fma_f32 v[84:85], v[232:233], v[224:225], v[84:85] op_sel:[0,1,0] op_sel_hi:[1,1,1]
    v_pk_fma_f32 v[86:87], v[234:235], v[224:225], v[86:87] op_sel:[0,1,0] op_sel_hi:[1,1,1]
    v_pk_fma_f32 v[100:101], v[232:233], v[226:227], v[100:101] op_sel:[0,0,0] op_sel_hi:[1,0,1]
    v_pk_fma_f32 v[102:103], v[234:235], v[226:227], v[102:103] op_sel:[0,0,0] op_sel_hi:[1,0,1]
    v_pk_fma_f32 v[116:117], v[232:233], v[226:227], v[116:117] op_sel:[0,1,0] op_sel_hi:[1,1,1]
    v_pk_fma_f32 v[118:119], v[234:235], v[226:227], v[118:119] op_sel:[0,1,0] op_sel_hi:[1,1,1]
    ds_read_b128 v[232:235], v250 offset:64
    s_waitcnt lgkmcnt(3)
    v_pk_fma_f32 v[8:9], v[236:237], v[220:221], v[8:9] op_sel:[0,0,0] op_sel_hi:[1,0,1]
    v_pk_fma_f32 v[10:11], v[238:239], v[220:221], v[10:11] op_sel:[0,0,0] op_sel_hi:[1,0,1]
    v_pk_fma_f32 v[24:25], v[236:237], v[220:221], v[24:25] op_sel:[0,1,0] op_sel_hi:[1,1,1]
    v_pk_fma_f32 v[26:27], v[238:239], v[220:221], v[26:27] op_sel:[0,1,0] op_sel_hi:[1,1,1]
    v_pk_fma_f32 v[40:41], v[236:237], v[222:223], v[40:41] op_sel:[0,0,0] op_sel_hi:[1,0,1]
    v_pk_fma_f32 v[42:43], v[238:239], v[222:223], v[42:43] op_sel:[0,0,0] op_sel_hi:[1,0,1]
    v_pk_fma_f32 v[56:57], v[236:237], v[222:223], v[56:57] op_sel:[0,1,0] op_sel_hi:[1,1,1]
    v_pk_fma_f32 v[58:59], v[238:239], v[222:223], v[58:59] op_sel:[0,1,0] op_sel_hi:[1,1,1]
    v_pk_fma_f32 v[72:73], v[236:237], v[224:225], v[72:73] op_sel:[0,0,0] op_sel_hi:[1,0,1]
    v_pk_fma_f32 v[74:75], v[238:239], v[224:225], v[74:75] op_sel:[0,0,0] op_sel_hi:[1,0,1]
    v_pk_fma_f32 v[88:89], v[236:237], v[224:225], v[88:89] op_sel:[0,1,0] op_sel_hi:[1,1,1]
    v_pk_fma_f32 v[90:91], v[238:239], v[224:225], v[90:91] op_sel:[0,1,0] op_sel_hi:[1,1,1]
    v_pk_fma_f32 v[104:105], v[236:237], v[226:227], v[104:105] op_sel:[0,0,0] op_sel_hi:[1,0,1]
    v_pk_fma_f32 v[106:107], v[238:239], v[226:227], v[106:107] op_sel:[0,0,0] op_sel_hi:[1,0,1]
    v_pk_fma_f32 v[120:121], v[236:237], v[226:227], v[120:121] op_sel:[0,1,0] op_sel_hi:[1,1,1]
    v_pk_fma_f32 v[122:123], v[238:239], v[226:227], v[122:123] op_sel:[0,1,0] op_sel_hi:[1,1,1]
    ds_read_b128 v[236:239], v250 offset:128
    s_waitcnt lgkmcnt(2)
    v_pk_fma_f32 v[12:13], v[240:241], v[220:221], v[12:13] op_sel:[0,0,0] op_sel_hi:[1,0,1]
    v_pk_fma_f32 v[14:15], v[242:243], v[220:221], v[14:15] op_sel:[0,0,0] op_sel_hi:[1,0,1]
    v_pk_fma_f32 v[28:29], v[240:241], v[220:221], v[28:29] op_sel:[0,1,0] op_sel_hi:[1,1,1]
    v_pk_fma_f32 v[30:31], v[242:243], v[220:221], v[30:31] op_sel:[0,1,0] op_sel_hi:[1,1,1]
    v_pk_fma_f32 v[44:45], v[240:241], v[222:223], v[44:45] op_sel:[0,0,0] op_sel_hi:[1,0,1]
    v_pk_fma_f32 v[46:47], v[242:243], v[222:223], v[46:47] op_sel:[0,0,0] op_sel_hi:[1,0,1]
    v_pk_fma_f32 v[60:61], v[240:241], v[222:223], v[60:61] op_sel:[0,1,0] op_sel_hi:[1,1,1]
    v_pk_fma_f32 v[62:63], v[242:243], v[222:223], v[62:63] op_sel:[0,1,0] op_sel_hi:[1,1,1]
    v_pk_fma_f32 v[76:77], v[240:241], v[224:225], v[76:77] op_sel:[0,0,0] op_sel_hi:[1,0,1]
    v_pk_fma_f32 v[78:79], v[242:243], v[224:225], v[78:79] op_sel:[0,0,0] op_sel_hi:[1,0,1]
    v_pk_fma_f32 v[92:93], v[240:241], v[224:225], v[92:93] op_sel:[0,1,0] op_sel_hi:[1,1,1]
    v_pk_fma_f32 v[94:95], v[242:243], v[224:225], v[94:95] op_sel:[0,1,0] op_sel_hi:[1,1,1]
    v_pk_fma_f32 v[108:109], v[240:241], v[226:227], v[108:109] op_sel:[0,0,0] op_sel_hi:[1,0,1]
    v_pk_fma_f32 v[110:111], v[242:243], v[226:227], v[110:111] op_sel:[0,0,0] op_sel_hi:[1,0,1]
    v_pk_fma_f32 v[124:125], v[240:241], v[226:227], v[124:125] op_sel:[0,1,0] op_sel_hi:[1,1,1]
    v_pk_fma_f32 v[126:127], v[242:243], v[226:227], v[126:127] op_sel:[0,1,0] op_sel_hi:[1,1,1]
    ds_read_b128 v[240:243], v250 offset:192
    s_waitcnt lgkmcnt(0)
    v_pk_mul_f32 v[220:221], v[228:229], v[210:211] op_sel_hi:[1,0]
    v_pk_mul_f32 v[222:223], v[230:231], v[210:211] op_sel_hi:[1,0]
    v_pk_mul_f32 v[224:225], v[232:233], v[210:211] op_sel_hi:[1,0]
    v_pk_mul_f32 v[226:227], v[234:235], v[210:211] op_sel_hi:[1,0]
    v_pk_mul_f32 v[64:65], v[64:65], v[228:229]
    v_pk_mul_f32 v[66:67], v[66:67], v[230:231]
    v_pk_mul_f32 v[68:69], v[68:69], v[232:233]
    v_pk_mul_f32 v[70:71], v[70:71], v[234:235]
    v_cvt_pk_bf16_f32 v64, v64, v65
    v_cvt_pk_bf16_f32 v65, v66, v67
    v_cvt_pk_bf16_f32 v66, v68, v69
    v_cvt_pk_bf16_f32 v67, v70, v71
    v_pk_mul_f32 v[80:81], v[80:81], v[228:229]
    v_pk_mul_f32 v[82:83], v[82:83], v[230:231]
    v_pk_mul_f32 v[84:85], v[84:85], v[232:233]
    v_pk_mul_f32 v[86:87], v[86:87], v[234:235]
    v_cvt_pk_bf16_f32 v80, v80, v81
    v_cvt_pk_bf16_f32 v81, v82, v83
    v_cvt_pk_bf16_f32 v82, v84, v85
    v_cvt_pk_bf16_f32 v83, v86, v87
    v_pk_mul_f32 v[96:97], v[96:97], v[228:229]
    v_pk_mul_f32 v[98:99], v[98:99], v[230:231]
    v_pk_mul_f32 v[100:101], v[100:101], v[232:233]
    v_pk_mul_f32 v[102:103], v[102:103], v[234:235]
    v_cvt_pk_bf16_f32 v96, v96, v97
    v_cvt_pk_bf16_f32 v97, v98, v99
    v_cvt_pk_bf16_f32 v98, v100, v101
    v_cvt_pk_bf16_f32 v99, v102, v103
    v_pk_mul_f32 v[112:113], v[112:113], v[228:229]
    v_pk_mul_f32 v[114:115], v[114:115], v[230:231]
    v_pk_mul_f32 v[116:117], v[116:117], v[232:233]
    v_pk_mul_f32 v[118:119], v[118:119], v[234:235]
    v_cvt_pk_bf16_f32 v112, v112, v113
    v_cvt_pk_bf16_f32 v113, v114, v115
    v_cvt_pk_bf16_f32 v114, v116, v117
    v_cvt_pk_bf16_f32 v115, v118, v119
    v_pk_mul_f32 v[212:213], v[0:1], v[220:221]
    v_pk_mul_f32 v[214:215], v[2:3], v[222:223]
    v_pk_mul_f32 v[216:217], v[4:5], v[224:225]
    v_pk_mul_f32 v[218:219], v[6:7], v[226:227]
    v_pk_fma_f32 v[0:1], v[0:1], v[228:229], 1.0 op_sel_hi:[1,1,0]
    v_pk_fma_f32 v[2:3], v[2:3], v[230:231], 1.0 op_sel_hi:[1,1,0]
    v_pk_fma_f32 v[4:5], v[4:5], v[232:233], 1.0 op_sel_hi:[1,1,0]
    v_pk_fma_f32 v[6:7], v[6:7], v[234:235], 1.0 op_sel_hi:[1,1,0]
    v_exp_f32 v212, v212 clamp
    v_exp_f32 v213, v213 clamp
    v_exp_f32 v214, v214 clamp
    v_exp_f32 v215, v215 clamp
    v_exp_f32 v216, v216 clamp
    v_exp_f32 v217, v217 clamp
    v_exp_f32 v218, v218 clamp
    v_exp_f32 v219, v219 clamp
    v_max_f32 v0, v0, v212
    v_max_f32 v1, v1, v213
    v_max_f32 v2, v2, v214
    v_max_f32 v3, v3, v215
    v_max_f32 v4, v4, v216
    v_max_f32 v5, v5, v217
    v_max_f32 v6, v6, v218
    v_max_f32 v7, v7, v219
    v_pk_add_f32 v[0:1], v[0:1], v[210:211] op_sel:[0,1] op_sel_hi:[1,1]
    v_pk_add_f32 v[2:3], v[2:3], v[210:211] op_sel:[0,1] op_sel_hi:[1,1]
    v_pk_add_f32 v[4:5], v[4:5], v[210:211] op_sel:[0,1] op_sel_hi:[1,1]
    v_pk_add_f32 v[6:7], v[6:7], v[210:211] op_sel:[0,1] op_sel_hi:[1,1]
    v_cvt_pk_bf16_f32 v0, v0, v1
    v_cvt_pk_bf16_f32 v1, v2, v3
    v_cvt_pk_bf16_f32 v2, v4, v5
    v_cvt_pk_bf16_f32 v3, v6, v7
    v_pk_mul_f32 v[212:213], v[16:17], v[220:221]
    v_pk_mul_f32 v[214:215], v[18:19], v[222:223]
    v_pk_mul_f32 v[216:217], v[20:21], v[224:225]
    v_pk_mul_f32 v[218:219], v[22:23], v[226:227]
    v_pk_fma_f32 v[16:17], v[16:17], v[228:229], 1.0 op_sel_hi:[1,1,0]
    v_pk_fma_f32 v[18:19], v[18:19], v[230:231], 1.0 op_sel_hi:[1,1,0]
    v_pk_fma_f32 v[20:21], v[20:21], v[232:233], 1.0 op_sel_hi:[1,1,0]
    v_pk_fma_f32 v[22:23], v[22:23], v[234:235], 1.0 op_sel_hi:[1,1,0]
    v_exp_f32 v212, v212 clamp
    v_exp_f32 v213, v213 clamp
    v_exp_f32 v214, v214 clamp
    v_exp_f32 v215, v215 clamp
    v_exp_f32 v216, v216 clamp
    v_exp_f32 v217, v217 clamp
    v_exp_f32 v218, v218 clamp
    v_exp_f32 v219, v219 clamp
    v_max_f32 v16, v16, v212
    v_max_f32 v17, v17, v213
    v_max_f32 v18, v18, v214
    v_max_f32 v19, v19, v215
    v_max_f32 v20, v20, v216
    v_max_f32 v21, v21, v217
    v_max_f32 v22, v22, v218
    v_max_f32 v23, v23, v219
    v_pk_add_f32 v[16:17], v[16:17], v[210:211] op_sel:[0,1] op_sel_hi:[1,1]
    v_pk_add_f32 v[18:19], v[18:19], v[210:211] op_sel:[0,1] op_sel_hi:[1,1]
    v_pk_add_f32 v[20:21], v[20:21], v[210:211] op_sel:[0,1] op_sel_hi:[1,1]
    v_pk_add_f32 v[22:23], v[22:23], v[210:211] op_sel:[0,1] op_sel_hi:[1,1]
    v_cvt_pk_bf16_f32 v16, v16, v17
    v_cvt_pk_bf16_f32 v17, v18, v19
    v_cvt_pk_bf16_f32 v18, v20, v21
    v_cvt_pk_bf16_f32 v19, v22, v23
    v_pk_mul_f32 v[212:213], v[32:33], v[220:221]
    v_pk_mul_f32 v[214:215], v[34:35], v[222:223]
    v_pk_mul_f32 v[216:217], v[36:37], v[224:225]
    v_pk_mul_f32 v[218:219], v[38:39], v[226:227]
    v_pk_fma_f32 v[32:33], v[32:33], v[228:229], 1.0 op_sel_hi:[1,1,0]
    v_pk_fma_f32 v[34:35], v[34:35], v[230:231], 1.0 op_sel_hi:[1,1,0]
    v_pk_fma_f32 v[36:37], v[36:37], v[232:233], 1.0 op_sel_hi:[1,1,0]
    v_pk_fma_f32 v[38:39], v[38:39], v[234:235], 1.0 op_sel_hi:[1,1,0]
    v_exp_f32 v212, v212 clamp
    v_exp_f32 v213, v213 clamp
    v_exp_f32 v214, v214 clamp
    v_exp_f32 v215, v215 clamp
    v_exp_f32 v216, v216 clamp
    v_exp_f32 v217, v217 clamp
    v_exp_f32 v218, v218 clamp
    v_exp_f32 v219, v219 clamp
    v_max_f32 v32, v32, v212
    v_max_f32 v33, v33, v213
    v_max_f32 v34, v34, v214
    v_max_f32 v35, v35, v215
    v_max_f32 v36, v36, v216
    v_max_f32 v37, v37, v217
    v_max_f32 v38, v38, v218
    v_max_f32 v39, v39, v219
    v_pk_add_f32 v[32:33], v[32:33], v[210:211] op_sel:[0,1] op_sel_hi:[1,1]
    v_pk_add_f32 v[34:35], v[34:35], v[210:211] op_sel:[0,1] op_sel_hi:[1,1]
    v_pk_add_f32 v[36:37], v[36:37], v[210:211] op_sel:[0,1] op_sel_hi:[1,1]
    v_pk_add_f32 v[38:39], v[38:39], v[210:211] op_sel:[0,1] op_sel_hi:[1,1]
    v_cvt_pk_bf16_f32 v32, v32, v33
    v_cvt_pk_bf16_f32 v33, v34, v35
    v_cvt_pk_bf16_f32 v34, v36, v37
    v_cvt_pk_bf16_f32 v35, v38, v39
    v_pk_mul_f32 v[212:213], v[48:49], v[220:221]
    v_pk_mul_f32 v[214:215], v[50:51], v[222:223]
    v_pk_mul_f32 v[216:217], v[52:53], v[224:225]
    v_pk_mul_f32 v[218:219], v[54:55], v[226:227]
    v_pk_fma_f32 v[48:49], v[48:49], v[228:229], 1.0 op_sel_hi:[1,1,0]
    v_pk_fma_f32 v[50:51], v[50:51], v[230:231], 1.0 op_sel_hi:[1,1,0]
    v_pk_fma_f32 v[52:53], v[52:53], v[232:233], 1.0 op_sel_hi:[1,1,0]
    v_pk_fma_f32 v[54:55], v[54:55], v[234:235], 1.0 op_sel_hi:[1,1,0]
    v_exp_f32 v212, v212 clamp
    v_exp_f32 v213, v213 clamp
    v_exp_f32 v214, v214 clamp
    v_exp_f32 v215, v215 clamp
    v_exp_f32 v216, v216 clamp
    v_exp_f32 v217, v217 clamp
    v_exp_f32 v218, v218 clamp
    v_exp_f32 v219, v219 clamp
    v_max_f32 v48, v48, v212
    v_max_f32 v49, v49, v213
    v_max_f32 v50, v50, v214
    v_max_f32 v51, v51, v215
    v_max_f32 v52, v52, v216
    v_max_f32 v53, v53, v217
    v_max_f32 v54, v54, v218
    v_max_f32 v55, v55, v219
    v_pk_add_f32 v[48:49], v[48:49], v[210:211] op_sel:[0,1] op_sel_hi:[1,1]
    v_pk_add_f32 v[50:51], v[50:51], v[210:211] op_sel:[0,1] op_sel_hi:[1,1]
    v_pk_add_f32 v[52:53], v[52:53], v[210:211] op_sel:[0,1] op_sel_hi:[1,1]
    v_pk_add_f32 v[54:55], v[54:55], v[210:211] op_sel:[0,1] op_sel_hi:[1,1]
    v_cvt_pk_bf16_f32 v48, v48, v49
    v_cvt_pk_bf16_f32 v49, v50, v51
    v_cvt_pk_bf16_f32 v50, v52, v53
    v_cvt_pk_bf16_f32 v51, v54, v55
    v_pk_mul_f32 v[220:221], v[236:237], v[210:211] op_sel_hi:[1,0]
    v_pk_mul_f32 v[222:223], v[238:239], v[210:211] op_sel_hi:[1,0]
    v_pk_mul_f32 v[224:225], v[240:241], v[210:211] op_sel_hi:[1,0]
    v_pk_mul_f32 v[226:227], v[242:243], v[210:211] op_sel_hi:[1,0]
    v_pk_mul_f32 v[72:73], v[72:73], v[236:237]
    v_pk_mul_f32 v[74:75], v[74:75], v[238:239]
    v_pk_mul_f32 v[76:77], v[76:77], v[240:241]
    v_pk_mul_f32 v[78:79], v[78:79], v[242:243]
    v_cvt_pk_bf16_f32 v72, v72, v73
    v_cvt_pk_bf16_f32 v73, v74, v75
    v_cvt_pk_bf16_f32 v74, v76, v77
    v_cvt_pk_bf16_f32 v75, v78, v79
    v_pk_mul_f32 v[88:89], v[88:89], v[236:237]
    v_pk_mul_f32 v[90:91], v[90:91], v[238:239]
    v_pk_mul_f32 v[92:93], v[92:93], v[240:241]
    v_pk_mul_f32 v[94:95], v[94:95], v[242:243]
    v_cvt_pk_bf16_f32 v88, v88, v89
    v_cvt_pk_bf16_f32 v89, v90, v91
    v_cvt_pk_bf16_f32 v90, v92, v93
    v_cvt_pk_bf16_f32 v91, v94, v95
    v_pk_mul_f32 v[104:105], v[104:105], v[236:237]
    v_pk_mul_f32 v[106:107], v[106:107], v[238:239]
    v_pk_mul_f32 v[108:109], v[108:109], v[240:241]
    v_pk_mul_f32 v[110:111], v[110:111], v[242:243]
    v_cvt_pk_bf16_f32 v104, v104, v105
    v_cvt_pk_bf16_f32 v105, v106, v107
    v_cvt_pk_bf16_f32 v106, v108, v109
    v_cvt_pk_bf16_f32 v107, v110, v111
    v_pk_mul_f32 v[120:121], v[120:121], v[236:237]
    v_pk_mul_f32 v[122:123], v[122:123], v[238:239]
    v_pk_mul_f32 v[124:125], v[124:125], v[240:241]
    v_pk_mul_f32 v[126:127], v[126:127], v[242:243]
    v_cvt_pk_bf16_f32 v120, v120, v121
    v_cvt_pk_bf16_f32 v121, v122, v123
    v_cvt_pk_bf16_f32 v122, v124, v125
    v_cvt_pk_bf16_f32 v123, v126, v127
    v_pk_mul_f32 v[212:213], v[8:9], v[220:221]
    v_pk_mul_f32 v[214:215], v[10:11], v[222:223]
    v_pk_mul_f32 v[216:217], v[12:13], v[224:225]
    v_pk_mul_f32 v[218:219], v[14:15], v[226:227]
    v_pk_fma_f32 v[8:9], v[8:9], v[236:237], 1.0 op_sel_hi:[1,1,0]
    v_pk_fma_f32 v[10:11], v[10:11], v[238:239], 1.0 op_sel_hi:[1,1,0]
    v_pk_fma_f32 v[12:13], v[12:13], v[240:241], 1.0 op_sel_hi:[1,1,0]
    v_pk_fma_f32 v[14:15], v[14:15], v[242:243], 1.0 op_sel_hi:[1,1,0]
    v_exp_f32 v212, v212 clamp
    v_exp_f32 v213, v213 clamp
    v_exp_f32 v214, v214 clamp
    v_exp_f32 v215, v215 clamp
    v_exp_f32 v216, v216 clamp
    v_exp_f32 v217, v217 clamp
    v_exp_f32 v218, v218 clamp
    v_exp_f32 v219, v219 clamp
    v_max_f32 v8, v8, v212
    v_max_f32 v9, v9, v213
    v_max_f32 v10, v10, v214
    v_max_f32 v11, v11, v215
    v_max_f32 v12, v12, v216
    v_max_f32 v13, v13, v217
    v_max_f32 v14, v14, v218
    v_max_f32 v15, v15, v219
    v_pk_add_f32 v[8:9], v[8:9], v[210:211] op_sel:[0,1] op_sel_hi:[1,1]
    v_pk_add_f32 v[10:11], v[10:11], v[210:211] op_sel:[0,1] op_sel_hi:[1,1]
    v_pk_add_f32 v[12:13], v[12:13], v[210:211] op_sel:[0,1] op_sel_hi:[1,1]
    v_pk_add_f32 v[14:15], v[14:15], v[210:211] op_sel:[0,1] op_sel_hi:[1,1]
    v_cvt_pk_bf16_f32 v8, v8, v9
    v_cvt_pk_bf16_f32 v9, v10, v11
    v_cvt_pk_bf16_f32 v10, v12, v13
    v_cvt_pk_bf16_f32 v11, v14, v15
    v_pk_mul_f32 v[212:213], v[24:25], v[220:221]
    v_pk_mul_f32 v[214:215], v[26:27], v[222:223]
    v_pk_mul_f32 v[216:217], v[28:29], v[224:225]
    v_pk_mul_f32 v[218:219], v[30:31], v[226:227]
    v_pk_fma_f32 v[24:25], v[24:25], v[236:237], 1.0 op_sel_hi:[1,1,0]
    v_pk_fma_f32 v[26:27], v[26:27], v[238:239], 1.0 op_sel_hi:[1,1,0]
    v_pk_fma_f32 v[28:29], v[28:29], v[240:241], 1.0 op_sel_hi:[1,1,0]
    v_pk_fma_f32 v[30:31], v[30:31], v[242:243], 1.0 op_sel_hi:[1,1,0]
    v_exp_f32 v212, v212 clamp
    v_exp_f32 v213, v213 clamp
    v_exp_f32 v214, v214 clamp
    v_exp_f32 v215, v215 clamp
    v_exp_f32 v216, v216 clamp
    v_exp_f32 v217, v217 clamp
    v_exp_f32 v218, v218 clamp
    v_exp_f32 v219, v219 clamp
    v_max_f32 v24, v24, v212
    v_max_f32 v25, v25, v213
    v_max_f32 v26, v26, v214
    v_max_f32 v27, v27, v215
    v_max_f32 v28, v28, v216
    v_max_f32 v29, v29, v217
    v_max_f32 v30, v30, v218
    v_max_f32 v31, v31, v219
    v_pk_add_f32 v[24:25], v[24:25], v[210:211] op_sel:[0,1] op_sel_hi:[1,1]
    v_pk_add_f32 v[26:27], v[26:27], v[210:211] op_sel:[0,1] op_sel_hi:[1,1]
    v_pk_add_f32 v[28:29], v[28:29], v[210:211] op_sel:[0,1] op_sel_hi:[1,1]
    v_pk_add_f32 v[30:31], v[30:31], v[210:211] op_sel:[0,1] op_sel_hi:[1,1]
    v_cvt_pk_bf16_f32 v24, v24, v25
    v_cvt_pk_bf16_f32 v25, v26, v27
    v_cvt_pk_bf16_f32 v26, v28, v29
    v_cvt_pk_bf16_f32 v27, v30, v31
    v_pk_mul_f32 v[212:213], v[40:41], v[220:221]
    v_pk_mul_f32 v[214:215], v[42:43], v[222:223]
    v_pk_mul_f32 v[216:217], v[44:45], v[224:225]
    v_pk_mul_f32 v[218:219], v[46:47], v[226:227]
    v_pk_fma_f32 v[40:41], v[40:41], v[236:237], 1.0 op_sel_hi:[1,1,0]
    v_pk_fma_f32 v[42:43], v[42:43], v[238:239], 1.0 op_sel_hi:[1,1,0]
    v_pk_fma_f32 v[44:45], v[44:45], v[240:241], 1.0 op_sel_hi:[1,1,0]
    v_pk_fma_f32 v[46:47], v[46:47], v[242:243], 1.0 op_sel_hi:[1,1,0]
    v_exp_f32 v212, v212 clamp
    v_exp_f32 v213, v213 clamp
    v_exp_f32 v214, v214 clamp
    v_exp_f32 v215, v215 clamp
    v_exp_f32 v216, v216 clamp
    v_exp_f32 v217, v217 clamp
    v_exp_f32 v218, v218 clamp
    v_exp_f32 v219, v219 clamp
    v_max_f32 v40, v40, v212
    v_max_f32 v41, v41, v213
    v_max_f32 v42, v42, v214
    v_max_f32 v43, v43, v215
    v_max_f32 v44, v44, v216
    v_max_f32 v45, v45, v217
    v_max_f32 v46, v46, v218
    v_max_f32 v47, v47, v219
    v_pk_add_f32 v[40:41], v[40:41], v[210:211] op_sel:[0,1] op_sel_hi:[1,1]
    v_pk_add_f32 v[42:43], v[42:43], v[210:211] op_sel:[0,1] op_sel_hi:[1,1]
    v_pk_add_f32 v[44:45], v[44:45], v[210:211] op_sel:[0,1] op_sel_hi:[1,1]
    v_pk_add_f32 v[46:47], v[46:47], v[210:211] op_sel:[0,1] op_sel_hi:[1,1]
    v_cvt_pk_bf16_f32 v40, v40, v41
    v_cvt_pk_bf16_f32 v41, v42, v43
    v_cvt_pk_bf16_f32 v42, v44, v45
    v_cvt_pk_bf16_f32 v43, v46, v47
    v_pk_mul_f32 v[212:213], v[56:57], v[220:221]
    v_pk_mul_f32 v[214:215], v[58:59], v[222:223]
    v_pk_mul_f32 v[216:217], v[60:61], v[224:225]
    v_pk_mul_f32 v[218:219], v[62:63], v[226:227]
    v_pk_fma_f32 v[56:57], v[56:57], v[236:237], 1.0 op_sel_hi:[1,1,0]
    v_pk_fma_f32 v[58:59], v[58:59], v[238:239], 1.0 op_sel_hi:[1,1,0]
    v_pk_fma_f32 v[60:61], v[60:61], v[240:241], 1.0 op_sel_hi:[1,1,0]
    v_pk_fma_f32 v[62:63], v[62:63], v[242:243], 1.0 op_sel_hi:[1,1,0]
    v_exp_f32 v212, v212 clamp
    v_exp_f32 v213, v213 clamp
    v_exp_f32 v214, v214 clamp
    v_exp_f32 v215, v215 clamp
    v_exp_f32 v216, v216 clamp
    v_exp_f32 v217, v217 clamp
    v_exp_f32 v218, v218 clamp
    v_exp_f32 v219, v219 clamp
    v_max_f32 v56, v56, v212
    v_max_f32 v57, v57, v213
    v_max_f32 v58, v58, v214
    v_max_f32 v59, v59, v215
    v_max_f32 v60, v60, v216
    v_max_f32 v61, v61, v217
    v_max_f32 v62, v62, v218
    v_max_f32 v63, v63, v219
    v_pk_add_f32 v[56:57], v[56:57], v[210:211] op_sel:[0,1] op_sel_hi:[1,1]
    v_pk_add_f32 v[58:59], v[58:59], v[210:211] op_sel:[0,1] op_sel_hi:[1,1]
    v_pk_add_f32 v[60:61], v[60:61], v[210:211] op_sel:[0,1] op_sel_hi:[1,1]
    v_pk_add_f32 v[62:63], v[62:63], v[210:211] op_sel:[0,1] op_sel_hi:[1,1]
    v_cvt_pk_bf16_f32 v56, v56, v57
    v_cvt_pk_bf16_f32 v57, v58, v59
    v_cvt_pk_bf16_f32 v58, v60, v61
    v_cvt_pk_bf16_f32 v59, v62, v63
    v_mov_b32 v100, 0x3f803f80
    v_mov_b32 v101, 0x3f803f80
    v_mov_b32 v102, 0x3f803f80
    v_mov_b32 v103, 0x3f803f80
    s_nop 1
    v_mfma_f32_16x16x32_bf16 v[4:7], v[0:3], v[64:67], 0
    v_mfma_f32_16x16x32_bf16 v[12:15], v[0:3], v[80:83], 0
    v_mfma_f32_16x16x32_bf16 v[20:23], v[0:3], v[100:103], 0
    v_mfma_f32_16x16x32_bf16 v[28:31], v[16:19], v[64:67], 0
    v_mfma_f32_16x16x32_bf16 v[36:39], v[16:19], v[80:83], 0
    v_mfma_f32_16x16x32_bf16 v[44:47], v[16:19], v[100:103], 0
    v_mfma_f32_16x16x32_bf16 v[52:55], v[32:35], v[96:99], 0
    v_mfma_f32_16x16x32_bf16 v[60:63], v[32:35], v[112:115], 0
    v_mfma_f32_16x16x32_bf16 v[68:71], v[32:35], v[100:103], 0
    v_mfma_f32_16x16x32_bf16 v[76:79], v[48:51], v[96:99], 0
    v_mfma_f32_16x16x32_bf16 v[84:87], v[48:51], v[112:115], 0
    v_mfma_f32_16x16x32_bf16 v[92:95], v[48:51], v[100:103], 0
    v_mfma_f32_16x16x32_bf16 v[4:7], v[8:11], v[72:75], v[4:7]
    v_mfma_f32_16x16x32_bf16 v[12:15], v[8:11], v[88:91], v[12:15]
    v_mfma_f32_16x16x32_bf16 v[20:23], v[8:11], v[100:103], v[20:23]
    v_mfma_f32_16x16x32_bf16 v[28:31], v[24:27], v[72:75], v[28:31]
    v_mfma_f32_16x16x32_bf16 v[36:39], v[24:27], v[88:91], v[36:39]
    v_mfma_f32_16x16x32_bf16 v[44:47], v[24:27], v[100:103], v[44:47]
    v_mfma_f32_16x16x32_bf16 v[52:55], v[40:43], v[104:107], v[52:55]
    v_mfma_f32_16x16x32_bf16 v[60:63], v[40:43], v[120:123], v[60:63]
    v_mfma_f32_16x16x32_bf16 v[68:71], v[40:43], v[100:103], v[68:71]
    v_mfma_f32_16x16x32_bf16 v[76:79], v[56:59], v[104:107], v[76:79]
    v_mfma_f32_16x16x32_bf16 v[84:87], v[56:59], v[120:123], v[84:87]
    v_mfma_f32_16x16x32_bf16 v[92:95], v[56:59], v[100:103], v[92:95]
    s_mul_i32 s34, s29, 24576
    s_add_u32 s34, s34, 54272
    v_add_u32 v248, s34, v244
    s_mul_i32 s34, s29, 3072
    s_add_u32 s34, s34, 54272
    v_add_u32 v249, s34, v244
    v_add_u32 v250, 49152, v249
    s_nop 1
    ds_write_b128 v248, v[4:7] offset:0
    ds_write_b128 v248, v[12:15] offset:1024
    ds_write_b128 v248, v[20:23] offset:2048
    ds_write_b128 v248, v[28:31] offset:3072
    ds_write_b128 v248, v[36:39] offset:4096
    ds_write_b128 v248, v[44:47] offset:5120
    ds_write_b128 v248, v[52:55] offset:6144
    ds_write_b128 v248, v[60:63] offset:7168
    ds_write_b128 v248, v[68:71] offset:8192
    ds_write_b128 v248, v[76:79] offset:9216
    ds_write_b128 v248, v[84:87] offset:10240
    ds_write_b128 v248, v[92:95] offset:11264
    s_waitcnt lgkmcnt(0)
    s_barrier
    ds_read_b128 v[0:3], v249 offset:0
    ds_read_b128 v[16:19], v249 offset:24576
    ds_read_b128 v[32:35], v250 offset:0
    ds_read_b128 v[48:51], v250 offset:24576
    ds_read_b128 v[64:67], v249 offset:1024
    ds_read_b128 v[80:83], v249 offset:25600
    ds_read_b128 v[96:99], v250 offset:1024
    ds_read_b128 v[112:115], v250 offset:25600
    ds_read_b128 v[8:11], v249 offset:2048
    ds_read_b128 v[24:27], v249 offset:26624
    ds_read_b128 v[40:43], v250 offset:2048
    ds_read_b128 v[56:59], v250 offset:26624
    s_lshl_b32 s34, s30, 5
    s_lshl_b32 s35, s32, 1
    s_add_u32 s34, s34, s35
    s_mul_i32 s34, s34, 6
    s_mul_i32 s35, s29, 3
    s_add_u32 s34, s34, s35
    s_lshl_b32 s34, s34, 10
    s_add_u32 s34, s34, 37748736
    s_waitcnt lgkmcnt(8)
    v_pk_add_f32 v[0:1], v[0:1], v[16:17]
    v_pk_add_f32 v[32:33], v[32:33], v[48:49]
    v_pk_add_f32 v[2:3], v[2:3], v[18:19]
    v_pk_add_f32 v[34:35], v[34:35], v[50:51]
    v_pk_add_f32 v[0:1], v[0:1], v[32:33]
    v_pk_add_f32 v[2:3], v[2:3], v[34:35]
    buffer_store_dwordx4 v[0:3], v244, s[16:19], s34 offen offset:0
    s_waitcnt lgkmcnt(4)
    v_pk_add_f32 v[64:65], v[64:65], v[80:81]
    v_pk_add_f32 v[96:97], v[96:97], v[112:113]
    v_pk_add_f32 v[66:67], v[66:67], v[82:83]
    v_pk_add_f32 v[98:99], v[98:99], v[114:115]
    v_pk_add_f32 v[64:65], v[64:65], v[96:97]
    v_pk_add_f32 v[66:67], v[66:67], v[98:99]
    buffer_store_dwordx4 v[64:67], v244, s[16:19], s34 offen offset:1024
    s_waitcnt lgkmcnt(0)
    v_pk_add_f32 v[8:9], v[8:9], v[24:25]
    v_pk_add_f32 v[40:41], v[40:41], v[56:57]
    v_pk_add_f32 v[10:11], v[10:11], v[26:27]
    v_pk_add_f32 v[42:43], v[42:43], v[58:59]
    v_pk_add_f32 v[8:9], v[8:9], v[40:41]
    v_pk_add_f32 v[10:11], v[10:11], v[42:43]
    buffer_store_dwordx4 v[8:11], v244, s[16:19], s34 offen offset:2048
    v_bfe_u32 v212, v255, 2, 1
    v_lshlrev_b32 v212, 9, v212
    v_bfe_u32 v213, v255, 3, 1
    v_lshl_add_u32 v212, v213, 7, v212
    v_and_b32 v213, 3, v255
    v_lshl_add_u32 v212, v213, 5, v212
    v_bfe_u32 v213, v255, 5, 1
    v_lshl_add_u32 v212, v213, 4, v212
    v_bfe_u32 v213, v255, 4, 1
    v_lshl_add_u32 v245, v213, 8, v212
    v_lshl_add_u32 v246, v213, 3, v212
    s_mov_b32 s39, 0x40000
    s_nop 0
k1_kernel_E_poll:
    s_mov_b32 s35, s37
    buffer_load_dwordx2 v[0:1], v247, s[16:19], s35 offen sc1
    s_add_u32 s35, s35, 16384
    buffer_load_dwordx2 v[2:3], v247, s[16:19], s35 offen sc1
    s_add_u32 s35, s35, 16384
    buffer_load_dwordx2 v[4:5], v247, s[16:19], s35 offen sc1
    s_add_u32 s35, s35, 16384
    buffer_load_dwordx2 v[6:7], v247, s[16:19], s35 offen sc1
    s_add_u32 s35, s35, 16384
    buffer_load_dwordx2 v[8:9], v247, s[16:19], s35 offen sc1
    s_add_u32 s35, s35, 16384
    buffer_load_dwordx2 v[10:11], v247, s[16:19], s35 offen sc1
    s_add_u32 s35, s35, 16384
    buffer_load_dwordx2 v[12:13], v247, s[16:19], s35 offen sc1
    s_add_u32 s35, s35, 16384
    buffer_load_dwordx2 v[14:15], v247, s[16:19], s35 offen sc1
    s_add_u32 s35, s35, 16384
    buffer_load_dwordx2 v[16:17], v247, s[16:19], s35 offen sc1
    s_add_u32 s35, s35, 16384
    buffer_load_dwordx2 v[18:19], v247, s[16:19], s35 offen sc1
    s_add_u32 s35, s35, 16384
    buffer_load_dwordx2 v[20:21], v247, s[16:19], s35 offen sc1
    s_add_u32 s35, s35, 16384
    buffer_load_dwordx2 v[22:23], v247, s[16:19], s35 offen sc1
    s_add_u32 s35, s35, 16384
    buffer_load_dwordx2 v[24:25], v247, s[16:19], s35 offen sc1
    s_add_u32 s35, s35, 16384
    buffer_load_dwordx2 v[26:27], v247, s[16:19], s35 offen sc1
    s_add_u32 s35, s35, 16384
    buffer_load_dwordx2 v[28:29], v247, s[16:19], s35 offen sc1
    s_add_u32 s35, s35, 16384
    buffer_load_dwordx2 v[30:31], v247, s[16:19], s35 offen sc1
    s_waitcnt vmcnt(0)
k1_kernel_E_chk:
    v_max3_u32 v212, v0, v1, v2
    v_max3_u32 v212, v212, v3, v4
    v_max3_u32 v212, v212, v5, v6
    v_max3_u32 v212, v212, v7, v8
    v_max3_u32 v212, v212, v9, v10
    v_max3_u32 v212, v212, v11, v12
    v_max3_u32 v212, v212, v13, v14
    v_max3_u32 v212, v212, v15, v16
    v_max3_u32 v212, v212, v17, v18
    v_max3_u32 v212, v212, v19, v20
    v_max3_u32 v212, v212, v21, v22
    v_max3_u32 v212, v212, v23, v24
    v_max3_u32 v212, v212, v25, v26
    v_max3_u32 v212, v212, v27, v28
    v_max3_u32 v212, v212, v29, v30
    v_max_u32 v212, v212, v31
    v_cmp_eq_u32 vcc, -1, v212
    s_sub_u32 s39, s39, 1
    s_cbranch_scc1 k1_kernel_E_go
    s_cbranch_vccnz k1_kernel_E_poll
k1_kernel_E_go:
    v_pk_add_f32 v[0:1], v[0:1], v[16:17]
    v_pk_add_f32 v[2:3], v[2:3], v[18:19]
    v_pk_add_f32 v[4:5], v[4:5], v[20:21]
    v_pk_add_f32 v[6:7], v[6:7], v[22:23]
    v_pk_add_f32 v[8:9], v[8:9], v[24:25]
    v_pk_add_f32 v[10:11], v[10:11], v[26:27]
    v_pk_add_f32 v[12:13], v[12:13], v[28:29]
    v_pk_add_f32 v[14:15], v[14:15], v[30:31]
    v_pk_add_f32 v[0:1], v[0:1], v[8:9]
    v_pk_add_f32 v[2:3], v[2:3], v[10:11]
    v_pk_add_f32 v[4:5], v[4:5], v[12:13]
    v_pk_add_f32 v[6:7], v[6:7], v[14:15]
    v_pk_add_f32 v[0:1], v[0:1], v[4:5]
    v_pk_add_f32 v[2:3], v[2:3], v[6:7]
    v_pk_add_f32 v[0:1], v[0:1], v[2:3]
    v_mul_f32 v0, 0x3a124925, v0
    v_mul_f32 v1, 0x3a124925, v1
    v_fma_f32 v1, -v0, v0, v1
    v_max_f32 v1, 0, v1
    v_cvt_pk_bf16_f32 v1, v1, v1
    v_lshlrev_b32 v1, 16, v1
    v_add_f32 v1, 0x3727c5ac, v1
    v_cvt_pk_bf16_f32 v1, v1, v1
    v_lshlrev_b32 v1, 16, v1
    v_sqrt_f32 v1, v1
    v_cvt_pk_bf16_f32 v0, v0, v0
    v_lshlrev_b32 v0, 16, v0
    v_cvt_pk_bf16_f32 v1, v1, v1
    v_lshlrev_b32 v1, 16, v1
    v_rcp_f32 v1, v1
    s_nop 0
    v_mul_f32 v0, v0, v1
    v_mov_b32 v228, v1
    v_mov_b32 v232, v1
    v_sub_f32 v229, 0, v0
    v_sub_f32 v233, 0, v0
    s_nop 1
    v_permlane32_swap_b32 v228, v232
    v_permlane32_swap_b32 v229, v233
    v_mov_b32 v230, v228
    v_mov_b32 v231, v229
    v_mov_b32 v234, v232
    v_mov_b32 v235, v233
    s_nop 0
    v_permlane16_swap_b32 v228, v230
    v_permlane16_swap_b32 v229, v231
    v_permlane16_swap_b32 v232, v234
    v_permlane16_swap_b32 v233, v235
    v_pk_fma_f32 v[128:129], v[128:129], v[228:229], v[228:229] op_sel:[0,0,1] op_sel_hi:[1,0,1]
    v_pk_fma_f32 v[130:131], v[130:131], v[228:229], v[228:229] op_sel:[0,0,1] op_sel_hi:[1,0,1]
    v_pk_fma_f32 v[144:145], v[144:145], v[228:229], v[228:229] op_sel:[0,0,1] op_sel_hi:[1,0,1]
    v_pk_fma_f32 v[146:147], v[146:147], v[228:229], v[228:229] op_sel:[0,0,1] op_sel_hi:[1,0,1]
    v_pk_fma_f32 v[132:133], v[132:133], v[230:231], v[230:231] op_sel:[0,0,1] op_sel_hi:[1,0,1]
    v_pk_fma_f32 v[134:135], v[134:135], v[230:231], v[230:231] op_sel:[0,0,1] op_sel_hi:[1,0,1]
    v_pk_fma_f32 v[148:149], v[148:149], v[230:231], v[230:231] op_sel:[0,0,1] op_sel_hi:[1,0,1]
    v_pk_fma_f32 v[150:151], v[150:151], v[230:231], v[230:231] op_sel:[0,0,1] op_sel_hi:[1,0,1]
    v_pk_fma_f32 v[136:137], v[136:137], v[232:233], v[232:233] op_sel:[0,0,1] op_sel_hi:[1,0,1]
    v_pk_fma_f32 v[138:139], v[138:139], v[232:233], v[232:233] op_sel:[0,0,1] op_sel_hi:[1,0,1]
    v_pk_fma_f32 v[152:153], v[152:153], v[232:233], v[232:233] op_sel:[0,0,1] op_sel_hi:[1,0,1]
    v_pk_fma_f32 v[154:155], v[154:155], v[232:233], v[232:233] op_sel:[0,0,1] op_sel_hi:[1,0,1]
    v_pk_fma_f32 v[140:141], v[140:141], v[234:235], v[234:235] op_sel:[0,0,1] op_sel_hi:[1,0,1]
    v_pk_fma_f32 v[142:143], v[142:143], v[234:235], v[234:235] op_sel:[0,0,1] op_sel_hi:[1,0,1]
    v_pk_fma_f32 v[156:157], v[156:157], v[234:235], v[234:235] op_sel:[0,0,1] op_sel_hi:[1,0,1]
    v_pk_fma_f32 v[158:159], v[158:159], v[234:235], v[234:235] op_sel:[0,0,1] op_sel_hi:[1,0,1]
    v_cvt_pk_bf16_f32 v128, v128, v129
    v_cvt_pk_bf16_f32 v129, v130, v131
    v_cvt_pk_bf16_f32 v130, v144, v145
    v_cvt_pk_bf16_f32 v131, v146, v147
    v_cvt_pk_bf16_f32 v132, v132, v133
    v_cvt_pk_bf16_f32 v133, v134, v135
    v_cvt_pk_bf16_f32 v134, v148, v149
    v_cvt_pk_bf16_f32 v135, v150, v151
    v_cvt_pk_bf16_f32 v136, v136, v137
    v_cvt_pk_bf16_f32 v137, v138, v139
    v_cvt_pk_bf16_f32 v138, v152, v153
    v_cvt_pk_bf16_f32 v139, v154, v155
    v_cvt_pk_bf16_f32 v140, v140, v141
    v_cvt_pk_bf16_f32 v141, v142, v143
    v_cvt_pk_bf16_f32 v142, v156, v157
    v_cvt_pk_bf16_f32 v143, v158, v159
    s_nop 0
    v_permlane16_swap_b32 v128, v130
    v_permlane16_swap_b32 v129, v131
    buffer_store_dwordx4 v[128:131], v245, s[16:19], s60 offen offset:0
    v_permlane16_swap_b32 v132, v134
    v_permlane16_swap_b32 v133, v135
    buffer_store_dwordx4 v[132:135], v245, s[16:19], s61 offen offset:0
    v_permlane16_swap_b32 v136, v138
    v_permlane16_swap_b32 v137, v139
    buffer_store_dwordx4 v[136:139], v245, s[16:19], s62 offen offset:0
    v_permlane16_swap_b32 v140, v142
    v_permlane16_swap_b32 v141, v143
    buffer_store_dwordx4 v[140:143], v245, s[16:19], s63 offen offset:0
    v_pk_fma_f32 v[160:161], v[160:161], v[228:229], v[228:229] op_sel:[0,0,1] op_sel_hi:[1,0,1]
    v_pk_fma_f32 v[162:163], v[162:163], v[228:229], v[228:229] op_sel:[0,0,1] op_sel_hi:[1,0,1]
    v_pk_fma_f32 v[176:177], v[176:177], v[228:229], v[228:229] op_sel:[0,0,1] op_sel_hi:[1,0,1]
    v_pk_fma_f32 v[178:179], v[178:179], v[228:229], v[228:229] op_sel:[0,0,1] op_sel_hi:[1,0,1]
    v_pk_fma_f32 v[164:165], v[164:165], v[230:231], v[230:231] op_sel:[0,0,1] op_sel_hi:[1,0,1]
    v_pk_fma_f32 v[166:167], v[166:167], v[230:231], v[230:231] op_sel:[0,0,1] op_sel_hi:[1,0,1]
    v_pk_fma_f32 v[180:181], v[180:181], v[230:231], v[230:231] op_sel:[0,0,1] op_sel_hi:[1,0,1]
    v_pk_fma_f32 v[182:183], v[182:183], v[230:231], v[230:231] op_sel:[0,0,1] op_sel_hi:[1,0,1]
    v_pk_fma_f32 v[168:169], v[168:169], v[232:233], v[232:233] op_sel:[0,0,1] op_sel_hi:[1,0,1]
    v_pk_fma_f32 v[170:171], v[170:171], v[232:233], v[232:233] op_sel:[0,0,1] op_sel_hi:[1,0,1]
    v_pk_fma_f32 v[184:185], v[184:185], v[232:233], v[232:233] op_sel:[0,0,1] op_sel_hi:[1,0,1]
    v_pk_fma_f32 v[186:187], v[186:187], v[232:233], v[232:233] op_sel:[0,0,1] op_sel_hi:[1,0,1]
    v_pk_fma_f32 v[172:173], v[172:173], v[234:235], v[234:235] op_sel:[0,0,1] op_sel_hi:[1,0,1]
    v_pk_fma_f32 v[174:175], v[174:175], v[234:235], v[234:235] op_sel:[0,0,1] op_sel_hi:[1,0,1]
    v_pk_fma_f32 v[188:189], v[188:189], v[234:235], v[234:235] op_sel:[0,0,1] op_sel_hi:[1,0,1]
    v_pk_fma_f32 v[190:191], v[190:191], v[234:235], v[234:235] op_sel:[0,0,1] op_sel_hi:[1,0,1]
    v_cvt_pk_bf16_f32 v160, v160, v161
    v_cvt_pk_bf16_f32 v161, v162, v163
    v_cvt_pk_bf16_f32 v162, v176, v177
    v_cvt_pk_bf16_f32 v163, v178, v179
    v_cvt_pk_bf16_f32 v164, v164, v165
    v_cvt_pk_bf16_f32 v165, v166, v167
    v_cvt_pk_bf16_f32 v166, v180, v181
    v_cvt_pk_bf16_f32 v167, v182, v183
    v_cvt_pk_bf16_f32 v168, v168, v169
    v_cvt_pk_bf16_f32 v169, v170, v171
    v_cvt_pk_bf16_f32 v170, v184, v185
    v_cvt_pk_bf16_f32 v171, v186, v187
    v_cvt_pk_bf16_f32 v172, v172, v173
    v_cvt_pk_bf16_f32 v173, v174, v175
    v_cvt_pk_bf16_f32 v174, v188, v189
    v_cvt_pk_bf16_f32 v175, v190, v191
    s_nop 0
    v_permlane16_swap_b32 v160, v162
    v_permlane16_swap_b32 v161, v163
    buffer_store_dwordx4 v[160:163], v245, s[16:19], s60 offen offset:1024
    v_permlane16_swap_b32 v164, v166
    v_permlane16_swap_b32 v165, v167
    buffer_store_dwordx4 v[164:167], v245, s[16:19], s61 offen offset:1024
    v_permlane16_swap_b32 v168, v170
    v_permlane16_swap_b32 v169, v171
    buffer_store_dwordx4 v[168:171], v245, s[16:19], s62 offen offset:1024
    v_permlane16_swap_b32 v172, v174
    v_permlane16_swap_b32 v173, v175
    buffer_store_dwordx4 v[172:175], v245, s[16:19], s63 offen offset:1024
    v_pk_fma_f32 v[192:193], v[192:193], v[228:229], v[228:229] op_sel:[0,0,1] op_sel_hi:[1,0,1]
    v_pk_fma_f32 v[194:195], v[194:195], v[228:229], v[228:229] op_sel:[0,0,1] op_sel_hi:[1,0,1]
    v_pk_fma_f32 v[196:197], v[196:197], v[230:231], v[230:231] op_sel:[0,0,1] op_sel_hi:[1,0,1]
    v_pk_fma_f32 v[198:199], v[198:199], v[230:231], v[230:231] op_sel:[0,0,1] op_sel_hi:[1,0,1]
    v_pk_fma_f32 v[200:201], v[200:201], v[232:233], v[232:233] op_sel:[0,0,1] op_sel_hi:[1,0,1]
    v_pk_fma_f32 v[202:203], v[202:203], v[232:233], v[232:233] op_sel:[0,0,1] op_sel_hi:[1,0,1]
    v_pk_fma_f32 v[204:205], v[204:205], v[234:235], v[234:235] op_sel:[0,0,1] op_sel_hi:[1,0,1]
    v_pk_fma_f32 v[206:207], v[206:207], v[234:235], v[234:235] op_sel:[0,0,1] op_sel_hi:[1,0,1]
    v_cvt_pk_bf16_f32 v192, v192, v193
    v_cvt_pk_bf16_f32 v193, v194, v195
    v_cvt_pk_bf16_f32 v196, v196, v197
    v_cvt_pk_bf16_f32 v197, v198, v199
    v_cvt_pk_bf16_f32 v200, v200, v201
    v_cvt_pk_bf16_f32 v201, v202, v203
    v_cvt_pk_bf16_f32 v204, v204, v205
    v_cvt_pk_bf16_f32 v205, v206, v207
    buffer_store_dwordx2 v[192:193], v246, s[16:19], s60 offen offset:2048
    buffer_store_dwordx2 v[196:197], v246, s[16:19], s61 offen offset:2048
    buffer_store_dwordx2 v[200:201], v246, s[16:19], s62 offen offset:2048
    buffer_store_dwordx2 v[204:205], v246, s[16:19], s63 offen offset:2048
k1_kernel_E_done:
    s_endpgm
k1_kernel_E_sig:
    s_cmp_eq_u32 s56, 2
    s_cbranch_scc0 k1_kernel_E_sig1
    buffer_load_dword v253, v252, s[44:47], 0 offen sc1
    s_branch k1_kernel_E_sigd
k1_kernel_E_sig1:
    s_mov_b32 s56, 2
    v_mov_b32 v246, 1
    s_mov_b64 exec, 1
    buffer_atomic_add v246, off, s[44:47], s53 sc1
    s_mov_b64 exec, -1
    s_branch k1_kernel_E_sigd
k1_kernel_E_spin:
    s_mov_b32 s35, 0x40000
k1_kernel_E_spin1:
    buffer_load_dword v253, v252, s[44:47], 0 offen sc1
    s_waitcnt vmcnt(0)
    v_cmp_gt_u32 vcc, 32, v253
    s_sub_u32 s35, s35, 1
    s_cbranch_scc1 k1_kernel_E_spun
    s_cbranch_vccnz k1_kernel_E_spin1
    s_branch k1_kernel_E_spun
k1_kernel_E_cx:
    s_mov_b32 s35, 0x40000
k1_kernel_E_cx1:
    buffer_load_dwordx4 v[248:251], v252, s[16:19], s87 offen sc1
    s_waitcnt vmcnt(0)
    v_max3_u32 v209, v248, v249, v250
    v_max_u32 v209, v209, v251
    v_cmp_eq_u32 vcc, -1, v209
    s_sub_u32 s35, s35, 1
    s_cbranch_scc1 k1_kernel_E_cxd
    s_cbranch_vccnz k1_kernel_E_cx1
    s_branch k1_kernel_E_cxd
k1_kernel_O:
    v_lshrrev_b32 v246, 3, v255
    s_lshl_b32 s34, s29, 3
    v_add_u32 v247, s34, v246
    v_bfe_u32 v248, v247, 1, 1
    v_bfe_u32 v249, v247, 3, 1
    v_lshl_or_b32 v248, v249, 1, v248
    v_bfe_u32 v249, v255, 1, 2
    v_xor_b32 v248, v248, v249
    v_and_b32 v249, 1, v255
    v_lshlrev_b32 v249, 4, v249
    v_lshl_or_b32 v248, v248, 5, v249
    v_mul_u32_u24 v247, 6144, v247
    v_add_u32 v247, v247, v248
    s_lshl_b32 s34, s32, 7
    v_add_u32 v216, s34, v247
    s_mul_i32 s35, s32, 448
    s_add_u32 s35, s35, 160
    s_lshl_b32 s34, s29, 5
    s_add_u32 s34, s34, 0
    v_lshrrev_b32 v246, 1, v255
    v_add_u32 v246, s34, v246
    v_mul_u32_u24 v247, 7282, v246
    v_bfe_u32 v247, v247, 19, 1
    v_lshlrev_b32 v247, 2, v247
    v_xor_b32 v246, v246, v247
    v_mul_u32_u24 v247, 58255, v246
    v_lshrrev_b32 v247, 19, v247
    v_mul_u32_u24 v248, 9, v247
    v_sub_u32 v248, v246, v248
    v_mul_u32_u24 v247, 7168, v247
    v_lshl_add_u32 v247, v248, 5, v247
    v_and_b32 v248, 1, v255
    v_lshl_add_u32 v247, v248, 4, v247
    v_add_u32 v217, s35, v247
    s_lshl_b32 s34, s29, 5
    s_add_u32 s34, s34, 128
    v_lshrrev_b32 v246, 1, v255
    v_add_u32 v246, s34, v246
    v_mul_u32_u24 v247, 7282, v246
    v_bfe_u32 v247, v247, 19, 1
    v_lshlrev_b32 v247, 2, v247
    v_xor_b32 v246, v246, v247
    v_mul_u32_u24 v247, 58255, v246
    v_lshrrev_b32 v247, 19, v247
    v_mul_u32_u24 v248, 9, v247
    v_sub_u32 v248, v246, v248
    v_mul_u32_u24 v247, 7168, v247
    v_lshl_add_u32 v247, v248, 5, v247
    v_and_b32 v248, 1, v255
    v_lshl_add_u32 v247, v248, 4, v247
    v_add_u32 v218, s35, v247
    s_mov_b32 s34, 256
    v_lshrrev_b32 v246, 1, v255
    v_add_u32 v246, s34, v246
    v_mul_u32_u24 v247, 7282, v246
    v_bfe_u32 v247, v247, 19, 1
    v_lshlrev_b32 v247, 2, v247
    v_xor_b32 v246, v246, v247
    v_mul_u32_u24 v247, 58255, v246
    v_lshrrev_b32 v247, 19, v247
    v_mul_u32_u24 v248, 9, v247
    v_sub_u32 v248, v246, v248
    v_mul_u32_u24 v247, 7168, v247
    v_lshl_add_u32 v247, v248, 5, v247
    v_and_b32 v248, 1, v255
    v_lshl_add_u32 v247, v248, 4, v247
    v_add_u32 v219, s35, v247
    s_cmp_eq_u32 s29, 0
    s_cselect_b32 s34, -1, 0
    v_and_b32 v219, s34, v219
    s_mov_b32 s36, 53248
    s_cselect_b32 s40, 12288, s36
    s_cselect_b32 s41, 25600, s36
    s_cselect_b32 s42, 38912, s36
    s_cselect_b32 s43, 52224, s36
    s_waitcnt lgkmcnt(0)
    buffer_load_dwordx4 v[0:3], v20, s[4:7], s55 offen offset:0
    buffer_load_dwordx4 v[4:7], v20, s[4:7], s55 offen offset:16
    buffer_load_dwordx4 v[8:11], v20, s[4:7], s55 offen offset:32
    buffer_load_dwordx4 v[12:15], v20, s[4:7], s55 offen offset:48
    s_add_u32 m0, s24, 0
    s_nop 0
    buffer_load_dwordx4 v216, s[8:11], s21 offen lds
    v_lshrrev_b32 v246, 4, v255
    v_bfe_u32 v247, v255, 2, 2
    v_lshl_add_u32 v247, v246, 3, v247
    v_mul_u32_u24 v248, 9, v247
    v_and_b32 v249, 1, v246
    v_lshlrev_b32 v249, 2, v249
    v_and_b32 v250, 3, v255
    v_lshlrev_b32 v250, 3, v250
    v_add_u32 v251, 0, v248
    v_xor_b32 v251, v251, v249
    v_lshl_add_u32 v226, v251, 5, v250
    v_add_u32 v251, 1, v248
    v_xor_b32 v251, v251, v249
    s_add_u32 m0, s50, 0
    s_nop 0
    buffer_load_dwordx4 v208, s[4:7], s20 offen lds
    v_lshl_add_u32 v227, v251, 5, v250
    v_add_u32 v251, 2, v248
    v_xor_b32 v251, v251, v249
    v_lshl_add_u32 v228, v251, 5, v250
    v_add_u32 v251, 3, v248
    v_xor_b32 v251, v251, v249
    v_lshl_add_u32 v229, v251, 5, v250
    v_add_u32 v251, 4, v248
    v_xor_b32 v251, v251, v249
    v_lshl_add_u32 v230, v251, 5, v250
    v_add_u32 v251, 5, v248
    v_xor_b32 v251, v251, v249
    v_lshl_add_u32 v231, v251, 5, v250
    v_add_u32 v251, 6, v248
    s_add_u32 m0, s50, 1024
    s_nop 0
    buffer_load_dwordx4 v209, s[4:7], s20 offen lds
    v_xor_b32 v251, v251, v249
    v_lshl_add_u32 v232, v251, 5, v250
    v_add_u32 v251, 7, v248
    v_xor_b32 v251, v251, v249
    v_lshl_add_u32 v233, v251, 5, v250
    s_add_u32 s34, s29, 0
    s_and_b32 s35, s34, 7
    s_lshr_b32 s34, s34, 3
    s_lshl_b32 s34, s34, 8
    s_add_u32 s34, s34, 4096
    v_add_u32 v251, s35, v248
    v_xor_b32 v251, v251, v249
    v_lshl_add_u32 v251, v251, 5, v250
    v_add_u32 v244, s34, v251
    s_add_u32 m0, s24, 4096
    s_nop 0
    buffer_load_dwordx4 v217, s[12:15], s22 offen lds
    s_add_u32 s34, s29, 36
    s_and_b32 s35, s34, 7
    s_lshr_b32 s34, s34, 3
    s_lshl_b32 s34, s34, 8
    s_add_u32 s34, s34, 4096
    v_add_u32 v251, s35, v248
    v_xor_b32 v251, v251, v249
    v_lshl_add_u32 v251, v251, 5, v250
    v_add_u32 v245, s34, v251
    s_add_u32 s34, s29, 4
    s_and_b32 s35, s34, 7
    s_lshr_b32 s34, s34, 3
    s_lshl_b32 s34, s34, 8
    s_add_u32 s34, s34, 4096
    s_add_u32 m0, s50, 2048
    s_nop 0
    buffer_load_dwordx4 v210, s[4:7], s20 offen lds
    v_add_u32 v251, s35, v248
    v_xor_b32 v251, v251, v249
    v_lshl_add_u32 v251, v251, 5, v250
    v_add_u32 v220, s34, v251
    s_add_u32 s34, s29, 40
    s_and_b32 s35, s34, 7
    s_lshr_b32 s34, s34, 3
    s_lshl_b32 s34, s34, 8
    s_add_u32 s34, s34, 4096
    v_add_u32 v251, s35, v248
    v_xor_b32 v251, v251, v249
    v_lshl_add_u32 v251, v251, 5, v250
    v_add_u32 v221, s34, v251
    s_add_u32 m0, s50, 3072
    s_nop 0
    buffer_load_dwordx4 v211, s[4:7], s20 offen lds
    s_add_u32 s34, s83, 60
    s_and_b32 s35, s34, 7
    s_lshr_b32 s34, s34, 3
    s_lshl_b32 s34, s34, 8
    s_add_u32 s34, s34, 2048
    v_add_u32 v251, s35, v248
    v_xor_b32 v251, v251, v249
    v_lshl_add_u32 v251, v251, 5, v250
    v_add_u32 v234, s34, v251
    s_add_u32 s34, s83, 96
    s_and_b32 s35, s34, 7
    s_lshr_b32 s34, s34, 3
    s_lshl_b32 s34, s34, 8
    s_add_u32 s34, s34, 2048
    s_add_u32 m0, s24, 8192
    s_nop 0
    buffer_load_dwordx4 v218, s[12:15], s22 offen lds
    v_add_u32 v251, s35, v248
    v_xor_b32 v251, v251, v249
    v_lshl_add_u32 v251, v251, 5, v250
    v_add_u32 v235, s34, v251
    v_bfe_u32 v251, v255, 3, 1
    v_lshrrev_b32 v249, 1, v249
    v_or_b32 v251, v251, v249
    v_lshl_add_u32 v250, v247, 7, v250
    v_xor_b32 v252, 0, v251
    v_lshl_add_u32 v222, v252, 5, v250
    v_xor_b32 v252, 1, v251
    v_lshl_add_u32 v223, v252, 5, v250
    v_xor_b32 v252, 2, v251
    v_lshl_add_u32 v224, v252, 5, v250
    s_add_u32 m0, s50, 4096
    s_nop 0
    buffer_load_dwordx4 v212, s[4:7], s20 offen lds
    v_xor_b32 v252, 3, v251
    v_lshl_add_u32 v225, v252, 5, v250
    v_xor_b32 v252, s29, v251
    v_lshl_add_u32 v252, v252, 5, v250
    v_add_u32 v242, 0, v252
    v_add_u32 v243, 512, v252
    s_lshr_b32 s34, s83, 2
    s_lshl_b32 s34, s34, 12
    s_add_u32 s35, s34, 512
    s_cmp_ge_u32 s83, 4
    s_cbranch_scc1 k1_kernel_O_win
    v_add_u32 v234, s34, v252
    v_add_u32 v235, s35, v252
k1_kernel_O_win:
    v_and_b32 v251, 15, v255
    v_lshrrev_b32 v252, 1, v251
    v_xor_b32 v252, v252, v246
    v_lshlrev_b32 v252, 4, v252
    s_add_u32 m0, s50, 5120
    s_nop 0
    buffer_load_dwordx4 v213, s[4:7], s20 offen lds
    v_lshl_add_u32 v238, v251, 7, v252
    v_xor_b32 v239, 64, v238
    v_add_u32 v240, s50, v238
    v_add_u32 v241, s50, v239
    v_mov_b32 v251, 0x3f803f80
    v_accvgpr_write_b32 a112, v251
    v_accvgpr_write_b32 a113, v251
    v_accvgpr_write_b32 a114, v251
    v_accvgpr_write_b32 a115, v251
    v_accvgpr_write_b32 a96, 0
    v_accvgpr_write_b32 a97, 0
    v_accvgpr_write_b32 a98, 0
    v_accvgpr_write_b32 a99, 0
    v_accvgpr_write_b32 a100, 0
    s_mov_b32 m0, s40
    s_nop 0
    buffer_load_dwordx4 v219, s[12:15], s22 offen lds
    v_accvgpr_write_b32 a101, 0
    v_accvgpr_write_b32 a102, 0
    v_accvgpr_write_b32 a103, 0
    v_accvgpr_write_b32 a104, 0
    v_accvgpr_write_b32 a105, 0
    v_accvgpr_write_b32 a106, 0
    v_accvgpr_write_b32 a107, 0
    v_accvgpr_write_b32 a108, 0
    v_accvgpr_write_b32 a109, 0
    v_accvgpr_write_b32 a110, 0
    v_accvgpr_write_b32 a111, 0
    v_accvgpr_write_b32 a116, 0
    v_accvgpr_write_b32 a117, 0
    s_add_u32 m0, s50, 6144
    s_nop 0
    buffer_load_dwordx4 v214, s[4:7], s20 offen lds
    v_accvgpr_write_b32 a118, 0
    v_accvgpr_write_b32 a119, 0
    v_and_b32 v252, 7, v255
    v_lshlrev_b32 v252, 5, v252
    v_mov_b32 v253, 32
    s_lshl_b32 s34, s2, 2
    s_add_u32 s34, s34, s29
    s_lshl_b32 s80, s34, 13
    s_mul_i32 s81, s34, 3584
    s_lshl_b32 s82, s34, 11
    v_mov_b32 v24, 0
    v_mov_b32 v25, 0
    v_mov_b32 v26, 0
    v_mov_b32 v27, 0
    s_add_u32 m0, s50, 7168
    s_nop 0
    buffer_load_dwordx4 v215, s[4:7], s20 offen lds
    s_add_u32 s21, s21, 196608
    s_add_u32 s22, s22, 229376
    s_add_u32 s20, s20, 128
    v_mov_b32 v28, 0
    v_mov_b32 v29, 0
    v_mov_b32 v30, 0
    v_mov_b32 v31, 0
    v_mov_b32 v32, 0
    v_mov_b32 v33, 0
    v_mov_b32 v34, 0
    v_mov_b32 v35, 0
    v_mov_b32 v36, 0
    v_mov_b32 v37, 0
    v_mov_b32 v38, 0
    v_mov_b32 v39, 0
    v_mov_b32 v40, 0
    v_mov_b32 v41, 0
    s_add_u32 m0, s24, 13312
    s_nop 0
    buffer_load_dwordx4 v216, s[8:11], s21 offen lds
    v_mov_b32 v42, 0
    v_mov_b32 v43, 0
    v_mov_b32 v44, 0
    v_mov_b32 v45, 0
    v_mov_b32 v46, 0
    v_mov_b32 v47, 0
    v_mov_b32 v48, 0
    v_mov_b32 v49, 0
    v_mov_b32 v50, 0
    v_mov_b32 v51, 0
    v_mov_b32 v52, 0
    v_mov_b32 v53, 0
    v_mov_b32 v54, 0
    v_mov_b32 v55, 0
    s_add_u32 m0, s50, 8192
    s_nop 0
    buffer_load_dwordx4 v208, s[4:7], s20 offen lds
    v_mov_b32 v56, 0
    v_mov_b32 v57, 0
    v_mov_b32 v58, 0
    v_mov_b32 v59, 0
    v_mov_b32 v60, 0
    v_mov_b32 v61, 0
    v_mov_b32 v62, 0
    v_mov_b32 v63, 0
    v_mov_b32 v64, 0
    v_mov_b32 v65, 0
    v_mov_b32 v66, 0
    v_mov_b32 v67, 0
    v_mov_b32 v68, 0
    v_mov_b32 v69, 0
    s_add_u32 m0, s50, 9216
    s_nop 0
    buffer_load_dwordx4 v209, s[4:7], s20 offen lds
    v_mov_b32 v70, 0
    v_mov_b32 v71, 0
    v_mov_b32 v72, 0
    v_mov_b32 v73, 0
    v_mov_b32 v74, 0
    v_mov_b32 v75, 0
    v_mov_b32 v76, 0
    v_mov_b32 v77, 0
    v_mov_b32 v78, 0
    v_mov_b32 v79, 0
    v_mov_b32 v80, 0
    v_mov_b32 v81, 0
    v_mov_b32 v82, 0
    s_add_u32 m0, s24, 17408
    s_nop 0
    buffer_load_dwordx4 v217, s[12:15], s22 offen lds
    v_mov_b32 v83, 0
    v_mov_b32 v84, 0
    v_mov_b32 v85, 0
    v_mov_b32 v86, 0
    v_mov_b32 v87, 0
    v_mov_b32 v88, 0
    v_mov_b32 v89, 0
    v_mov_b32 v90, 0
    v_mov_b32 v91, 0
    v_mov_b32 v92, 0
    v_mov_b32 v93, 0
    v_mov_b32 v94, 0
    v_mov_b32 v95, 0
    v_mov_b32 v96, 0
    s_add_u32 m0, s50, 10240
    s_nop 0
    buffer_load_dwordx4 v210, s[4:7], s20 offen lds
    v_mov_b32 v97, 0
    v_mov_b32 v98, 0
    v_mov_b32 v99, 0
    v_mov_b32 v100, 0
    v_mov_b32 v101, 0
    v_mov_b32 v102, 0
    v_mov_b32 v103, 0
    v_mov_b32 v104, 0
    v_mov_b32 v105, 0
    v_mov_b32 v106, 0
    v_mov_b32 v107, 0
    v_mov_b32 v108, 0
    v_mov_b32 v109, 0
    v_mov_b32 v110, 0
    s_add_u32 m0, s50, 11264
    s_nop 0
    buffer_load_dwordx4 v211, s[4:7], s20 offen lds
    v_mov_b32 v111, 0
    v_mov_b32 v112, 0
    v_mov_b32 v113, 0
    v_mov_b32 v114, 0
    v_mov_b32 v115, 0
    v_mov_b32 v116, 0
    v_mov_b32 v117, 0
    v_mov_b32 v118, 0
    v_mov_b32 v119, 0
    v_mov_b32 v120, 0
    v_mov_b32 v121, 0
    v_mov_b32 v122, 0
    v_mov_b32 v123, 0
    v_mov_b32 v124, 0
    s_add_u32 m0, s24, 21504
    s_nop 0
    buffer_load_dwordx4 v218, s[12:15], s22 offen lds
    v_mov_b32 v125, 0
    v_mov_b32 v126, 0
    v_mov_b32 v127, 0
    v_mov_b32 v128, 0
    v_mov_b32 v129, 0
    v_mov_b32 v130, 0
    v_mov_b32 v131, 0
    v_mov_b32 v132, 0
    v_mov_b32 v133, 0
    v_mov_b32 v134, 0
    v_mov_b32 v135, 0
    v_mov_b32 v136, 0
    v_mov_b32 v137, 0
    v_mov_b32 v138, 0
    s_add_u32 m0, s50, 12288
    s_nop 0
    buffer_load_dwordx4 v212, s[4:7], s20 offen lds
    v_mov_b32 v139, 0
    v_mov_b32 v140, 0
    v_mov_b32 v141, 0
    v_mov_b32 v142, 0
    v_mov_b32 v143, 0
    v_mov_b32 v144, 0
    v_mov_b32 v145, 0
    v_mov_b32 v146, 0
    v_mov_b32 v147, 0
    v_mov_b32 v148, 0
    v_mov_b32 v149, 0
    v_mov_b32 v150, 0
    v_mov_b32 v151, 0
    s_add_u32 m0, s50, 13312
    s_nop 0
    buffer_load_dwordx4 v213, s[4:7], s20 offen lds
    v_mov_b32 v152, 0
    v_mov_b32 v153, 0
    v_mov_b32 v154, 0
    v_mov_b32 v155, 0
    v_mov_b32 v156, 0
    v_mov_b32 v157, 0
    v_mov_b32 v158, 0
    v_mov_b32 v159, 0
    v_mov_b32 v160, 0
    v_mov_b32 v161, 0
    v_mov_b32 v162, 0
    v_mov_b32 v163, 0
    v_mov_b32 v164, 0
    v_mov_b32 v165, 0
    s_mov_b32 m0, s41
    s_nop 0
    buffer_load_dwordx4 v219, s[12:15], s22 offen lds
    v_mov_b32 v166, 0
    v_mov_b32 v167, 0
    v_mov_b32 v168, 0
    v_mov_b32 v169, 0
    v_mov_b32 v170, 0
    v_mov_b32 v171, 0
    v_mov_b32 v172, 0
    v_mov_b32 v173, 0
    v_mov_b32 v174, 0
    v_mov_b32 v175, 0
    v_mov_b32 v176, 0
    v_mov_b32 v177, 0
    v_mov_b32 v178, 0
    v_mov_b32 v179, 0
    s_add_u32 m0, s50, 14336
    s_nop 0
    buffer_load_dwordx4 v214, s[4:7], s20 offen lds
    v_mov_b32 v180, 0
    v_mov_b32 v181, 0
    v_mov_b32 v182, 0
    v_mov_b32 v183, 0
    v_mov_b32 v184, 0
    v_mov_b32 v185, 0
    v_mov_b32 v186, 0
    v_mov_b32 v187, 0
    v_mov_b32 v188, 0
    v_mov_b32 v189, 0
    v_mov_b32 v190, 0
    v_mov_b32 v191, 0
    v_mov_b32 v192, 0
    v_mov_b32 v193, 0
    s_add_u32 m0, s50, 15360
    s_nop 0
    buffer_load_dwordx4 v215, s[4:7], s20 offen lds
    s_add_u32 s21, s21, 196608
    s_add_u32 s22, s22, 229376
    s_add_u32 s20, s20, 128
    v_mov_b32 v194, 0
    v_mov_b32 v195, 0
    v_mov_b32 v196, 0
    v_mov_b32 v197, 0
    v_mov_b32 v198, 0
    v_mov_b32 v199, 0
    v_mov_b32 v200, 0
    v_mov_b32 v201, 0
    v_mov_b32 v202, 0
    v_mov_b32 v203, 0
    v_mov_b32 v204, 0
    v_mov_b32 v205, 0
    v_mov_b32 v206, 0
    v_mov_b32 v207, 0
    s_waitcnt vmcnt(24)
    s_add_u32 m0, s24, 26624
    s_nop 0
    buffer_load_dwordx4 v216, s[8:11], s21 offen lds
    v_mov_b32 v21, 0x3f803f80
    v_dot2_f32_bf16 v16, v0, v21, 0
    v_dot2_f32_bf16 v18, v0, v0, 0
    v_dot2_f32_bf16 v17, v1, v21, 0
    v_dot2_f32_bf16 v19, v1, v1, 0
    v_dot2_f32_bf16 v16, v2, v21, v16
    v_dot2_f32_bf16 v18, v2, v2, v18
    v_dot2_f32_bf16 v17, v3, v21, v17
    v_dot2_f32_bf16 v19, v3, v3, v19
    v_dot2_f32_bf16 v16, v4, v21, v16
    s_add_u32 m0, s50, 16384
    s_nop 0
    buffer_load_dwordx4 v208, s[4:7], s20 offen lds
    v_dot2_f32_bf16 v18, v4, v4, v18
    v_dot2_f32_bf16 v17, v5, v21, v17
    v_dot2_f32_bf16 v19, v5, v5, v19
    v_dot2_f32_bf16 v16, v6, v21, v16
    v_dot2_f32_bf16 v18, v6, v6, v18
    v_dot2_f32_bf16 v17, v7, v21, v17
    v_dot2_f32_bf16 v19, v7, v7, v19
    v_dot2_f32_bf16 v16, v8, v21, v16
    v_dot2_f32_bf16 v18, v8, v8, v18
    v_dot2_f32_bf16 v17, v9, v21, v17
    s_add_u32 m0, s24, 30720
    s_nop 0
    buffer_load_dwordx4 v217, s[12:15], s22 offen lds
    v_dot2_f32_bf16 v19, v9, v9, v19
    v_dot2_f32_bf16 v16, v10, v21, v16
    v_dot2_f32_bf16 v18, v10, v10, v18
    v_dot2_f32_bf16 v17, v11, v21, v17
    v_dot2_f32_bf16 v19, v11, v11, v19
    v_dot2_f32_bf16 v16, v12, v21, v16
    v_dot2_f32_bf16 v18, v12, v12, v18
    v_dot2_f32_bf16 v17, v13, v21, v17
    v_dot2_f32_bf16 v19, v13, v13, v19
    v_dot2_f32_bf16 v16, v14, v21, v16
    s_add_u32 m0, s50, 17408
    s_nop 0
    buffer_load_dwordx4 v209, s[4:7], s20 offen lds
    v_dot2_f32_bf16 v18, v14, v14, v18
    v_dot2_f32_bf16 v17, v15, v21, v17
    v_dot2_f32_bf16 v19, v15, v15, v19
    v_mov_b32 v0, -1
    v_mov_b32 v1, -1
    v_and_b32 v8, 48, v255
    v_mov_b32 v2, -1
    v_mov_b32 v3, -1
    v_mov_b32 v4, 0
    v_add_f32 v16, v16, v17
    v_add_f32 v17, v18, v19
    s_add_u32 m0, s24, 34816
    s_nop 0
    buffer_load_dwordx4 v218, s[12:15], s22 offen lds
    v_lshlrev_b32 v5, 3, v255
    v_lshlrev_b32 v6, 2, v255
    v_add_f32_dpp v16, v16, v16 row_ror:8 row_mask:0xf bank_mask:0xf
    v_add_f32_dpp v17, v17, v17 row_ror:8 row_mask:0xf bank_mask:0xf
    s_nop 0
    v_add_f32_dpp v16, v16, v16 row_ror:4 row_mask:0xf bank_mask:0xf
    v_add_f32_dpp v17, v17, v17 row_ror:4 row_mask:0xf bank_mask:0xf
    s_nop 0
    v_add_f32_dpp v16, v16, v16 row_ror:2 row_mask:0xf bank_mask:0xf
    v_add_f32_dpp v17, v17, v17 row_ror:2 row_mask:0xf bank_mask:0xf
    s_add_u32 m0, s50, 18432
    s_nop 0
    buffer_load_dwordx4 v210, s[4:7], s20 offen lds
    s_nop 0
    v_add_f32_dpp v16, v16, v16 row_ror:1 row_mask:0xf bank_mask:0xf
    v_add_f32_dpp v17, v17, v17 row_ror:1 row_mask:0xf bank_mask:0xf
    s_nop 0
    v_mov_b32 v18, v16
    v_mov_b32 v19, v17
    v_lshrrev_b32 v7, 5, v255
    v_lshlrev_b32 v7, 3, v7
    v_permlane16_swap_b32 v18, v16
    v_permlane16_swap_b32 v19, v17
    s_mov_b32 m0, s42
    s_nop 0
    buffer_load_dwordx4 v219, s[12:15], s22 offen lds
    v_add_f32 v16, v16, v18
    v_add_f32 v17, v17, v19
    v_mul_f32 v16, 0x3a800000, v16
    v_mul_f32 v17, 0x3a800000, v17
    v_fma_f32 v17, -v16, v16, v17
    v_max_f32 v17, 0, v17
    v_cvt_pk_bf16_f32 v17, v17, v17
    v_lshlrev_b32 v17, 16, v17
    v_add_f32 v17, 0x3727c5ac, v17
    v_cvt_pk_bf16_f32 v17, v17, v17
    s_add_u32 m0, s50, 19456
    s_nop 0
    buffer_load_dwordx4 v211, s[4:7], s20 offen lds
    s_add_u32 s21, s21, 196608
    s_add_u32 s22, s22, 229376
    v_lshlrev_b32 v17, 16, v17
    v_sqrt_f32 v17, v17
    v_cvt_pk_bf16_f32 v16, v16, v16
    v_lshlrev_b32 v16, 16, v16
    v_cvt_pk_bf16_f32 v17, v17, v17
    v_lshlrev_b32 v17, 16, v17
    v_rcp_f32 v17, v17
    s_nop 0
    v_sub_f32 v18, 0, v16
    v_mov_b32 v16, v17
    v_mov_b32 v17, v18
    s_mov_b32 exec_lo, 1
    s_mov_b32 exec_hi, 1
    buffer_store_dwordx2 v[16:17], v7, s[16:19], s57 offen sc1
    s_mov_b64 exec, s[84:85]
    buffer_store_dwordx4 v[0:3], v8, s[16:19], s86 offen sc1
    s_mov_b64 exec, -1
    s_cmp_lt_u32 s32, 8
    s_cbranch_scc1 k1_kernel_O_nost
    buffer_store_dwordx2 v[2:3], v5, s[16:19], s58 offen sc1
k1_kernel_O_nost:
    s_cmp_lg_u32 s29, 0
    s_cbranch_scc1 k1_kernel_O_nofl
    buffer_store_dword v4, v6, s[16:19], s59 offen
k1_kernel_O_nofl:
    s_nop 1
    v_mov_b32 v0, 0
    v_mov_b32 v1, 0
    v_mov_b32 v2, 0
    v_mov_b32 v3, 0
    v_mov_b32 v4, 0
    v_mov_b32 v5, 0
    v_mov_b32 v6, 0
    v_mov_b32 v7, 0
    v_mov_b32 v8, 0
    v_mov_b32 v9, 0
    v_mov_b32 v10, 0
    v_mov_b32 v11, 0
    v_mov_b32 v12, 0
    v_mov_b32 v13, 0
    v_mov_b32 v14, 0
    v_mov_b32 v15, 0
    v_mov_b32 v16, 0
    v_mov_b32 v17, 0
    v_mov_b32 v18, 0
    v_mov_b32 v19, 0
    v_mov_b32 v20, 0
    v_mov_b32 v21, 0
    v_mov_b32 v22, 0
    v_mov_b32 v23, 0
    s_waitcnt vmcnt(20)
    s_barrier
    ds_read_b128 a[52:55], v240 offset:0
    ds_read_b128 a[56:59], v240 offset:2048
    ds_read_b128 a[60:63], v240 offset:4096
    ds_read_b128 a[64:67], v240 offset:6144
    ds_read_b64_tr_b16 a[0:1], v222 offset:0
    ds_read_b64_tr_b16 a[2:3], v222 offset:512
    ds_read_b64_tr_b16 a[4:5], v223 offset:0
    ds_read_b64_tr_b16 a[6:7], v223 offset:512
    ds_read_b64_tr_b16 a[8:9], v224 offset:0
    ds_read_b64_tr_b16 a[10:11], v224 offset:512
    ds_read_b64_tr_b16 a[12:13], v225 offset:0
    ds_read_b64_tr_b16 a[14:15], v225 offset:512
    s_mov_b32 s33, 7
    .p2align 4
k1_kernel_loop_2:
    s_waitcnt lgkmcnt(6)
    v_mfma_f32_16x16x32_bf16 v[0:3], a[0:3], a[52:55], v[0:3]
    ds_read_b64_tr_b16 a[16:17], v226 offset:4096
    v_mfma_f32_16x16x32_bf16 v[4:7], a[0:3], a[56:59], v[4:7]
    ds_read_b64_tr_b16 a[18:19], v230 offset:5120
    ds_read_b64_tr_b16 a[84:85], v234 offset:0
    v_mfma_f32_16x16x32_bf16 v[8:11], a[0:3], a[60:63], v[8:11]
    ds_read_b128 a[68:71], v241 offset:0
    s_add_u32 m0, s24, 39936
    v_mfma_f32_16x16x32_bf16 v[12:15], a[0:3], a[64:67], v[12:15]
    buffer_load_dwordx4 v216, s[8:11], s21 offen lds
    s_waitcnt lgkmcnt(8)
    v_mfma_f32_16x16x32_bf16 v[28:31], a[4:7], a[64:67], v[28:31]
    ds_read_b64_tr_b16 a[20:21], v227 offset:4096
    v_mfma_f32_16x16x32_bf16 v[24:27], a[4:7], a[60:63], v[24:27]
    ds_read_b64_tr_b16 a[22:23], v231 offset:5120
    ds_read_b64_tr_b16 a[86:87], v235 offset:0
    v_mfma_f32_16x16x32_bf16 v[20:23], a[4:7], a[56:59], v[20:23]
    s_add_u32 m0, s48, 4096
    v_mfma_f32_16x16x32_bf16 v[16:19], a[4:7], a[52:55], v[16:19]
    buffer_load_dwordx4 v212, s[4:7], s20 offen lds
    s_waitcnt lgkmcnt(9)
    v_mfma_f32_16x16x32_bf16 v[32:35], a[8:11], a[52:55], v[32:35]
    ds_read_b64_tr_b16 a[24:25], v228 offset:4096
    v_mfma_f32_16x16x32_bf16 v[36:39], a[8:11], a[56:59], v[36:39]
    ds_read_b64_tr_b16 a[26:27], v232 offset:5120
    v_mfma_f32_16x16x32_bf16 v[40:43], a[8:11], a[60:63], v[40:43]
    ds_read_b128 a[72:75], v241 offset:2048
    s_add_u32 m0, s24, 44032
    v_mfma_f32_16x16x32_bf16 v[44:47], a[8:11], a[64:67], v[44:47]
    buffer_load_dwordx4 v217, s[12:15], s22 offen lds
    s_waitcnt lgkmcnt(10)
    v_mfma_f32_16x16x32_bf16 v[60:63], a[12:15], a[64:67], v[60:63]
    ds_read_b64_tr_b16 a[28:29], v229 offset:4096
    v_mfma_f32_16x16x32_bf16 v[56:59], a[12:15], a[60:63], v[56:59]
    ds_read_b64_tr_b16 a[30:31], v233 offset:5120
    v_mfma_f32_16x16x32_bf16 v[52:55], a[12:15], a[56:59], v[52:55]
    s_add_u32 m0, s48, 5120
    v_mfma_f32_16x16x32_bf16 v[48:51], a[12:15], a[52:55], v[48:51]
    buffer_load_dwordx4 v213, s[4:7], s20 offen lds
    s_waitcnt lgkmcnt(10)
    v_mfma_f32_16x16x32_bf16 v[64:67], a[16:19], a[52:55], v[64:67]
    ds_read_b64_tr_b16 a[32:33], v230 offset:4096
    v_mfma_f32_16x16x32_bf16 v[68:71], a[16:19], a[56:59], v[68:71]
    ds_read_b64_tr_b16 a[34:35], v226 offset:5376
    v_mfma_f32_16x16x32_bf16 v[72:75], a[16:19], a[60:63], v[72:75]
    ds_read_b128 a[76:79], v241 offset:4096
    s_add_u32 m0, s24, 48128
    v_mfma_f32_16x16x32_bf16 v[76:79], a[16:19], a[64:67], v[76:79]
    buffer_load_dwordx4 v218, s[12:15], s22 offen lds
    s_waitcnt lgkmcnt(9)
    v_mfma_f32_16x16x32_bf16 v[92:95], a[20:23], a[64:67], v[92:95]
    ds_read_b64_tr_b16 a[36:37], v231 offset:4096
    v_mfma_f32_16x16x32_bf16 v[88:91], a[20:23], a[60:63], v[88:91]
    ds_read_b64_tr_b16 a[38:39], v227 offset:5376
    v_mfma_f32_16x16x32_bf16 v[84:87], a[20:23], a[56:59], v[84:87]
    s_add_u32 m0, s48, 6144
    v_mfma_f32_16x16x32_bf16 v[80:83], a[20:23], a[52:55], v[80:83]
    buffer_load_dwordx4 v214, s[4:7], s20 offen lds
    s_waitcnt lgkmcnt(8)
    v_mfma_f32_16x16x32_bf16 v[96:99], a[24:27], a[52:55], v[96:99]
    ds_read_b64_tr_b16 a[40:41], v232 offset:4096
    v_mfma_f32_16x16x32_bf16 v[100:103], a[24:27], a[56:59], v[100:103]
    ds_read_b64_tr_b16 a[42:43], v228 offset:5376
    v_mfma_f32_16x16x32_bf16 v[104:107], a[24:27], a[60:63], v[104:107]
    ds_read_b128 a[80:83], v241 offset:6144
    s_mov_b32 m0, s43
    v_mfma_f32_16x16x32_bf16 v[108:111], a[24:27], a[64:67], v[108:111]
    buffer_load_dwordx4 v219, s[12:15], s22 offen lds
    s_waitcnt lgkmcnt(8)
    v_mfma_f32_16x16x32_bf16 v[124:127], a[28:31], a[64:67], v[124:127]
    ds_read_b64_tr_b16 a[44:45], v233 offset:4096
    v_mfma_f32_16x16x32_bf16 v[120:123], a[28:31], a[60:63], v[120:123]
    ds_read_b64_tr_b16 a[46:47], v229 offset:5376
    v_mfma_f32_16x16x32_bf16 v[116:119], a[28:31], a[56:59], v[116:119]
    s_add_u32 m0, s48, 7168
    v_mfma_f32_16x16x32_bf16 v[112:115], a[28:31], a[52:55], v[112:115]
    buffer_load_dwordx4 v215, s[4:7], s20 offen lds
    s_waitcnt lgkmcnt(8)
    v_mfma_f32_16x16x32_bf16 v[128:131], a[32:35], a[52:55], v[128:131]
    ds_read_b64_tr_b16 a[48:49], v226 offset:4352
    v_mfma_f32_16x16x32_bf16 v[132:135], a[32:35], a[56:59], v[132:135]
    ds_read_b64_tr_b16 a[50:51], v230 offset:5376
    v_mfma_f32_16x16x32_bf16 v[136:139], a[32:35], a[60:63], v[136:139]
    s_add_u32 s21, s21, 196608
    v_mfma_f32_16x16x32_bf16 v[140:143], a[32:35], a[64:67], v[140:143]
    s_add_u32 s22, s22, 229376
    s_waitcnt lgkmcnt(7)
    v_mfma_f32_16x16x32_bf16 v[156:159], a[36:39], a[64:67], v[156:159]
    v_mfma_f32_16x16x32_bf16 a[116:119], a[84:87], a[112:115], a[116:119]
    v_mfma_f32_16x16x32_bf16 v[152:155], a[36:39], a[60:63], v[152:155]
    v_mfma_f32_16x16x32_bf16 v[148:151], a[36:39], a[56:59], v[148:151]
    s_add_u32 s20, s20, 128
    v_mfma_f32_16x16x32_bf16 v[144:147], a[36:39], a[52:55], v[144:147]
    s_waitcnt vmcnt(16) lgkmcnt(0)
    s_barrier
    v_mfma_f32_16x16x32_bf16 v[160:163], a[40:43], a[52:55], v[160:163]
    ds_read_b64_tr_b16 a[0:1], v222 offset:13312
    v_mfma_f32_16x16x32_bf16 v[164:167], a[40:43], a[56:59], v[164:167]
    ds_read_b64_tr_b16 a[2:3], v222 offset:13824
    v_mfma_f32_16x16x32_bf16 v[168:171], a[40:43], a[60:63], v[168:171]
    ds_read_b64_tr_b16 a[4:5], v223 offset:13312
    v_mfma_f32_16x16x32_bf16 v[172:175], a[40:43], a[64:67], v[172:175]
    ds_read_b64_tr_b16 a[6:7], v223 offset:13824
    v_mfma_f32_16x16x32_bf16 v[188:191], a[44:47], a[64:67], v[188:191]
    ds_read_b64_tr_b16 a[8:9], v224 offset:13312
    v_mfma_f32_16x16x32_bf16 v[184:187], a[44:47], a[60:63], v[184:187]
    ds_read_b64_tr_b16 a[10:11], v224 offset:13824
    v_mfma_f32_16x16x32_bf16 v[180:183], a[44:47], a[56:59], v[180:183]
    ds_read_b64_tr_b16 a[12:13], v225 offset:13312
    v_mfma_f32_16x16x32_bf16 v[176:179], a[44:47], a[52:55], v[176:179]
    ds_read_b64_tr_b16 a[14:15], v225 offset:13824
    v_mfma_f32_16x16x32_bf16 v[192:195], a[48:51], a[52:55], v[192:195]
    s_mov_b32 s48, s49
    s_add_u32 s49, s49, 8192
    v_mfma_f32_16x16x32_bf16 v[196:199], a[48:51], a[56:59], v[196:199]
    v_mfma_f32_16x16x32_bf16 v[200:203], a[48:51], a[60:63], v[200:203]
    s_cmp_eq_u32 s49, s51
    s_cselect_b32 s49, s50, s49
    v_mfma_f32_16x16x32_bf16 v[204:207], a[48:51], a[64:67], v[204:207]
    v_add_u32 v240, s49, v238
    v_add_u32 v241, s49, v239
    s_waitcnt lgkmcnt(6)
    v_mfma_f32_16x16x32_bf16 v[12:15], a[0:3], a[80:83], v[12:15]
    ds_read_b64_tr_b16 a[16:17], v226 offset:17408
    v_mfma_f32_16x16x32_bf16 v[8:11], a[0:3], a[76:79], v[8:11]
    ds_read_b64_tr_b16 a[18:19], v230 offset:18432
    ds_read_b64_tr_b16 a[84:85], v234 offset:13312
    v_mfma_f32_16x16x32_bf16 v[4:7], a[0:3], a[72:75], v[4:7]
    ds_read_b128 a[52:55], v240 offset:0
    s_add_u32 m0, s24, 0
    v_mfma_f32_16x16x32_bf16 v[0:3], a[0:3], a[68:71], v[0:3]
    buffer_load_dwordx4 v216, s[8:11], s21 offen lds
    s_waitcnt lgkmcnt(8)
    v_mfma_f32_16x16x32_bf16 v[16:19], a[4:7], a[68:71], v[16:19]
    ds_read_b64_tr_b16 a[20:21], v227 offset:17408
    v_mfma_f32_16x16x32_bf16 v[20:23], a[4:7], a[72:75], v[20:23]
    ds_read_b64_tr_b16 a[22:23], v231 offset:18432
    ds_read_b64_tr_b16 a[86:87], v235 offset:13312
    v_mfma_f32_16x16x32_bf16 v[24:27], a[4:7], a[76:79], v[24:27]
    s_add_u32 m0, s48, 0
    v_mfma_f32_16x16x32_bf16 v[28:31], a[4:7], a[80:83], v[28:31]
    buffer_load_dwordx4 v208, s[4:7], s20 offen lds
    s_waitcnt lgkmcnt(9)
    v_mfma_f32_16x16x32_bf16 v[44:47], a[8:11], a[80:83], v[44:47]
    ds_read_b64_tr_b16 a[24:25], v228 offset:17408
    v_mfma_f32_16x16x32_bf16 v[40:43], a[8:11], a[76:79], v[40:43]
    ds_read_b64_tr_b16 a[26:27], v232 offset:18432
    v_mfma_f32_16x16x32_bf16 v[36:39], a[8:11], a[72:75], v[36:39]
    ds_read_b128 a[56:59], v240 offset:2048
    s_add_u32 m0, s24, 4096
    v_mfma_f32_16x16x32_bf16 v[32:35], a[8:11], a[68:71], v[32:35]
    buffer_load_dwordx4 v217, s[12:15], s22 offen lds
    s_waitcnt lgkmcnt(10)
    v_mfma_f32_16x16x32_bf16 v[48:51], a[12:15], a[68:71], v[48:51]
    ds_read_b64_tr_b16 a[28:29], v229 offset:17408
    v_mfma_f32_16x16x32_bf16 v[52:55], a[12:15], a[72:75], v[52:55]
    ds_read_b64_tr_b16 a[30:31], v233 offset:18432
    v_mfma_f32_16x16x32_bf16 v[56:59], a[12:15], a[76:79], v[56:59]
    s_add_u32 m0, s48, 1024
    v_mfma_f32_16x16x32_bf16 v[60:63], a[12:15], a[80:83], v[60:63]
    buffer_load_dwordx4 v209, s[4:7], s20 offen lds
    s_waitcnt lgkmcnt(10)
    v_mfma_f32_16x16x32_bf16 v[76:79], a[16:19], a[80:83], v[76:79]
    ds_read_b64_tr_b16 a[32:33], v230 offset:17408
    v_mfma_f32_16x16x32_bf16 v[72:75], a[16:19], a[76:79], v[72:75]
    ds_read_b64_tr_b16 a[34:35], v226 offset:18688
    v_mfma_f32_16x16x32_bf16 v[68:71], a[16:19], a[72:75], v[68:71]
    ds_read_b128 a[60:63], v240 offset:4096
    s_add_u32 m0, s24, 8192
    v_mfma_f32_16x16x32_bf16 v[64:67], a[16:19], a[68:71], v[64:67]
    buffer_load_dwordx4 v218, s[12:15], s22 offen lds
    s_waitcnt lgkmcnt(9)
    v_mfma_f32_16x16x32_bf16 v[80:83], a[20:23], a[68:71], v[80:83]
    ds_read_b64_tr_b16 a[36:37], v231 offset:17408
    v_mfma_f32_16x16x32_bf16 v[84:87], a[20:23], a[72:75], v[84:87]
    ds_read_b64_tr_b16 a[38:39], v227 offset:18688
    v_mfma_f32_16x16x32_bf16 v[88:91], a[20:23], a[76:79], v[88:91]
    s_add_u32 m0, s48, 2048
    v_mfma_f32_16x16x32_bf16 v[92:95], a[20:23], a[80:83], v[92:95]
    buffer_load_dwordx4 v210, s[4:7], s20 offen lds
    s_waitcnt lgkmcnt(8)
    v_mfma_f32_16x16x32_bf16 v[108:111], a[24:27], a[80:83], v[108:111]
    ds_read_b64_tr_b16 a[40:41], v232 offset:17408
    v_mfma_f32_16x16x32_bf16 v[104:107], a[24:27], a[76:79], v[104:107]
    ds_read_b64_tr_b16 a[42:43], v228 offset:18688
    v_mfma_f32_16x16x32_bf16 v[100:103], a[24:27], a[72:75], v[100:103]
    ds_read_b128 a[64:67], v240 offset:6144
    s_mov_b32 m0, s40
    v_mfma_f32_16x16x32_bf16 v[96:99], a[24:27], a[68:71], v[96:99]
    buffer_load_dwordx4 v219, s[12:15], s22 offen lds
    s_waitcnt lgkmcnt(8)
    v_mfma_f32_16x16x32_bf16 v[112:115], a[28:31], a[68:71], v[112:115]
    ds_read_b64_tr_b16 a[44:45], v233 offset:17408
    v_mfma_f32_16x16x32_bf16 v[116:119], a[28:31], a[72:75], v[116:119]
    ds_read_b64_tr_b16 a[46:47], v229 offset:18688
    v_mfma_f32_16x16x32_bf16 v[120:123], a[28:31], a[76:79], v[120:123]
    s_add_u32 m0, s48, 3072
    v_mfma_f32_16x16x32_bf16 v[124:127], a[28:31], a[80:83], v[124:127]
    buffer_load_dwordx4 v211, s[4:7], s20 offen lds
    s_waitcnt lgkmcnt(8)
    v_mfma_f32_16x16x32_bf16 v[140:143], a[32:35], a[80:83], v[140:143]
    ds_read_b64_tr_b16 a[48:49], v226 offset:17664
    v_mfma_f32_16x16x32_bf16 v[136:139], a[32:35], a[76:79], v[136:139]
    ds_read_b64_tr_b16 a[50:51], v230 offset:18688
    v_mfma_f32_16x16x32_bf16 v[132:135], a[32:35], a[72:75], v[132:135]
    s_add_u32 s21, s21, 196608
    v_mfma_f32_16x16x32_bf16 v[128:131], a[32:35], a[68:71], v[128:131]
    s_add_u32 s22, s22, 229376
    s_waitcnt lgkmcnt(7)
    v_mfma_f32_16x16x32_bf16 v[144:147], a[36:39], a[68:71], v[144:147]
    v_mfma_f32_16x16x32_bf16 a[116:119], a[84:87], a[112:115], a[116:119]
    v_mfma_f32_16x16x32_bf16 v[148:151], a[36:39], a[72:75], v[148:151]
    v_mfma_f32_16x16x32_bf16 v[152:155], a[36:39], a[76:79], v[152:155]
    v_mfma_f32_16x16x32_bf16 v[156:159], a[36:39], a[80:83], v[156:159]
    s_waitcnt vmcnt(17) lgkmcnt(0)
    s_barrier
    v_mfma_f32_16x16x32_bf16 v[172:175], a[40:43], a[80:83], v[172:175]
    ds_read_b64_tr_b16 a[0:1], v222 offset:26624
    v_mfma_f32_16x16x32_bf16 v[168:171], a[40:43], a[76:79], v[168:171]
    ds_read_b64_tr_b16 a[2:3], v222 offset:27136
    v_mfma_f32_16x16x32_bf16 v[164:167], a[40:43], a[72:75], v[164:167]
    ds_read_b64_tr_b16 a[4:5], v223 offset:26624
    v_mfma_f32_16x16x32_bf16 v[160:163], a[40:43], a[68:71], v[160:163]
    ds_read_b64_tr_b16 a[6:7], v223 offset:27136
    v_mfma_f32_16x16x32_bf16 v[176:179], a[44:47], a[68:71], v[176:179]
    ds_read_b64_tr_b16 a[8:9], v224 offset:26624
    v_mfma_f32_16x16x32_bf16 v[180:183], a[44:47], a[72:75], v[180:183]
    ds_read_b64_tr_b16 a[10:11], v224 offset:27136
    v_mfma_f32_16x16x32_bf16 v[184:187], a[44:47], a[76:79], v[184:187]
    ds_read_b64_tr_b16 a[12:13], v225 offset:26624
    v_mfma_f32_16x16x32_bf16 v[188:191], a[44:47], a[80:83], v[188:191]
    ds_read_b64_tr_b16 a[14:15], v225 offset:27136
    v_mfma_f32_16x16x32_bf16 v[204:207], a[48:51], a[80:83], v[204:207]
    v_mfma_f32_16x16x32_bf16 v[200:203], a[48:51], a[76:79], v[200:203]
    v_mfma_f32_16x16x32_bf16 v[196:199], a[48:51], a[72:75], v[196:199]
    v_mfma_f32_16x16x32_bf16 v[192:195], a[48:51], a[68:71], v[192:195]
    s_waitcnt lgkmcnt(6)
    v_mfma_f32_16x16x32_bf16 v[0:3], a[0:3], a[52:55], v[0:3]
    ds_read_b64_tr_b16 a[16:17], v226 offset:30720
    v_mfma_f32_16x16x32_bf16 v[4:7], a[0:3], a[56:59], v[4:7]
    ds_read_b64_tr_b16 a[18:19], v230 offset:31744
    ds_read_b64_tr_b16 a[84:85], v234 offset:26624
    v_mfma_f32_16x16x32_bf16 v[8:11], a[0:3], a[60:63], v[8:11]
    ds_read_b128 a[68:71], v241 offset:0
    s_add_u32 m0, s24, 13312
    v_mfma_f32_16x16x32_bf16 v[12:15], a[0:3], a[64:67], v[12:15]
    buffer_load_dwordx4 v216, s[8:11], s21 offen lds
    s_waitcnt lgkmcnt(8)
    v_mfma_f32_16x16x32_bf16 v[28:31], a[4:7], a[64:67], v[28:31]
    ds_read_b64_tr_b16 a[20:21], v227 offset:30720
    v_mfma_f32_16x16x32_bf16 v[24:27], a[4:7], a[60:63], v[24:27]
    ds_read_b64_tr_b16 a[22:23], v231 offset:31744
    ds_read_b64_tr_b16 a[86:87], v235 offset:26624
    v_mfma_f32_16x16x32_bf16 v[20:23], a[4:7], a[56:59], v[20:23]
    s_add_u32 m0, s48, 4096
    v_mfma_f32_16x16x32_bf16 v[16:19], a[4:7], a[52:55], v[16:19]
    buffer_load_dwordx4 v212, s[4:7], s20 offen lds
    s_waitcnt lgkmcnt(9)
    v_mfma_f32_16x16x32_bf16 v[32:35], a[8:11], a[52:55], v[32:35]
    ds_read_b64_tr_b16 a[24:25], v228 offset:30720
    v_mfma_f32_16x16x32_bf16 v[36:39], a[8:11], a[56:59], v[36:39]
    ds_read_b64_tr_b16 a[26:27], v232 offset:31744
    v_mfma_f32_16x16x32_bf16 v[40:43], a[8:11], a[60:63], v[40:43]
    ds_read_b128 a[72:75], v241 offset:2048
    s_add_u32 m0, s24, 17408
    v_mfma_f32_16x16x32_bf16 v[44:47], a[8:11], a[64:67], v[44:47]
    buffer_load_dwordx4 v217, s[12:15], s22 offen lds
    s_waitcnt lgkmcnt(10)
    v_mfma_f32_16x16x32_bf16 v[60:63], a[12:15], a[64:67], v[60:63]
    ds_read_b64_tr_b16 a[28:29], v229 offset:30720
    v_mfma_f32_16x16x32_bf16 v[56:59], a[12:15], a[60:63], v[56:59]
    ds_read_b64_tr_b16 a[30:31], v233 offset:31744
    v_mfma_f32_16x16x32_bf16 v[52:55], a[12:15], a[56:59], v[52:55]
    s_add_u32 m0, s48, 5120
    v_mfma_f32_16x16x32_bf16 v[48:51], a[12:15], a[52:55], v[48:51]
    buffer_load_dwordx4 v213, s[4:7], s20 offen lds
    s_waitcnt lgkmcnt(10)
    v_mfma_f32_16x16x32_bf16 v[64:67], a[16:19], a[52:55], v[64:67]
    ds_read_b64_tr_b16 a[32:33], v230 offset:30720
    v_mfma_f32_16x16x32_bf16 v[68:71], a[16:19], a[56:59], v[68:71]
    ds_read_b64_tr_b16 a[34:35], v226 offset:32000
    v_mfma_f32_16x16x32_bf16 v[72:75], a[16:19], a[60:63], v[72:75]
    ds_read_b128 a[76:79], v241 offset:4096
    s_add_u32 m0, s24, 21504
    v_mfma_f32_16x16x32_bf16 v[76:79], a[16:19], a[64:67], v[76:79]
    buffer_load_dwordx4 v218, s[12:15], s22 offen lds
    s_waitcnt lgkmcnt(9)
    v_mfma_f32_16x16x32_bf16 v[92:95], a[20:23], a[64:67], v[92:95]
    ds_read_b64_tr_b16 a[36:37], v231 offset:30720
    v_mfma_f32_16x16x32_bf16 v[88:91], a[20:23], a[60:63], v[88:91]
    ds_read_b64_tr_b16 a[38:39], v227 offset:32000
    v_mfma_f32_16x16x32_bf16 v[84:87], a[20:23], a[56:59], v[84:87]
    s_add_u32 m0, s48, 6144
    v_mfma_f32_16x16x32_bf16 v[80:83], a[20:23], a[52:55], v[80:83]
    buffer_load_dwordx4 v214, s[4:7], s20 offen lds
    s_waitcnt lgkmcnt(8)
    v_mfma_f32_16x16x32_bf16 v[96:99], a[24:27], a[52:55], v[96:99]
    ds_read_b64_tr_b16 a[40:41], v232 offset:30720
    v_mfma_f32_16x16x32_bf16 v[100:103], a[24:27], a[56:59], v[100:103]
    ds_read_b64_tr_b16 a[42:43], v228 offset:32000
    v_mfma_f32_16x16x32_bf16 v[104:107], a[24:27], a[60:63], v[104:107]
    ds_read_b128 a[80:83], v241 offset:6144
    s_mov_b32 m0, s41
    v_mfma_f32_16x16x32_bf16 v[108:111], a[24:27], a[64:67], v[108:111]
    buffer_load_dwordx4 v219, s[12:15], s22 offen lds
    s_waitcnt lgkmcnt(8)
    v_mfma_f32_16x16x32_bf16 v[124:127], a[28:31], a[64:67], v[124:127]
    ds_read_b64_tr_b16 a[44:45], v233 offset:30720
    v_mfma_f32_16x16x32_bf16 v[120:123], a[28:31], a[60:63], v[120:123]
    ds_read_b64_tr_b16 a[46:47], v229 offset:32000
    v_mfma_f32_16x16x32_bf16 v[116:119], a[28:31], a[56:59], v[116:119]
    s_add_u32 m0, s48, 7168
    v_mfma_f32_16x16x32_bf16 v[112:115], a[28:31], a[52:55], v[112:115]
    buffer_load_dwordx4 v215, s[4:7], s20 offen lds
    s_waitcnt lgkmcnt(8)
    v_mfma_f32_16x16x32_bf16 v[128:131], a[32:35], a[52:55], v[128:131]
    ds_read_b64_tr_b16 a[48:49], v226 offset:30976
    v_mfma_f32_16x16x32_bf16 v[132:135], a[32:35], a[56:59], v[132:135]
    ds_read_b64_tr_b16 a[50:51], v230 offset:32000
    v_mfma_f32_16x16x32_bf16 v[136:139], a[32:35], a[60:63], v[136:139]
    s_add_u32 s21, s21, 196608
    v_mfma_f32_16x16x32_bf16 v[140:143], a[32:35], a[64:67], v[140:143]
    s_add_u32 s22, s22, 229376
    s_waitcnt lgkmcnt(7)
    v_mfma_f32_16x16x32_bf16 v[156:159], a[36:39], a[64:67], v[156:159]
    v_mfma_f32_16x16x32_bf16 a[116:119], a[84:87], a[112:115], a[116:119]
    v_mfma_f32_16x16x32_bf16 v[152:155], a[36:39], a[60:63], v[152:155]
    v_mfma_f32_16x16x32_bf16 v[148:151], a[36:39], a[56:59], v[148:151]
    s_add_u32 s20, s20, 128
    v_mfma_f32_16x16x32_bf16 v[144:147], a[36:39], a[52:55], v[144:147]
    s_waitcnt vmcnt(16) lgkmcnt(0)
    s_barrier
    v_mfma_f32_16x16x32_bf16 v[160:163], a[40:43], a[52:55], v[160:163]
    ds_read_b64_tr_b16 a[0:1], v222 offset:39936
    v_mfma_f32_16x16x32_bf16 v[164:167], a[40:43], a[56:59], v[164:167]
    ds_read_b64_tr_b16 a[2:3], v222 offset:40448
    v_mfma_f32_16x16x32_bf16 v[168:171], a[40:43], a[60:63], v[168:171]
    ds_read_b64_tr_b16 a[4:5], v223 offset:39936
    v_mfma_f32_16x16x32_bf16 v[172:175], a[40:43], a[64:67], v[172:175]
    ds_read_b64_tr_b16 a[6:7], v223 offset:40448
    v_mfma_f32_16x16x32_bf16 v[188:191], a[44:47], a[64:67], v[188:191]
    ds_read_b64_tr_b16 a[8:9], v224 offset:39936
    v_mfma_f32_16x16x32_bf16 v[184:187], a[44:47], a[60:63], v[184:187]
    ds_read_b64_tr_b16 a[10:11], v224 offset:40448
    v_mfma_f32_16x16x32_bf16 v[180:183], a[44:47], a[56:59], v[180:183]
    ds_read_b64_tr_b16 a[12:13], v225 offset:39936
    v_mfma_f32_16x16x32_bf16 v[176:179], a[44:47], a[52:55], v[176:179]
    ds_read_b64_tr_b16 a[14:15], v225 offset:40448
    v_mfma_f32_16x16x32_bf16 v[192:195], a[48:51], a[52:55], v[192:195]
    s_mov_b32 s48, s49
    s_add_u32 s49, s49, 8192
    v_mfma_f32_16x16x32_bf16 v[196:199], a[48:51], a[56:59], v[196:199]
    v_mfma_f32_16x16x32_bf16 v[200:203], a[48:51], a[60:63], v[200:203]
    s_cmp_eq_u32 s49, s51
    s_cselect_b32 s49, s50, s49
    v_mfma_f32_16x16x32_bf16 v[204:207], a[48:51], a[64:67], v[204:207]
    v_add_u32 v240, s49, v238
    v_add_u32 v241, s49, v239
    s_waitcnt lgkmcnt(6)
    v_mfma_f32_16x16x32_bf16 v[12:15], a[0:3], a[80:83], v[12:15]
    ds_read_b64_tr_b16 a[16:17], v226 offset:44032
    v_mfma_f32_16x16x32_bf16 v[8:11], a[0:3], a[76:79], v[8:11]
    ds_read_b64_tr_b16 a[18:19], v230 offset:45056
    ds_read_b64_tr_b16 a[84:85], v234 offset:39936
    v_mfma_f32_16x16x32_bf16 v[4:7], a[0:3], a[72:75], v[4:7]
    ds_read_b128 a[52:55], v240 offset:0
    s_add_u32 m0, s24, 26624
    v_mfma_f32_16x16x32_bf16 v[0:3], a[0:3], a[68:71], v[0:3]
    buffer_load_dwordx4 v216, s[8:11], s21 offen lds
    s_waitcnt lgkmcnt(8)
    v_mfma_f32_16x16x32_bf16 v[16:19], a[4:7], a[68:71], v[16:19]
    ds_read_b64_tr_b16 a[20:21], v227 offset:44032
    v_mfma_f32_16x16x32_bf16 v[20:23], a[4:7], a[72:75], v[20:23]
    ds_read_b64_tr_b16 a[22:23], v231 offset:45056
    ds_read_b64_tr_b16 a[86:87], v235 offset:39936
    v_mfma_f32_16x16x32_bf16 v[24:27], a[4:7], a[76:79], v[24:27]
    s_add_u32 m0, s48, 0
    v_mfma_f32_16x16x32_bf16 v[28:31], a[4:7], a[80:83], v[28:31]
    buffer_load_dwordx4 v208, s[4:7], s20 offen lds
    s_waitcnt lgkmcnt(9)
    v_mfma_f32_16x16x32_bf16 v[44:47], a[8:11], a[80:83], v[44:47]
    ds_read_b64_tr_b16 a[24:25], v228 offset:44032
    v_mfma_f32_16x16x32_bf16 v[40:43], a[8:11], a[76:79], v[40:43]
    ds_read_b64_tr_b16 a[26:27], v232 offset:45056
    v_mfma_f32_16x16x32_bf16 v[36:39], a[8:11], a[72:75], v[36:39]
    ds_read_b128 a[56:59], v240 offset:2048
    s_add_u32 m0, s24, 30720
    v_mfma_f32_16x16x32_bf16 v[32:35], a[8:11], a[68:71], v[32:35]
    buffer_load_dwordx4 v217, s[12:15], s22 offen lds
    s_waitcnt lgkmcnt(10)
    v_mfma_f32_16x16x32_bf16 v[48:51], a[12:15], a[68:71], v[48:51]
    ds_read_b64_tr_b16 a[28:29], v229 offset:44032
    v_mfma_f32_16x16x32_bf16 v[52:55], a[12:15], a[72:75], v[52:55]
    ds_read_b64_tr_b16 a[30:31], v233 offset:45056
    v_mfma_f32_16x16x32_bf16 v[56:59], a[12:15], a[76:79], v[56:59]
    s_add_u32 m0, s48, 1024
    v_mfma_f32_16x16x32_bf16 v[60:63], a[12:15], a[80:83], v[60:63]
    buffer_load_dwordx4 v209, s[4:7], s20 offen lds
    s_waitcnt lgkmcnt(10)
    v_mfma_f32_16x16x32_bf16 v[76:79], a[16:19], a[80:83], v[76:79]
    ds_read_b64_tr_b16 a[32:33], v230 offset:44032
    v_mfma_f32_16x16x32_bf16 v[72:75], a[16:19], a[76:79], v[72:75]
    ds_read_b64_tr_b16 a[34:35], v226 offset:45312
    v_mfma_f32_16x16x32_bf16 v[68:71], a[16:19], a[72:75], v[68:71]
    ds_read_b128 a[60:63], v240 offset:4096
    s_add_u32 m0, s24, 34816
    v_mfma_f32_16x16x32_bf16 v[64:67], a[16:19], a[68:71], v[64:67]
    buffer_load_dwordx4 v218, s[12:15], s22 offen lds
    s_waitcnt lgkmcnt(9)
    v_mfma_f32_16x16x32_bf16 v[80:83], a[20:23], a[68:71], v[80:83]
    ds_read_b64_tr_b16 a[36:37], v231 offset:44032
    v_mfma_f32_16x16x32_bf16 v[84:87], a[20:23], a[72:75], v[84:87]
    ds_read_b64_tr_b16 a[38:39], v227 offset:45312
    v_mfma_f32_16x16x32_bf16 v[88:91], a[20:23], a[76:79], v[88:91]
    s_add_u32 m0, s48, 2048
    v_mfma_f32_16x16x32_bf16 v[92:95], a[20:23], a[80:83], v[92:95]
    buffer_load_dwordx4 v210, s[4:7], s20 offen lds
    s_waitcnt lgkmcnt(8)
    v_mfma_f32_16x16x32_bf16 v[108:111], a[24:27], a[80:83], v[108:111]
    ds_read_b64_tr_b16 a[40:41], v232 offset:44032
    v_mfma_f32_16x16x32_bf16 v[104:107], a[24:27], a[76:79], v[104:107]
    ds_read_b64_tr_b16 a[42:43], v228 offset:45312
    v_mfma_f32_16x16x32_bf16 v[100:103], a[24:27], a[72:75], v[100:103]
    ds_read_b128 a[64:67], v240 offset:6144
    s_mov_b32 m0, s42
    v_mfma_f32_16x16x32_bf16 v[96:99], a[24:27], a[68:71], v[96:99]
    buffer_load_dwordx4 v219, s[12:15], s22 offen lds
    s_waitcnt lgkmcnt(8)
    v_mfma_f32_16x16x32_bf16 v[112:115], a[28:31], a[68:71], v[112:115]
    ds_read_b64_tr_b16 a[44:45], v233 offset:44032
    v_mfma_f32_16x16x32_bf16 v[116:119], a[28:31], a[72:75], v[116:119]
    ds_read_b64_tr_b16 a[46:47], v229 offset:45312
    v_mfma_f32_16x16x32_bf16 v[120:123], a[28:31], a[76:79], v[120:123]
    s_add_u32 m0, s48, 3072
    v_mfma_f32_16x16x32_bf16 v[124:127], a[28:31], a[80:83], v[124:127]
    buffer_load_dwordx4 v211, s[4:7], s20 offen lds
    s_waitcnt lgkmcnt(8)
    v_mfma_f32_16x16x32_bf16 v[140:143], a[32:35], a[80:83], v[140:143]
    ds_read_b64_tr_b16 a[48:49], v226 offset:44288
    v_mfma_f32_16x16x32_bf16 v[136:139], a[32:35], a[76:79], v[136:139]
    ds_read_b64_tr_b16 a[50:51], v230 offset:45312
    v_mfma_f32_16x16x32_bf16 v[132:135], a[32:35], a[72:75], v[132:135]
    s_add_u32 s21, s21, 196608
    v_mfma_f32_16x16x32_bf16 v[128:131], a[32:35], a[68:71], v[128:131]
    s_add_u32 s22, s22, 229376
    s_waitcnt lgkmcnt(7)
    v_mfma_f32_16x16x32_bf16 v[144:147], a[36:39], a[68:71], v[144:147]
    v_mfma_f32_16x16x32_bf16 a[116:119], a[84:87], a[112:115], a[116:119]
    v_mfma_f32_16x16x32_bf16 v[148:151], a[36:39], a[72:75], v[148:151]
    v_mfma_f32_16x16x32_bf16 v[152:155], a[36:39], a[76:79], v[152:155]
    v_mfma_f32_16x16x32_bf16 v[156:159], a[36:39], a[80:83], v[156:159]
    s_waitcnt vmcnt(17) lgkmcnt(0)
    s_barrier
    v_mfma_f32_16x16x32_bf16 v[172:175], a[40:43], a[80:83], v[172:175]
    ds_read_b64_tr_b16 a[0:1], v222 offset:0
    v_mfma_f32_16x16x32_bf16 v[168:171], a[40:43], a[76:79], v[168:171]
    ds_read_b64_tr_b16 a[2:3], v222 offset:512
    v_mfma_f32_16x16x32_bf16 v[164:167], a[40:43], a[72:75], v[164:167]
    ds_read_b64_tr_b16 a[4:5], v223 offset:0
    v_mfma_f32_16x16x32_bf16 v[160:163], a[40:43], a[68:71], v[160:163]
    ds_read_b64_tr_b16 a[6:7], v223 offset:512
    v_mfma_f32_16x16x32_bf16 v[176:179], a[44:47], a[68:71], v[176:179]
    ds_read_b64_tr_b16 a[8:9], v224 offset:0
    v_mfma_f32_16x16x32_bf16 v[180:183], a[44:47], a[72:75], v[180:183]
    ds_read_b64_tr_b16 a[10:11], v224 offset:512
    v_mfma_f32_16x16x32_bf16 v[184:187], a[44:47], a[76:79], v[184:187]
    ds_read_b64_tr_b16 a[12:13], v225 offset:0
    v_mfma_f32_16x16x32_bf16 v[188:191], a[44:47], a[80:83], v[188:191]
    ds_read_b64_tr_b16 a[14:15], v225 offset:512
    v_mfma_f32_16x16x32_bf16 v[204:207], a[48:51], a[80:83], v[204:207]
    v_mfma_f32_16x16x32_bf16 v[200:203], a[48:51], a[76:79], v[200:203]
    v_mfma_f32_16x16x32_bf16 v[196:199], a[48:51], a[72:75], v[196:199]
    v_mfma_f32_16x16x32_bf16 v[192:195], a[48:51], a[68:71], v[192:195]
    s_cmp_eq_u32 s33, s56
    s_cbranch_scc1 k1_kernel_O_sig
k1_kernel_O_sigd:
    s_sub_u32 s33, s33, 1
    s_cmp_lg_u32 s33, 0
    s_cbranch_scc1 k1_kernel_loop_2
    s_waitcnt lgkmcnt(6)
    v_mfma_f32_16x16x32_bf16 v[0:3], a[0:3], a[52:55], v[0:3]
    ds_read_b64_tr_b16 a[16:17], v226 offset:4096
    v_cmp_gt_u32 vcc, 32, v253
    v_mfma_f32_16x16x32_bf16 v[4:7], a[0:3], a[56:59], v[4:7]
    ds_read_b64_tr_b16 a[18:19], v230 offset:5120
    ds_read_b64_tr_b16 a[84:85], v242 offset:0
    v_mfma_f32_16x16x32_bf16 v[8:11], a[0:3], a[60:63], v[8:11]
    ds_read_b128 a[68:71], v241 offset:0
    s_add_u32 m0, s24, 39936
    v_mfma_f32_16x16x32_bf16 v[12:15], a[0:3], a[64:67], v[12:15]
    buffer_load_dwordx4 v216, s[8:11], s21 offen lds
    s_waitcnt lgkmcnt(8)
    v_mfma_f32_16x16x32_bf16 v[28:31], a[4:7], a[64:67], v[28:31]
    ds_read_b64_tr_b16 a[20:21], v227 offset:4096
    s_cbranch_vccnz k1_kernel_O_spin
k1_kernel_O_spun:
    v_mfma_f32_16x16x32_bf16 v[24:27], a[4:7], a[60:63], v[24:27]
    ds_read_b64_tr_b16 a[22:23], v231 offset:5120
    ds_read_b64_tr_b16 a[86:87], v243 offset:0
    v_mfma_f32_16x16x32_bf16 v[20:23], a[4:7], a[56:59], v[20:23]
    v_mfma_f32_16x16x32_bf16 v[16:19], a[4:7], a[52:55], v[16:19]
    v_and_b32 v253, 48, v255
    s_waitcnt lgkmcnt(9)
    v_mfma_f32_16x16x32_bf16 v[32:35], a[8:11], a[52:55], v[32:35]
    ds_read_b64_tr_b16 a[24:25], v228 offset:4096
    v_mfma_f32_16x16x32_bf16 v[36:39], a[8:11], a[56:59], v[36:39]
    ds_read_b64_tr_b16 a[26:27], v232 offset:5120
    ds_read_b64_tr_b16 a[88:89], v244 offset:0
    v_mfma_f32_16x16x32_bf16 v[40:43], a[8:11], a[60:63], v[40:43]
    ds_read_b128 a[72:75], v241 offset:2048
    s_add_u32 m0, s24, 44032
    v_mfma_f32_16x16x32_bf16 v[44:47], a[8:11], a[64:67], v[44:47]
    buffer_load_dwordx4 v217, s[12:15], s22 offen lds
    s_waitcnt lgkmcnt(11)
    v_mfma_f32_16x16x32_bf16 v[60:63], a[12:15], a[64:67], v[60:63]
    ds_read_b64_tr_b16 a[28:29], v229 offset:4096
    v_mfma_f32_16x16x32_bf16 v[56:59], a[12:15], a[60:63], v[56:59]
    ds_read_b64_tr_b16 a[30:31], v233 offset:5120
    ds_read_b64_tr_b16 a[90:91], v245 offset:0
    v_mfma_f32_16x16x32_bf16 v[52:55], a[12:15], a[56:59], v[52:55]
    s_mov_b64 exec, s[84:85]
    buffer_store_dwordx4 a[116:119], v253, s[16:19], s86 offen sc1
    s_mov_b64 exec, -1
    v_mfma_f32_16x16x32_bf16 v[48:51], a[12:15], a[52:55], v[48:51]
    v_lshlrev_b32 v215, 3, v255
    s_waitcnt lgkmcnt(12)
    v_mfma_f32_16x16x32_bf16 v[64:67], a[16:19], a[52:55], v[64:67]
    ds_read_b64_tr_b16 a[32:33], v230 offset:4096
    v_mfma_f32_16x16x32_bf16 v[68:71], a[16:19], a[56:59], v[68:71]
    ds_read_b64_tr_b16 a[34:35], v226 offset:5376
    ds_read_b64_tr_b16 a[92:93], v220 offset:0
    v_mfma_f32_16x16x32_bf16 v[72:75], a[16:19], a[60:63], v[72:75]
    ds_read_b128 a[76:79], v241 offset:4096
    s_add_u32 m0, s24, 48128
    v_mfma_f32_16x16x32_bf16 v[76:79], a[16:19], a[64:67], v[76:79]
    buffer_load_dwordx4 v218, s[12:15], s22 offen lds
    s_waitcnt lgkmcnt(12)
    v_mfma_f32_16x16x32_bf16 v[92:95], a[20:23], a[64:67], v[92:95]
    ds_read_b64_tr_b16 a[36:37], v231 offset:4096
    v_mfma_f32_16x16x32_bf16 v[88:91], a[20:23], a[60:63], v[88:91]
    ds_read_b64_tr_b16 a[38:39], v227 offset:5376
    ds_read_b64_tr_b16 a[94:95], v221 offset:0
    s_waitcnt lgkmcnt(14)
    v_mfma_f32_16x16x32_bf16 a[96:99], a[84:87], a[112:115], a[96:99]
    v_mfma_f32_16x16x32_bf16 v[84:87], a[20:23], a[56:59], v[84:87]
    v_lshlrev_b32 v212, 7, v255
    v_mfma_f32_16x16x32_bf16 v[80:83], a[20:23], a[52:55], v[80:83]
    v_min_u32 v213, 3456, v212
    s_waitcnt lgkmcnt(12)
    v_mfma_f32_16x16x32_bf16 v[96:99], a[24:27], a[52:55], v[96:99]
    ds_read_b64_tr_b16 a[40:41], v232 offset:4096
    v_mfma_f32_16x16x32_bf16 v[100:103], a[24:27], a[56:59], v[100:103]
    ds_read_b64_tr_b16 a[42:43], v228 offset:5376
    v_mfma_f32_16x16x32_bf16 v[104:107], a[24:27], a[60:63], v[104:107]
    ds_read_b128 a[80:83], v241 offset:6144
    s_mov_b32 m0, s43
    v_mfma_f32_16x16x32_bf16 v[108:111], a[24:27], a[64:67], v[108:111]
    buffer_load_dwordx4 v219, s[12:15], s22 offen lds
    s_waitcnt lgkmcnt(11)
    v_mfma_f32_16x16x32_bf16 v[124:127], a[28:31], a[64:67], v[124:127]
    ds_read_b64_tr_b16 a[44:45], v233 offset:4096
    v_mfma_f32_16x16x32_bf16 v[120:123], a[28:31], a[60:63], v[120:123]
    ds_read_b64_tr_b16 a[46:47], v229 offset:5376
    s_waitcnt lgkmcnt(12)
    v_mfma_f32_16x16x32_bf16 a[100:103], a[88:91], a[112:115], a[100:103]
    v_mfma_f32_16x16x32_bf16 v[116:119], a[28:31], a[56:59], v[116:119]
    v_min_u32 v214, 1920, v212
    v_mfma_f32_16x16x32_bf16 v[112:115], a[28:31], a[52:55], v[112:115]
    s_waitcnt lgkmcnt(10)
    v_mfma_f32_16x16x32_bf16 v[128:131], a[32:35], a[52:55], v[128:131]
    ds_read_b64_tr_b16 a[48:49], v226 offset:4352
    v_mfma_f32_16x16x32_bf16 v[132:135], a[32:35], a[56:59], v[132:135]
    ds_read_b64_tr_b16 a[50:51], v230 offset:5376
    v_mfma_f32_16x16x32_bf16 v[136:139], a[32:35], a[60:63], v[136:139]
    s_getpc_b64 s[94:95]
k1_kernel_O_pc:
    s_add_u32 s94, s94, k1_kernel_O_epi - k1_kernel_O_pc
    s_addc_u32 s95, s95, 0
    s_add_u32 s21, s21, 196608
    v_mfma_f32_16x16x32_bf16 v[140:143], a[32:35], a[64:67], v[140:143]
    v_lshlrev_b32 v210, 7, v255
    s_add_u32 s22, s22, 229376
    s_waitcnt lgkmcnt(8)
    v_mfma_f32_16x16x32_bf16 v[156:159], a[36:39], a[64:67], v[156:159]
    s_sub_u32 s34, s29, 1
    s_max_i32 s34, s34, 0
    v_mov_b32 v211, s34
    v_mfma_f32_16x16x32_bf16 v[152:155], a[36:39], a[60:63], v[152:155]
    s_waitcnt lgkmcnt(7)
    v_mfma_f32_16x16x32_bf16 a[104:107], a[92:95], a[112:115], a[104:107]
    v_lshl_add_u32 v210, v211, 13, v210
    v_mfma_f32_16x16x32_bf16 v[148:151], a[36:39], a[56:59], v[148:151]
    s_add_u32 s20, s20, 128
    v_mov_b32 v211, s95
    v_mfma_f32_16x16x32_bf16 v[144:147], a[36:39], a[52:55], v[144:147]
    s_waitcnt vmcnt(12) lgkmcnt(0)
    s_barrier
    v_mfma_f32_16x16x32_bf16 v[160:163], a[40:43], a[52:55], v[160:163]
    ds_read_b64_tr_b16 a[0:1], v222 offset:13312
    v_mfma_f32_16x16x32_bf16 v[164:167], a[40:43], a[56:59], v[164:167]
    ds_read_b64_tr_b16 a[2:3], v222 offset:13824
    v_mfma_f32_16x16x32_bf16 v[168:171], a[40:43], a[60:63], v[168:171]
    ds_read_b64_tr_b16 a[4:5], v223 offset:13312
    v_mfma_f32_16x16x32_bf16 v[172:175], a[40:43], a[64:67], v[172:175]
    ds_read_b64_tr_b16 a[6:7], v223 offset:13824
    v_mfma_f32_16x16x32_bf16 v[188:191], a[44:47], a[64:67], v[188:191]
    ds_read_b64_tr_b16 a[8:9], v224 offset:13312
    v_mfma_f32_16x16x32_bf16 v[184:187], a[44:47], a[60:63], v[184:187]
    ds_read_b64_tr_b16 a[10:11], v224 offset:13824
    v_mfma_f32_16x16x32_bf16 v[180:183], a[44:47], a[56:59], v[180:183]
    ds_read_b64_tr_b16 a[12:13], v225 offset:13312
    v_mfma_f32_16x16x32_bf16 v[176:179], a[44:47], a[52:55], v[176:179]
    ds_read_b64_tr_b16 a[14:15], v225 offset:13824
    v_mfma_f32_16x16x32_bf16 v[192:195], a[48:51], a[52:55], v[192:195]
    s_mov_b32 s48, s49
    s_add_u32 s49, s49, 8192
    buffer_load_dwordx2 v[236:237], v215, s[16:19], s52 offen sc1
    v_mfma_f32_16x16x32_bf16 v[196:199], a[48:51], a[56:59], v[196:199]
    v_mfma_f32_16x16x32_bf16 a[108:111], a[48:51], a[112:115], a[108:111]
    v_mfma_f32_16x16x32_bf16 v[200:203], a[48:51], a[60:63], v[200:203]
    s_cmp_eq_u32 s49, s51
    s_cselect_b32 s49, s50, s49
    v_add_co_u32 v210, vcc, s94, v210
    v_mfma_f32_16x16x32_bf16 v[204:207], a[48:51], a[64:67], v[204:207]
    v_add_u32 v240, s49, v238
    v_add_u32 v241, s49, v239
    v_addc_co_u32 v211, vcc, 0, v211, vcc
    s_waitcnt lgkmcnt(6)
    v_mfma_f32_16x16x32_bf16 v[12:15], a[0:3], a[80:83], v[12:15]
    ds_read_b64_tr_b16 a[16:17], v226 offset:17408
    s_not_b64 exec, s[92:93]
    global_load_dword v254, v[210:211], off
    s_mov_b64 exec, -1
    v_mfma_f32_16x16x32_bf16 v[8:11], a[0:3], a[76:79], v[8:11]
    ds_read_b64_tr_b16 a[18:19], v230 offset:18432
    ds_read_b64_tr_b16 a[84:85], v242 offset:13312
    v_mfma_f32_16x16x32_bf16 v[4:7], a[0:3], a[72:75], v[4:7]
    ds_read_b128 a[52:55], v240 offset:0
    s_not_b64 exec, s[92:93]
    buffer_load_dword v254, v212, s[68:71], s80 offen
    s_mov_b64 exec, -1
    v_mfma_f32_16x16x32_bf16 v[0:3], a[0:3], a[68:71], v[0:3]
    v_mov_b32 v248, 0
    s_waitcnt lgkmcnt(8)
    v_mfma_f32_16x16x32_bf16 v[16:19], a[4:7], a[68:71], v[16:19]
    ds_read_b64_tr_b16 a[20:21], v227 offset:17408
    v_mfma_f32_16x16x32_bf16 v[20:23], a[4:7], a[72:75], v[20:23]
    ds_read_b64_tr_b16 a[22:23], v231 offset:18432
    ds_read_b64_tr_b16 a[86:87], v243 offset:13312
    v_mfma_f32_16x16x32_bf16 v[24:27], a[4:7], a[76:79], v[24:27]
    v_mfma_f32_16x16x32_bf16 v[28:31], a[4:7], a[80:83], v[28:31]
    v_mov_b32 v249, 0
    s_waitcnt lgkmcnt(9)
    v_mfma_f32_16x16x32_bf16 v[44:47], a[8:11], a[80:83], v[44:47]
    ds_read_b64_tr_b16 a[24:25], v228 offset:17408
    v_mfma_f32_16x16x32_bf16 v[40:43], a[8:11], a[76:79], v[40:43]
    ds_read_b64_tr_b16 a[26:27], v232 offset:18432
    ds_read_b64_tr_b16 a[88:89], v244 offset:13312
    v_mfma_f32_16x16x32_bf16 v[36:39], a[8:11], a[72:75], v[36:39]
    ds_read_b128 a[56:59], v240 offset:2048
    s_not_b64 exec, s[92:93]
    buffer_load_dword v254, v213, s[72:75], s81 offen
    s_mov_b64 exec, -1
    v_mfma_f32_16x16x32_bf16 v[32:35], a[8:11], a[68:71], v[32:35]
    v_mov_b32 v250, 0
    s_waitcnt lgkmcnt(11)
    v_mfma_f32_16x16x32_bf16 v[48:51], a[12:15], a[68:71], v[48:51]
    ds_read_b64_tr_b16 a[28:29], v229 offset:17408
    v_mfma_f32_16x16x32_bf16 v[52:55], a[12:15], a[72:75], v[52:55]
    ds_read_b64_tr_b16 a[30:31], v233 offset:18432
    ds_read_b64_tr_b16 a[90:91], v245 offset:13312
    v_mfma_f32_16x16x32_bf16 v[56:59], a[12:15], a[76:79], v[56:59]
    v_mfma_f32_16x16x32_bf16 v[60:63], a[12:15], a[80:83], v[60:63]
    v_mov_b32 v251, 0
    s_waitcnt lgkmcnt(12)
    v_mfma_f32_16x16x32_bf16 v[76:79], a[16:19], a[80:83], v[76:79]
    ds_read_b64_tr_b16 a[32:33], v230 offset:17408
    v_mfma_f32_16x16x32_bf16 v[72:75], a[16:19], a[76:79], v[72:75]
    ds_read_b64_tr_b16 a[34:35], v226 offset:18688
    ds_read_b64_tr_b16 a[92:93], v220 offset:13312
    v_mfma_f32_16x16x32_bf16 v[68:71], a[16:19], a[72:75], v[68:71]
    ds_read_b128 a[60:63], v240 offset:4096
    s_not_b64 exec, s[92:93]
    buffer_load_dword v254, v214, s[76:79], s82 offen
    s_mov_b64 exec, -1
    v_mfma_f32_16x16x32_bf16 v[64:67], a[16:19], a[68:71], v[64:67]
    s_waitcnt lgkmcnt(12)
    v_mfma_f32_16x16x32_bf16 v[80:83], a[20:23], a[68:71], v[80:83]
    ds_read_b64_tr_b16 a[36:37], v231 offset:17408
    v_mfma_f32_16x16x32_bf16 v[84:87], a[20:23], a[72:75], v[84:87]
    ds_read_b64_tr_b16 a[38:39], v227 offset:18688
    ds_read_b64_tr_b16 a[94:95], v221 offset:13312
    s_waitcnt lgkmcnt(14)
    v_mfma_f32_16x16x32_bf16 a[96:99], a[84:87], a[112:115], a[96:99]
    v_mfma_f32_16x16x32_bf16 v[88:91], a[20:23], a[76:79], v[88:91]
    v_mfma_f32_16x16x32_bf16 v[92:95], a[20:23], a[80:83], v[92:95]
    s_waitcnt lgkmcnt(12)
    v_mfma_f32_16x16x32_bf16 v[108:111], a[24:27], a[80:83], v[108:111]
    ds_read_b64_tr_b16 a[40:41], v232 offset:17408
    v_mfma_f32_16x16x32_bf16 v[104:107], a[24:27], a[76:79], v[104:107]
    ds_read_b64_tr_b16 a[42:43], v228 offset:18688
    v_mfma_f32_16x16x32_bf16 v[100:103], a[24:27], a[72:75], v[100:103]
    ds_read_b128 a[64:67], v240 offset:6144
    v_mfma_f32_16x16x32_bf16 v[96:99], a[24:27], a[68:71], v[96:99]
    s_waitcnt lgkmcnt(11)
    v_mfma_f32_16x16x32_bf16 v[112:115], a[28:31], a[68:71], v[112:115]
    ds_read_b64_tr_b16 a[44:45], v233 offset:17408
    v_mfma_f32_16x16x32_bf16 v[116:119], a[28:31], a[72:75], v[116:119]
    ds_read_b64_tr_b16 a[46:47], v229 offset:18688
    s_waitcnt lgkmcnt(12)
    v_mfma_f32_16x16x32_bf16 a[100:103], a[88:91], a[112:115], a[100:103]
    v_mfma_f32_16x16x32_bf16 v[120:123], a[28:31], a[76:79], v[120:123]
    v_mfma_f32_16x16x32_bf16 v[124:127], a[28:31], a[80:83], v[124:127]
    s_waitcnt lgkmcnt(10)
    v_mfma_f32_16x16x32_bf16 v[140:143], a[32:35], a[80:83], v[140:143]
    ds_read_b64_tr_b16 a[48:49], v226 offset:17664
    v_mfma_f32_16x16x32_bf16 v[136:139], a[32:35], a[76:79], v[136:139]
    ds_read_b64_tr_b16 a[50:51], v230 offset:18688
    v_mfma_f32_16x16x32_bf16 v[132:135], a[32:35], a[72:75], v[132:135]
    v_mfma_f32_16x16x32_bf16 v[128:131], a[32:35], a[68:71], v[128:131]
    s_waitcnt lgkmcnt(8)
    v_mfma_f32_16x16x32_bf16 v[144:147], a[36:39], a[68:71], v[144:147]
    v_mfma_f32_16x16x32_bf16 v[148:151], a[36:39], a[72:75], v[148:151]
    s_waitcnt lgkmcnt(7)
    v_mfma_f32_16x16x32_bf16 a[104:107], a[92:95], a[112:115], a[104:107]
    v_mfma_f32_16x16x32_bf16 v[152:155], a[36:39], a[76:79], v[152:155]
    v_mfma_f32_16x16x32_bf16 v[156:159], a[36:39], a[80:83], v[156:159]
    s_waitcnt vmcnt(10) lgkmcnt(0)
    s_barrier
    v_mfma_f32_16x16x32_bf16 v[172:175], a[40:43], a[80:83], v[172:175]
    ds_read_b64_tr_b16 a[0:1], v222 offset:26624
    v_mfma_f32_16x16x32_bf16 v[168:171], a[40:43], a[76:79], v[168:171]
    ds_read_b64_tr_b16 a[2:3], v222 offset:27136
    v_mfma_f32_16x16x32_bf16 v[164:167], a[40:43], a[72:75], v[164:167]
    ds_read_b64_tr_b16 a[4:5], v223 offset:26624
    v_mfma_f32_16x16x32_bf16 v[160:163], a[40:43], a[68:71], v[160:163]
    ds_read_b64_tr_b16 a[6:7], v223 offset:27136
    v_mfma_f32_16x16x32_bf16 v[176:179], a[44:47], a[68:71], v[176:179]
    ds_read_b64_tr_b16 a[8:9], v224 offset:26624
    v_mfma_f32_16x16x32_bf16 v[180:183], a[44:47], a[72:75], v[180:183]
    ds_read_b64_tr_b16 a[10:11], v224 offset:27136
    v_mfma_f32_16x16x32_bf16 v[184:187], a[44:47], a[76:79], v[184:187]
    ds_read_b64_tr_b16 a[12:13], v225 offset:26624
    v_mfma_f32_16x16x32_bf16 v[188:191], a[44:47], a[80:83], v[188:191]
    ds_read_b64_tr_b16 a[14:15], v225 offset:27136
    v_mfma_f32_16x16x32_bf16 v[204:207], a[48:51], a[80:83], v[204:207]
    v_mfma_f32_16x16x32_bf16 v[200:203], a[48:51], a[76:79], v[200:203]
    v_mfma_f32_16x16x32_bf16 a[108:111], a[48:51], a[112:115], a[108:111]
    v_mfma_f32_16x16x32_bf16 v[196:199], a[48:51], a[72:75], v[196:199]
    v_min_u32 v252, 51, v255
    v_mfma_f32_16x16x32_bf16 v[192:195], a[48:51], a[68:71], v[192:195]
    v_lshlrev_b32 v252, 4, v252
    s_waitcnt lgkmcnt(6)
    v_mfma_f32_16x16x32_bf16 v[0:3], a[0:3], a[52:55], v[0:3]
    ds_read_b64_tr_b16 a[16:17], v226 offset:30720
    v_mfma_f32_16x16x32_bf16 v[4:7], a[0:3], a[56:59], v[4:7]
    ds_read_b64_tr_b16 a[18:19], v230 offset:31744
    ds_read_b64_tr_b16 a[84:85], v242 offset:26624
    v_mfma_f32_16x16x32_bf16 v[8:11], a[0:3], a[60:63], v[8:11]
    ds_read_b128 a[68:71], v241 offset:0
    v_mfma_f32_16x16x32_bf16 v[12:15], a[0:3], a[64:67], v[12:15]
    s_waitcnt lgkmcnt(8)
    v_mfma_f32_16x16x32_bf16 v[28:31], a[4:7], a[64:67], v[28:31]
    ds_read_b64_tr_b16 a[20:21], v227 offset:30720
    v_mfma_f32_16x16x32_bf16 v[24:27], a[4:7], a[60:63], v[24:27]
    ds_read_b64_tr_b16 a[22:23], v231 offset:31744
    ds_read_b64_tr_b16 a[86:87], v243 offset:26624
    v_mfma_f32_16x16x32_bf16 v[20:23], a[4:7], a[56:59], v[20:23]
    v_mfma_f32_16x16x32_bf16 v[16:19], a[4:7], a[52:55], v[16:19]
    s_waitcnt lgkmcnt(9)
    v_mfma_f32_16x16x32_bf16 v[32:35], a[8:11], a[52:55], v[32:35]
    ds_read_b64_tr_b16 a[24:25], v228 offset:30720
    v_mfma_f32_16x16x32_bf16 v[36:39], a[8:11], a[56:59], v[36:39]
    ds_read_b64_tr_b16 a[26:27], v232 offset:31744
    ds_read_b64_tr_b16 a[88:89], v244 offset:26624
    v_mfma_f32_16x16x32_bf16 v[40:43], a[8:11], a[60:63], v[40:43]
    ds_read_b128 a[72:75], v241 offset:2048
    v_mfma_f32_16x16x32_bf16 v[44:47], a[8:11], a[64:67], v[44:47]
    s_waitcnt lgkmcnt(11)
    v_mfma_f32_16x16x32_bf16 v[60:63], a[12:15], a[64:67], v[60:63]
    ds_read_b64_tr_b16 a[28:29], v229 offset:30720
    v_mfma_f32_16x16x32_bf16 v[56:59], a[12:15], a[60:63], v[56:59]
    ds_read_b64_tr_b16 a[30:31], v233 offset:31744
    ds_read_b64_tr_b16 a[90:91], v245 offset:26624
    v_mfma_f32_16x16x32_bf16 v[52:55], a[12:15], a[56:59], v[52:55]
    v_mfma_f32_16x16x32_bf16 v[48:51], a[12:15], a[52:55], v[48:51]
    s_waitcnt lgkmcnt(12)
    v_mfma_f32_16x16x32_bf16 v[64:67], a[16:19], a[52:55], v[64:67]
    ds_read_b64_tr_b16 a[32:33], v230 offset:30720
    v_mfma_f32_16x16x32_bf16 v[68:71], a[16:19], a[56:59], v[68:71]
    ds_read_b64_tr_b16 a[34:35], v226 offset:32000
    ds_read_b64_tr_b16 a[92:93], v220 offset:26624
    v_mfma_f32_16x16x32_bf16 v[72:75], a[16:19], a[60:63], v[72:75]
    ds_read_b128 a[76:79], v241 offset:4096
    v_mfma_f32_16x16x32_bf16 v[76:79], a[16:19], a[64:67], v[76:79]
    s_waitcnt lgkmcnt(12)
    v_mfma_f32_16x16x32_bf16 v[92:95], a[20:23], a[64:67], v[92:95]
    ds_read_b64_tr_b16 a[36:37], v231 offset:30720
    v_mfma_f32_16x16x32_bf16 v[88:91], a[20:23], a[60:63], v[88:91]
    ds_read_b64_tr_b16 a[38:39], v227 offset:32000
    ds_read_b64_tr_b16 a[94:95], v221 offset:26624
    s_waitcnt lgkmcnt(14)
    v_mfma_f32_16x16x32_bf16 a[96:99], a[84:87], a[112:115], a[96:99]
    v_mfma_f32_16x16x32_bf16 v[84:87], a[20:23], a[56:59], v[84:87]
    v_mfma_f32_16x16x32_bf16 v[80:83], a[20:23], a[52:55], v[80:83]
    s_waitcnt lgkmcnt(12)
    v_mfma_f32_16x16x32_bf16 v[96:99], a[24:27], a[52:55], v[96:99]
    ds_read_b64_tr_b16 a[40:41], v232 offset:30720
    v_mfma_f32_16x16x32_bf16 v[100:103], a[24:27], a[56:59], v[100:103]
    ds_read_b64_tr_b16 a[42:43], v228 offset:32000
    v_mfma_f32_16x16x32_bf16 v[104:107], a[24:27], a[60:63], v[104:107]
    ds_read_b128 a[80:83], v241 offset:6144
    v_mfma_f32_16x16x32_bf16 v[108:111], a[24:27], a[64:67], v[108:111]
    s_waitcnt lgkmcnt(11)
    v_mfma_f32_16x16x32_bf16 v[124:127], a[28:31], a[64:67], v[124:127]
    ds_read_b64_tr_b16 a[44:45], v233 offset:30720
    v_mfma_f32_16x16x32_bf16 v[120:123], a[28:31], a[60:63], v[120:123]
    ds_read_b64_tr_b16 a[46:47], v229 offset:32000
    s_waitcnt lgkmcnt(12)
    v_mfma_f32_16x16x32_bf16 a[100:103], a[88:91], a[112:115], a[100:103]
    v_mfma_f32_16x16x32_bf16 v[116:119], a[28:31], a[56:59], v[116:119]
    v_mfma_f32_16x16x32_bf16 v[112:115], a[28:31], a[52:55], v[112:115]
    s_waitcnt lgkmcnt(10)
    v_mfma_f32_16x16x32_bf16 v[128:131], a[32:35], a[52:55], v[128:131]
    ds_read_b64_tr_b16 a[48:49], v226 offset:30976
    v_mfma_f32_16x16x32_bf16 v[132:135], a[32:35], a[56:59], v[132:135]
    ds_read_b64_tr_b16 a[50:51], v230 offset:32000
    v_mfma_f32_16x16x32_bf16 v[136:139], a[32:35], a[60:63], v[136:139]
    s_mov_b64 exec, s[92:93]
    buffer_load_dwordx4 v[248:251], v252, s[16:19], s87 offen sc1
    s_mov_b64 exec, -1
    v_mfma_f32_16x16x32_bf16 v[140:143], a[32:35], a[64:67], v[140:143]
    s_waitcnt lgkmcnt(8)
    v_mfma_f32_16x16x32_bf16 v[156:159], a[36:39], a[64:67], v[156:159]
    v_mfma_f32_16x16x32_bf16 v[152:155], a[36:39], a[60:63], v[152:155]
    s_waitcnt lgkmcnt(7)
    v_mfma_f32_16x16x32_bf16 a[104:107], a[92:95], a[112:115], a[104:107]
    v_mfma_f32_16x16x32_bf16 v[148:151], a[36:39], a[56:59], v[148:151]
    s_add_u32 s20, s20, 128
    v_mfma_f32_16x16x32_bf16 v[144:147], a[36:39], a[52:55], v[144:147]
    s_waitcnt vmcnt(6) lgkmcnt(0)
    s_barrier
    v_mfma_f32_16x16x32_bf16 v[160:163], a[40:43], a[52:55], v[160:163]
    ds_read_b64_tr_b16 a[0:1], v222 offset:39936
    v_mfma_f32_16x16x32_bf16 v[164:167], a[40:43], a[56:59], v[164:167]
    ds_read_b64_tr_b16 a[2:3], v222 offset:40448
    v_mfma_f32_16x16x32_bf16 v[168:171], a[40:43], a[60:63], v[168:171]
    ds_read_b64_tr_b16 a[4:5], v223 offset:39936
    v_mfma_f32_16x16x32_bf16 v[172:175], a[40:43], a[64:67], v[172:175]
    ds_read_b64_tr_b16 a[6:7], v223 offset:40448
    v_mfma_f32_16x16x32_bf16 v[188:191], a[44:47], a[64:67], v[188:191]
    ds_read_b64_tr_b16 a[8:9], v224 offset:39936
    v_mfma_f32_16x16x32_bf16 v[184:187], a[44:47], a[60:63], v[184:187]
    ds_read_b64_tr_b16 a[10:11], v224 offset:40448
    v_mfma_f32_16x16x32_bf16 v[180:183], a[44:47], a[56:59], v[180:183]
    ds_read_b64_tr_b16 a[12:13], v225 offset:39936
    v_mfma_f32_16x16x32_bf16 v[176:179], a[44:47], a[52:55], v[176:179]
    ds_read_b64_tr_b16 a[14:15], v225 offset:40448
    v_mfma_f32_16x16x32_bf16 v[192:195], a[48:51], a[52:55], v[192:195]
    s_mov_b32 s48, s49
    s_add_u32 s49, s49, 8192
    v_mfma_f32_16x16x32_bf16 v[196:199], a[48:51], a[56:59], v[196:199]
    v_mfma_f32_16x16x32_bf16 a[108:111], a[48:51], a[112:115], a[108:111]
    v_mfma_f32_16x16x32_bf16 v[200:203], a[48:51], a[60:63], v[200:203]
    s_cmp_eq_u32 s49, s51
    s_cselect_b32 s49, s50, s49
    v_mfma_f32_16x16x32_bf16 v[204:207], a[48:51], a[64:67], v[204:207]
    v_add_u32 v240, s49, v238
    v_add_u32 v241, s49, v239
    s_waitcnt lgkmcnt(6)
    v_mfma_f32_16x16x32_bf16 v[12:15], a[0:3], a[80:83], v[12:15]
    ds_read_b64_tr_b16 a[16:17], v226 offset:44032
    v_mfma_f32_16x16x32_bf16 v[8:11], a[0:3], a[76:79], v[8:11]
    ds_read_b64_tr_b16 a[18:19], v230 offset:45056
    ds_read_b64_tr_b16 a[84:85], v242 offset:39936
    v_mfma_f32_16x16x32_bf16 v[4:7], a[0:3], a[72:75], v[4:7]
    s_mov_b64 exec, s[92:93]
    buffer_load_dword v254, v212, s[68:71], s80 offen
    s_mov_b64 exec, -1
    v_mfma_f32_16x16x32_bf16 v[0:3], a[0:3], a[68:71], v[0:3]
    s_waitcnt lgkmcnt(7)
    v_mfma_f32_16x16x32_bf16 v[16:19], a[4:7], a[68:71], v[16:19]
    ds_read_b64_tr_b16 a[20:21], v227 offset:44032
    v_mfma_f32_16x16x32_bf16 v[20:23], a[4:7], a[72:75], v[20:23]
    ds_read_b64_tr_b16 a[22:23], v231 offset:45056
    ds_read_b64_tr_b16 a[86:87], v243 offset:39936
    v_mfma_f32_16x16x32_bf16 v[24:27], a[4:7], a[76:79], v[24:27]
    s_lshl_b32 s34, s29, 9
    v_mfma_f32_16x16x32_bf16 v[28:31], a[4:7], a[80:83], v[28:31]
    s_add_u32 s34, s34, 154624
    s_waitcnt lgkmcnt(8)
    v_mfma_f32_16x16x32_bf16 v[44:47], a[8:11], a[80:83], v[44:47]
    ds_read_b64_tr_b16 a[24:25], v228 offset:44032
    v_mfma_f32_16x16x32_bf16 v[40:43], a[8:11], a[76:79], v[40:43]
    ds_read_b64_tr_b16 a[26:27], v232 offset:45056
    ds_read_b64_tr_b16 a[88:89], v244 offset:39936
    v_mfma_f32_16x16x32_bf16 v[36:39], a[8:11], a[72:75], v[36:39]
    s_mov_b64 exec, s[92:93]
    buffer_load_dword v254, v213, s[72:75], s81 offen
    s_mov_b64 exec, -1
    v_mfma_f32_16x16x32_bf16 v[32:35], a[8:11], a[68:71], v[32:35]
    s_waitcnt lgkmcnt(9)
    v_mfma_f32_16x16x32_bf16 v[48:51], a[12:15], a[68:71], v[48:51]
    ds_read_b64_tr_b16 a[28:29], v229 offset:44032
    v_mfma_f32_16x16x32_bf16 v[52:55], a[12:15], a[72:75], v[52:55]
    ds_read_b64_tr_b16 a[30:31], v233 offset:45056
    ds_read_b64_tr_b16 a[90:91], v245 offset:39936
    v_mfma_f32_16x16x32_bf16 v[56:59], a[12:15], a[76:79], v[56:59]
    v_lshl_add_u32 v246, v255, 2, s34
    v_mfma_f32_16x16x32_bf16 v[60:63], a[12:15], a[80:83], v[60:63]
    s_lshl_b32 s34, s29, 6
    s_waitcnt lgkmcnt(10)
    v_mfma_f32_16x16x32_bf16 v[76:79], a[16:19], a[80:83], v[76:79]
    ds_read_b64_tr_b16 a[32:33], v230 offset:44032
    v_mfma_f32_16x16x32_bf16 v[72:75], a[16:19], a[76:79], v[72:75]
    ds_read_b64_tr_b16 a[34:35], v226 offset:45312
    ds_read_b64_tr_b16 a[92:93], v220 offset:39936
    v_mfma_f32_16x16x32_bf16 v[68:71], a[16:19], a[72:75], v[68:71]
    s_mov_b64 exec, s[92:93]
    buffer_load_dword v254, v214, s[76:79], s82 offen
    s_mov_b64 exec, -1
    v_mfma_f32_16x16x32_bf16 v[64:67], a[16:19], a[68:71], v[64:67]
    s_waitcnt lgkmcnt(10)
    v_mfma_f32_16x16x32_bf16 v[80:83], a[20:23], a[68:71], v[80:83]
    ds_read_b64_tr_b16 a[36:37], v231 offset:44032
    v_mfma_f32_16x16x32_bf16 v[84:87], a[20:23], a[72:75], v[84:87]
    ds_read_b64_tr_b16 a[38:39], v227 offset:45312
    ds_read_b64_tr_b16 a[94:95], v221 offset:39936
    s_waitcnt lgkmcnt(12)
    v_mfma_f32_16x16x32_bf16 a[96:99], a[84:87], a[112:115], a[96:99]
    v_mfma_f32_16x16x32_bf16 v[88:91], a[20:23], a[76:79], v[88:91]
    s_add_u32 s34, s34, 152576
    v_mfma_f32_16x16x32_bf16 v[92:95], a[20:23], a[80:83], v[92:95]
    v_and_b32 v247, 48, v255
    s_waitcnt lgkmcnt(10)
    v_mfma_f32_16x16x32_bf16 v[108:111], a[24:27], a[80:83], v[108:111]
    ds_read_b64_tr_b16 a[40:41], v232 offset:44032
    v_mfma_f32_16x16x32_bf16 v[104:107], a[24:27], a[76:79], v[104:107]
    ds_read_b64_tr_b16 a[42:43], v228 offset:45312
    v_mfma_f32_16x16x32_bf16 v[100:103], a[24:27], a[72:75], v[100:103]
    v_mfma_f32_16x16x32_bf16 v[96:99], a[24:27], a[68:71], v[96:99]
    s_waitcnt lgkmcnt(9)
    v_mfma_f32_16x16x32_bf16 v[112:115], a[28:31], a[68:71], v[112:115]
    ds_read_b64_tr_b16 a[44:45], v233 offset:44032
    v_mfma_f32_16x16x32_bf16 v[116:119], a[28:31], a[72:75], v[116:119]
    ds_read_b64_tr_b16 a[46:47], v229 offset:45312
    s_waitcnt lgkmcnt(10)
    v_mfma_f32_16x16x32_bf16 a[100:103], a[88:91], a[112:115], a[100:103]
    v_mfma_f32_16x16x32_bf16 v[120:123], a[28:31], a[76:79], v[120:123]
    v_add_u32 v208, 153344, v247
    v_mfma_f32_16x16x32_bf16 v[124:127], a[28:31], a[80:83], v[124:127]
    v_add_u32 v247, s34, v247
    s_waitcnt lgkmcnt(8)
    v_mfma_f32_16x16x32_bf16 v[140:143], a[32:35], a[80:83], v[140:143]
    ds_read_b64_tr_b16 a[48:49], v226 offset:44288
    v_mfma_f32_16x16x32_bf16 v[136:139], a[32:35], a[76:79], v[136:139]
    ds_read_b64_tr_b16 a[50:51], v230 offset:45312
    v_mfma_f32_16x16x32_bf16 v[132:135], a[32:35], a[72:75], v[132:135]
    v_mfma_f32_16x16x32_bf16 v[128:131], a[32:35], a[68:71], v[128:131]
    s_waitcnt lgkmcnt(7)
    v_mfma_f32_16x16x32_bf16 v[144:147], a[36:39], a[68:71], v[144:147]
    v_mfma_f32_16x16x32_bf16 v[148:151], a[36:39], a[72:75], v[148:151]
    s_waitcnt lgkmcnt(6)
    v_mfma_f32_16x16x32_bf16 a[104:107], a[92:95], a[112:115], a[104:107]
    v_mfma_f32_16x16x32_bf16 v[152:155], a[36:39], a[76:79], v[152:155]
    v_mfma_f32_16x16x32_bf16 v[156:159], a[36:39], a[80:83], v[156:159]
    s_waitcnt lgkmcnt(4)
    v_mfma_f32_16x16x32_bf16 v[172:175], a[40:43], a[80:83], v[172:175]
    s_waitcnt vmcnt(8)
    ds_write_b32 v246, v236
    v_mfma_f32_16x16x32_bf16 v[168:171], a[40:43], a[76:79], v[168:171]
    ds_write_b32 v246, v237 offset:256
    v_mfma_f32_16x16x32_bf16 v[164:167], a[40:43], a[72:75], v[164:167]
    v_mfma_f32_16x16x32_bf16 v[160:163], a[40:43], a[68:71], v[160:163]
    s_mov_b32 exec_lo, 0x10001
    s_mov_b32 exec_hi, 0x10001
    ds_write_b128 v247, a[96:99] offset:0
    ds_write_b128 v247, a[100:103] offset:256
    ds_write_b128 v247, a[104:107] offset:512
    s_mov_b64 exec, -1
    s_waitcnt lgkmcnt(7)
    v_mfma_f32_16x16x32_bf16 v[176:179], a[44:47], a[68:71], v[176:179]
    v_mfma_f32_16x16x32_bf16 v[180:183], a[44:47], a[72:75], v[180:183]
    v_mfma_f32_16x16x32_bf16 v[184:187], a[44:47], a[76:79], v[184:187]
    s_waitcnt vmcnt(3)
    v_max3_u32 v253, v248, v249, v250
    v_mfma_f32_16x16x32_bf16 v[188:191], a[44:47], a[80:83], v[188:191]
    v_max_u32 v253, v253, v251
    v_cmp_eq_u32 vcc, -1, v253
    s_waitcnt lgkmcnt(5)
    v_mfma_f32_16x16x32_bf16 v[204:207], a[48:51], a[80:83], v[204:207]
    v_add_u32 v253, 153600, v252
    v_mfma_f32_16x16x32_bf16 v[200:203], a[48:51], a[76:79], v[200:203]
    v_mfma_f32_16x16x32_bf16 a[108:111], a[48:51], a[112:115], a[108:111]
    v_mfma_f32_16x16x32_bf16 v[196:199], a[48:51], a[72:75], v[196:199]
    s_cbranch_vccnz k1_kernel_O_cx
k1_kernel_O_cxd:
    s_mov_b64 exec, s[92:93]
    ds_write_b128 v253, v[248:251]
    s_mov_b64 exec, -1
    v_mfma_f32_16x16x32_bf16 v[192:195], a[48:51], a[68:71], v[192:195]
k1_kernel_O_epi:
    s_nop 4
    s_mov_b32 exec_lo, 0x10001
    s_mov_b32 exec_hi, 0x10001
    ds_write_b128 v208, a[108:111]
    s_mov_b64 exec, -1
    s_waitcnt lgkmcnt(0)
    s_barrier
    v_mov_b32 v210, 0x3fb8aa3b
    v_mov_b32 v211, 0x358637bd
    v_lshlrev_b32 v244, 4, v255
    s_and_b32 s36, s32, 7
    s_mul_i32 s36, s36, 7
    s_add_u32 s36, s36, 2
    s_lshl_b32 s34, s29, 9
    s_add_u32 s34, s34, 154624
    v_and_b32 v250, 15, v255
    v_lshl_add_u32 v250, v250, 2, s34
    v_and_b32 v251, 48, v255
    v_add_u32 v251, 152576, v251
    ds_read2_b32 v[212:213], v250 offset0:64 offset1:80
    ds_read2_b32 v[214:215], v250 offset0:96 offset1:112
    ds_read2_b32 v[216:217], v250 offset0:0 offset1:16
    ds_read2_b32 v[218:219], v250 offset0:32 offset1:48
    ds_read_b128 v[220:223], v251 offset:320
    ds_read_b128 v[224:227], v251 offset:1344
    ds_read_b128 v[228:231], v251 offset:384
    ds_read_b128 v[232:235], v251 offset:1408
    ds_read_b128 v[236:239], v251 offset:448
    ds_read_b128 v[240:243], v251 offset:1472
    s_waitcnt lgkmcnt(4)
    v_pk_add_f32 v[220:221], v[220:221], v[224:225]
    v_pk_add_f32 v[222:223], v[222:223], v[226:227]
    v_pk_fma_f32 v[80:81], v[220:221], v[212:213], v[80:81] op_sel:[0,0,0] op_sel_hi:[1,0,1]
    v_pk_fma_f32 v[82:83], v[222:223], v[212:213], v[82:83] op_sel:[0,0,0] op_sel_hi:[1,0,1]
    v_pk_fma_f32 v[84:85], v[220:221], v[212:213], v[84:85] op_sel:[0,1,0] op_sel_hi:[1,1,1]
    v_pk_fma_f32 v[86:87], v[222:223], v[212:213], v[86:87] op_sel:[0,1,0] op_sel_hi:[1,1,1]
    v_pk_fma_f32 v[88:89], v[220:221], v[214:215], v[88:89] op_sel:[0,0,0] op_sel_hi:[1,0,1]
    v_pk_fma_f32 v[90:91], v[222:223], v[214:215], v[90:91] op_sel:[0,0,0] op_sel_hi:[1,0,1]
    v_pk_fma_f32 v[92:93], v[220:221], v[214:215], v[92:93] op_sel:[0,1,0] op_sel_hi:[1,1,1]
    v_pk_fma_f32 v[94:95], v[222:223], v[214:215], v[94:95] op_sel:[0,1,0] op_sel_hi:[1,1,1]
    ds_read_b128 v[220:223], v251 offset:512
    ds_read_b128 v[224:227], v251 offset:1536
    s_waitcnt lgkmcnt(4)
    v_pk_add_f32 v[228:229], v[228:229], v[232:233]
    v_pk_add_f32 v[230:231], v[230:231], v[234:235]
    v_pk_fma_f32 v[96:97], v[228:229], v[212:213], v[96:97] op_sel:[0,0,0] op_sel_hi:[1,0,1]
    v_pk_fma_f32 v[98:99], v[230:231], v[212:213], v[98:99] op_sel:[0,0,0] op_sel_hi:[1,0,1]
    v_pk_fma_f32 v[100:101], v[228:229], v[212:213], v[100:101] op_sel:[0,1,0] op_sel_hi:[1,1,1]
    v_pk_fma_f32 v[102:103], v[230:231], v[212:213], v[102:103] op_sel:[0,1,0] op_sel_hi:[1,1,1]
    v_pk_fma_f32 v[104:105], v[228:229], v[214:215], v[104:105] op_sel:[0,0,0] op_sel_hi:[1,0,1]
    v_pk_fma_f32 v[106:107], v[230:231], v[214:215], v[106:107] op_sel:[0,0,0] op_sel_hi:[1,0,1]
    v_pk_fma_f32 v[108:109], v[228:229], v[214:215], v[108:109] op_sel:[0,1,0] op_sel_hi:[1,1,1]
    v_pk_fma_f32 v[110:111], v[230:231], v[214:215], v[110:111] op_sel:[0,1,0] op_sel_hi:[1,1,1]
    ds_read_b128 v[228:231], v251 offset:576
    ds_read_b128 v[232:235], v251 offset:1600
    s_waitcnt lgkmcnt(4)
    v_pk_add_f32 v[236:237], v[236:237], v[240:241]
    v_pk_add_f32 v[238:239], v[238:239], v[242:243]
    v_pk_fma_f32 v[112:113], v[236:237], v[212:213], v[112:113] op_sel:[0,0,0] op_sel_hi:[1,0,1]
    v_pk_fma_f32 v[114:115], v[238:239], v[212:213], v[114:115] op_sel:[0,0,0] op_sel_hi:[1,0,1]
    v_pk_fma_f32 v[116:117], v[236:237], v[212:213], v[116:117] op_sel:[0,1,0] op_sel_hi:[1,1,1]
    v_pk_fma_f32 v[118:119], v[238:239], v[212:213], v[118:119] op_sel:[0,1,0] op_sel_hi:[1,1,1]
    v_pk_fma_f32 v[120:121], v[236:237], v[214:215], v[120:121] op_sel:[0,0,0] op_sel_hi:[1,0,1]
    v_pk_fma_f32 v[122:123], v[238:239], v[214:215], v[122:123] op_sel:[0,0,0] op_sel_hi:[1,0,1]
    v_pk_fma_f32 v[124:125], v[236:237], v[214:215], v[124:125] op_sel:[0,1,0] op_sel_hi:[1,1,1]
    v_pk_fma_f32 v[126:127], v[238:239], v[214:215], v[126:127] op_sel:[0,1,0] op_sel_hi:[1,1,1]
    ds_read_b128 v[236:239], v251 offset:640
    ds_read_b128 v[240:243], v251 offset:1664
    s_waitcnt lgkmcnt(4)
    v_pk_add_f32 v[220:221], v[220:221], v[224:225]
    v_pk_add_f32 v[222:223], v[222:223], v[226:227]
    v_pk_fma_f32 v[128:129], v[220:221], v[212:213], v[128:129] op_sel:[0,0,0] op_sel_hi:[1,0,1]
    v_pk_fma_f32 v[130:131], v[222:223], v[212:213], v[130:131] op_sel:[0,0,0] op_sel_hi:[1,0,1]
    v_pk_fma_f32 v[132:133], v[220:221], v[212:213], v[132:133] op_sel:[0,1,0] op_sel_hi:[1,1,1]
    v_pk_fma_f32 v[134:135], v[222:223], v[212:213], v[134:135] op_sel:[0,1,0] op_sel_hi:[1,1,1]
    v_pk_fma_f32 v[136:137], v[220:221], v[214:215], v[136:137] op_sel:[0,0,0] op_sel_hi:[1,0,1]
    v_pk_fma_f32 v[138:139], v[222:223], v[214:215], v[138:139] op_sel:[0,0,0] op_sel_hi:[1,0,1]
    v_pk_fma_f32 v[140:141], v[220:221], v[214:215], v[140:141] op_sel:[0,1,0] op_sel_hi:[1,1,1]
    v_pk_fma_f32 v[142:143], v[222:223], v[214:215], v[142:143] op_sel:[0,1,0] op_sel_hi:[1,1,1]
    ds_read_b128 v[220:223], v251 offset:704
    ds_read_b128 v[224:227], v251 offset:1728
    s_waitcnt lgkmcnt(4)
    v_pk_add_f32 v[228:229], v[228:229], v[232:233]
    v_pk_add_f32 v[230:231], v[230:231], v[234:235]
    v_pk_fma_f32 v[144:145], v[228:229], v[212:213], v[144:145] op_sel:[0,0,0] op_sel_hi:[1,0,1]
    v_pk_fma_f32 v[146:147], v[230:231], v[212:213], v[146:147] op_sel:[0,0,0] op_sel_hi:[1,0,1]
    v_pk_fma_f32 v[148:149], v[228:229], v[212:213], v[148:149] op_sel:[0,1,0] op_sel_hi:[1,1,1]
    v_pk_fma_f32 v[150:151], v[230:231], v[212:213], v[150:151] op_sel:[0,1,0] op_sel_hi:[1,1,1]
    v_pk_fma_f32 v[152:153], v[228:229], v[214:215], v[152:153] op_sel:[0,0,0] op_sel_hi:[1,0,1]
    v_pk_fma_f32 v[154:155], v[230:231], v[214:215], v[154:155] op_sel:[0,0,0] op_sel_hi:[1,0,1]
    v_pk_fma_f32 v[156:157], v[228:229], v[214:215], v[156:157] op_sel:[0,1,0] op_sel_hi:[1,1,1]
    v_pk_fma_f32 v[158:159], v[230:231], v[214:215], v[158:159] op_sel:[0,1,0] op_sel_hi:[1,1,1]
    ds_read_b128 v[228:231], v251 offset:768
    ds_read_b128 v[232:235], v251 offset:1792
    s_waitcnt lgkmcnt(4)
    v_pk_add_f32 v[236:237], v[236:237], v[240:241]
    v_pk_add_f32 v[238:239], v[238:239], v[242:243]
    v_pk_fma_f32 v[160:161], v[236:237], v[212:213], v[160:161] op_sel:[0,0,0] op_sel_hi:[1,0,1]
    v_pk_fma_f32 v[162:163], v[238:239], v[212:213], v[162:163] op_sel:[0,0,0] op_sel_hi:[1,0,1]
    v_pk_fma_f32 v[164:165], v[236:237], v[212:213], v[164:165] op_sel:[0,1,0] op_sel_hi:[1,1,1]
    v_pk_fma_f32 v[166:167], v[238:239], v[212:213], v[166:167] op_sel:[0,1,0] op_sel_hi:[1,1,1]
    v_pk_fma_f32 v[168:169], v[236:237], v[214:215], v[168:169] op_sel:[0,0,0] op_sel_hi:[1,0,1]
    v_pk_fma_f32 v[170:171], v[238:239], v[214:215], v[170:171] op_sel:[0,0,0] op_sel_hi:[1,0,1]
    v_pk_fma_f32 v[172:173], v[236:237], v[214:215], v[172:173] op_sel:[0,1,0] op_sel_hi:[1,1,1]
    v_pk_fma_f32 v[174:175], v[238:239], v[214:215], v[174:175] op_sel:[0,1,0] op_sel_hi:[1,1,1]
    ds_read_b128 v[236:239], v251 offset:256
    ds_read_b128 v[240:243], v251 offset:1280
    s_waitcnt lgkmcnt(4)
    v_pk_add_f32 v[220:221], v[220:221], v[224:225]
    v_pk_add_f32 v[222:223], v[222:223], v[226:227]
    v_pk_fma_f32 v[176:177], v[220:221], v[212:213], v[176:177] op_sel:[0,0,0] op_sel_hi:[1,0,1]
    v_pk_fma_f32 v[178:179], v[222:223], v[212:213], v[178:179] op_sel:[0,0,0] op_sel_hi:[1,0,1]
    v_pk_fma_f32 v[180:181], v[220:221], v[212:213], v[180:181] op_sel:[0,1,0] op_sel_hi:[1,1,1]
    v_pk_fma_f32 v[182:183], v[222:223], v[212:213], v[182:183] op_sel:[0,1,0] op_sel_hi:[1,1,1]
    v_pk_fma_f32 v[184:185], v[220:221], v[214:215], v[184:185] op_sel:[0,0,0] op_sel_hi:[1,0,1]
    v_pk_fma_f32 v[186:187], v[222:223], v[214:215], v[186:187] op_sel:[0,0,0] op_sel_hi:[1,0,1]
    v_pk_fma_f32 v[188:189], v[220:221], v[214:215], v[188:189] op_sel:[0,1,0] op_sel_hi:[1,1,1]
    v_pk_fma_f32 v[190:191], v[222:223], v[214:215], v[190:191] op_sel:[0,1,0] op_sel_hi:[1,1,1]
    s_waitcnt lgkmcnt(2)
    v_pk_add_f32 v[228:229], v[228:229], v[232:233]
    v_pk_add_f32 v[230:231], v[230:231], v[234:235]
    v_pk_fma_f32 v[192:193], v[228:229], v[212:213], v[192:193] op_sel:[0,0,0] op_sel_hi:[1,0,1]
    v_pk_fma_f32 v[194:195], v[230:231], v[212:213], v[194:195] op_sel:[0,0,0] op_sel_hi:[1,0,1]
    v_pk_fma_f32 v[196:197], v[228:229], v[212:213], v[196:197] op_sel:[0,1,0] op_sel_hi:[1,1,1]
    v_pk_fma_f32 v[198:199], v[230:231], v[212:213], v[198:199] op_sel:[0,1,0] op_sel_hi:[1,1,1]
    v_pk_fma_f32 v[200:201], v[228:229], v[214:215], v[200:201] op_sel:[0,0,0] op_sel_hi:[1,0,1]
    v_pk_fma_f32 v[202:203], v[230:231], v[214:215], v[202:203] op_sel:[0,0,0] op_sel_hi:[1,0,1]
    v_pk_fma_f32 v[204:205], v[228:229], v[214:215], v[204:205] op_sel:[0,1,0] op_sel_hi:[1,1,1]
    v_pk_fma_f32 v[206:207], v[230:231], v[214:215], v[206:207] op_sel:[0,1,0] op_sel_hi:[1,1,1]
    s_waitcnt lgkmcnt(0)
    v_pk_add_f32 v[236:237], v[236:237], v[240:241]
    v_pk_add_f32 v[238:239], v[238:239], v[242:243]
    v_pk_fma_f32 v[64:65], v[236:237], v[212:213], v[64:65] op_sel:[0,0,0] op_sel_hi:[1,0,1]
    v_pk_fma_f32 v[66:67], v[238:239], v[212:213], v[66:67] op_sel:[0,0,0] op_sel_hi:[1,0,1]
    v_pk_fma_f32 v[68:69], v[236:237], v[212:213], v[68:69] op_sel:[0,1,0] op_sel_hi:[1,1,1]
    v_pk_fma_f32 v[70:71], v[238:239], v[212:213], v[70:71] op_sel:[0,1,0] op_sel_hi:[1,1,1]
    v_pk_fma_f32 v[72:73], v[236:237], v[214:215], v[72:73] op_sel:[0,0,0] op_sel_hi:[1,0,1]
    v_pk_fma_f32 v[74:75], v[238:239], v[214:215], v[74:75] op_sel:[0,0,0] op_sel_hi:[1,0,1]
    v_pk_fma_f32 v[76:77], v[236:237], v[214:215], v[76:77] op_sel:[0,1,0] op_sel_hi:[1,1,1]
    v_pk_fma_f32 v[78:79], v[238:239], v[214:215], v[78:79] op_sel:[0,1,0] op_sel_hi:[1,1,1]
    v_mul_f32 v212, v216, v216
    v_mul_f32 v213, v217, v217
    v_mul_f32 v214, v218, v218
    v_mul_f32 v215, v219, v219
    v_mul_f32 v220, 0xbdd2d3e8, v216
    v_mul_f32 v221, 0xc0135761, v216
    v_mul_f32 v222, 0xbdd2d3e8, v217
    v_mul_f32 v223, 0xc0135761, v217
    v_mul_f32 v224, 0xbdd2d3e8, v218
    v_mul_f32 v225, 0xc0135761, v218
    v_mul_f32 v226, 0xbdd2d3e8, v219
    v_mul_f32 v227, 0xc0135761, v219
    v_mul_f32 v220, v220, v212
    v_rcp_f32 v208, v216
    v_mul_f32 v222, v222, v213
    v_rcp_f32 v209, v217
    v_mul_f32 v224, v224, v214
    v_rcp_f32 v252, v218
    v_mul_f32 v226, v226, v215
    v_rcp_f32 v253, v219
    s_cmp_ge_u32 s32, 8
    s_cbranch_scc1 k1_kernel_O_z2
    s_lshl_b32 s34, s30, 4
    s_lshl_b32 s35, s29, 2
    s_add_u32 s34, s34, s35
    s_mul_i32 s34, s34, 56
    s_add_u32 s34, s34, s36
    s_lshl_b32 s34, s34, 10
    s_add_u32 s60, s34, 12582912
    s_add_u32 s61, s60, 57344
    s_add_u32 s62, s60, 114688
    s_add_u32 s63, s60, 172032
    v_add_u32 v245, 1024, v244
    v_pk_mul_f32 v[212:213], v[80:81], v[80:81]
    v_pk_mul_f32 v[214:215], v[82:83], v[82:83]
    v_pk_mul_f32 v[216:217], v[96:97], v[96:97]
    v_pk_mul_f32 v[218:219], v[98:99], v[98:99]
    v_pk_fma_f32 v[212:213], v[212:213], v[220:221], v[220:221] op_sel:[0,0,1] op_sel_hi:[1,0,1]
    v_pk_fma_f32 v[214:215], v[214:215], v[220:221], v[220:221] op_sel:[0,0,1] op_sel_hi:[1,0,1]
    v_pk_fma_f32 v[216:217], v[216:217], v[220:221], v[220:221] op_sel:[0,0,1] op_sel_hi:[1,0,1]
    v_pk_fma_f32 v[218:219], v[218:219], v[220:221], v[220:221] op_sel:[0,0,1] op_sel_hi:[1,0,1]
    v_pk_mul_f32 v[212:213], v[212:213], v[80:81]
    v_pk_mul_f32 v[214:215], v[214:215], v[82:83]
    v_pk_mul_f32 v[216:217], v[216:217], v[96:97]
    v_pk_mul_f32 v[218:219], v[218:219], v[98:99]
    v_exp_f32 v212, v212
    v_exp_f32 v213, v213
    v_exp_f32 v214, v214
    v_exp_f32 v215, v215
    v_exp_f32 v216, v216
    v_exp_f32 v217, v217
    v_exp_f32 v218, v218
    v_exp_f32 v219, v219
    v_pk_fma_f32 v[212:213], v[212:213], v[208:209], v[208:209] op_sel:[0,0,0] op_sel_hi:[1,0,0]
    v_pk_fma_f32 v[214:215], v[214:215], v[208:209], v[208:209] op_sel:[0,0,0] op_sel_hi:[1,0,0]
    v_pk_fma_f32 v[216:217], v[216:217], v[208:209], v[208:209] op_sel:[0,0,0] op_sel_hi:[1,0,0]
    v_pk_fma_f32 v[218:219], v[218:219], v[208:209], v[208:209] op_sel:[0,0,0] op_sel_hi:[1,0,0]
    v_rcp_f32 v212, v212
    v_rcp_f32 v213, v213
    v_rcp_f32 v214, v214
    v_rcp_f32 v215, v215
    v_rcp_f32 v216, v216
    v_rcp_f32 v217, v217
    v_rcp_f32 v218, v218
    v_rcp_f32 v219, v219
    v_pk_mul_f32 v[80:81], v[80:81], v[212:213]
    v_pk_mul_f32 v[82:83], v[82:83], v[214:215]
    v_pk_mul_f32 v[96:97], v[96:97], v[216:217]
    v_pk_mul_f32 v[98:99], v[98:99], v[218:219]
    v_cvt_pk_bf16_f32 v80, v80, v81
    v_cvt_pk_bf16_f32 v81, v82, v83
    v_cvt_pk_bf16_f32 v82, v96, v97
    v_cvt_pk_bf16_f32 v83, v98, v99
    buffer_store_dwordx4 v[80:83], v245, s[16:19], s60 offen offset:0
    v_pk_mul_f32 v[212:213], v[84:85], v[84:85]
    v_pk_mul_f32 v[214:215], v[86:87], v[86:87]
    v_pk_mul_f32 v[216:217], v[100:101], v[100:101]
    v_pk_mul_f32 v[218:219], v[102:103], v[102:103]
    v_pk_fma_f32 v[212:213], v[212:213], v[222:223], v[222:223] op_sel:[0,0,1] op_sel_hi:[1,0,1]
    v_pk_fma_f32 v[214:215], v[214:215], v[222:223], v[222:223] op_sel:[0,0,1] op_sel_hi:[1,0,1]
    v_pk_fma_f32 v[216:217], v[216:217], v[222:223], v[222:223] op_sel:[0,0,1] op_sel_hi:[1,0,1]
    v_pk_fma_f32 v[218:219], v[218:219], v[222:223], v[222:223] op_sel:[0,0,1] op_sel_hi:[1,0,1]
    v_pk_mul_f32 v[212:213], v[212:213], v[84:85]
    v_pk_mul_f32 v[214:215], v[214:215], v[86:87]
    v_pk_mul_f32 v[216:217], v[216:217], v[100:101]
    v_pk_mul_f32 v[218:219], v[218:219], v[102:103]
    v_exp_f32 v212, v212
    v_exp_f32 v213, v213
    v_exp_f32 v214, v214
    v_exp_f32 v215, v215
    v_exp_f32 v216, v216
    v_exp_f32 v217, v217
    v_exp_f32 v218, v218
    v_exp_f32 v219, v219
    v_pk_fma_f32 v[212:213], v[212:213], v[208:209], v[208:209] op_sel:[0,1,1] op_sel_hi:[1,1,1]
    v_pk_fma_f32 v[214:215], v[214:215], v[208:209], v[208:209] op_sel:[0,1,1] op_sel_hi:[1,1,1]
    v_pk_fma_f32 v[216:217], v[216:217], v[208:209], v[208:209] op_sel:[0,1,1] op_sel_hi:[1,1,1]
    v_pk_fma_f32 v[218:219], v[218:219], v[208:209], v[208:209] op_sel:[0,1,1] op_sel_hi:[1,1,1]
    v_rcp_f32 v212, v212
    v_rcp_f32 v213, v213
    v_rcp_f32 v214, v214
    v_rcp_f32 v215, v215
    v_rcp_f32 v216, v216
    v_rcp_f32 v217, v217
    v_rcp_f32 v218, v218
    v_rcp_f32 v219, v219
    v_pk_mul_f32 v[84:85], v[84:85], v[212:213]
    v_pk_mul_f32 v[86:87], v[86:87], v[214:215]
    v_pk_mul_f32 v[100:101], v[100:101], v[216:217]
    v_pk_mul_f32 v[102:103], v[102:103], v[218:219]
    v_cvt_pk_bf16_f32 v84, v84, v85
    v_cvt_pk_bf16_f32 v85, v86, v87
    v_cvt_pk_bf16_f32 v86, v100, v101
    v_cvt_pk_bf16_f32 v87, v102, v103
    buffer_store_dwordx4 v[84:87], v245, s[16:19], s61 offen offset:0
    v_pk_mul_f32 v[212:213], v[88:89], v[88:89]
    v_pk_mul_f32 v[214:215], v[90:91], v[90:91]
    v_pk_mul_f32 v[216:217], v[104:105], v[104:105]
    v_pk_mul_f32 v[218:219], v[106:107], v[106:107]
    v_pk_fma_f32 v[212:213], v[212:213], v[224:225], v[224:225] op_sel:[0,0,1] op_sel_hi:[1,0,1]
    v_pk_fma_f32 v[214:215], v[214:215], v[224:225], v[224:225] op_sel:[0,0,1] op_sel_hi:[1,0,1]
    v_pk_fma_f32 v[216:217], v[216:217], v[224:225], v[224:225] op_sel:[0,0,1] op_sel_hi:[1,0,1]
    v_pk_fma_f32 v[218:219], v[218:219], v[224:225], v[224:225] op_sel:[0,0,1] op_sel_hi:[1,0,1]
    v_pk_mul_f32 v[212:213], v[212:213], v[88:89]
    v_pk_mul_f32 v[214:215], v[214:215], v[90:91]
    v_pk_mul_f32 v[216:217], v[216:217], v[104:105]
    v_pk_mul_f32 v[218:219], v[218:219], v[106:107]
    v_exp_f32 v212, v212
    v_exp_f32 v213, v213
    v_exp_f32 v214, v214
    v_exp_f32 v215, v215
    v_exp_f32 v216, v216
    v_exp_f32 v217, v217
    v_exp_f32 v218, v218
    v_exp_f32 v219, v219
    v_pk_fma_f32 v[212:213], v[212:213], v[252:253], v[252:253] op_sel:[0,0,0] op_sel_hi:[1,0,0]
    v_pk_fma_f32 v[214:215], v[214:215], v[252:253], v[252:253] op_sel:[0,0,0] op_sel_hi:[1,0,0]
    v_pk_fma_f32 v[216:217], v[216:217], v[252:253], v[252:253] op_sel:[0,0,0] op_sel_hi:[1,0,0]
    v_pk_fma_f32 v[218:219], v[218:219], v[252:253], v[252:253] op_sel:[0,0,0] op_sel_hi:[1,0,0]
    v_rcp_f32 v212, v212
    v_rcp_f32 v213, v213
    v_rcp_f32 v214, v214
    v_rcp_f32 v215, v215
    v_rcp_f32 v216, v216
    v_rcp_f32 v217, v217
    v_rcp_f32 v218, v218
    v_rcp_f32 v219, v219
    v_pk_mul_f32 v[88:89], v[88:89], v[212:213]
    v_pk_mul_f32 v[90:91], v[90:91], v[214:215]
    v_pk_mul_f32 v[104:105], v[104:105], v[216:217]
    v_pk_mul_f32 v[106:107], v[106:107], v[218:219]
    v_cvt_pk_bf16_f32 v88, v88, v89
    v_cvt_pk_bf16_f32 v89, v90, v91
    v_cvt_pk_bf16_f32 v90, v104, v105
    v_cvt_pk_bf16_f32 v91, v106, v107
    buffer_store_dwordx4 v[88:91], v245, s[16:19], s62 offen offset:0
    v_pk_mul_f32 v[212:213], v[92:93], v[92:93]
    v_pk_mul_f32 v[214:215], v[94:95], v[94:95]
    v_pk_mul_f32 v[216:217], v[108:109], v[108:109]
    v_pk_mul_f32 v[218:219], v[110:111], v[110:111]
    v_pk_fma_f32 v[212:213], v[212:213], v[226:227], v[226:227] op_sel:[0,0,1] op_sel_hi:[1,0,1]
    v_pk_fma_f32 v[214:215], v[214:215], v[226:227], v[226:227] op_sel:[0,0,1] op_sel_hi:[1,0,1]
    v_pk_fma_f32 v[216:217], v[216:217], v[226:227], v[226:227] op_sel:[0,0,1] op_sel_hi:[1,0,1]
    v_pk_fma_f32 v[218:219], v[218:219], v[226:227], v[226:227] op_sel:[0,0,1] op_sel_hi:[1,0,1]
    v_pk_mul_f32 v[212:213], v[212:213], v[92:93]
    v_pk_mul_f32 v[214:215], v[214:215], v[94:95]
    v_pk_mul_f32 v[216:217], v[216:217], v[108:109]
    v_pk_mul_f32 v[218:219], v[218:219], v[110:111]
    v_exp_f32 v212, v212
    v_exp_f32 v213, v213
    v_exp_f32 v214, v214
    v_exp_f32 v215, v215
    v_exp_f32 v216, v216
    v_exp_f32 v217, v217
    v_exp_f32 v218, v218
    v_exp_f32 v219, v219
    v_pk_fma_f32 v[212:213], v[212:213], v[252:253], v[252:253] op_sel:[0,1,1] op_sel_hi:[1,1,1]
    v_pk_fma_f32 v[214:215], v[214:215], v[252:253], v[252:253] op_sel:[0,1,1] op_sel_hi:[1,1,1]
    v_pk_fma_f32 v[216:217], v[216:217], v[252:253], v[252:253] op_sel:[0,1,1] op_sel_hi:[1,1,1]
    v_pk_fma_f32 v[218:219], v[218:219], v[252:253], v[252:253] op_sel:[0,1,1] op_sel_hi:[1,1,1]
    v_rcp_f32 v212, v212
    v_rcp_f32 v213, v213
    v_rcp_f32 v214, v214
    v_rcp_f32 v215, v215
    v_rcp_f32 v216, v216
    v_rcp_f32 v217, v217
    v_rcp_f32 v218, v218
    v_rcp_f32 v219, v219
    v_pk_mul_f32 v[92:93], v[92:93], v[212:213]
    v_pk_mul_f32 v[94:95], v[94:95], v[214:215]
    v_pk_mul_f32 v[108:109], v[108:109], v[216:217]
    v_pk_mul_f32 v[110:111], v[110:111], v[218:219]
    v_cvt_pk_bf16_f32 v92, v92, v93
    v_cvt_pk_bf16_f32 v93, v94, v95
    v_cvt_pk_bf16_f32 v94, v108, v109
    v_cvt_pk_bf16_f32 v95, v110, v111
    buffer_store_dwordx4 v[92:95], v245, s[16:19], s63 offen offset:0
    v_pk_mul_f32 v[212:213], v[112:113], v[112:113]
    v_pk_mul_f32 v[214:215], v[114:115], v[114:115]
    v_pk_mul_f32 v[216:217], v[128:129], v[128:129]
    v_pk_mul_f32 v[218:219], v[130:131], v[130:131]
    v_pk_fma_f32 v[212:213], v[212:213], v[220:221], v[220:221] op_sel:[0,0,1] op_sel_hi:[1,0,1]
    v_pk_fma_f32 v[214:215], v[214:215], v[220:221], v[220:221] op_sel:[0,0,1] op_sel_hi:[1,0,1]
    v_pk_fma_f32 v[216:217], v[216:217], v[220:221], v[220:221] op_sel:[0,0,1] op_sel_hi:[1,0,1]
    v_pk_fma_f32 v[218:219], v[218:219], v[220:221], v[220:221] op_sel:[0,0,1] op_sel_hi:[1,0,1]
    v_pk_mul_f32 v[212:213], v[212:213], v[112:113]
    v_pk_mul_f32 v[214:215], v[214:215], v[114:115]
    v_pk_mul_f32 v[216:217], v[216:217], v[128:129]
    v_pk_mul_f32 v[218:219], v[218:219], v[130:131]
    v_exp_f32 v212, v212
    v_exp_f32 v213, v213
    v_exp_f32 v214, v214
    v_exp_f32 v215, v215
    v_exp_f32 v216, v216
    v_exp_f32 v217, v217
    v_exp_f32 v218, v218
    v_exp_f32 v219, v219
    v_pk_fma_f32 v[212:213], v[212:213], v[208:209], v[208:209] op_sel:[0,0,0] op_sel_hi:[1,0,0]
    v_pk_fma_f32 v[214:215], v[214:215], v[208:209], v[208:209] op_sel:[0,0,0] op_sel_hi:[1,0,0]
    v_pk_fma_f32 v[216:217], v[216:217], v[208:209], v[208:209] op_sel:[0,0,0] op_sel_hi:[1,0,0]
    v_pk_fma_f32 v[218:219], v[218:219], v[208:209], v[208:209] op_sel:[0,0,0] op_sel_hi:[1,0,0]
    v_rcp_f32 v212, v212
    v_rcp_f32 v213, v213
    v_rcp_f32 v214, v214
    v_rcp_f32 v215, v215
    v_rcp_f32 v216, v216
    v_rcp_f32 v217, v217
    v_rcp_f32 v218, v218
    v_rcp_f32 v219, v219
    v_pk_mul_f32 v[112:113], v[112:113], v[212:213]
    v_pk_mul_f32 v[114:115], v[114:115], v[214:215]
    v_pk_mul_f32 v[128:129], v[128:129], v[216:217]
    v_pk_mul_f32 v[130:131], v[130:131], v[218:219]
    v_cvt_pk_bf16_f32 v112, v112, v113
    v_cvt_pk_bf16_f32 v113, v114, v115
    v_cvt_pk_bf16_f32 v114, v128, v129
    v_cvt_pk_bf16_f32 v115, v130, v131
    buffer_store_dwordx4 v[112:115], v245, s[16:19], s60 offen offset:1024
    v_pk_mul_f32 v[212:213], v[116:117], v[116:117]
    v_pk_mul_f32 v[214:215], v[118:119], v[118:119]
    v_pk_mul_f32 v[216:217], v[132:133], v[132:133]
    v_pk_mul_f32 v[218:219], v[134:135], v[134:135]
    v_pk_fma_f32 v[212:213], v[212:213], v[222:223], v[222:223] op_sel:[0,0,1] op_sel_hi:[1,0,1]
    v_pk_fma_f32 v[214:215], v[214:215], v[222:223], v[222:223] op_sel:[0,0,1] op_sel_hi:[1,0,1]
    v_pk_fma_f32 v[216:217], v[216:217], v[222:223], v[222:223] op_sel:[0,0,1] op_sel_hi:[1,0,1]
    v_pk_fma_f32 v[218:219], v[218:219], v[222:223], v[222:223] op_sel:[0,0,1] op_sel_hi:[1,0,1]
    v_pk_mul_f32 v[212:213], v[212:213], v[116:117]
    v_pk_mul_f32 v[214:215], v[214:215], v[118:119]
    v_pk_mul_f32 v[216:217], v[216:217], v[132:133]
    v_pk_mul_f32 v[218:219], v[218:219], v[134:135]
    v_exp_f32 v212, v212
    v_exp_f32 v213, v213
    v_exp_f32 v214, v214
    v_exp_f32 v215, v215
    v_exp_f32 v216, v216
    v_exp_f32 v217, v217
    v_exp_f32 v218, v218
    v_exp_f32 v219, v219
    v_pk_fma_f32 v[212:213], v[212:213], v[208:209], v[208:209] op_sel:[0,1,1] op_sel_hi:[1,1,1]
    v_pk_fma_f32 v[214:215], v[214:215], v[208:209], v[208:209] op_sel:[0,1,1] op_sel_hi:[1,1,1]
    v_pk_fma_f32 v[216:217], v[216:217], v[208:209], v[208:209] op_sel:[0,1,1] op_sel_hi:[1,1,1]
    v_pk_fma_f32 v[218:219], v[218:219], v[208:209], v[208:209] op_sel:[0,1,1] op_sel_hi:[1,1,1]
    v_rcp_f32 v212, v212
    v_rcp_f32 v213, v213
    v_rcp_f32 v214, v214
    v_rcp_f32 v215, v215
    v_rcp_f32 v216, v216
    v_rcp_f32 v217, v217
    v_rcp_f32 v218, v218
    v_rcp_f32 v219, v219
    v_pk_mul_f32 v[116:117], v[116:117], v[212:213]
    v_pk_mul_f32 v[118:119], v[118:119], v[214:215]
    v_pk_mul_f32 v[132:133], v[132:133], v[216:217]
    v_pk_mul_f32 v[134:135], v[134:135], v[218:219]
    v_cvt_pk_bf16_f32 v116, v116, v117
    v_cvt_pk_bf16_f32 v117, v118, v119
    v_cvt_pk_bf16_f32 v118, v132, v133
    v_cvt_pk_bf16_f32 v119, v134, v135
    buffer_store_dwordx4 v[116:119], v245, s[16:19], s61 offen offset:1024
    v_pk_mul_f32 v[212:213], v[120:121], v[120:121]
    v_pk_mul_f32 v[214:215], v[122:123], v[122:123]
    v_pk_mul_f32 v[216:217], v[136:137], v[136:137]
    v_pk_mul_f32 v[218:219], v[138:139], v[138:139]
    v_pk_fma_f32 v[212:213], v[212:213], v[224:225], v[224:225] op_sel:[0,0,1] op_sel_hi:[1,0,1]
    v_pk_fma_f32 v[214:215], v[214:215], v[224:225], v[224:225] op_sel:[0,0,1] op_sel_hi:[1,0,1]
    v_pk_fma_f32 v[216:217], v[216:217], v[224:225], v[224:225] op_sel:[0,0,1] op_sel_hi:[1,0,1]
    v_pk_fma_f32 v[218:219], v[218:219], v[224:225], v[224:225] op_sel:[0,0,1] op_sel_hi:[1,0,1]
    v_pk_mul_f32 v[212:213], v[212:213], v[120:121]
    v_pk_mul_f32 v[214:215], v[214:215], v[122:123]
    v_pk_mul_f32 v[216:217], v[216:217], v[136:137]
    v_pk_mul_f32 v[218:219], v[218:219], v[138:139]
    v_exp_f32 v212, v212
    v_exp_f32 v213, v213
    v_exp_f32 v214, v214
    v_exp_f32 v215, v215
    v_exp_f32 v216, v216
    v_exp_f32 v217, v217
    v_exp_f32 v218, v218
    v_exp_f32 v219, v219
    v_pk_fma_f32 v[212:213], v[212:213], v[252:253], v[252:253] op_sel:[0,0,0] op_sel_hi:[1,0,0]
    v_pk_fma_f32 v[214:215], v[214:215], v[252:253], v[252:253] op_sel:[0,0,0] op_sel_hi:[1,0,0]
    v_pk_fma_f32 v[216:217], v[216:217], v[252:253], v[252:253] op_sel:[0,0,0] op_sel_hi:[1,0,0]
    v_pk_fma_f32 v[218:219], v[218:219], v[252:253], v[252:253] op_sel:[0,0,0] op_sel_hi:[1,0,0]
    v_rcp_f32 v212, v212
    v_rcp_f32 v213, v213
    v_rcp_f32 v214, v214
    v_rcp_f32 v215, v215
    v_rcp_f32 v216, v216
    v_rcp_f32 v217, v217
    v_rcp_f32 v218, v218
    v_rcp_f32 v219, v219
    v_pk_mul_f32 v[120:121], v[120:121], v[212:213]
    v_pk_mul_f32 v[122:123], v[122:123], v[214:215]
    v_pk_mul_f32 v[136:137], v[136:137], v[216:217]
    v_pk_mul_f32 v[138:139], v[138:139], v[218:219]
    v_cvt_pk_bf16_f32 v120, v120, v121
    v_cvt_pk_bf16_f32 v121, v122, v123
    v_cvt_pk_bf16_f32 v122, v136, v137
    v_cvt_pk_bf16_f32 v123, v138, v139
    buffer_store_dwordx4 v[120:123], v245, s[16:19], s62 offen offset:1024
    v_pk_mul_f32 v[212:213], v[124:125], v[124:125]
    v_pk_mul_f32 v[214:215], v[126:127], v[126:127]
    v_pk_mul_f32 v[216:217], v[140:141], v[140:141]
    v_pk_mul_f32 v[218:219], v[142:143], v[142:143]
    v_pk_fma_f32 v[212:213], v[212:213], v[226:227], v[226:227] op_sel:[0,0,1] op_sel_hi:[1,0,1]
    v_pk_fma_f32 v[214:215], v[214:215], v[226:227], v[226:227] op_sel:[0,0,1] op_sel_hi:[1,0,1]
    v_pk_fma_f32 v[216:217], v[216:217], v[226:227], v[226:227] op_sel:[0,0,1] op_sel_hi:[1,0,1]
    v_pk_fma_f32 v[218:219], v[218:219], v[226:227], v[226:227] op_sel:[0,0,1] op_sel_hi:[1,0,1]
    v_pk_mul_f32 v[212:213], v[212:213], v[124:125]
    v_pk_mul_f32 v[214:215], v[214:215], v[126:127]
    v_pk_mul_f32 v[216:217], v[216:217], v[140:141]
    v_pk_mul_f32 v[218:219], v[218:219], v[142:143]
    v_exp_f32 v212, v212
    v_exp_f32 v213, v213
    v_exp_f32 v214, v214
    v_exp_f32 v215, v215
    v_exp_f32 v216, v216
    v_exp_f32 v217, v217
    v_exp_f32 v218, v218
    v_exp_f32 v219, v219
    v_pk_fma_f32 v[212:213], v[212:213], v[252:253], v[252:253] op_sel:[0,1,1] op_sel_hi:[1,1,1]
    v_pk_fma_f32 v[214:215], v[214:215], v[252:253], v[252:253] op_sel:[0,1,1] op_sel_hi:[1,1,1]
    v_pk_fma_f32 v[216:217], v[216:217], v[252:253], v[252:253] op_sel:[0,1,1] op_sel_hi:[1,1,1]
    v_pk_fma_f32 v[218:219], v[218:219], v[252:253], v[252:253] op_sel:[0,1,1] op_sel_hi:[1,1,1]
    v_rcp_f32 v212, v212
    v_rcp_f32 v213, v213
    v_rcp_f32 v214, v214
    v_rcp_f32 v215, v215
    v_rcp_f32 v216, v216
    v_rcp_f32 v217, v217
    v_rcp_f32 v218, v218
    v_rcp_f32 v219, v219
    v_pk_mul_f32 v[124:125], v[124:125], v[212:213]
    v_pk_mul_f32 v[126:127], v[126:127], v[214:215]
    v_pk_mul_f32 v[140:141], v[140:141], v[216:217]
    v_pk_mul_f32 v[142:143], v[142:143], v[218:219]
    v_cvt_pk_bf16_f32 v124, v124, v125
    v_cvt_pk_bf16_f32 v125, v126, v127
    v_cvt_pk_bf16_f32 v126, v140, v141
    v_cvt_pk_bf16_f32 v127, v142, v143
    buffer_store_dwordx4 v[124:127], v245, s[16:19], s63 offen offset:1024
    v_pk_mul_f32 v[212:213], v[144:145], v[144:145]
    v_pk_mul_f32 v[214:215], v[146:147], v[146:147]
    v_pk_mul_f32 v[216:217], v[160:161], v[160:161]
    v_pk_mul_f32 v[218:219], v[162:163], v[162:163]
    v_pk_fma_f32 v[212:213], v[212:213], v[220:221], v[220:221] op_sel:[0,0,1] op_sel_hi:[1,0,1]
    v_pk_fma_f32 v[214:215], v[214:215], v[220:221], v[220:221] op_sel:[0,0,1] op_sel_hi:[1,0,1]
    v_pk_fma_f32 v[216:217], v[216:217], v[220:221], v[220:221] op_sel:[0,0,1] op_sel_hi:[1,0,1]
    v_pk_fma_f32 v[218:219], v[218:219], v[220:221], v[220:221] op_sel:[0,0,1] op_sel_hi:[1,0,1]
    v_pk_mul_f32 v[212:213], v[212:213], v[144:145]
    v_pk_mul_f32 v[214:215], v[214:215], v[146:147]
    v_pk_mul_f32 v[216:217], v[216:217], v[160:161]
    v_pk_mul_f32 v[218:219], v[218:219], v[162:163]
    v_exp_f32 v212, v212
    v_exp_f32 v213, v213
    v_exp_f32 v214, v214
    v_exp_f32 v215, v215
    v_exp_f32 v216, v216
    v_exp_f32 v217, v217
    v_exp_f32 v218, v218
    v_exp_f32 v219, v219
    v_pk_fma_f32 v[212:213], v[212:213], v[208:209], v[208:209] op_sel:[0,0,0] op_sel_hi:[1,0,0]
    v_pk_fma_f32 v[214:215], v[214:215], v[208:209], v[208:209] op_sel:[0,0,0] op_sel_hi:[1,0,0]
    v_pk_fma_f32 v[216:217], v[216:217], v[208:209], v[208:209] op_sel:[0,0,0] op_sel_hi:[1,0,0]
    v_pk_fma_f32 v[218:219], v[218:219], v[208:209], v[208:209] op_sel:[0,0,0] op_sel_hi:[1,0,0]
    v_rcp_f32 v212, v212
    v_rcp_f32 v213, v213
    v_rcp_f32 v214, v214
    v_rcp_f32 v215, v215
    v_rcp_f32 v216, v216
    v_rcp_f32 v217, v217
    v_rcp_f32 v218, v218
    v_rcp_f32 v219, v219
    v_pk_mul_f32 v[144:145], v[144:145], v[212:213]
    v_pk_mul_f32 v[146:147], v[146:147], v[214:215]
    v_pk_mul_f32 v[160:161], v[160:161], v[216:217]
    v_pk_mul_f32 v[162:163], v[162:163], v[218:219]
    v_cvt_pk_bf16_f32 v144, v144, v145
    v_cvt_pk_bf16_f32 v145, v146, v147
    v_cvt_pk_bf16_f32 v146, v160, v161
    v_cvt_pk_bf16_f32 v147, v162, v163
    buffer_store_dwordx4 v[144:147], v245, s[16:19], s60 offen offset:2048
    v_pk_mul_f32 v[212:213], v[148:149], v[148:149]
    v_pk_mul_f32 v[214:215], v[150:151], v[150:151]
    v_pk_mul_f32 v[216:217], v[164:165], v[164:165]
    v_pk_mul_f32 v[218:219], v[166:167], v[166:167]
    v_pk_fma_f32 v[212:213], v[212:213], v[222:223], v[222:223] op_sel:[0,0,1] op_sel_hi:[1,0,1]
    v_pk_fma_f32 v[214:215], v[214:215], v[222:223], v[222:223] op_sel:[0,0,1] op_sel_hi:[1,0,1]
    v_pk_fma_f32 v[216:217], v[216:217], v[222:223], v[222:223] op_sel:[0,0,1] op_sel_hi:[1,0,1]
    v_pk_fma_f32 v[218:219], v[218:219], v[222:223], v[222:223] op_sel:[0,0,1] op_sel_hi:[1,0,1]
    v_pk_mul_f32 v[212:213], v[212:213], v[148:149]
    v_pk_mul_f32 v[214:215], v[214:215], v[150:151]
    v_pk_mul_f32 v[216:217], v[216:217], v[164:165]
    v_pk_mul_f32 v[218:219], v[218:219], v[166:167]
    v_exp_f32 v212, v212
    v_exp_f32 v213, v213
    v_exp_f32 v214, v214
    v_exp_f32 v215, v215
    v_exp_f32 v216, v216
    v_exp_f32 v217, v217
    v_exp_f32 v218, v218
    v_exp_f32 v219, v219
    v_pk_fma_f32 v[212:213], v[212:213], v[208:209], v[208:209] op_sel:[0,1,1] op_sel_hi:[1,1,1]
    v_pk_fma_f32 v[214:215], v[214:215], v[208:209], v[208:209] op_sel:[0,1,1] op_sel_hi:[1,1,1]
    v_pk_fma_f32 v[216:217], v[216:217], v[208:209], v[208:209] op_sel:[0,1,1] op_sel_hi:[1,1,1]
    v_pk_fma_f32 v[218:219], v[218:219], v[208:209], v[208:209] op_sel:[0,1,1] op_sel_hi:[1,1,1]
    v_rcp_f32 v212, v212
    v_rcp_f32 v213, v213
    v_rcp_f32 v214, v214
    v_rcp_f32 v215, v215
    v_rcp_f32 v216, v216
    v_rcp_f32 v217, v217
    v_rcp_f32 v218, v218
    v_rcp_f32 v219, v219
    v_pk_mul_f32 v[148:149], v[148:149], v[212:213]
    v_pk_mul_f32 v[150:151], v[150:151], v[214:215]
    v_pk_mul_f32 v[164:165], v[164:165], v[216:217]
    v_pk_mul_f32 v[166:167], v[166:167], v[218:219]
    v_cvt_pk_bf16_f32 v148, v148, v149
    v_cvt_pk_bf16_f32 v149, v150, v151
    v_cvt_pk_bf16_f32 v150, v164, v165
    v_cvt_pk_bf16_f32 v151, v166, v167
    buffer_store_dwordx4 v[148:151], v245, s[16:19], s61 offen offset:2048
    v_pk_mul_f32 v[212:213], v[152:153], v[152:153]
    v_pk_mul_f32 v[214:215], v[154:155], v[154:155]
    v_pk_mul_f32 v[216:217], v[168:169], v[168:169]
    v_pk_mul_f32 v[218:219], v[170:171], v[170:171]
    v_pk_fma_f32 v[212:213], v[212:213], v[224:225], v[224:225] op_sel:[0,0,1] op_sel_hi:[1,0,1]
    v_pk_fma_f32 v[214:215], v[214:215], v[224:225], v[224:225] op_sel:[0,0,1] op_sel_hi:[1,0,1]
    v_pk_fma_f32 v[216:217], v[216:217], v[224:225], v[224:225] op_sel:[0,0,1] op_sel_hi:[1,0,1]
    v_pk_fma_f32 v[218:219], v[218:219], v[224:225], v[224:225] op_sel:[0,0,1] op_sel_hi:[1,0,1]
    v_pk_mul_f32 v[212:213], v[212:213], v[152:153]
    v_pk_mul_f32 v[214:215], v[214:215], v[154:155]
    v_pk_mul_f32 v[216:217], v[216:217], v[168:169]
    v_pk_mul_f32 v[218:219], v[218:219], v[170:171]
    v_exp_f32 v212, v212
    v_exp_f32 v213, v213
    v_exp_f32 v214, v214
    v_exp_f32 v215, v215
    v_exp_f32 v216, v216
    v_exp_f32 v217, v217
    v_exp_f32 v218, v218
    v_exp_f32 v219, v219
    v_pk_fma_f32 v[212:213], v[212:213], v[252:253], v[252:253] op_sel:[0,0,0] op_sel_hi:[1,0,0]
    v_pk_fma_f32 v[214:215], v[214:215], v[252:253], v[252:253] op_sel:[0,0,0] op_sel_hi:[1,0,0]
    v_pk_fma_f32 v[216:217], v[216:217], v[252:253], v[252:253] op_sel:[0,0,0] op_sel_hi:[1,0,0]
    v_pk_fma_f32 v[218:219], v[218:219], v[252:253], v[252:253] op_sel:[0,0,0] op_sel_hi:[1,0,0]
    v_rcp_f32 v212, v212
    v_rcp_f32 v213, v213
    v_rcp_f32 v214, v214
    v_rcp_f32 v215, v215
    v_rcp_f32 v216, v216
    v_rcp_f32 v217, v217
    v_rcp_f32 v218, v218
    v_rcp_f32 v219, v219
    v_pk_mul_f32 v[152:153], v[152:153], v[212:213]
    v_pk_mul_f32 v[154:155], v[154:155], v[214:215]
    v_pk_mul_f32 v[168:169], v[168:169], v[216:217]
    v_pk_mul_f32 v[170:171], v[170:171], v[218:219]
    v_cvt_pk_bf16_f32 v152, v152, v153
    v_cvt_pk_bf16_f32 v153, v154, v155
    v_cvt_pk_bf16_f32 v154, v168, v169
    v_cvt_pk_bf16_f32 v155, v170, v171
    buffer_store_dwordx4 v[152:155], v245, s[16:19], s62 offen offset:2048
    v_pk_mul_f32 v[212:213], v[156:157], v[156:157]
    v_pk_mul_f32 v[214:215], v[158:159], v[158:159]
    v_pk_mul_f32 v[216:217], v[172:173], v[172:173]
    v_pk_mul_f32 v[218:219], v[174:175], v[174:175]
    v_pk_fma_f32 v[212:213], v[212:213], v[226:227], v[226:227] op_sel:[0,0,1] op_sel_hi:[1,0,1]
    v_pk_fma_f32 v[214:215], v[214:215], v[226:227], v[226:227] op_sel:[0,0,1] op_sel_hi:[1,0,1]
    v_pk_fma_f32 v[216:217], v[216:217], v[226:227], v[226:227] op_sel:[0,0,1] op_sel_hi:[1,0,1]
    v_pk_fma_f32 v[218:219], v[218:219], v[226:227], v[226:227] op_sel:[0,0,1] op_sel_hi:[1,0,1]
    v_pk_mul_f32 v[212:213], v[212:213], v[156:157]
    v_pk_mul_f32 v[214:215], v[214:215], v[158:159]
    v_pk_mul_f32 v[216:217], v[216:217], v[172:173]
    v_pk_mul_f32 v[218:219], v[218:219], v[174:175]
    v_exp_f32 v212, v212
    v_exp_f32 v213, v213
    v_exp_f32 v214, v214
    v_exp_f32 v215, v215
    v_exp_f32 v216, v216
    v_exp_f32 v217, v217
    v_exp_f32 v218, v218
    v_exp_f32 v219, v219
    v_pk_fma_f32 v[212:213], v[212:213], v[252:253], v[252:253] op_sel:[0,1,1] op_sel_hi:[1,1,1]
    v_pk_fma_f32 v[214:215], v[214:215], v[252:253], v[252:253] op_sel:[0,1,1] op_sel_hi:[1,1,1]
    v_pk_fma_f32 v[216:217], v[216:217], v[252:253], v[252:253] op_sel:[0,1,1] op_sel_hi:[1,1,1]
    v_pk_fma_f32 v[218:219], v[218:219], v[252:253], v[252:253] op_sel:[0,1,1] op_sel_hi:[1,1,1]
    v_rcp_f32 v212, v212
    v_rcp_f32 v213, v213
    v_rcp_f32 v214, v214
    v_rcp_f32 v215, v215
    v_rcp_f32 v216, v216
    v_rcp_f32 v217, v217
    v_rcp_f32 v218, v218
    v_rcp_f32 v219, v219
    v_pk_mul_f32 v[156:157], v[156:157], v[212:213]
    v_pk_mul_f32 v[158:159], v[158:159], v[214:215]
    v_pk_mul_f32 v[172:173], v[172:173], v[216:217]
    v_pk_mul_f32 v[174:175], v[174:175], v[218:219]
    v_cvt_pk_bf16_f32 v156, v156, v157
    v_cvt_pk_bf16_f32 v157, v158, v159
    v_cvt_pk_bf16_f32 v158, v172, v173
    v_cvt_pk_bf16_f32 v159, v174, v175
    buffer_store_dwordx4 v[156:159], v245, s[16:19], s63 offen offset:2048
    v_pk_mul_f32 v[212:213], v[176:177], v[176:177]
    v_pk_mul_f32 v[214:215], v[178:179], v[178:179]
    v_pk_mul_f32 v[216:217], v[192:193], v[192:193]
    v_pk_mul_f32 v[218:219], v[194:195], v[194:195]
    v_pk_fma_f32 v[212:213], v[212:213], v[220:221], v[220:221] op_sel:[0,0,1] op_sel_hi:[1,0,1]
    v_pk_fma_f32 v[214:215], v[214:215], v[220:221], v[220:221] op_sel:[0,0,1] op_sel_hi:[1,0,1]
    v_pk_fma_f32 v[216:217], v[216:217], v[220:221], v[220:221] op_sel:[0,0,1] op_sel_hi:[1,0,1]
    v_pk_fma_f32 v[218:219], v[218:219], v[220:221], v[220:221] op_sel:[0,0,1] op_sel_hi:[1,0,1]
    v_pk_mul_f32 v[212:213], v[212:213], v[176:177]
    v_pk_mul_f32 v[214:215], v[214:215], v[178:179]
    v_pk_mul_f32 v[216:217], v[216:217], v[192:193]
    v_pk_mul_f32 v[218:219], v[218:219], v[194:195]
    v_exp_f32 v212, v212
    v_exp_f32 v213, v213
    v_exp_f32 v214, v214
    v_exp_f32 v215, v215
    v_exp_f32 v216, v216
    v_exp_f32 v217, v217
    v_exp_f32 v218, v218
    v_exp_f32 v219, v219
    v_pk_fma_f32 v[212:213], v[212:213], v[208:209], v[208:209] op_sel:[0,0,0] op_sel_hi:[1,0,0]
    v_pk_fma_f32 v[214:215], v[214:215], v[208:209], v[208:209] op_sel:[0,0,0] op_sel_hi:[1,0,0]
    v_pk_fma_f32 v[216:217], v[216:217], v[208:209], v[208:209] op_sel:[0,0,0] op_sel_hi:[1,0,0]
    v_pk_fma_f32 v[218:219], v[218:219], v[208:209], v[208:209] op_sel:[0,0,0] op_sel_hi:[1,0,0]
    v_rcp_f32 v212, v212
    v_rcp_f32 v213, v213
    v_rcp_f32 v214, v214
    v_rcp_f32 v215, v215
    v_rcp_f32 v216, v216
    v_rcp_f32 v217, v217
    v_rcp_f32 v218, v218
    v_rcp_f32 v219, v219
    v_pk_mul_f32 v[176:177], v[176:177], v[212:213]
    v_pk_mul_f32 v[178:179], v[178:179], v[214:215]
    v_pk_mul_f32 v[192:193], v[192:193], v[216:217]
    v_pk_mul_f32 v[194:195], v[194:195], v[218:219]
    v_cvt_pk_bf16_f32 v176, v176, v177
    v_cvt_pk_bf16_f32 v177, v178, v179
    v_cvt_pk_bf16_f32 v178, v192, v193
    v_cvt_pk_bf16_f32 v179, v194, v195
    buffer_store_dwordx4 v[176:179], v245, s[16:19], s60 offen offset:3072
    v_pk_mul_f32 v[212:213], v[180:181], v[180:181]
    v_pk_mul_f32 v[214:215], v[182:183], v[182:183]
    v_pk_mul_f32 v[216:217], v[196:197], v[196:197]
    v_pk_mul_f32 v[218:219], v[198:199], v[198:199]
    v_pk_fma_f32 v[212:213], v[212:213], v[222:223], v[222:223] op_sel:[0,0,1] op_sel_hi:[1,0,1]
    v_pk_fma_f32 v[214:215], v[214:215], v[222:223], v[222:223] op_sel:[0,0,1] op_sel_hi:[1,0,1]
    v_pk_fma_f32 v[216:217], v[216:217], v[222:223], v[222:223] op_sel:[0,0,1] op_sel_hi:[1,0,1]
    v_pk_fma_f32 v[218:219], v[218:219], v[222:223], v[222:223] op_sel:[0,0,1] op_sel_hi:[1,0,1]
    v_pk_mul_f32 v[212:213], v[212:213], v[180:181]
    v_pk_mul_f32 v[214:215], v[214:215], v[182:183]
    v_pk_mul_f32 v[216:217], v[216:217], v[196:197]
    v_pk_mul_f32 v[218:219], v[218:219], v[198:199]
    v_exp_f32 v212, v212
    v_exp_f32 v213, v213
    v_exp_f32 v214, v214
    v_exp_f32 v215, v215
    v_exp_f32 v216, v216
    v_exp_f32 v217, v217
    v_exp_f32 v218, v218
    v_exp_f32 v219, v219
    v_pk_fma_f32 v[212:213], v[212:213], v[208:209], v[208:209] op_sel:[0,1,1] op_sel_hi:[1,1,1]
    v_pk_fma_f32 v[214:215], v[214:215], v[208:209], v[208:209] op_sel:[0,1,1] op_sel_hi:[1,1,1]
    v_pk_fma_f32 v[216:217], v[216:217], v[208:209], v[208:209] op_sel:[0,1,1] op_sel_hi:[1,1,1]
    v_pk_fma_f32 v[218:219], v[218:219], v[208:209], v[208:209] op_sel:[0,1,1] op_sel_hi:[1,1,1]
    v_rcp_f32 v212, v212
    v_rcp_f32 v213, v213
    v_rcp_f32 v214, v214
    v_rcp_f32 v215, v215
    v_rcp_f32 v216, v216
    v_rcp_f32 v217, v217
    v_rcp_f32 v218, v218
    v_rcp_f32 v219, v219
    v_pk_mul_f32 v[180:181], v[180:181], v[212:213]
    v_pk_mul_f32 v[182:183], v[182:183], v[214:215]
    v_pk_mul_f32 v[196:197], v[196:197], v[216:217]
    v_pk_mul_f32 v[198:199], v[198:199], v[218:219]
    v_cvt_pk_bf16_f32 v180, v180, v181
    v_cvt_pk_bf16_f32 v181, v182, v183
    v_cvt_pk_bf16_f32 v182, v196, v197
    v_cvt_pk_bf16_f32 v183, v198, v199
    buffer_store_dwordx4 v[180:183], v245, s[16:19], s61 offen offset:3072
    v_pk_mul_f32 v[212:213], v[184:185], v[184:185]
    v_pk_mul_f32 v[214:215], v[186:187], v[186:187]
    v_pk_mul_f32 v[216:217], v[200:201], v[200:201]
    v_pk_mul_f32 v[218:219], v[202:203], v[202:203]
    v_pk_fma_f32 v[212:213], v[212:213], v[224:225], v[224:225] op_sel:[0,0,1] op_sel_hi:[1,0,1]
    v_pk_fma_f32 v[214:215], v[214:215], v[224:225], v[224:225] op_sel:[0,0,1] op_sel_hi:[1,0,1]
    v_pk_fma_f32 v[216:217], v[216:217], v[224:225], v[224:225] op_sel:[0,0,1] op_sel_hi:[1,0,1]
    v_pk_fma_f32 v[218:219], v[218:219], v[224:225], v[224:225] op_sel:[0,0,1] op_sel_hi:[1,0,1]
    v_pk_mul_f32 v[212:213], v[212:213], v[184:185]
    v_pk_mul_f32 v[214:215], v[214:215], v[186:187]
    v_pk_mul_f32 v[216:217], v[216:217], v[200:201]
    v_pk_mul_f32 v[218:219], v[218:219], v[202:203]
    v_exp_f32 v212, v212
    v_exp_f32 v213, v213
    v_exp_f32 v214, v214
    v_exp_f32 v215, v215
    v_exp_f32 v216, v216
    v_exp_f32 v217, v217
    v_exp_f32 v218, v218
    v_exp_f32 v219, v219
    v_pk_fma_f32 v[212:213], v[212:213], v[252:253], v[252:253] op_sel:[0,0,0] op_sel_hi:[1,0,0]
    v_pk_fma_f32 v[214:215], v[214:215], v[252:253], v[252:253] op_sel:[0,0,0] op_sel_hi:[1,0,0]
    v_pk_fma_f32 v[216:217], v[216:217], v[252:253], v[252:253] op_sel:[0,0,0] op_sel_hi:[1,0,0]
    v_pk_fma_f32 v[218:219], v[218:219], v[252:253], v[252:253] op_sel:[0,0,0] op_sel_hi:[1,0,0]
    v_rcp_f32 v212, v212
    v_rcp_f32 v213, v213
    v_rcp_f32 v214, v214
    v_rcp_f32 v215, v215
    v_rcp_f32 v216, v216
    v_rcp_f32 v217, v217
    v_rcp_f32 v218, v218
    v_rcp_f32 v219, v219
    v_pk_mul_f32 v[184:185], v[184:185], v[212:213]
    v_pk_mul_f32 v[186:187], v[186:187], v[214:215]
    v_pk_mul_f32 v[200:201], v[200:201], v[216:217]
    v_pk_mul_f32 v[202:203], v[202:203], v[218:219]
    v_cvt_pk_bf16_f32 v184, v184, v185
    v_cvt_pk_bf16_f32 v185, v186, v187
    v_cvt_pk_bf16_f32 v186, v200, v201
    v_cvt_pk_bf16_f32 v187, v202, v203
    buffer_store_dwordx4 v[184:187], v245, s[16:19], s62 offen offset:3072
    v_pk_mul_f32 v[212:213], v[188:189], v[188:189]
    v_pk_mul_f32 v[214:215], v[190:191], v[190:191]
    v_pk_mul_f32 v[216:217], v[204:205], v[204:205]
    v_pk_mul_f32 v[218:219], v[206:207], v[206:207]
    v_pk_fma_f32 v[212:213], v[212:213], v[226:227], v[226:227] op_sel:[0,0,1] op_sel_hi:[1,0,1]
    v_pk_fma_f32 v[214:215], v[214:215], v[226:227], v[226:227] op_sel:[0,0,1] op_sel_hi:[1,0,1]
    v_pk_fma_f32 v[216:217], v[216:217], v[226:227], v[226:227] op_sel:[0,0,1] op_sel_hi:[1,0,1]
    v_pk_fma_f32 v[218:219], v[218:219], v[226:227], v[226:227] op_sel:[0,0,1] op_sel_hi:[1,0,1]
    v_pk_mul_f32 v[212:213], v[212:213], v[188:189]
    v_pk_mul_f32 v[214:215], v[214:215], v[190:191]
    v_pk_mul_f32 v[216:217], v[216:217], v[204:205]
    v_pk_mul_f32 v[218:219], v[218:219], v[206:207]
    v_exp_f32 v212, v212
    v_exp_f32 v213, v213
    v_exp_f32 v214, v214
    v_exp_f32 v215, v215
    v_exp_f32 v216, v216
    v_exp_f32 v217, v217
    v_exp_f32 v218, v218
    v_exp_f32 v219, v219
    v_pk_fma_f32 v[212:213], v[212:213], v[252:253], v[252:253] op_sel:[0,1,1] op_sel_hi:[1,1,1]
    v_pk_fma_f32 v[214:215], v[214:215], v[252:253], v[252:253] op_sel:[0,1,1] op_sel_hi:[1,1,1]
    v_pk_fma_f32 v[216:217], v[216:217], v[252:253], v[252:253] op_sel:[0,1,1] op_sel_hi:[1,1,1]
    v_pk_fma_f32 v[218:219], v[218:219], v[252:253], v[252:253] op_sel:[0,1,1] op_sel_hi:[1,1,1]
    v_rcp_f32 v212, v212
    v_rcp_f32 v213, v213
    v_rcp_f32 v214, v214
    v_rcp_f32 v215, v215
    v_rcp_f32 v216, v216
    v_rcp_f32 v217, v217
    v_rcp_f32 v218, v218
    v_rcp_f32 v219, v219
    v_pk_mul_f32 v[188:189], v[188:189], v[212:213]
    v_pk_mul_f32 v[190:191], v[190:191], v[214:215]
    v_pk_mul_f32 v[204:205], v[204:205], v[216:217]
    v_pk_mul_f32 v[206:207], v[206:207], v[218:219]
    v_cvt_pk_bf16_f32 v188, v188, v189
    v_cvt_pk_bf16_f32 v189, v190, v191
    v_cvt_pk_bf16_f32 v190, v204, v205
    v_cvt_pk_bf16_f32 v191, v206, v207
    buffer_store_dwordx4 v[188:191], v245, s[16:19], s63 offen offset:3072
    v_pk_mul_f32 v[212:213], v[64:65], v[64:65]
    v_pk_mul_f32 v[214:215], v[66:67], v[66:67]
    v_pk_mul_f32 v[216:217], v[68:69], v[68:69]
    v_pk_mul_f32 v[218:219], v[70:71], v[70:71]
    v_pk_fma_f32 v[212:213], v[212:213], v[220:221], v[220:221] op_sel:[0,0,1] op_sel_hi:[1,0,1]
    v_pk_fma_f32 v[214:215], v[214:215], v[220:221], v[220:221] op_sel:[0,0,1] op_sel_hi:[1,0,1]
    v_pk_fma_f32 v[216:217], v[216:217], v[222:223], v[222:223] op_sel:[0,0,1] op_sel_hi:[1,0,1]
    v_pk_fma_f32 v[218:219], v[218:219], v[222:223], v[222:223] op_sel:[0,0,1] op_sel_hi:[1,0,1]
    v_pk_mul_f32 v[212:213], v[212:213], v[64:65]
    v_pk_mul_f32 v[214:215], v[214:215], v[66:67]
    v_pk_mul_f32 v[216:217], v[216:217], v[68:69]
    v_pk_mul_f32 v[218:219], v[218:219], v[70:71]
    v_exp_f32 v212, v212
    v_exp_f32 v213, v213
    v_exp_f32 v214, v214
    v_exp_f32 v215, v215
    v_exp_f32 v216, v216
    v_exp_f32 v217, v217
    v_exp_f32 v218, v218
    v_exp_f32 v219, v219
    v_pk_fma_f32 v[212:213], v[212:213], v[208:209], v[208:209] op_sel:[0,0,0] op_sel_hi:[1,0,0]
    v_pk_fma_f32 v[214:215], v[214:215], v[208:209], v[208:209] op_sel:[0,0,0] op_sel_hi:[1,0,0]
    v_pk_fma_f32 v[216:217], v[216:217], v[208:209], v[208:209] op_sel:[0,1,1] op_sel_hi:[1,1,1]
    v_pk_fma_f32 v[218:219], v[218:219], v[208:209], v[208:209] op_sel:[0,1,1] op_sel_hi:[1,1,1]
    v_rcp_f32 v212, v212
    v_rcp_f32 v213, v213
    v_rcp_f32 v214, v214
    v_rcp_f32 v215, v215
    v_rcp_f32 v216, v216
    v_rcp_f32 v217, v217
    v_rcp_f32 v218, v218
    v_rcp_f32 v219, v219
    v_pk_mul_f32 v[64:65], v[64:65], v[212:213]
    v_pk_mul_f32 v[66:67], v[66:67], v[214:215]
    v_pk_mul_f32 v[68:69], v[68:69], v[216:217]
    v_pk_mul_f32 v[70:71], v[70:71], v[218:219]
    v_cvt_pk_bf16_f32 v64, v64, v65
    v_cvt_pk_bf16_f32 v65, v66, v67
    v_cvt_pk_bf16_f32 v68, v68, v69
    v_cvt_pk_bf16_f32 v69, v70, v71
    buffer_store_dwordx2 v[64:65], v244, s[16:19], s60 offen offset:8
    buffer_store_dwordx2 v[68:69], v244, s[16:19], s61 offen offset:8
    v_pk_mul_f32 v[212:213], v[72:73], v[72:73]
    v_pk_mul_f32 v[214:215], v[74:75], v[74:75]
    v_pk_mul_f32 v[216:217], v[76:77], v[76:77]
    v_pk_mul_f32 v[218:219], v[78:79], v[78:79]
    v_pk_fma_f32 v[212:213], v[212:213], v[224:225], v[224:225] op_sel:[0,0,1] op_sel_hi:[1,0,1]
    v_pk_fma_f32 v[214:215], v[214:215], v[224:225], v[224:225] op_sel:[0,0,1] op_sel_hi:[1,0,1]
    v_pk_fma_f32 v[216:217], v[216:217], v[226:227], v[226:227] op_sel:[0,0,1] op_sel_hi:[1,0,1]
    v_pk_fma_f32 v[218:219], v[218:219], v[226:227], v[226:227] op_sel:[0,0,1] op_sel_hi:[1,0,1]
    v_pk_mul_f32 v[212:213], v[212:213], v[72:73]
    v_pk_mul_f32 v[214:215], v[214:215], v[74:75]
    v_pk_mul_f32 v[216:217], v[216:217], v[76:77]
    v_pk_mul_f32 v[218:219], v[218:219], v[78:79]
    v_exp_f32 v212, v212
    v_exp_f32 v213, v213
    v_exp_f32 v214, v214
    v_exp_f32 v215, v215
    v_exp_f32 v216, v216
    v_exp_f32 v217, v217
    v_exp_f32 v218, v218
    v_exp_f32 v219, v219
    v_pk_fma_f32 v[212:213], v[212:213], v[252:253], v[252:253] op_sel:[0,0,0] op_sel_hi:[1,0,0]
    v_pk_fma_f32 v[214:215], v[214:215], v[252:253], v[252:253] op_sel:[0,0,0] op_sel_hi:[1,0,0]
    v_pk_fma_f32 v[216:217], v[216:217], v[252:253], v[252:253] op_sel:[0,1,1] op_sel_hi:[1,1,1]
    v_pk_fma_f32 v[218:219], v[218:219], v[252:253], v[252:253] op_sel:[0,1,1] op_sel_hi:[1,1,1]
    v_rcp_f32 v212, v212
    v_rcp_f32 v213, v213
    v_rcp_f32 v214, v214
    v_rcp_f32 v215, v215
    v_rcp_f32 v216, v216
    v_rcp_f32 v217, v217
    v_rcp_f32 v218, v218
    v_rcp_f32 v219, v219
    v_pk_mul_f32 v[72:73], v[72:73], v[212:213]
    v_pk_mul_f32 v[74:75], v[74:75], v[214:215]
    v_pk_mul_f32 v[76:77], v[76:77], v[216:217]
    v_pk_mul_f32 v[78:79], v[78:79], v[218:219]
    v_cvt_pk_bf16_f32 v72, v72, v73
    v_cvt_pk_bf16_f32 v73, v74, v75
    v_cvt_pk_bf16_f32 v76, v76, v77
    v_cvt_pk_bf16_f32 v77, v78, v79
    buffer_store_dwordx2 v[72:73], v244, s[16:19], s62 offen offset:8
    buffer_store_dwordx2 v[76:77], v244, s[16:19], s63 offen offset:8
    s_lshl_b32 s34, s29, 9
    s_add_u32 s34, s34, 154624
    v_and_b32 v250, 15, v255
    v_lshl_add_u32 v250, v250, 2, s34
    v_and_b32 v251, 48, v255
    v_add_u32 v251, 152576, v251
    ds_read2_b32 v[212:213], v250 offset0:64 offset1:80
    ds_read2_b32 v[214:215], v250 offset0:96 offset1:112
    ds_read2_b32 v[216:217], v250 offset0:0 offset1:16
    ds_read2_b32 v[218:219], v250 offset0:32 offset1:48
    ds_read_b128 v[220:223], v251 offset:0
    ds_read_b128 v[224:227], v251 offset:1024
    ds_read_b128 v[228:231], v251 offset:64
    ds_read_b128 v[232:235], v251 offset:1088
    ds_read_b128 v[236:239], v251 offset:128
    ds_read_b128 v[240:243], v251 offset:1152
    s_waitcnt lgkmcnt(4)
    v_pk_add_f32 v[220:221], v[220:221], v[224:225]
    v_pk_add_f32 v[222:223], v[222:223], v[226:227]
    v_pk_fma_f32 v[0:1], v[220:221], v[212:213], v[0:1] op_sel:[0,0,0] op_sel_hi:[1,0,1]
    v_pk_fma_f32 v[2:3], v[222:223], v[212:213], v[2:3] op_sel:[0,0,0] op_sel_hi:[1,0,1]
    v_pk_fma_f32 v[4:5], v[220:221], v[212:213], v[4:5] op_sel:[0,1,0] op_sel_hi:[1,1,1]
    v_pk_fma_f32 v[6:7], v[222:223], v[212:213], v[6:7] op_sel:[0,1,0] op_sel_hi:[1,1,1]
    v_pk_fma_f32 v[8:9], v[220:221], v[214:215], v[8:9] op_sel:[0,0,0] op_sel_hi:[1,0,1]
    v_pk_fma_f32 v[10:11], v[222:223], v[214:215], v[10:11] op_sel:[0,0,0] op_sel_hi:[1,0,1]
    v_pk_fma_f32 v[12:13], v[220:221], v[214:215], v[12:13] op_sel:[0,1,0] op_sel_hi:[1,1,1]
    v_pk_fma_f32 v[14:15], v[222:223], v[214:215], v[14:15] op_sel:[0,1,0] op_sel_hi:[1,1,1]
    ds_read_b128 v[220:223], v251 offset:192
    ds_read_b128 v[224:227], v251 offset:1216
    s_waitcnt lgkmcnt(4)
    v_pk_add_f32 v[228:229], v[228:229], v[232:233]
    v_pk_add_f32 v[230:231], v[230:231], v[234:235]
    v_pk_fma_f32 v[16:17], v[228:229], v[212:213], v[16:17] op_sel:[0,0,0] op_sel_hi:[1,0,1]
    v_pk_fma_f32 v[18:19], v[230:231], v[212:213], v[18:19] op_sel:[0,0,0] op_sel_hi:[1,0,1]
    v_pk_fma_f32 v[20:21], v[228:229], v[212:213], v[20:21] op_sel:[0,1,0] op_sel_hi:[1,1,1]
    v_pk_fma_f32 v[22:23], v[230:231], v[212:213], v[22:23] op_sel:[0,1,0] op_sel_hi:[1,1,1]
    v_pk_fma_f32 v[24:25], v[228:229], v[214:215], v[24:25] op_sel:[0,0,0] op_sel_hi:[1,0,1]
    v_pk_fma_f32 v[26:27], v[230:231], v[214:215], v[26:27] op_sel:[0,0,0] op_sel_hi:[1,0,1]
    v_pk_fma_f32 v[28:29], v[228:229], v[214:215], v[28:29] op_sel:[0,1,0] op_sel_hi:[1,1,1]
    v_pk_fma_f32 v[30:31], v[230:231], v[214:215], v[30:31] op_sel:[0,1,0] op_sel_hi:[1,1,1]
    s_waitcnt lgkmcnt(2)
    v_pk_add_f32 v[236:237], v[236:237], v[240:241]
    v_pk_add_f32 v[238:239], v[238:239], v[242:243]
    v_pk_fma_f32 v[32:33], v[236:237], v[212:213], v[32:33] op_sel:[0,0,0] op_sel_hi:[1,0,1]
    v_pk_fma_f32 v[34:35], v[238:239], v[212:213], v[34:35] op_sel:[0,0,0] op_sel_hi:[1,0,1]
    v_pk_fma_f32 v[36:37], v[236:237], v[212:213], v[36:37] op_sel:[0,1,0] op_sel_hi:[1,1,1]
    v_pk_fma_f32 v[38:39], v[238:239], v[212:213], v[38:39] op_sel:[0,1,0] op_sel_hi:[1,1,1]
    v_pk_fma_f32 v[40:41], v[236:237], v[214:215], v[40:41] op_sel:[0,0,0] op_sel_hi:[1,0,1]
    v_pk_fma_f32 v[42:43], v[238:239], v[214:215], v[42:43] op_sel:[0,0,0] op_sel_hi:[1,0,1]
    v_pk_fma_f32 v[44:45], v[236:237], v[214:215], v[44:45] op_sel:[0,1,0] op_sel_hi:[1,1,1]
    v_pk_fma_f32 v[46:47], v[238:239], v[214:215], v[46:47] op_sel:[0,1,0] op_sel_hi:[1,1,1]
    s_waitcnt lgkmcnt(0)
    v_pk_add_f32 v[220:221], v[220:221], v[224:225]
    v_pk_add_f32 v[222:223], v[222:223], v[226:227]
    v_pk_fma_f32 v[48:49], v[220:221], v[212:213], v[48:49] op_sel:[0,0,0] op_sel_hi:[1,0,1]
    v_pk_fma_f32 v[50:51], v[222:223], v[212:213], v[50:51] op_sel:[0,0,0] op_sel_hi:[1,0,1]
    v_pk_fma_f32 v[52:53], v[220:221], v[212:213], v[52:53] op_sel:[0,1,0] op_sel_hi:[1,1,1]
    v_pk_fma_f32 v[54:55], v[222:223], v[212:213], v[54:55] op_sel:[0,1,0] op_sel_hi:[1,1,1]
    v_pk_fma_f32 v[56:57], v[220:221], v[214:215], v[56:57] op_sel:[0,0,0] op_sel_hi:[1,0,1]
    v_pk_fma_f32 v[58:59], v[222:223], v[214:215], v[58:59] op_sel:[0,0,0] op_sel_hi:[1,0,1]
    v_pk_fma_f32 v[60:61], v[220:221], v[214:215], v[60:61] op_sel:[0,1,0] op_sel_hi:[1,1,1]
    v_pk_fma_f32 v[62:63], v[222:223], v[214:215], v[62:63] op_sel:[0,1,0] op_sel_hi:[1,1,1]
    v_mul_f32 v220, 0x3fb8aa3b, v216
    v_mov_b32 v221, v216
    v_mul_f32 v222, 0x3fb8aa3b, v217
    v_mov_b32 v223, v217
    v_mul_f32 v224, 0x3fb8aa3b, v218
    v_mov_b32 v225, v218
    v_mul_f32 v226, 0x3fb8aa3b, v219
    v_mov_b32 v227, v219
    s_lshl_b32 s36, s32, 1
    s_lshl_b32 s34, s30, 4
    s_lshl_b32 s35, s29, 2
    s_add_u32 s34, s34, s35
    s_mul_i32 s34, s34, 32
    s_add_u32 s34, s34, s36
    s_lshl_b32 s34, s34, 10
    s_add_u32 s64, s34, 4194304
    s_add_u32 s65, s64, 32768
    s_add_u32 s66, s64, 65536
    s_add_u32 s67, s64, 98304
    v_pk_mul_f32 v[212:213], v[0:1], v[220:221] op_sel_hi:[1,0]
    v_pk_mul_f32 v[214:215], v[2:3], v[220:221] op_sel_hi:[1,0]
    v_pk_mul_f32 v[216:217], v[16:17], v[220:221] op_sel_hi:[1,0]
    v_pk_mul_f32 v[218:219], v[18:19], v[220:221] op_sel_hi:[1,0]
    v_pk_fma_f32 v[0:1], v[0:1], v[220:221], 1.0 op_sel:[0,1,0] op_sel_hi:[1,1,0]
    v_pk_fma_f32 v[2:3], v[2:3], v[220:221], 1.0 op_sel:[0,1,0] op_sel_hi:[1,1,0]
    v_pk_fma_f32 v[16:17], v[16:17], v[220:221], 1.0 op_sel:[0,1,0] op_sel_hi:[1,1,0]
    v_pk_fma_f32 v[18:19], v[18:19], v[220:221], 1.0 op_sel:[0,1,0] op_sel_hi:[1,1,0]
    v_exp_f32 v212, v212 clamp
    v_exp_f32 v213, v213 clamp
    v_exp_f32 v214, v214 clamp
    v_exp_f32 v215, v215 clamp
    v_exp_f32 v216, v216 clamp
    v_exp_f32 v217, v217 clamp
    v_exp_f32 v218, v218 clamp
    v_exp_f32 v219, v219 clamp
    v_max_f32 v0, v0, v212
    v_max_f32 v1, v1, v213
    v_max_f32 v2, v2, v214
    v_max_f32 v3, v3, v215
    v_max_f32 v16, v16, v216
    v_max_f32 v17, v17, v217
    v_max_f32 v18, v18, v218
    v_max_f32 v19, v19, v219
    v_pk_add_f32 v[0:1], v[0:1], v[210:211] op_sel:[0,1] op_sel_hi:[1,1]
    v_pk_add_f32 v[2:3], v[2:3], v[210:211] op_sel:[0,1] op_sel_hi:[1,1]
    v_pk_add_f32 v[16:17], v[16:17], v[210:211] op_sel:[0,1] op_sel_hi:[1,1]
    v_pk_add_f32 v[18:19], v[18:19], v[210:211] op_sel:[0,1] op_sel_hi:[1,1]
    v_cvt_pk_bf16_f32 v0, v0, v1
    v_cvt_pk_bf16_f32 v1, v2, v3
    v_cvt_pk_bf16_f32 v2, v16, v17
    v_cvt_pk_bf16_f32 v3, v18, v19
    buffer_store_dwordx4 v[0:3], v244, s[16:19], s64 offen offset:0
    v_pk_mul_f32 v[212:213], v[4:5], v[222:223] op_sel_hi:[1,0]
    v_pk_mul_f32 v[214:215], v[6:7], v[222:223] op_sel_hi:[1,0]
    v_pk_mul_f32 v[216:217], v[20:21], v[222:223] op_sel_hi:[1,0]
    v_pk_mul_f32 v[218:219], v[22:23], v[222:223] op_sel_hi:[1,0]
    v_pk_fma_f32 v[4:5], v[4:5], v[222:223], 1.0 op_sel:[0,1,0] op_sel_hi:[1,1,0]
    v_pk_fma_f32 v[6:7], v[6:7], v[222:223], 1.0 op_sel:[0,1,0] op_sel_hi:[1,1,0]
    v_pk_fma_f32 v[20:21], v[20:21], v[222:223], 1.0 op_sel:[0,1,0] op_sel_hi:[1,1,0]
    v_pk_fma_f32 v[22:23], v[22:23], v[222:223], 1.0 op_sel:[0,1,0] op_sel_hi:[1,1,0]
    v_exp_f32 v212, v212 clamp
    v_exp_f32 v213, v213 clamp
    v_exp_f32 v214, v214 clamp
    v_exp_f32 v215, v215 clamp
    v_exp_f32 v216, v216 clamp
    v_exp_f32 v217, v217 clamp
    v_exp_f32 v218, v218 clamp
    v_exp_f32 v219, v219 clamp
    v_max_f32 v4, v4, v212
    v_max_f32 v5, v5, v213
    v_max_f32 v6, v6, v214
    v_max_f32 v7, v7, v215
    v_max_f32 v20, v20, v216
    v_max_f32 v21, v21, v217
    v_max_f32 v22, v22, v218
    v_max_f32 v23, v23, v219
    v_pk_add_f32 v[4:5], v[4:5], v[210:211] op_sel:[0,1] op_sel_hi:[1,1]
    v_pk_add_f32 v[6:7], v[6:7], v[210:211] op_sel:[0,1] op_sel_hi:[1,1]
    v_pk_add_f32 v[20:21], v[20:21], v[210:211] op_sel:[0,1] op_sel_hi:[1,1]
    v_pk_add_f32 v[22:23], v[22:23], v[210:211] op_sel:[0,1] op_sel_hi:[1,1]
    v_cvt_pk_bf16_f32 v4, v4, v5
    v_cvt_pk_bf16_f32 v5, v6, v7
    v_cvt_pk_bf16_f32 v6, v20, v21
    v_cvt_pk_bf16_f32 v7, v22, v23
    buffer_store_dwordx4 v[4:7], v244, s[16:19], s65 offen offset:0
    v_pk_mul_f32 v[212:213], v[8:9], v[224:225] op_sel_hi:[1,0]
    v_pk_mul_f32 v[214:215], v[10:11], v[224:225] op_sel_hi:[1,0]
    v_pk_mul_f32 v[216:217], v[24:25], v[224:225] op_sel_hi:[1,0]
    v_pk_mul_f32 v[218:219], v[26:27], v[224:225] op_sel_hi:[1,0]
    v_pk_fma_f32 v[8:9], v[8:9], v[224:225], 1.0 op_sel:[0,1,0] op_sel_hi:[1,1,0]
    v_pk_fma_f32 v[10:11], v[10:11], v[224:225], 1.0 op_sel:[0,1,0] op_sel_hi:[1,1,0]
    v_pk_fma_f32 v[24:25], v[24:25], v[224:225], 1.0 op_sel:[0,1,0] op_sel_hi:[1,1,0]
    v_pk_fma_f32 v[26:27], v[26:27], v[224:225], 1.0 op_sel:[0,1,0] op_sel_hi:[1,1,0]
    v_exp_f32 v212, v212 clamp
    v_exp_f32 v213, v213 clamp
    v_exp_f32 v214, v214 clamp
    v_exp_f32 v215, v215 clamp
    v_exp_f32 v216, v216 clamp
    v_exp_f32 v217, v217 clamp
    v_exp_f32 v218, v218 clamp
    v_exp_f32 v219, v219 clamp
    v_max_f32 v8, v8, v212
    v_max_f32 v9, v9, v213
    v_max_f32 v10, v10, v214
    v_max_f32 v11, v11, v215
    v_max_f32 v24, v24, v216
    v_max_f32 v25, v25, v217
    v_max_f32 v26, v26, v218
    v_max_f32 v27, v27, v219
    v_pk_add_f32 v[8:9], v[8:9], v[210:211] op_sel:[0,1] op_sel_hi:[1,1]
    v_pk_add_f32 v[10:11], v[10:11], v[210:211] op_sel:[0,1] op_sel_hi:[1,1]
    v_pk_add_f32 v[24:25], v[24:25], v[210:211] op_sel:[0,1] op_sel_hi:[1,1]
    v_pk_add_f32 v[26:27], v[26:27], v[210:211] op_sel:[0,1] op_sel_hi:[1,1]
    v_cvt_pk_bf16_f32 v8, v8, v9
    v_cvt_pk_bf16_f32 v9, v10, v11
    v_cvt_pk_bf16_f32 v10, v24, v25
    v_cvt_pk_bf16_f32 v11, v26, v27
    buffer_store_dwordx4 v[8:11], v244, s[16:19], s66 offen offset:0
    v_pk_mul_f32 v[212:213], v[12:13], v[226:227] op_sel_hi:[1,0]
    v_pk_mul_f32 v[214:215], v[14:15], v[226:227] op_sel_hi:[1,0]
    v_pk_mul_f32 v[216:217], v[28:29], v[226:227] op_sel_hi:[1,0]
    v_pk_mul_f32 v[218:219], v[30:31], v[226:227] op_sel_hi:[1,0]
    v_pk_fma_f32 v[12:13], v[12:13], v[226:227], 1.0 op_sel:[0,1,0] op_sel_hi:[1,1,0]
    v_pk_fma_f32 v[14:15], v[14:15], v[226:227], 1.0 op_sel:[0,1,0] op_sel_hi:[1,1,0]
    v_pk_fma_f32 v[28:29], v[28:29], v[226:227], 1.0 op_sel:[0,1,0] op_sel_hi:[1,1,0]
    v_pk_fma_f32 v[30:31], v[30:31], v[226:227], 1.0 op_sel:[0,1,0] op_sel_hi:[1,1,0]
    v_exp_f32 v212, v212 clamp
    v_exp_f32 v213, v213 clamp
    v_exp_f32 v214, v214 clamp
    v_exp_f32 v215, v215 clamp
    v_exp_f32 v216, v216 clamp
    v_exp_f32 v217, v217 clamp
    v_exp_f32 v218, v218 clamp
    v_exp_f32 v219, v219 clamp
    v_max_f32 v12, v12, v212
    v_max_f32 v13, v13, v213
    v_max_f32 v14, v14, v214
    v_max_f32 v15, v15, v215
    v_max_f32 v28, v28, v216
    v_max_f32 v29, v29, v217
    v_max_f32 v30, v30, v218
    v_max_f32 v31, v31, v219
    v_pk_add_f32 v[12:13], v[12:13], v[210:211] op_sel:[0,1] op_sel_hi:[1,1]
    v_pk_add_f32 v[14:15], v[14:15], v[210:211] op_sel:[0,1] op_sel_hi:[1,1]
    v_pk_add_f32 v[28:29], v[28:29], v[210:211] op_sel:[0,1] op_sel_hi:[1,1]
    v_pk_add_f32 v[30:31], v[30:31], v[210:211] op_sel:[0,1] op_sel_hi:[1,1]
    v_cvt_pk_bf16_f32 v12, v12, v13
    v_cvt_pk_bf16_f32 v13, v14, v15
    v_cvt_pk_bf16_f32 v14, v28, v29
    v_cvt_pk_bf16_f32 v15, v30, v31
    buffer_store_dwordx4 v[12:15], v244, s[16:19], s67 offen offset:0
    v_pk_mul_f32 v[212:213], v[32:33], v[220:221] op_sel_hi:[1,0]
    v_pk_mul_f32 v[214:215], v[34:35], v[220:221] op_sel_hi:[1,0]
    v_pk_mul_f32 v[216:217], v[48:49], v[220:221] op_sel_hi:[1,0]
    v_pk_mul_f32 v[218:219], v[50:51], v[220:221] op_sel_hi:[1,0]
    v_pk_fma_f32 v[32:33], v[32:33], v[220:221], 1.0 op_sel:[0,1,0] op_sel_hi:[1,1,0]
    v_pk_fma_f32 v[34:35], v[34:35], v[220:221], 1.0 op_sel:[0,1,0] op_sel_hi:[1,1,0]
    v_pk_fma_f32 v[48:49], v[48:49], v[220:221], 1.0 op_sel:[0,1,0] op_sel_hi:[1,1,0]
    v_pk_fma_f32 v[50:51], v[50:51], v[220:221], 1.0 op_sel:[0,1,0] op_sel_hi:[1,1,0]
    v_exp_f32 v212, v212 clamp
    v_exp_f32 v213, v213 clamp
    v_exp_f32 v214, v214 clamp
    v_exp_f32 v215, v215 clamp
    v_exp_f32 v216, v216 clamp
    v_exp_f32 v217, v217 clamp
    v_exp_f32 v218, v218 clamp
    v_exp_f32 v219, v219 clamp
    v_max_f32 v32, v32, v212
    v_max_f32 v33, v33, v213
    v_max_f32 v34, v34, v214
    v_max_f32 v35, v35, v215
    v_max_f32 v48, v48, v216
    v_max_f32 v49, v49, v217
    v_max_f32 v50, v50, v218
    v_max_f32 v51, v51, v219
    v_pk_add_f32 v[32:33], v[32:33], v[210:211] op_sel:[0,1] op_sel_hi:[1,1]
    v_pk_add_f32 v[34:35], v[34:35], v[210:211] op_sel:[0,1] op_sel_hi:[1,1]
    v_pk_add_f32 v[48:49], v[48:49], v[210:211] op_sel:[0,1] op_sel_hi:[1,1]
    v_pk_add_f32 v[50:51], v[50:51], v[210:211] op_sel:[0,1] op_sel_hi:[1,1]
    v_cvt_pk_bf16_f32 v32, v32, v33
    v_cvt_pk_bf16_f32 v33, v34, v35
    v_cvt_pk_bf16_f32 v34, v48, v49
    v_cvt_pk_bf16_f32 v35, v50, v51
    buffer_store_dwordx4 v[32:35], v244, s[16:19], s64 offen offset:1024
    v_pk_mul_f32 v[212:213], v[36:37], v[222:223] op_sel_hi:[1,0]
    v_pk_mul_f32 v[214:215], v[38:39], v[222:223] op_sel_hi:[1,0]
    v_pk_mul_f32 v[216:217], v[52:53], v[222:223] op_sel_hi:[1,0]
    v_pk_mul_f32 v[218:219], v[54:55], v[222:223] op_sel_hi:[1,0]
    v_pk_fma_f32 v[36:37], v[36:37], v[222:223], 1.0 op_sel:[0,1,0] op_sel_hi:[1,1,0]
    v_pk_fma_f32 v[38:39], v[38:39], v[222:223], 1.0 op_sel:[0,1,0] op_sel_hi:[1,1,0]
    v_pk_fma_f32 v[52:53], v[52:53], v[222:223], 1.0 op_sel:[0,1,0] op_sel_hi:[1,1,0]
    v_pk_fma_f32 v[54:55], v[54:55], v[222:223], 1.0 op_sel:[0,1,0] op_sel_hi:[1,1,0]
    v_exp_f32 v212, v212 clamp
    v_exp_f32 v213, v213 clamp
    v_exp_f32 v214, v214 clamp
    v_exp_f32 v215, v215 clamp
    v_exp_f32 v216, v216 clamp
    v_exp_f32 v217, v217 clamp
    v_exp_f32 v218, v218 clamp
    v_exp_f32 v219, v219 clamp
    v_max_f32 v36, v36, v212
    v_max_f32 v37, v37, v213
    v_max_f32 v38, v38, v214
    v_max_f32 v39, v39, v215
    v_max_f32 v52, v52, v216
    v_max_f32 v53, v53, v217
    v_max_f32 v54, v54, v218
    v_max_f32 v55, v55, v219
    v_pk_add_f32 v[36:37], v[36:37], v[210:211] op_sel:[0,1] op_sel_hi:[1,1]
    v_pk_add_f32 v[38:39], v[38:39], v[210:211] op_sel:[0,1] op_sel_hi:[1,1]
    v_pk_add_f32 v[52:53], v[52:53], v[210:211] op_sel:[0,1] op_sel_hi:[1,1]
    v_pk_add_f32 v[54:55], v[54:55], v[210:211] op_sel:[0,1] op_sel_hi:[1,1]
    v_cvt_pk_bf16_f32 v36, v36, v37
    v_cvt_pk_bf16_f32 v37, v38, v39
    v_cvt_pk_bf16_f32 v38, v52, v53
    v_cvt_pk_bf16_f32 v39, v54, v55
    buffer_store_dwordx4 v[36:39], v244, s[16:19], s65 offen offset:1024
    v_pk_mul_f32 v[212:213], v[40:41], v[224:225] op_sel_hi:[1,0]
    v_pk_mul_f32 v[214:215], v[42:43], v[224:225] op_sel_hi:[1,0]
    v_pk_mul_f32 v[216:217], v[56:57], v[224:225] op_sel_hi:[1,0]
    v_pk_mul_f32 v[218:219], v[58:59], v[224:225] op_sel_hi:[1,0]
    v_pk_fma_f32 v[40:41], v[40:41], v[224:225], 1.0 op_sel:[0,1,0] op_sel_hi:[1,1,0]
    v_pk_fma_f32 v[42:43], v[42:43], v[224:225], 1.0 op_sel:[0,1,0] op_sel_hi:[1,1,0]
    v_pk_fma_f32 v[56:57], v[56:57], v[224:225], 1.0 op_sel:[0,1,0] op_sel_hi:[1,1,0]
    v_pk_fma_f32 v[58:59], v[58:59], v[224:225], 1.0 op_sel:[0,1,0] op_sel_hi:[1,1,0]
    v_exp_f32 v212, v212 clamp
    v_exp_f32 v213, v213 clamp
    v_exp_f32 v214, v214 clamp
    v_exp_f32 v215, v215 clamp
    v_exp_f32 v216, v216 clamp
    v_exp_f32 v217, v217 clamp
    v_exp_f32 v218, v218 clamp
    v_exp_f32 v219, v219 clamp
    v_max_f32 v40, v40, v212
    v_max_f32 v41, v41, v213
    v_max_f32 v42, v42, v214
    v_max_f32 v43, v43, v215
    v_max_f32 v56, v56, v216
    v_max_f32 v57, v57, v217
    v_max_f32 v58, v58, v218
    v_max_f32 v59, v59, v219
    v_pk_add_f32 v[40:41], v[40:41], v[210:211] op_sel:[0,1] op_sel_hi:[1,1]
    v_pk_add_f32 v[42:43], v[42:43], v[210:211] op_sel:[0,1] op_sel_hi:[1,1]
    v_pk_add_f32 v[56:57], v[56:57], v[210:211] op_sel:[0,1] op_sel_hi:[1,1]
    v_pk_add_f32 v[58:59], v[58:59], v[210:211] op_sel:[0,1] op_sel_hi:[1,1]
    v_cvt_pk_bf16_f32 v40, v40, v41
    v_cvt_pk_bf16_f32 v41, v42, v43
    v_cvt_pk_bf16_f32 v42, v56, v57
    v_cvt_pk_bf16_f32 v43, v58, v59
    buffer_store_dwordx4 v[40:43], v244, s[16:19], s66 offen offset:1024
    v_pk_mul_f32 v[212:213], v[44:45], v[226:227] op_sel_hi:[1,0]
    v_pk_mul_f32 v[214:215], v[46:47], v[226:227] op_sel_hi:[1,0]
    v_pk_mul_f32 v[216:217], v[60:61], v[226:227] op_sel_hi:[1,0]
    v_pk_mul_f32 v[218:219], v[62:63], v[226:227] op_sel_hi:[1,0]
    v_pk_fma_f32 v[44:45], v[44:45], v[226:227], 1.0 op_sel:[0,1,0] op_sel_hi:[1,1,0]
    v_pk_fma_f32 v[46:47], v[46:47], v[226:227], 1.0 op_sel:[0,1,0] op_sel_hi:[1,1,0]
    v_pk_fma_f32 v[60:61], v[60:61], v[226:227], 1.0 op_sel:[0,1,0] op_sel_hi:[1,1,0]
    v_pk_fma_f32 v[62:63], v[62:63], v[226:227], 1.0 op_sel:[0,1,0] op_sel_hi:[1,1,0]
    v_exp_f32 v212, v212 clamp
    v_exp_f32 v213, v213 clamp
    v_exp_f32 v214, v214 clamp
    v_exp_f32 v215, v215 clamp
    v_exp_f32 v216, v216 clamp
    v_exp_f32 v217, v217 clamp
    v_exp_f32 v218, v218 clamp
    v_exp_f32 v219, v219 clamp
    v_max_f32 v44, v44, v212
    v_max_f32 v45, v45, v213
    v_max_f32 v46, v46, v214
    v_max_f32 v47, v47, v215
    v_max_f32 v60, v60, v216
    v_max_f32 v61, v61, v217
    v_max_f32 v62, v62, v218
    v_max_f32 v63, v63, v219
    v_pk_add_f32 v[44:45], v[44:45], v[210:211] op_sel:[0,1] op_sel_hi:[1,1]
    v_pk_add_f32 v[46:47], v[46:47], v[210:211] op_sel:[0,1] op_sel_hi:[1,1]
    v_pk_add_f32 v[60:61], v[60:61], v[210:211] op_sel:[0,1] op_sel_hi:[1,1]
    v_pk_add_f32 v[62:63], v[62:63], v[210:211] op_sel:[0,1] op_sel_hi:[1,1]
    v_cvt_pk_bf16_f32 v44, v44, v45
    v_cvt_pk_bf16_f32 v45, v46, v47
    v_cvt_pk_bf16_f32 v46, v60, v61
    v_cvt_pk_bf16_f32 v47, v62, v63
    buffer_store_dwordx4 v[44:47], v244, s[16:19], s67 offen offset:1024
    s_branch k1_kernel_O_done
k1_kernel_O_z2:
    s_lshl_b32 s34, s30, 4
    s_lshl_b32 s35, s29, 2
    s_add_u32 s34, s34, s35
    s_mul_i32 s34, s34, 56
    s_add_u32 s34, s34, s36
    s_lshl_b32 s34, s34, 10
    s_add_u32 s60, s34, 20971520
    s_add_u32 s61, s60, 57344
    s_add_u32 s62, s60, 114688
    s_add_u32 s63, s60, 172032
    v_pk_mul_f32 v[212:213], v[80:81], v[80:81]
    v_pk_mul_f32 v[214:215], v[82:83], v[82:83]
    v_pk_mul_f32 v[216:217], v[96:97], v[96:97]
    v_pk_mul_f32 v[218:219], v[98:99], v[98:99]
    v_pk_fma_f32 v[212:213], v[212:213], v[220:221], v[220:221] op_sel:[0,0,1] op_sel_hi:[1,0,1]
    v_pk_fma_f32 v[214:215], v[214:215], v[220:221], v[220:221] op_sel:[0,0,1] op_sel_hi:[1,0,1]
    v_pk_fma_f32 v[216:217], v[216:217], v[220:221], v[220:221] op_sel:[0,0,1] op_sel_hi:[1,0,1]
    v_pk_fma_f32 v[218:219], v[218:219], v[220:221], v[220:221] op_sel:[0,0,1] op_sel_hi:[1,0,1]
    v_pk_mul_f32 v[212:213], v[212:213], v[80:81]
    v_pk_mul_f32 v[214:215], v[214:215], v[82:83]
    v_pk_mul_f32 v[216:217], v[216:217], v[96:97]
    v_pk_mul_f32 v[218:219], v[218:219], v[98:99]
    v_exp_f32 v212, v212
    v_exp_f32 v213, v213
    v_exp_f32 v214, v214
    v_exp_f32 v215, v215
    v_exp_f32 v216, v216
    v_exp_f32 v217, v217
    v_exp_f32 v218, v218
    v_exp_f32 v219, v219
    v_pk_fma_f32 v[212:213], v[212:213], v[208:209], v[208:209] op_sel:[0,0,0] op_sel_hi:[1,0,0]
    v_pk_fma_f32 v[214:215], v[214:215], v[208:209], v[208:209] op_sel:[0,0,0] op_sel_hi:[1,0,0]
    v_pk_fma_f32 v[216:217], v[216:217], v[208:209], v[208:209] op_sel:[0,0,0] op_sel_hi:[1,0,0]
    v_pk_fma_f32 v[218:219], v[218:219], v[208:209], v[208:209] op_sel:[0,0,0] op_sel_hi:[1,0,0]
    v_rcp_f32 v212, v212
    v_rcp_f32 v213, v213
    v_rcp_f32 v214, v214
    v_rcp_f32 v215, v215
    v_rcp_f32 v216, v216
    v_rcp_f32 v217, v217
    v_rcp_f32 v218, v218
    v_rcp_f32 v219, v219
    v_pk_mul_f32 v[80:81], v[80:81], v[212:213]
    v_pk_mul_f32 v[82:83], v[82:83], v[214:215]
    v_pk_mul_f32 v[96:97], v[96:97], v[216:217]
    v_pk_mul_f32 v[98:99], v[98:99], v[218:219]
    v_pk_mul_f32 v[236:237], v[80:81], v[80:81]
    v_pk_add_f32 v[228:229], v[80:81], v[82:83]
    v_pk_fma_f32 v[236:237], v[82:83], v[82:83], v[236:237]
    v_pk_add_f32 v[228:229], v[228:229], v[96:97]
    v_pk_fma_f32 v[236:237], v[96:97], v[96:97], v[236:237]
    v_pk_add_f32 v[228:229], v[228:229], v[98:99]
    v_pk_fma_f32 v[236:237], v[98:99], v[98:99], v[236:237]
    v_pk_mul_f32 v[212:213], v[84:85], v[84:85]
    v_pk_mul_f32 v[214:215], v[86:87], v[86:87]
    v_pk_mul_f32 v[216:217], v[100:101], v[100:101]
    v_pk_mul_f32 v[218:219], v[102:103], v[102:103]
    v_pk_fma_f32 v[212:213], v[212:213], v[222:223], v[222:223] op_sel:[0,0,1] op_sel_hi:[1,0,1]
    v_pk_fma_f32 v[214:215], v[214:215], v[222:223], v[222:223] op_sel:[0,0,1] op_sel_hi:[1,0,1]
    v_pk_fma_f32 v[216:217], v[216:217], v[222:223], v[222:223] op_sel:[0,0,1] op_sel_hi:[1,0,1]
    v_pk_fma_f32 v[218:219], v[218:219], v[222:223], v[222:223] op_sel:[0,0,1] op_sel_hi:[1,0,1]
    v_pk_mul_f32 v[212:213], v[212:213], v[84:85]
    v_pk_mul_f32 v[214:215], v[214:215], v[86:87]
    v_pk_mul_f32 v[216:217], v[216:217], v[100:101]
    v_pk_mul_f32 v[218:219], v[218:219], v[102:103]
    v_exp_f32 v212, v212
    v_exp_f32 v213, v213
    v_exp_f32 v214, v214
    v_exp_f32 v215, v215
    v_exp_f32 v216, v216
    v_exp_f32 v217, v217
    v_exp_f32 v218, v218
    v_exp_f32 v219, v219
    v_pk_fma_f32 v[212:213], v[212:213], v[208:209], v[208:209] op_sel:[0,1,1] op_sel_hi:[1,1,1]
    v_pk_fma_f32 v[214:215], v[214:215], v[208:209], v[208:209] op_sel:[0,1,1] op_sel_hi:[1,1,1]
    v_pk_fma_f32 v[216:217], v[216:217], v[208:209], v[208:209] op_sel:[0,1,1] op_sel_hi:[1,1,1]
    v_pk_fma_f32 v[218:219], v[218:219], v[208:209], v[208:209] op_sel:[0,1,1] op_sel_hi:[1,1,1]
    v_rcp_f32 v212, v212
    v_rcp_f32 v213, v213
    v_rcp_f32 v214, v214
    v_rcp_f32 v215, v215
    v_rcp_f32 v216, v216
    v_rcp_f32 v217, v217
    v_rcp_f32 v218, v218
    v_rcp_f32 v219, v219
    v_pk_mul_f32 v[84:85], v[84:85], v[212:213]
    v_pk_mul_f32 v[86:87], v[86:87], v[214:215]
    v_pk_mul_f32 v[100:101], v[100:101], v[216:217]
    v_pk_mul_f32 v[102:103], v[102:103], v[218:219]
    v_pk_mul_f32 v[238:239], v[84:85], v[84:85]
    v_pk_add_f32 v[230:231], v[84:85], v[86:87]
    v_pk_fma_f32 v[238:239], v[86:87], v[86:87], v[238:239]
    v_pk_add_f32 v[230:231], v[230:231], v[100:101]
    v_pk_fma_f32 v[238:239], v[100:101], v[100:101], v[238:239]
    v_pk_add_f32 v[230:231], v[230:231], v[102:103]
    v_pk_fma_f32 v[238:239], v[102:103], v[102:103], v[238:239]
    v_pk_mul_f32 v[212:213], v[88:89], v[88:89]
    v_pk_mul_f32 v[214:215], v[90:91], v[90:91]
    v_pk_mul_f32 v[216:217], v[104:105], v[104:105]
    v_pk_mul_f32 v[218:219], v[106:107], v[106:107]
    v_pk_fma_f32 v[212:213], v[212:213], v[224:225], v[224:225] op_sel:[0,0,1] op_sel_hi:[1,0,1]
    v_pk_fma_f32 v[214:215], v[214:215], v[224:225], v[224:225] op_sel:[0,0,1] op_sel_hi:[1,0,1]
    v_pk_fma_f32 v[216:217], v[216:217], v[224:225], v[224:225] op_sel:[0,0,1] op_sel_hi:[1,0,1]
    v_pk_fma_f32 v[218:219], v[218:219], v[224:225], v[224:225] op_sel:[0,0,1] op_sel_hi:[1,0,1]
    v_pk_mul_f32 v[212:213], v[212:213], v[88:89]
    v_pk_mul_f32 v[214:215], v[214:215], v[90:91]
    v_pk_mul_f32 v[216:217], v[216:217], v[104:105]
    v_pk_mul_f32 v[218:219], v[218:219], v[106:107]
    v_exp_f32 v212, v212
    v_exp_f32 v213, v213
    v_exp_f32 v214, v214
    v_exp_f32 v215, v215
    v_exp_f32 v216, v216
    v_exp_f32 v217, v217
    v_exp_f32 v218, v218
    v_exp_f32 v219, v219
    v_pk_fma_f32 v[212:213], v[212:213], v[252:253], v[252:253] op_sel:[0,0,0] op_sel_hi:[1,0,0]
    v_pk_fma_f32 v[214:215], v[214:215], v[252:253], v[252:253] op_sel:[0,0,0] op_sel_hi:[1,0,0]
    v_pk_fma_f32 v[216:217], v[216:217], v[252:253], v[252:253] op_sel:[0,0,0] op_sel_hi:[1,0,0]
    v_pk_fma_f32 v[218:219], v[218:219], v[252:253], v[252:253] op_sel:[0,0,0] op_sel_hi:[1,0,0]
    v_rcp_f32 v212, v212
    v_rcp_f32 v213, v213
    v_rcp_f32 v214, v214
    v_rcp_f32 v215, v215
    v_rcp_f32 v216, v216
    v_rcp_f32 v217, v217
    v_rcp_f32 v218, v218
    v_rcp_f32 v219, v219
    v_pk_mul_f32 v[88:89], v[88:89], v[212:213]
    v_pk_mul_f32 v[90:91], v[90:91], v[214:215]
    v_pk_mul_f32 v[104:105], v[104:105], v[216:217]
    v_pk_mul_f32 v[106:107], v[106:107], v[218:219]
    v_pk_mul_f32 v[240:241], v[88:89], v[88:89]
    v_pk_add_f32 v[232:233], v[88:89], v[90:91]
    v_pk_fma_f32 v[240:241], v[90:91], v[90:91], v[240:241]
    v_pk_add_f32 v[232:233], v[232:233], v[104:105]
    v_pk_fma_f32 v[240:241], v[104:105], v[104:105], v[240:241]
    v_pk_add_f32 v[232:233], v[232:233], v[106:107]
    v_pk_fma_f32 v[240:241], v[106:107], v[106:107], v[240:241]
    v_pk_mul_f32 v[212:213], v[92:93], v[92:93]
    v_pk_mul_f32 v[214:215], v[94:95], v[94:95]
    v_pk_mul_f32 v[216:217], v[108:109], v[108:109]
    v_pk_mul_f32 v[218:219], v[110:111], v[110:111]
    v_pk_fma_f32 v[212:213], v[212:213], v[226:227], v[226:227] op_sel:[0,0,1] op_sel_hi:[1,0,1]
    v_pk_fma_f32 v[214:215], v[214:215], v[226:227], v[226:227] op_sel:[0,0,1] op_sel_hi:[1,0,1]
    v_pk_fma_f32 v[216:217], v[216:217], v[226:227], v[226:227] op_sel:[0,0,1] op_sel_hi:[1,0,1]
    v_pk_fma_f32 v[218:219], v[218:219], v[226:227], v[226:227] op_sel:[0,0,1] op_sel_hi:[1,0,1]
    v_pk_mul_f32 v[212:213], v[212:213], v[92:93]
    v_pk_mul_f32 v[214:215], v[214:215], v[94:95]
    v_pk_mul_f32 v[216:217], v[216:217], v[108:109]
    v_pk_mul_f32 v[218:219], v[218:219], v[110:111]
    v_exp_f32 v212, v212
    v_exp_f32 v213, v213
    v_exp_f32 v214, v214
    v_exp_f32 v215, v215
    v_exp_f32 v216, v216
    v_exp_f32 v217, v217
    v_exp_f32 v218, v218
    v_exp_f32 v219, v219
    v_pk_fma_f32 v[212:213], v[212:213], v[252:253], v[252:253] op_sel:[0,1,1] op_sel_hi:[1,1,1]
    v_pk_fma_f32 v[214:215], v[214:215], v[252:253], v[252:253] op_sel:[0,1,1] op_sel_hi:[1,1,1]
    v_pk_fma_f32 v[216:217], v[216:217], v[252:253], v[252:253] op_sel:[0,1,1] op_sel_hi:[1,1,1]
    v_pk_fma_f32 v[218:219], v[218:219], v[252:253], v[252:253] op_sel:[0,1,1] op_sel_hi:[1,1,1]
    v_rcp_f32 v212, v212
    v_rcp_f32 v213, v213
    v_rcp_f32 v214, v214
    v_rcp_f32 v215, v215
    v_rcp_f32 v216, v216
    v_rcp_f32 v217, v217
    v_rcp_f32 v218, v218
    v_rcp_f32 v219, v219
    v_pk_mul_f32 v[92:93], v[92:93], v[212:213]
    v_pk_mul_f32 v[94:95], v[94:95], v[214:215]
    v_pk_mul_f32 v[108:109], v[108:109], v[216:217]
    v_pk_mul_f32 v[110:111], v[110:111], v[218:219]
    v_pk_mul_f32 v[242:243], v[92:93], v[92:93]
    v_pk_add_f32 v[234:235], v[92:93], v[94:95]
    v_pk_fma_f32 v[242:243], v[94:95], v[94:95], v[242:243]
    v_pk_add_f32 v[234:235], v[234:235], v[108:109]
    v_pk_fma_f32 v[242:243], v[108:109], v[108:109], v[242:243]
    v_pk_add_f32 v[234:235], v[234:235], v[110:111]
    v_pk_fma_f32 v[242:243], v[110:111], v[110:111], v[242:243]
    v_pk_mul_f32 v[212:213], v[112:113], v[112:113]
    v_pk_mul_f32 v[214:215], v[114:115], v[114:115]
    v_pk_mul_f32 v[216:217], v[128:129], v[128:129]
    v_pk_mul_f32 v[218:219], v[130:131], v[130:131]
    v_pk_fma_f32 v[212:213], v[212:213], v[220:221], v[220:221] op_sel:[0,0,1] op_sel_hi:[1,0,1]
    v_pk_fma_f32 v[214:215], v[214:215], v[220:221], v[220:221] op_sel:[0,0,1] op_sel_hi:[1,0,1]
    v_pk_fma_f32 v[216:217], v[216:217], v[220:221], v[220:221] op_sel:[0,0,1] op_sel_hi:[1,0,1]
    v_pk_fma_f32 v[218:219], v[218:219], v[220:221], v[220:221] op_sel:[0,0,1] op_sel_hi:[1,0,1]
    v_pk_mul_f32 v[212:213], v[212:213], v[112:113]
    v_pk_mul_f32 v[214:215], v[214:215], v[114:115]
    v_pk_mul_f32 v[216:217], v[216:217], v[128:129]
    v_pk_mul_f32 v[218:219], v[218:219], v[130:131]
    v_exp_f32 v212, v212
    v_exp_f32 v213, v213
    v_exp_f32 v214, v214
    v_exp_f32 v215, v215
    v_exp_f32 v216, v216
    v_exp_f32 v217, v217
    v_exp_f32 v218, v218
    v_exp_f32 v219, v219
    v_pk_fma_f32 v[212:213], v[212:213], v[208:209], v[208:209] op_sel:[0,0,0] op_sel_hi:[1,0,0]
    v_pk_fma_f32 v[214:215], v[214:215], v[208:209], v[208:209] op_sel:[0,0,0] op_sel_hi:[1,0,0]
    v_pk_fma_f32 v[216:217], v[216:217], v[208:209], v[208:209] op_sel:[0,0,0] op_sel_hi:[1,0,0]
    v_pk_fma_f32 v[218:219], v[218:219], v[208:209], v[208:209] op_sel:[0,0,0] op_sel_hi:[1,0,0]
    v_rcp_f32 v212, v212
    v_rcp_f32 v213, v213
    v_rcp_f32 v214, v214
    v_rcp_f32 v215, v215
    v_rcp_f32 v216, v216
    v_rcp_f32 v217, v217
    v_rcp_f32 v218, v218
    v_rcp_f32 v219, v219
    v_pk_mul_f32 v[112:113], v[112:113], v[212:213]
    v_pk_mul_f32 v[114:115], v[114:115], v[214:215]
    v_pk_mul_f32 v[128:129], v[128:129], v[216:217]
    v_pk_mul_f32 v[130:131], v[130:131], v[218:219]
    v_pk_add_f32 v[228:229], v[228:229], v[112:113]
    v_pk_fma_f32 v[236:237], v[112:113], v[112:113], v[236:237]
    v_pk_add_f32 v[228:229], v[228:229], v[114:115]
    v_pk_fma_f32 v[236:237], v[114:115], v[114:115], v[236:237]
    v_pk_add_f32 v[228:229], v[228:229], v[128:129]
    v_pk_fma_f32 v[236:237], v[128:129], v[128:129], v[236:237]
    v_pk_add_f32 v[228:229], v[228:229], v[130:131]
    v_pk_fma_f32 v[236:237], v[130:131], v[130:131], v[236:237]
    v_pk_mul_f32 v[212:213], v[116:117], v[116:117]
    v_pk_mul_f32 v[214:215], v[118:119], v[118:119]
    v_pk_mul_f32 v[216:217], v[132:133], v[132:133]
    v_pk_mul_f32 v[218:219], v[134:135], v[134:135]
    v_pk_fma_f32 v[212:213], v[212:213], v[222:223], v[222:223] op_sel:[0,0,1] op_sel_hi:[1,0,1]
    v_pk_fma_f32 v[214:215], v[214:215], v[222:223], v[222:223] op_sel:[0,0,1] op_sel_hi:[1,0,1]
    v_pk_fma_f32 v[216:217], v[216:217], v[222:223], v[222:223] op_sel:[0,0,1] op_sel_hi:[1,0,1]
    v_pk_fma_f32 v[218:219], v[218:219], v[222:223], v[222:223] op_sel:[0,0,1] op_sel_hi:[1,0,1]
    v_pk_mul_f32 v[212:213], v[212:213], v[116:117]
    v_pk_mul_f32 v[214:215], v[214:215], v[118:119]
    v_pk_mul_f32 v[216:217], v[216:217], v[132:133]
    v_pk_mul_f32 v[218:219], v[218:219], v[134:135]
    v_exp_f32 v212, v212
    v_exp_f32 v213, v213
    v_exp_f32 v214, v214
    v_exp_f32 v215, v215
    v_exp_f32 v216, v216
    v_exp_f32 v217, v217
    v_exp_f32 v218, v218
    v_exp_f32 v219, v219
    v_pk_fma_f32 v[212:213], v[212:213], v[208:209], v[208:209] op_sel:[0,1,1] op_sel_hi:[1,1,1]
    v_pk_fma_f32 v[214:215], v[214:215], v[208:209], v[208:209] op_sel:[0,1,1] op_sel_hi:[1,1,1]
    v_pk_fma_f32 v[216:217], v[216:217], v[208:209], v[208:209] op_sel:[0,1,1] op_sel_hi:[1,1,1]
    v_pk_fma_f32 v[218:219], v[218:219], v[208:209], v[208:209] op_sel:[0,1,1] op_sel_hi:[1,1,1]
    v_rcp_f32 v212, v212
    v_rcp_f32 v213, v213
    v_rcp_f32 v214, v214
    v_rcp_f32 v215, v215
    v_rcp_f32 v216, v216
    v_rcp_f32 v217, v217
    v_rcp_f32 v218, v218
    v_rcp_f32 v219, v219
    v_pk_mul_f32 v[116:117], v[116:117], v[212:213]
    v_pk_mul_f32 v[118:119], v[118:119], v[214:215]
    v_pk_mul_f32 v[132:133], v[132:133], v[216:217]
    v_pk_mul_f32 v[134:135], v[134:135], v[218:219]
    v_pk_add_f32 v[230:231], v[230:231], v[116:117]
    v_pk_fma_f32 v[238:239], v[116:117], v[116:117], v[238:239]
    v_pk_add_f32 v[230:231], v[230:231], v[118:119]
    v_pk_fma_f32 v[238:239], v[118:119], v[118:119], v[238:239]
    v_pk_add_f32 v[230:231], v[230:231], v[132:133]
    v_pk_fma_f32 v[238:239], v[132:133], v[132:133], v[238:239]
    v_pk_add_f32 v[230:231], v[230:231], v[134:135]
    v_pk_fma_f32 v[238:239], v[134:135], v[134:135], v[238:239]
    v_pk_mul_f32 v[212:213], v[120:121], v[120:121]
    v_pk_mul_f32 v[214:215], v[122:123], v[122:123]
    v_pk_mul_f32 v[216:217], v[136:137], v[136:137]
    v_pk_mul_f32 v[218:219], v[138:139], v[138:139]
    v_pk_fma_f32 v[212:213], v[212:213], v[224:225], v[224:225] op_sel:[0,0,1] op_sel_hi:[1,0,1]
    v_pk_fma_f32 v[214:215], v[214:215], v[224:225], v[224:225] op_sel:[0,0,1] op_sel_hi:[1,0,1]
    v_pk_fma_f32 v[216:217], v[216:217], v[224:225], v[224:225] op_sel:[0,0,1] op_sel_hi:[1,0,1]
    v_pk_fma_f32 v[218:219], v[218:219], v[224:225], v[224:225] op_sel:[0,0,1] op_sel_hi:[1,0,1]
    v_pk_mul_f32 v[212:213], v[212:213], v[120:121]
    v_pk_mul_f32 v[214:215], v[214:215], v[122:123]
    v_pk_mul_f32 v[216:217], v[216:217], v[136:137]
    v_pk_mul_f32 v[218:219], v[218:219], v[138:139]
    v_exp_f32 v212, v212
    v_exp_f32 v213, v213
    v_exp_f32 v214, v214
    v_exp_f32 v215, v215
    v_exp_f32 v216, v216
    v_exp_f32 v217, v217
    v_exp_f32 v218, v218
    v_exp_f32 v219, v219
    v_pk_fma_f32 v[212:213], v[212:213], v[252:253], v[252:253] op_sel:[0,0,0] op_sel_hi:[1,0,0]
    v_pk_fma_f32 v[214:215], v[214:215], v[252:253], v[252:253] op_sel:[0,0,0] op_sel_hi:[1,0,0]
    v_pk_fma_f32 v[216:217], v[216:217], v[252:253], v[252:253] op_sel:[0,0,0] op_sel_hi:[1,0,0]
    v_pk_fma_f32 v[218:219], v[218:219], v[252:253], v[252:253] op_sel:[0,0,0] op_sel_hi:[1,0,0]
    v_rcp_f32 v212, v212
    v_rcp_f32 v213, v213
    v_rcp_f32 v214, v214
    v_rcp_f32 v215, v215
    v_rcp_f32 v216, v216
    v_rcp_f32 v217, v217
    v_rcp_f32 v218, v218
    v_rcp_f32 v219, v219
    v_pk_mul_f32 v[120:121], v[120:121], v[212:213]
    v_pk_mul_f32 v[122:123], v[122:123], v[214:215]
    v_pk_mul_f32 v[136:137], v[136:137], v[216:217]
    v_pk_mul_f32 v[138:139], v[138:139], v[218:219]
    v_pk_add_f32 v[232:233], v[232:233], v[120:121]
    v_pk_fma_f32 v[240:241], v[120:121], v[120:121], v[240:241]
    v_pk_add_f32 v[232:233], v[232:233], v[122:123]
    v_pk_fma_f32 v[240:241], v[122:123], v[122:123], v[240:241]
    v_pk_add_f32 v[232:233], v[232:233], v[136:137]
    v_pk_fma_f32 v[240:241], v[136:137], v[136:137], v[240:241]
    v_pk_add_f32 v[232:233], v[232:233], v[138:139]
    v_pk_fma_f32 v[240:241], v[138:139], v[138:139], v[240:241]
    v_pk_mul_f32 v[212:213], v[124:125], v[124:125]
    v_pk_mul_f32 v[214:215], v[126:127], v[126:127]
    v_pk_mul_f32 v[216:217], v[140:141], v[140:141]
    v_pk_mul_f32 v[218:219], v[142:143], v[142:143]
    v_pk_fma_f32 v[212:213], v[212:213], v[226:227], v[226:227] op_sel:[0,0,1] op_sel_hi:[1,0,1]
    v_pk_fma_f32 v[214:215], v[214:215], v[226:227], v[226:227] op_sel:[0,0,1] op_sel_hi:[1,0,1]
    v_pk_fma_f32 v[216:217], v[216:217], v[226:227], v[226:227] op_sel:[0,0,1] op_sel_hi:[1,0,1]
    v_pk_fma_f32 v[218:219], v[218:219], v[226:227], v[226:227] op_sel:[0,0,1] op_sel_hi:[1,0,1]
    v_pk_mul_f32 v[212:213], v[212:213], v[124:125]
    v_pk_mul_f32 v[214:215], v[214:215], v[126:127]
    v_pk_mul_f32 v[216:217], v[216:217], v[140:141]
    v_pk_mul_f32 v[218:219], v[218:219], v[142:143]
    v_exp_f32 v212, v212
    v_exp_f32 v213, v213
    v_exp_f32 v214, v214
    v_exp_f32 v215, v215
    v_exp_f32 v216, v216
    v_exp_f32 v217, v217
    v_exp_f32 v218, v218
    v_exp_f32 v219, v219
    v_pk_fma_f32 v[212:213], v[212:213], v[252:253], v[252:253] op_sel:[0,1,1] op_sel_hi:[1,1,1]
    v_pk_fma_f32 v[214:215], v[214:215], v[252:253], v[252:253] op_sel:[0,1,1] op_sel_hi:[1,1,1]
    v_pk_fma_f32 v[216:217], v[216:217], v[252:253], v[252:253] op_sel:[0,1,1] op_sel_hi:[1,1,1]
    v_pk_fma_f32 v[218:219], v[218:219], v[252:253], v[252:253] op_sel:[0,1,1] op_sel_hi:[1,1,1]
    v_rcp_f32 v212, v212
    v_rcp_f32 v213, v213
    v_rcp_f32 v214, v214
    v_rcp_f32 v215, v215
    v_rcp_f32 v216, v216
    v_rcp_f32 v217, v217
    v_rcp_f32 v218, v218
    v_rcp_f32 v219, v219
    v_pk_mul_f32 v[124:125], v[124:125], v[212:213]
    v_pk_mul_f32 v[126:127], v[126:127], v[214:215]
    v_pk_mul_f32 v[140:141], v[140:141], v[216:217]
    v_pk_mul_f32 v[142:143], v[142:143], v[218:219]
    v_pk_add_f32 v[234:235], v[234:235], v[124:125]
    v_pk_fma_f32 v[242:243], v[124:125], v[124:125], v[242:243]
    v_pk_add_f32 v[234:235], v[234:235], v[126:127]
    v_pk_fma_f32 v[242:243], v[126:127], v[126:127], v[242:243]
    v_pk_add_f32 v[234:235], v[234:235], v[140:141]
    v_pk_fma_f32 v[242:243], v[140:141], v[140:141], v[242:243]
    v_pk_add_f32 v[234:235], v[234:235], v[142:143]
    v_pk_fma_f32 v[242:243], v[142:143], v[142:143], v[242:243]
    v_pk_mul_f32 v[212:213], v[144:145], v[144:145]
    v_pk_mul_f32 v[214:215], v[146:147], v[146:147]
    v_pk_mul_f32 v[216:217], v[160:161], v[160:161]
    v_pk_mul_f32 v[218:219], v[162:163], v[162:163]
    v_pk_fma_f32 v[212:213], v[212:213], v[220:221], v[220:221] op_sel:[0,0,1] op_sel_hi:[1,0,1]
    v_pk_fma_f32 v[214:215], v[214:215], v[220:221], v[220:221] op_sel:[0,0,1] op_sel_hi:[1,0,1]
    v_pk_fma_f32 v[216:217], v[216:217], v[220:221], v[220:221] op_sel:[0,0,1] op_sel_hi:[1,0,1]
    v_pk_fma_f32 v[218:219], v[218:219], v[220:221], v[220:221] op_sel:[0,0,1] op_sel_hi:[1,0,1]
    v_pk_mul_f32 v[212:213], v[212:213], v[144:145]
    v_pk_mul_f32 v[214:215], v[214:215], v[146:147]
    v_pk_mul_f32 v[216:217], v[216:217], v[160:161]
    v_pk_mul_f32 v[218:219], v[218:219], v[162:163]
    v_exp_f32 v212, v212
    v_exp_f32 v213, v213
    v_exp_f32 v214, v214
    v_exp_f32 v215, v215
    v_exp_f32 v216, v216
    v_exp_f32 v217, v217
    v_exp_f32 v218, v218
    v_exp_f32 v219, v219
    v_pk_fma_f32 v[212:213], v[212:213], v[208:209], v[208:209] op_sel:[0,0,0] op_sel_hi:[1,0,0]
    v_pk_fma_f32 v[214:215], v[214:215], v[208:209], v[208:209] op_sel:[0,0,0] op_sel_hi:[1,0,0]
    v_pk_fma_f32 v[216:217], v[216:217], v[208:209], v[208:209] op_sel:[0,0,0] op_sel_hi:[1,0,0]
    v_pk_fma_f32 v[218:219], v[218:219], v[208:209], v[208:209] op_sel:[0,0,0] op_sel_hi:[1,0,0]
    v_rcp_f32 v212, v212
    v_rcp_f32 v213, v213
    v_rcp_f32 v214, v214
    v_rcp_f32 v215, v215
    v_rcp_f32 v216, v216
    v_rcp_f32 v217, v217
    v_rcp_f32 v218, v218
    v_rcp_f32 v219, v219
    v_pk_mul_f32 v[144:145], v[144:145], v[212:213]
    v_pk_mul_f32 v[146:147], v[146:147], v[214:215]
    v_pk_mul_f32 v[160:161], v[160:161], v[216:217]
    v_pk_mul_f32 v[162:163], v[162:163], v[218:219]
    v_pk_add_f32 v[228:229], v[228:229], v[144:145]
    v_pk_fma_f32 v[236:237], v[144:145], v[144:145], v[236:237]
    v_pk_add_f32 v[228:229], v[228:229], v[146:147]
    v_pk_fma_f32 v[236:237], v[146:147], v[146:147], v[236:237]
    v_pk_add_f32 v[228:229], v[228:229], v[160:161]
    v_pk_fma_f32 v[236:237], v[160:161], v[160:161], v[236:237]
    v_pk_add_f32 v[228:229], v[228:229], v[162:163]
    v_pk_fma_f32 v[236:237], v[162:163], v[162:163], v[236:237]
    v_pk_mul_f32 v[212:213], v[148:149], v[148:149]
    v_pk_mul_f32 v[214:215], v[150:151], v[150:151]
    v_pk_mul_f32 v[216:217], v[164:165], v[164:165]
    v_pk_mul_f32 v[218:219], v[166:167], v[166:167]
    v_pk_fma_f32 v[212:213], v[212:213], v[222:223], v[222:223] op_sel:[0,0,1] op_sel_hi:[1,0,1]
    v_pk_fma_f32 v[214:215], v[214:215], v[222:223], v[222:223] op_sel:[0,0,1] op_sel_hi:[1,0,1]
    v_pk_fma_f32 v[216:217], v[216:217], v[222:223], v[222:223] op_sel:[0,0,1] op_sel_hi:[1,0,1]
    v_pk_fma_f32 v[218:219], v[218:219], v[222:223], v[222:223] op_sel:[0,0,1] op_sel_hi:[1,0,1]
    v_pk_mul_f32 v[212:213], v[212:213], v[148:149]
    v_pk_mul_f32 v[214:215], v[214:215], v[150:151]
    v_pk_mul_f32 v[216:217], v[216:217], v[164:165]
    v_pk_mul_f32 v[218:219], v[218:219], v[166:167]
    v_exp_f32 v212, v212
    v_exp_f32 v213, v213
    v_exp_f32 v214, v214
    v_exp_f32 v215, v215
    v_exp_f32 v216, v216
    v_exp_f32 v217, v217
    v_exp_f32 v218, v218
    v_exp_f32 v219, v219
    v_pk_fma_f32 v[212:213], v[212:213], v[208:209], v[208:209] op_sel:[0,1,1] op_sel_hi:[1,1,1]
    v_pk_fma_f32 v[214:215], v[214:215], v[208:209], v[208:209] op_sel:[0,1,1] op_sel_hi:[1,1,1]
    v_pk_fma_f32 v[216:217], v[216:217], v[208:209], v[208:209] op_sel:[0,1,1] op_sel_hi:[1,1,1]
    v_pk_fma_f32 v[218:219], v[218:219], v[208:209], v[208:209] op_sel:[0,1,1] op_sel_hi:[1,1,1]
    v_rcp_f32 v212, v212
    v_rcp_f32 v213, v213
    v_rcp_f32 v214, v214
    v_rcp_f32 v215, v215
    v_rcp_f32 v216, v216
    v_rcp_f32 v217, v217
    v_rcp_f32 v218, v218
    v_rcp_f32 v219, v219
    v_pk_mul_f32 v[148:149], v[148:149], v[212:213]
    v_pk_mul_f32 v[150:151], v[150:151], v[214:215]
    v_pk_mul_f32 v[164:165], v[164:165], v[216:217]
    v_pk_mul_f32 v[166:167], v[166:167], v[218:219]
    v_pk_add_f32 v[230:231], v[230:231], v[148:149]
    v_pk_fma_f32 v[238:239], v[148:149], v[148:149], v[238:239]
    v_pk_add_f32 v[230:231], v[230:231], v[150:151]
    v_pk_fma_f32 v[238:239], v[150:151], v[150:151], v[238:239]
    v_pk_add_f32 v[230:231], v[230:231], v[164:165]
    v_pk_fma_f32 v[238:239], v[164:165], v[164:165], v[238:239]
    v_pk_add_f32 v[230:231], v[230:231], v[166:167]
    v_pk_fma_f32 v[238:239], v[166:167], v[166:167], v[238:239]
    v_pk_mul_f32 v[212:213], v[152:153], v[152:153]
    v_pk_mul_f32 v[214:215], v[154:155], v[154:155]
    v_pk_mul_f32 v[216:217], v[168:169], v[168:169]
    v_pk_mul_f32 v[218:219], v[170:171], v[170:171]
    v_pk_fma_f32 v[212:213], v[212:213], v[224:225], v[224:225] op_sel:[0,0,1] op_sel_hi:[1,0,1]
    v_pk_fma_f32 v[214:215], v[214:215], v[224:225], v[224:225] op_sel:[0,0,1] op_sel_hi:[1,0,1]
    v_pk_fma_f32 v[216:217], v[216:217], v[224:225], v[224:225] op_sel:[0,0,1] op_sel_hi:[1,0,1]
    v_pk_fma_f32 v[218:219], v[218:219], v[224:225], v[224:225] op_sel:[0,0,1] op_sel_hi:[1,0,1]
    v_pk_mul_f32 v[212:213], v[212:213], v[152:153]
    v_pk_mul_f32 v[214:215], v[214:215], v[154:155]
    v_pk_mul_f32 v[216:217], v[216:217], v[168:169]
    v_pk_mul_f32 v[218:219], v[218:219], v[170:171]
    v_exp_f32 v212, v212
    v_exp_f32 v213, v213
    v_exp_f32 v214, v214
    v_exp_f32 v215, v215
    v_exp_f32 v216, v216
    v_exp_f32 v217, v217
    v_exp_f32 v218, v218
    v_exp_f32 v219, v219
    v_pk_fma_f32 v[212:213], v[212:213], v[252:253], v[252:253] op_sel:[0,0,0] op_sel_hi:[1,0,0]
    v_pk_fma_f32 v[214:215], v[214:215], v[252:253], v[252:253] op_sel:[0,0,0] op_sel_hi:[1,0,0]
    v_pk_fma_f32 v[216:217], v[216:217], v[252:253], v[252:253] op_sel:[0,0,0] op_sel_hi:[1,0,0]
    v_pk_fma_f32 v[218:219], v[218:219], v[252:253], v[252:253] op_sel:[0,0,0] op_sel_hi:[1,0,0]
    v_rcp_f32 v212, v212
    v_rcp_f32 v213, v213
    v_rcp_f32 v214, v214
    v_rcp_f32 v215, v215
    v_rcp_f32 v216, v216
    v_rcp_f32 v217, v217
    v_rcp_f32 v218, v218
    v_rcp_f32 v219, v219
    v_pk_mul_f32 v[152:153], v[152:153], v[212:213]
    v_pk_mul_f32 v[154:155], v[154:155], v[214:215]
    v_pk_mul_f32 v[168:169], v[168:169], v[216:217]
    v_pk_mul_f32 v[170:171], v[170:171], v[218:219]
    v_pk_add_f32 v[232:233], v[232:233], v[152:153]
    v_pk_fma_f32 v[240:241], v[152:153], v[152:153], v[240:241]
    v_pk_add_f32 v[232:233], v[232:233], v[154:155]
    v_pk_fma_f32 v[240:241], v[154:155], v[154:155], v[240:241]
    v_pk_add_f32 v[232:233], v[232:233], v[168:169]
    v_pk_fma_f32 v[240:241], v[168:169], v[168:169], v[240:241]
    v_pk_add_f32 v[232:233], v[232:233], v[170:171]
    v_pk_fma_f32 v[240:241], v[170:171], v[170:171], v[240:241]
    v_pk_mul_f32 v[212:213], v[156:157], v[156:157]
    v_pk_mul_f32 v[214:215], v[158:159], v[158:159]
    v_pk_mul_f32 v[216:217], v[172:173], v[172:173]
    v_pk_mul_f32 v[218:219], v[174:175], v[174:175]
    v_pk_fma_f32 v[212:213], v[212:213], v[226:227], v[226:227] op_sel:[0,0,1] op_sel_hi:[1,0,1]
    v_pk_fma_f32 v[214:215], v[214:215], v[226:227], v[226:227] op_sel:[0,0,1] op_sel_hi:[1,0,1]
    v_pk_fma_f32 v[216:217], v[216:217], v[226:227], v[226:227] op_sel:[0,0,1] op_sel_hi:[1,0,1]
    v_pk_fma_f32 v[218:219], v[218:219], v[226:227], v[226:227] op_sel:[0,0,1] op_sel_hi:[1,0,1]
    v_pk_mul_f32 v[212:213], v[212:213], v[156:157]
    v_pk_mul_f32 v[214:215], v[214:215], v[158:159]
    v_pk_mul_f32 v[216:217], v[216:217], v[172:173]
    v_pk_mul_f32 v[218:219], v[218:219], v[174:175]
    v_exp_f32 v212, v212
    v_exp_f32 v213, v213
    v_exp_f32 v214, v214
    v_exp_f32 v215, v215
    v_exp_f32 v216, v216
    v_exp_f32 v217, v217
    v_exp_f32 v218, v218
    v_exp_f32 v219, v219
    v_pk_fma_f32 v[212:213], v[212:213], v[252:253], v[252:253] op_sel:[0,1,1] op_sel_hi:[1,1,1]
    v_pk_fma_f32 v[214:215], v[214:215], v[252:253], v[252:253] op_sel:[0,1,1] op_sel_hi:[1,1,1]
    v_pk_fma_f32 v[216:217], v[216:217], v[252:253], v[252:253] op_sel:[0,1,1] op_sel_hi:[1,1,1]
    v_pk_fma_f32 v[218:219], v[218:219], v[252:253], v[252:253] op_sel:[0,1,1] op_sel_hi:[1,1,1]
    v_rcp_f32 v212, v212
    v_rcp_f32 v213, v213
    v_rcp_f32 v214, v214
    v_rcp_f32 v215, v215
    v_rcp_f32 v216, v216
    v_rcp_f32 v217, v217
    v_rcp_f32 v218, v218
    v_rcp_f32 v219, v219
    v_pk_mul_f32 v[156:157], v[156:157], v[212:213]
    v_pk_mul_f32 v[158:159], v[158:159], v[214:215]
    v_pk_mul_f32 v[172:173], v[172:173], v[216:217]
    v_pk_mul_f32 v[174:175], v[174:175], v[218:219]
    v_pk_add_f32 v[234:235], v[234:235], v[156:157]
    v_pk_fma_f32 v[242:243], v[156:157], v[156:157], v[242:243]
    v_pk_add_f32 v[234:235], v[234:235], v[158:159]
    v_pk_fma_f32 v[242:243], v[158:159], v[158:159], v[242:243]
    v_pk_add_f32 v[234:235], v[234:235], v[172:173]
    v_pk_fma_f32 v[242:243], v[172:173], v[172:173], v[242:243]
    v_pk_add_f32 v[234:235], v[234:235], v[174:175]
    v_pk_fma_f32 v[242:243], v[174:175], v[174:175], v[242:243]
    v_pk_mul_f32 v[212:213], v[176:177], v[176:177]
    v_pk_mul_f32 v[214:215], v[178:179], v[178:179]
    v_pk_mul_f32 v[216:217], v[192:193], v[192:193]
    v_pk_mul_f32 v[218:219], v[194:195], v[194:195]
    v_pk_fma_f32 v[212:213], v[212:213], v[220:221], v[220:221] op_sel:[0,0,1] op_sel_hi:[1,0,1]
    v_pk_fma_f32 v[214:215], v[214:215], v[220:221], v[220:221] op_sel:[0,0,1] op_sel_hi:[1,0,1]
    v_pk_fma_f32 v[216:217], v[216:217], v[220:221], v[220:221] op_sel:[0,0,1] op_sel_hi:[1,0,1]
    v_pk_fma_f32 v[218:219], v[218:219], v[220:221], v[220:221] op_sel:[0,0,1] op_sel_hi:[1,0,1]
    v_pk_mul_f32 v[212:213], v[212:213], v[176:177]
    v_pk_mul_f32 v[214:215], v[214:215], v[178:179]
    v_pk_mul_f32 v[216:217], v[216:217], v[192:193]
    v_pk_mul_f32 v[218:219], v[218:219], v[194:195]
    v_exp_f32 v212, v212
    v_exp_f32 v213, v213
    v_exp_f32 v214, v214
    v_exp_f32 v215, v215
    v_exp_f32 v216, v216
    v_exp_f32 v217, v217
    v_exp_f32 v218, v218
    v_exp_f32 v219, v219
    v_pk_fma_f32 v[212:213], v[212:213], v[208:209], v[208:209] op_sel:[0,0,0] op_sel_hi:[1,0,0]
    v_pk_fma_f32 v[214:215], v[214:215], v[208:209], v[208:209] op_sel:[0,0,0] op_sel_hi:[1,0,0]
    v_pk_fma_f32 v[216:217], v[216:217], v[208:209], v[208:209] op_sel:[0,0,0] op_sel_hi:[1,0,0]
    v_pk_fma_f32 v[218:219], v[218:219], v[208:209], v[208:209] op_sel:[0,0,0] op_sel_hi:[1,0,0]
    v_rcp_f32 v212, v212
    v_rcp_f32 v213, v213
    v_rcp_f32 v214, v214
    v_rcp_f32 v215, v215
    v_rcp_f32 v216, v216
    v_rcp_f32 v217, v217
    v_rcp_f32 v218, v218
    v_rcp_f32 v219, v219
    v_pk_mul_f32 v[176:177], v[176:177], v[212:213]
    v_pk_mul_f32 v[178:179], v[178:179], v[214:215]
    v_pk_mul_f32 v[192:193], v[192:193], v[216:217]
    v_pk_mul_f32 v[194:195], v[194:195], v[218:219]
    v_pk_add_f32 v[228:229], v[228:229], v[176:177]
    v_pk_fma_f32 v[236:237], v[176:177], v[176:177], v[236:237]
    v_pk_add_f32 v[228:229], v[228:229], v[178:179]
    v_pk_fma_f32 v[236:237], v[178:179], v[178:179], v[236:237]
    v_pk_add_f32 v[228:229], v[228:229], v[192:193]
    v_pk_fma_f32 v[236:237], v[192:193], v[192:193], v[236:237]
    v_pk_add_f32 v[228:229], v[228:229], v[194:195]
    v_pk_fma_f32 v[236:237], v[194:195], v[194:195], v[236:237]
    v_pk_mul_f32 v[212:213], v[180:181], v[180:181]
    v_pk_mul_f32 v[214:215], v[182:183], v[182:183]
    v_pk_mul_f32 v[216:217], v[196:197], v[196:197]
    v_pk_mul_f32 v[218:219], v[198:199], v[198:199]
    v_pk_fma_f32 v[212:213], v[212:213], v[222:223], v[222:223] op_sel:[0,0,1] op_sel_hi:[1,0,1]
    v_pk_fma_f32 v[214:215], v[214:215], v[222:223], v[222:223] op_sel:[0,0,1] op_sel_hi:[1,0,1]
    v_pk_fma_f32 v[216:217], v[216:217], v[222:223], v[222:223] op_sel:[0,0,1] op_sel_hi:[1,0,1]
    v_pk_fma_f32 v[218:219], v[218:219], v[222:223], v[222:223] op_sel:[0,0,1] op_sel_hi:[1,0,1]
    v_pk_mul_f32 v[212:213], v[212:213], v[180:181]
    v_pk_mul_f32 v[214:215], v[214:215], v[182:183]
    v_pk_mul_f32 v[216:217], v[216:217], v[196:197]
    v_pk_mul_f32 v[218:219], v[218:219], v[198:199]
    v_exp_f32 v212, v212
    v_exp_f32 v213, v213
    v_exp_f32 v214, v214
    v_exp_f32 v215, v215
    v_exp_f32 v216, v216
    v_exp_f32 v217, v217
    v_exp_f32 v218, v218
    v_exp_f32 v219, v219
    v_pk_fma_f32 v[212:213], v[212:213], v[208:209], v[208:209] op_sel:[0,1,1] op_sel_hi:[1,1,1]
    v_pk_fma_f32 v[214:215], v[214:215], v[208:209], v[208:209] op_sel:[0,1,1] op_sel_hi:[1,1,1]
    v_pk_fma_f32 v[216:217], v[216:217], v[208:209], v[208:209] op_sel:[0,1,1] op_sel_hi:[1,1,1]
    v_pk_fma_f32 v[218:219], v[218:219], v[208:209], v[208:209] op_sel:[0,1,1] op_sel_hi:[1,1,1]
    v_rcp_f32 v212, v212
    v_rcp_f32 v213, v213
    v_rcp_f32 v214, v214
    v_rcp_f32 v215, v215
    v_rcp_f32 v216, v216
    v_rcp_f32 v217, v217
    v_rcp_f32 v218, v218
    v_rcp_f32 v219, v219
    v_pk_mul_f32 v[180:181], v[180:181], v[212:213]
    v_pk_mul_f32 v[182:183], v[182:183], v[214:215]
    v_pk_mul_f32 v[196:197], v[196:197], v[216:217]
    v_pk_mul_f32 v[198:199], v[198:199], v[218:219]
    v_pk_add_f32 v[230:231], v[230:231], v[180:181]
    v_pk_fma_f32 v[238:239], v[180:181], v[180:181], v[238:239]
    v_pk_add_f32 v[230:231], v[230:231], v[182:183]
    v_pk_fma_f32 v[238:239], v[182:183], v[182:183], v[238:239]
    v_pk_add_f32 v[230:231], v[230:231], v[196:197]
    v_pk_fma_f32 v[238:239], v[196:197], v[196:197], v[238:239]
    v_pk_add_f32 v[230:231], v[230:231], v[198:199]
    v_pk_fma_f32 v[238:239], v[198:199], v[198:199], v[238:239]
    v_pk_mul_f32 v[212:213], v[184:185], v[184:185]
    v_pk_mul_f32 v[214:215], v[186:187], v[186:187]
    v_pk_mul_f32 v[216:217], v[200:201], v[200:201]
    v_pk_mul_f32 v[218:219], v[202:203], v[202:203]
    v_pk_fma_f32 v[212:213], v[212:213], v[224:225], v[224:225] op_sel:[0,0,1] op_sel_hi:[1,0,1]
    v_pk_fma_f32 v[214:215], v[214:215], v[224:225], v[224:225] op_sel:[0,0,1] op_sel_hi:[1,0,1]
    v_pk_fma_f32 v[216:217], v[216:217], v[224:225], v[224:225] op_sel:[0,0,1] op_sel_hi:[1,0,1]
    v_pk_fma_f32 v[218:219], v[218:219], v[224:225], v[224:225] op_sel:[0,0,1] op_sel_hi:[1,0,1]
    v_pk_mul_f32 v[212:213], v[212:213], v[184:185]
    v_pk_mul_f32 v[214:215], v[214:215], v[186:187]
    v_pk_mul_f32 v[216:217], v[216:217], v[200:201]
    v_pk_mul_f32 v[218:219], v[218:219], v[202:203]
    v_exp_f32 v212, v212
    v_exp_f32 v213, v213
    v_exp_f32 v214, v214
    v_exp_f32 v215, v215
    v_exp_f32 v216, v216
    v_exp_f32 v217, v217
    v_exp_f32 v218, v218
    v_exp_f32 v219, v219
    v_pk_fma_f32 v[212:213], v[212:213], v[252:253], v[252:253] op_sel:[0,0,0] op_sel_hi:[1,0,0]
    v_pk_fma_f32 v[214:215], v[214:215], v[252:253], v[252:253] op_sel:[0,0,0] op_sel_hi:[1,0,0]
    v_pk_fma_f32 v[216:217], v[216:217], v[252:253], v[252:253] op_sel:[0,0,0] op_sel_hi:[1,0,0]
    v_pk_fma_f32 v[218:219], v[218:219], v[252:253], v[252:253] op_sel:[0,0,0] op_sel_hi:[1,0,0]
    v_rcp_f32 v212, v212
    v_rcp_f32 v213, v213
    v_rcp_f32 v214, v214
    v_rcp_f32 v215, v215
    v_rcp_f32 v216, v216
    v_rcp_f32 v217, v217
    v_rcp_f32 v218, v218
    v_rcp_f32 v219, v219
    v_pk_mul_f32 v[184:185], v[184:185], v[212:213]
    v_pk_mul_f32 v[186:187], v[186:187], v[214:215]
    v_pk_mul_f32 v[200:201], v[200:201], v[216:217]
    v_pk_mul_f32 v[202:203], v[202:203], v[218:219]
    v_pk_add_f32 v[232:233], v[232:233], v[184:185]
    v_pk_fma_f32 v[240:241], v[184:185], v[184:185], v[240:241]
    v_pk_add_f32 v[232:233], v[232:233], v[186:187]
    v_pk_fma_f32 v[240:241], v[186:187], v[186:187], v[240:241]
    v_pk_add_f32 v[232:233], v[232:233], v[200:201]
    v_pk_fma_f32 v[240:241], v[200:201], v[200:201], v[240:241]
    v_pk_add_f32 v[232:233], v[232:233], v[202:203]
    v_pk_fma_f32 v[240:241], v[202:203], v[202:203], v[240:241]
    v_pk_mul_f32 v[212:213], v[188:189], v[188:189]
    v_pk_mul_f32 v[214:215], v[190:191], v[190:191]
    v_pk_mul_f32 v[216:217], v[204:205], v[204:205]
    v_pk_mul_f32 v[218:219], v[206:207], v[206:207]
    v_pk_fma_f32 v[212:213], v[212:213], v[226:227], v[226:227] op_sel:[0,0,1] op_sel_hi:[1,0,1]
    v_pk_fma_f32 v[214:215], v[214:215], v[226:227], v[226:227] op_sel:[0,0,1] op_sel_hi:[1,0,1]
    v_pk_fma_f32 v[216:217], v[216:217], v[226:227], v[226:227] op_sel:[0,0,1] op_sel_hi:[1,0,1]
    v_pk_fma_f32 v[218:219], v[218:219], v[226:227], v[226:227] op_sel:[0,0,1] op_sel_hi:[1,0,1]
    v_pk_mul_f32 v[212:213], v[212:213], v[188:189]
    v_pk_mul_f32 v[214:215], v[214:215], v[190:191]
    v_pk_mul_f32 v[216:217], v[216:217], v[204:205]
    v_pk_mul_f32 v[218:219], v[218:219], v[206:207]
    v_exp_f32 v212, v212
    v_exp_f32 v213, v213
    v_exp_f32 v214, v214
    v_exp_f32 v215, v215
    v_exp_f32 v216, v216
    v_exp_f32 v217, v217
    v_exp_f32 v218, v218
    v_exp_f32 v219, v219
    v_pk_fma_f32 v[212:213], v[212:213], v[252:253], v[252:253] op_sel:[0,1,1] op_sel_hi:[1,1,1]
    v_pk_fma_f32 v[214:215], v[214:215], v[252:253], v[252:253] op_sel:[0,1,1] op_sel_hi:[1,1,1]
    v_pk_fma_f32 v[216:217], v[216:217], v[252:253], v[252:253] op_sel:[0,1,1] op_sel_hi:[1,1,1]
    v_pk_fma_f32 v[218:219], v[218:219], v[252:253], v[252:253] op_sel:[0,1,1] op_sel_hi:[1,1,1]
    v_rcp_f32 v212, v212
    v_rcp_f32 v213, v213
    v_rcp_f32 v214, v214
    v_rcp_f32 v215, v215
    v_rcp_f32 v216, v216
    v_rcp_f32 v217, v217
    v_rcp_f32 v218, v218
    v_rcp_f32 v219, v219
    v_pk_mul_f32 v[188:189], v[188:189], v[212:213]
    v_pk_mul_f32 v[190:191], v[190:191], v[214:215]
    v_pk_mul_f32 v[204:205], v[204:205], v[216:217]
    v_pk_mul_f32 v[206:207], v[206:207], v[218:219]
    v_pk_add_f32 v[234:235], v[234:235], v[188:189]
    v_pk_fma_f32 v[242:243], v[188:189], v[188:189], v[242:243]
    v_pk_add_f32 v[234:235], v[234:235], v[190:191]
    v_pk_fma_f32 v[242:243], v[190:191], v[190:191], v[242:243]
    v_pk_add_f32 v[234:235], v[234:235], v[204:205]
    v_pk_fma_f32 v[242:243], v[204:205], v[204:205], v[242:243]
    v_pk_add_f32 v[234:235], v[234:235], v[206:207]
    v_pk_fma_f32 v[242:243], v[206:207], v[206:207], v[242:243]
    v_pk_mul_f32 v[212:213], v[64:65], v[64:65]
    v_pk_mul_f32 v[214:215], v[66:67], v[66:67]
    v_pk_fma_f32 v[212:213], v[212:213], v[220:221], v[220:221] op_sel:[0,0,1] op_sel_hi:[1,0,1]
    v_pk_fma_f32 v[214:215], v[214:215], v[220:221], v[220:221] op_sel:[0,0,1] op_sel_hi:[1,0,1]
    v_pk_mul_f32 v[212:213], v[212:213], v[64:65]
    v_pk_mul_f32 v[214:215], v[214:215], v[66:67]
    v_exp_f32 v212, v212
    v_exp_f32 v213, v213
    v_exp_f32 v214, v214
    v_exp_f32 v215, v215
    v_pk_fma_f32 v[212:213], v[212:213], v[208:209], v[208:209] op_sel:[0,0,0] op_sel_hi:[1,0,0]
    v_pk_fma_f32 v[214:215], v[214:215], v[208:209], v[208:209] op_sel:[0,0,0] op_sel_hi:[1,0,0]
    v_rcp_f32 v212, v212
    v_rcp_f32 v213, v213
    v_rcp_f32 v214, v214
    v_rcp_f32 v215, v215
    v_pk_mul_f32 v[64:65], v[64:65], v[212:213]
    v_pk_mul_f32 v[66:67], v[66:67], v[214:215]
    v_pk_add_f32 v[228:229], v[228:229], v[64:65]
    v_pk_fma_f32 v[236:237], v[64:65], v[64:65], v[236:237]
    v_pk_add_f32 v[228:229], v[228:229], v[66:67]
    v_pk_fma_f32 v[236:237], v[66:67], v[66:67], v[236:237]
    v_pk_mul_f32 v[212:213], v[68:69], v[68:69]
    v_pk_mul_f32 v[214:215], v[70:71], v[70:71]
    v_pk_fma_f32 v[212:213], v[212:213], v[222:223], v[222:223] op_sel:[0,0,1] op_sel_hi:[1,0,1]
    v_pk_fma_f32 v[214:215], v[214:215], v[222:223], v[222:223] op_sel:[0,0,1] op_sel_hi:[1,0,1]
    v_pk_mul_f32 v[212:213], v[212:213], v[68:69]
    v_pk_mul_f32 v[214:215], v[214:215], v[70:71]
    v_exp_f32 v212, v212
    v_exp_f32 v213, v213
    v_exp_f32 v214, v214
    v_exp_f32 v215, v215
    v_pk_fma_f32 v[212:213], v[212:213], v[208:209], v[208:209] op_sel:[0,1,1] op_sel_hi:[1,1,1]
    v_pk_fma_f32 v[214:215], v[214:215], v[208:209], v[208:209] op_sel:[0,1,1] op_sel_hi:[1,1,1]
    v_rcp_f32 v212, v212
    v_rcp_f32 v213, v213
    v_rcp_f32 v214, v214
    v_rcp_f32 v215, v215
    v_pk_mul_f32 v[68:69], v[68:69], v[212:213]
    v_pk_mul_f32 v[70:71], v[70:71], v[214:215]
    v_pk_add_f32 v[230:231], v[230:231], v[68:69]
    v_pk_fma_f32 v[238:239], v[68:69], v[68:69], v[238:239]
    v_pk_add_f32 v[230:231], v[230:231], v[70:71]
    v_pk_fma_f32 v[238:239], v[70:71], v[70:71], v[238:239]
    v_pk_mul_f32 v[212:213], v[72:73], v[72:73]
    v_pk_mul_f32 v[214:215], v[74:75], v[74:75]
    v_pk_fma_f32 v[212:213], v[212:213], v[224:225], v[224:225] op_sel:[0,0,1] op_sel_hi:[1,0,1]
    v_pk_fma_f32 v[214:215], v[214:215], v[224:225], v[224:225] op_sel:[0,0,1] op_sel_hi:[1,0,1]
    v_pk_mul_f32 v[212:213], v[212:213], v[72:73]
    v_pk_mul_f32 v[214:215], v[214:215], v[74:75]
    v_exp_f32 v212, v212
    v_exp_f32 v213, v213
    v_exp_f32 v214, v214
    v_exp_f32 v215, v215
    v_pk_fma_f32 v[212:213], v[212:213], v[252:253], v[252:253] op_sel:[0,0,0] op_sel_hi:[1,0,0]
    v_pk_fma_f32 v[214:215], v[214:215], v[252:253], v[252:253] op_sel:[0,0,0] op_sel_hi:[1,0,0]
    v_rcp_f32 v212, v212
    v_rcp_f32 v213, v213
    v_rcp_f32 v214, v214
    v_rcp_f32 v215, v215
    v_pk_mul_f32 v[72:73], v[72:73], v[212:213]
    v_pk_mul_f32 v[74:75], v[74:75], v[214:215]
    v_pk_add_f32 v[232:233], v[232:233], v[72:73]
    v_pk_fma_f32 v[240:241], v[72:73], v[72:73], v[240:241]
    v_pk_add_f32 v[232:233], v[232:233], v[74:75]
    v_pk_fma_f32 v[240:241], v[74:75], v[74:75], v[240:241]
    v_pk_mul_f32 v[212:213], v[76:77], v[76:77]
    v_pk_mul_f32 v[214:215], v[78:79], v[78:79]
    v_pk_fma_f32 v[212:213], v[212:213], v[226:227], v[226:227] op_sel:[0,0,1] op_sel_hi:[1,0,1]
    v_pk_fma_f32 v[214:215], v[214:215], v[226:227], v[226:227] op_sel:[0,0,1] op_sel_hi:[1,0,1]
    v_pk_mul_f32 v[212:213], v[212:213], v[76:77]
    v_pk_mul_f32 v[214:215], v[214:215], v[78:79]
    v_exp_f32 v212, v212
    v_exp_f32 v213, v213
    v_exp_f32 v214, v214
    v_exp_f32 v215, v215
    v_pk_fma_f32 v[212:213], v[212:213], v[252:253], v[252:253] op_sel:[0,1,1] op_sel_hi:[1,1,1]
    v_pk_fma_f32 v[214:215], v[214:215], v[252:253], v[252:253] op_sel:[0,1,1] op_sel_hi:[1,1,1]
    v_rcp_f32 v212, v212
    v_rcp_f32 v213, v213
    v_rcp_f32 v214, v214
    v_rcp_f32 v215, v215
    v_pk_mul_f32 v[76:77], v[76:77], v[212:213]
    v_pk_mul_f32 v[78:79], v[78:79], v[214:215]
    v_pk_add_f32 v[234:235], v[234:235], v[76:77]
    v_pk_fma_f32 v[242:243], v[76:77], v[76:77], v[242:243]
    v_pk_add_f32 v[234:235], v[234:235], v[78:79]
    v_pk_fma_f32 v[242:243], v[78:79], v[78:79], v[242:243]
    v_add_f32 v228, v228, v229
    v_add_f32 v230, v230, v231
    v_add_f32 v232, v232, v233
    v_add_f32 v234, v234, v235
    v_add_f32 v236, v236, v237
    v_add_f32 v238, v238, v239
    v_add_f32 v240, v240, v241
    v_add_f32 v242, v242, v243
    s_lshl_b32 s34, s30, 8
    s_lshl_b32 s35, s29, 6
    s_add_u32 s34, s34, s35
    s_lshl_b32 s34, s34, 3
    s_add_u32 s37, s34, 39845888
    s_and_b32 s35, s31, 15
    s_lshl_b32 s35, s35, 14
    s_add_u32 s38, s37, s35
    v_permlane32_swap_b32 v228, v232
    v_permlane32_swap_b32 v230, v234
    v_permlane32_swap_b32 v236, v240
    v_permlane32_swap_b32 v238, v242
    v_add_f32 v228, v228, v232
    v_add_f32 v230, v230, v234
    v_add_f32 v236, v236, v240
    v_add_f32 v238, v238, v242
    v_lshlrev_b32 v247, 3, v255
    s_nop 0
    v_permlane16_swap_b32 v228, v230
    v_permlane16_swap_b32 v236, v238
    v_add_f32 v228, v228, v230
    v_add_f32 v229, v236, v238
    buffer_store_dwordx2 v[228:229], v247, s[16:19], s38 offen sc1
    s_lshl_b32 s34, s29, 9
    s_add_u32 s34, s34, 154624
    v_and_b32 v250, 15, v255
    v_lshl_add_u32 v250, v250, 2, s34
    v_and_b32 v251, 48, v255
    v_add_u32 v251, 152576, v251
    ds_read2_b32 v[212:213], v250 offset0:64 offset1:80
    ds_read2_b32 v[214:215], v250 offset0:96 offset1:112
    ds_read2_b32 v[216:217], v250 offset0:0 offset1:16
    ds_read2_b32 v[218:219], v250 offset0:32 offset1:48
    ds_read_b128 v[220:223], v251 offset:0
    ds_read_b128 v[224:227], v251 offset:1024
    ds_read_b128 v[228:231], v251 offset:64
    ds_read_b128 v[232:235], v251 offset:1088
    ds_read_b128 v[236:239], v251 offset:128
    ds_read_b128 v[240:243], v251 offset:1152
    s_waitcnt lgkmcnt(4)
    v_pk_add_f32 v[220:221], v[220:221], v[224:225]
    v_pk_add_f32 v[222:223], v[222:223], v[226:227]
    v_pk_fma_f32 v[0:1], v[220:221], v[212:213], v[0:1] op_sel:[0,0,0] op_sel_hi:[1,0,1]
    v_pk_fma_f32 v[2:3], v[222:223], v[212:213], v[2:3] op_sel:[0,0,0] op_sel_hi:[1,0,1]
    v_pk_fma_f32 v[4:5], v[220:221], v[212:213], v[4:5] op_sel:[0,1,0] op_sel_hi:[1,1,1]
    v_pk_fma_f32 v[6:7], v[222:223], v[212:213], v[6:7] op_sel:[0,1,0] op_sel_hi:[1,1,1]
    v_pk_fma_f32 v[8:9], v[220:221], v[214:215], v[8:9] op_sel:[0,0,0] op_sel_hi:[1,0,1]
    v_pk_fma_f32 v[10:11], v[222:223], v[214:215], v[10:11] op_sel:[0,0,0] op_sel_hi:[1,0,1]
    v_pk_fma_f32 v[12:13], v[220:221], v[214:215], v[12:13] op_sel:[0,1,0] op_sel_hi:[1,1,1]
    v_pk_fma_f32 v[14:15], v[222:223], v[214:215], v[14:15] op_sel:[0,1,0] op_sel_hi:[1,1,1]
    ds_read_b128 v[220:223], v251 offset:192
    ds_read_b128 v[224:227], v251 offset:1216
    s_waitcnt lgkmcnt(4)
    v_pk_add_f32 v[228:229], v[228:229], v[232:233]
    v_pk_add_f32 v[230:231], v[230:231], v[234:235]
    v_pk_fma_f32 v[16:17], v[228:229], v[212:213], v[16:17] op_sel:[0,0,0] op_sel_hi:[1,0,1]
    v_pk_fma_f32 v[18:19], v[230:231], v[212:213], v[18:19] op_sel:[0,0,0] op_sel_hi:[1,0,1]
    v_pk_fma_f32 v[20:21], v[228:229], v[212:213], v[20:21] op_sel:[0,1,0] op_sel_hi:[1,1,1]
    v_pk_fma_f32 v[22:23], v[230:231], v[212:213], v[22:23] op_sel:[0,1,0] op_sel_hi:[1,1,1]
    v_pk_fma_f32 v[24:25], v[228:229], v[214:215], v[24:25] op_sel:[0,0,0] op_sel_hi:[1,0,1]
    v_pk_fma_f32 v[26:27], v[230:231], v[214:215], v[26:27] op_sel:[0,0,0] op_sel_hi:[1,0,1]
    v_pk_fma_f32 v[28:29], v[228:229], v[214:215], v[28:29] op_sel:[0,1,0] op_sel_hi:[1,1,1]
    v_pk_fma_f32 v[30:31], v[230:231], v[214:215], v[30:31] op_sel:[0,1,0] op_sel_hi:[1,1,1]
    s_waitcnt lgkmcnt(2)
    v_pk_add_f32 v[236:237], v[236:237], v[240:241]
    v_pk_add_f32 v[238:239], v[238:239], v[242:243]
    v_pk_fma_f32 v[32:33], v[236:237], v[212:213], v[32:33] op_sel:[0,0,0] op_sel_hi:[1,0,1]
    v_pk_fma_f32 v[34:35], v[238:239], v[212:213], v[34:35] op_sel:[0,0,0] op_sel_hi:[1,0,1]
    v_pk_fma_f32 v[36:37], v[236:237], v[212:213], v[36:37] op_sel:[0,1,0] op_sel_hi:[1,1,1]
    v_pk_fma_f32 v[38:39], v[238:239], v[212:213], v[38:39] op_sel:[0,1,0] op_sel_hi:[1,1,1]
    v_pk_fma_f32 v[40:41], v[236:237], v[214:215], v[40:41] op_sel:[0,0,0] op_sel_hi:[1,0,1]
    v_pk_fma_f32 v[42:43], v[238:239], v[214:215], v[42:43] op_sel:[0,0,0] op_sel_hi:[1,0,1]
    v_pk_fma_f32 v[44:45], v[236:237], v[214:215], v[44:45] op_sel:[0,1,0] op_sel_hi:[1,1,1]
    v_pk_fma_f32 v[46:47], v[238:239], v[214:215], v[46:47] op_sel:[0,1,0] op_sel_hi:[1,1,1]
    s_waitcnt lgkmcnt(0)
    v_pk_add_f32 v[220:221], v[220:221], v[224:225]
    v_pk_add_f32 v[222:223], v[222:223], v[226:227]
    v_pk_fma_f32 v[48:49], v[220:221], v[212:213], v[48:49] op_sel:[0,0,0] op_sel_hi:[1,0,1]
    v_pk_fma_f32 v[50:51], v[222:223], v[212:213], v[50:51] op_sel:[0,0,0] op_sel_hi:[1,0,1]
    v_pk_fma_f32 v[52:53], v[220:221], v[212:213], v[52:53] op_sel:[0,1,0] op_sel_hi:[1,1,1]
    v_pk_fma_f32 v[54:55], v[222:223], v[212:213], v[54:55] op_sel:[0,1,0] op_sel_hi:[1,1,1]
    v_pk_fma_f32 v[56:57], v[220:221], v[214:215], v[56:57] op_sel:[0,0,0] op_sel_hi:[1,0,1]
    v_pk_fma_f32 v[58:59], v[222:223], v[214:215], v[58:59] op_sel:[0,0,0] op_sel_hi:[1,0,1]
    v_pk_fma_f32 v[60:61], v[220:221], v[214:215], v[60:61] op_sel:[0,1,0] op_sel_hi:[1,1,1]
    v_pk_fma_f32 v[62:63], v[222:223], v[214:215], v[62:63] op_sel:[0,1,0] op_sel_hi:[1,1,1]
    v_mul_f32 v220, 0x3fb8aa3b, v216
    v_mov_b32 v221, v216
    v_mul_f32 v222, 0x3fb8aa3b, v217
    v_mov_b32 v223, v217
    v_mul_f32 v224, 0x3fb8aa3b, v218
    v_mov_b32 v225, v218
    v_mul_f32 v226, 0x3fb8aa3b, v219
    v_mov_b32 v227, v219
    s_lshl_b32 s36, s32, 1
    s_lshl_b32 s34, s30, 4
    s_lshl_b32 s35, s29, 2
    s_add_u32 s34, s34, s35
    s_mul_i32 s34, s34, 32
    s_add_u32 s34, s34, s36
    s_lshl_b32 s34, s34, 10
    s_add_u32 s64, s34, 4194304
    s_add_u32 s65, s64, 32768
    s_add_u32 s66, s64, 65536
    s_add_u32 s67, s64, 98304
    v_pk_mul_f32 v[212:213], v[0:1], v[220:221] op_sel_hi:[1,0]
    v_pk_mul_f32 v[214:215], v[2:3], v[220:221] op_sel_hi:[1,0]
    v_pk_mul_f32 v[216:217], v[16:17], v[220:221] op_sel_hi:[1,0]
    v_pk_mul_f32 v[218:219], v[18:19], v[220:221] op_sel_hi:[1,0]
    v_pk_fma_f32 v[0:1], v[0:1], v[220:221], 1.0 op_sel:[0,1,0] op_sel_hi:[1,1,0]
    v_pk_fma_f32 v[2:3], v[2:3], v[220:221], 1.0 op_sel:[0,1,0] op_sel_hi:[1,1,0]
    v_pk_fma_f32 v[16:17], v[16:17], v[220:221], 1.0 op_sel:[0,1,0] op_sel_hi:[1,1,0]
    v_pk_fma_f32 v[18:19], v[18:19], v[220:221], 1.0 op_sel:[0,1,0] op_sel_hi:[1,1,0]
    v_exp_f32 v212, v212 clamp
    v_exp_f32 v213, v213 clamp
    v_exp_f32 v214, v214 clamp
    v_exp_f32 v215, v215 clamp
    v_exp_f32 v216, v216 clamp
    v_exp_f32 v217, v217 clamp
    v_exp_f32 v218, v218 clamp
    v_exp_f32 v219, v219 clamp
    v_max_f32 v0, v0, v212
    v_max_f32 v1, v1, v213
    v_max_f32 v2, v2, v214
    v_max_f32 v3, v3, v215
    v_max_f32 v16, v16, v216
    v_max_f32 v17, v17, v217
    v_max_f32 v18, v18, v218
    v_max_f32 v19, v19, v219
    v_pk_add_f32 v[0:1], v[0:1], v[210:211] op_sel:[0,1] op_sel_hi:[1,1]
    v_pk_add_f32 v[2:3], v[2:3], v[210:211] op_sel:[0,1] op_sel_hi:[1,1]
    v_pk_add_f32 v[16:17], v[16:17], v[210:211] op_sel:[0,1] op_sel_hi:[1,1]
    v_pk_add_f32 v[18:19], v[18:19], v[210:211] op_sel:[0,1] op_sel_hi:[1,1]
    v_cvt_pk_bf16_f32 v0, v0, v1
    v_cvt_pk_bf16_f32 v1, v2, v3
    v_cvt_pk_bf16_f32 v2, v16, v17
    v_cvt_pk_bf16_f32 v3, v18, v19
    buffer_store_dwordx4 v[0:3], v244, s[16:19], s64 offen offset:0
    v_pk_mul_f32 v[212:213], v[4:5], v[222:223] op_sel_hi:[1,0]
    v_pk_mul_f32 v[214:215], v[6:7], v[222:223] op_sel_hi:[1,0]
    v_pk_mul_f32 v[216:217], v[20:21], v[222:223] op_sel_hi:[1,0]
    v_pk_mul_f32 v[218:219], v[22:23], v[222:223] op_sel_hi:[1,0]
    v_pk_fma_f32 v[4:5], v[4:5], v[222:223], 1.0 op_sel:[0,1,0] op_sel_hi:[1,1,0]
    v_pk_fma_f32 v[6:7], v[6:7], v[222:223], 1.0 op_sel:[0,1,0] op_sel_hi:[1,1,0]
    v_pk_fma_f32 v[20:21], v[20:21], v[222:223], 1.0 op_sel:[0,1,0] op_sel_hi:[1,1,0]
    v_pk_fma_f32 v[22:23], v[22:23], v[222:223], 1.0 op_sel:[0,1,0] op_sel_hi:[1,1,0]
    v_exp_f32 v212, v212 clamp
    v_exp_f32 v213, v213 clamp
    v_exp_f32 v214, v214 clamp
    v_exp_f32 v215, v215 clamp
    v_exp_f32 v216, v216 clamp
    v_exp_f32 v217, v217 clamp
    v_exp_f32 v218, v218 clamp
    v_exp_f32 v219, v219 clamp
    v_max_f32 v4, v4, v212
    v_max_f32 v5, v5, v213
    v_max_f32 v6, v6, v214
    v_max_f32 v7, v7, v215
    v_max_f32 v20, v20, v216
    v_max_f32 v21, v21, v217
    v_max_f32 v22, v22, v218
    v_max_f32 v23, v23, v219
    v_pk_add_f32 v[4:5], v[4:5], v[210:211] op_sel:[0,1] op_sel_hi:[1,1]
    v_pk_add_f32 v[6:7], v[6:7], v[210:211] op_sel:[0,1] op_sel_hi:[1,1]
    v_pk_add_f32 v[20:21], v[20:21], v[210:211] op_sel:[0,1] op_sel_hi:[1,1]
    v_pk_add_f32 v[22:23], v[22:23], v[210:211] op_sel:[0,1] op_sel_hi:[1,1]
    v_cvt_pk_bf16_f32 v4, v4, v5
    v_cvt_pk_bf16_f32 v5, v6, v7
    v_cvt_pk_bf16_f32 v6, v20, v21
    v_cvt_pk_bf16_f32 v7, v22, v23
    buffer_store_dwordx4 v[4:7], v244, s[16:19], s65 offen offset:0
    v_pk_mul_f32 v[212:213], v[8:9], v[224:225] op_sel_hi:[1,0]
    v_pk_mul_f32 v[214:215], v[10:11], v[224:225] op_sel_hi:[1,0]
    v_pk_mul_f32 v[216:217], v[24:25], v[224:225] op_sel_hi:[1,0]
    v_pk_mul_f32 v[218:219], v[26:27], v[224:225] op_sel_hi:[1,0]
    v_pk_fma_f32 v[8:9], v[8:9], v[224:225], 1.0 op_sel:[0,1,0] op_sel_hi:[1,1,0]
    v_pk_fma_f32 v[10:11], v[10:11], v[224:225], 1.0 op_sel:[0,1,0] op_sel_hi:[1,1,0]
    v_pk_fma_f32 v[24:25], v[24:25], v[224:225], 1.0 op_sel:[0,1,0] op_sel_hi:[1,1,0]
    v_pk_fma_f32 v[26:27], v[26:27], v[224:225], 1.0 op_sel:[0,1,0] op_sel_hi:[1,1,0]
    v_exp_f32 v212, v212 clamp
    v_exp_f32 v213, v213 clamp
    v_exp_f32 v214, v214 clamp
    v_exp_f32 v215, v215 clamp
    v_exp_f32 v216, v216 clamp
    v_exp_f32 v217, v217 clamp
    v_exp_f32 v218, v218 clamp
    v_exp_f32 v219, v219 clamp
    v_max_f32 v8, v8, v212
    v_max_f32 v9, v9, v213
    v_max_f32 v10, v10, v214
    v_max_f32 v11, v11, v215
    v_max_f32 v24, v24, v216
    v_max_f32 v25, v25, v217
    v_max_f32 v26, v26, v218
    v_max_f32 v27, v27, v219
    v_pk_add_f32 v[8:9], v[8:9], v[210:211] op_sel:[0,1] op_sel_hi:[1,1]
    v_pk_add_f32 v[10:11], v[10:11], v[210:211] op_sel:[0,1] op_sel_hi:[1,1]
    v_pk_add_f32 v[24:25], v[24:25], v[210:211] op_sel:[0,1] op_sel_hi:[1,1]
    v_pk_add_f32 v[26:27], v[26:27], v[210:211] op_sel:[0,1] op_sel_hi:[1,1]
    v_cvt_pk_bf16_f32 v8, v8, v9
    v_cvt_pk_bf16_f32 v9, v10, v11
    v_cvt_pk_bf16_f32 v10, v24, v25
    v_cvt_pk_bf16_f32 v11, v26, v27
    buffer_store_dwordx4 v[8:11], v244, s[16:19], s66 offen offset:0
    v_pk_mul_f32 v[212:213], v[12:13], v[226:227] op_sel_hi:[1,0]
    v_pk_mul_f32 v[214:215], v[14:15], v[226:227] op_sel_hi:[1,0]
    v_pk_mul_f32 v[216:217], v[28:29], v[226:227] op_sel_hi:[1,0]
    v_pk_mul_f32 v[218:219], v[30:31], v[226:227] op_sel_hi:[1,0]
    v_pk_fma_f32 v[12:13], v[12:13], v[226:227], 1.0 op_sel:[0,1,0] op_sel_hi:[1,1,0]
    v_pk_fma_f32 v[14:15], v[14:15], v[226:227], 1.0 op_sel:[0,1,0] op_sel_hi:[1,1,0]
    v_pk_fma_f32 v[28:29], v[28:29], v[226:227], 1.0 op_sel:[0,1,0] op_sel_hi:[1,1,0]
    v_pk_fma_f32 v[30:31], v[30:31], v[226:227], 1.0 op_sel:[0,1,0] op_sel_hi:[1,1,0]
    v_exp_f32 v212, v212 clamp
    v_exp_f32 v213, v213 clamp
    v_exp_f32 v214, v214 clamp
    v_exp_f32 v215, v215 clamp
    v_exp_f32 v216, v216 clamp
    v_exp_f32 v217, v217 clamp
    v_exp_f32 v218, v218 clamp
    v_exp_f32 v219, v219 clamp
    v_max_f32 v12, v12, v212
    v_max_f32 v13, v13, v213
    v_max_f32 v14, v14, v214
    v_max_f32 v15, v15, v215
    v_max_f32 v28, v28, v216
    v_max_f32 v29, v29, v217
    v_max_f32 v30, v30, v218
    v_max_f32 v31, v31, v219
    v_pk_add_f32 v[12:13], v[12:13], v[210:211] op_sel:[0,1] op_sel_hi:[1,1]
    v_pk_add_f32 v[14:15], v[14:15], v[210:211] op_sel:[0,1] op_sel_hi:[1,1]
    v_pk_add_f32 v[28:29], v[28:29], v[210:211] op_sel:[0,1] op_sel_hi:[1,1]
    v_pk_add_f32 v[30:31], v[30:31], v[210:211] op_sel:[0,1] op_sel_hi:[1,1]
    v_cvt_pk_bf16_f32 v12, v12, v13
    v_cvt_pk_bf16_f32 v13, v14, v15
    v_cvt_pk_bf16_f32 v14, v28, v29
    v_cvt_pk_bf16_f32 v15, v30, v31
    buffer_store_dwordx4 v[12:15], v244, s[16:19], s67 offen offset:0
    v_pk_mul_f32 v[212:213], v[32:33], v[220:221] op_sel_hi:[1,0]
    v_pk_mul_f32 v[214:215], v[34:35], v[220:221] op_sel_hi:[1,0]
    v_pk_mul_f32 v[216:217], v[48:49], v[220:221] op_sel_hi:[1,0]
    v_pk_mul_f32 v[218:219], v[50:51], v[220:221] op_sel_hi:[1,0]
    v_pk_fma_f32 v[32:33], v[32:33], v[220:221], 1.0 op_sel:[0,1,0] op_sel_hi:[1,1,0]
    v_pk_fma_f32 v[34:35], v[34:35], v[220:221], 1.0 op_sel:[0,1,0] op_sel_hi:[1,1,0]
    v_pk_fma_f32 v[48:49], v[48:49], v[220:221], 1.0 op_sel:[0,1,0] op_sel_hi:[1,1,0]
    v_pk_fma_f32 v[50:51], v[50:51], v[220:221], 1.0 op_sel:[0,1,0] op_sel_hi:[1,1,0]
    v_exp_f32 v212, v212 clamp
    v_exp_f32 v213, v213 clamp
    v_exp_f32 v214, v214 clamp
    v_exp_f32 v215, v215 clamp
    v_exp_f32 v216, v216 clamp
    v_exp_f32 v217, v217 clamp
    v_exp_f32 v218, v218 clamp
    v_exp_f32 v219, v219 clamp
    v_max_f32 v32, v32, v212
    v_max_f32 v33, v33, v213
    v_max_f32 v34, v34, v214
    v_max_f32 v35, v35, v215
    v_max_f32 v48, v48, v216
    v_max_f32 v49, v49, v217
    v_max_f32 v50, v50, v218
    v_max_f32 v51, v51, v219
    v_pk_add_f32 v[32:33], v[32:33], v[210:211] op_sel:[0,1] op_sel_hi:[1,1]
    v_pk_add_f32 v[34:35], v[34:35], v[210:211] op_sel:[0,1] op_sel_hi:[1,1]
    v_pk_add_f32 v[48:49], v[48:49], v[210:211] op_sel:[0,1] op_sel_hi:[1,1]
    v_pk_add_f32 v[50:51], v[50:51], v[210:211] op_sel:[0,1] op_sel_hi:[1,1]
    v_cvt_pk_bf16_f32 v32, v32, v33
    v_cvt_pk_bf16_f32 v33, v34, v35
    v_cvt_pk_bf16_f32 v34, v48, v49
    v_cvt_pk_bf16_f32 v35, v50, v51
    buffer_store_dwordx4 v[32:35], v244, s[16:19], s64 offen offset:1024
    v_pk_mul_f32 v[212:213], v[36:37], v[222:223] op_sel_hi:[1,0]
    v_pk_mul_f32 v[214:215], v[38:39], v[222:223] op_sel_hi:[1,0]
    v_pk_mul_f32 v[216:217], v[52:53], v[222:223] op_sel_hi:[1,0]
    v_pk_mul_f32 v[218:219], v[54:55], v[222:223] op_sel_hi:[1,0]
    v_pk_fma_f32 v[36:37], v[36:37], v[222:223], 1.0 op_sel:[0,1,0] op_sel_hi:[1,1,0]
    v_pk_fma_f32 v[38:39], v[38:39], v[222:223], 1.0 op_sel:[0,1,0] op_sel_hi:[1,1,0]
    v_pk_fma_f32 v[52:53], v[52:53], v[222:223], 1.0 op_sel:[0,1,0] op_sel_hi:[1,1,0]
    v_pk_fma_f32 v[54:55], v[54:55], v[222:223], 1.0 op_sel:[0,1,0] op_sel_hi:[1,1,0]
    v_exp_f32 v212, v212 clamp
    v_exp_f32 v213, v213 clamp
    v_exp_f32 v214, v214 clamp
    v_exp_f32 v215, v215 clamp
    v_exp_f32 v216, v216 clamp
    v_exp_f32 v217, v217 clamp
    v_exp_f32 v218, v218 clamp
    v_exp_f32 v219, v219 clamp
    v_max_f32 v36, v36, v212
    v_max_f32 v37, v37, v213
    v_max_f32 v38, v38, v214
    v_max_f32 v39, v39, v215
    v_max_f32 v52, v52, v216
    v_max_f32 v53, v53, v217
    v_max_f32 v54, v54, v218
    v_max_f32 v55, v55, v219
    v_pk_add_f32 v[36:37], v[36:37], v[210:211] op_sel:[0,1] op_sel_hi:[1,1]
    v_pk_add_f32 v[38:39], v[38:39], v[210:211] op_sel:[0,1] op_sel_hi:[1,1]
    v_pk_add_f32 v[52:53], v[52:53], v[210:211] op_sel:[0,1] op_sel_hi:[1,1]
    v_pk_add_f32 v[54:55], v[54:55], v[210:211] op_sel:[0,1] op_sel_hi:[1,1]
    v_cvt_pk_bf16_f32 v36, v36, v37
    v_cvt_pk_bf16_f32 v37, v38, v39
    v_cvt_pk_bf16_f32 v38, v52, v53
    v_cvt_pk_bf16_f32 v39, v54, v55
    buffer_store_dwordx4 v[36:39], v244, s[16:19], s65 offen offset:1024
    v_pk_mul_f32 v[212:213], v[40:41], v[224:225] op_sel_hi:[1,0]
    v_pk_mul_f32 v[214:215], v[42:43], v[224:225] op_sel_hi:[1,0]
    v_pk_mul_f32 v[216:217], v[56:57], v[224:225] op_sel_hi:[1,0]
    v_pk_mul_f32 v[218:219], v[58:59], v[224:225] op_sel_hi:[1,0]
    v_pk_fma_f32 v[40:41], v[40:41], v[224:225], 1.0 op_sel:[0,1,0] op_sel_hi:[1,1,0]
    v_pk_fma_f32 v[42:43], v[42:43], v[224:225], 1.0 op_sel:[0,1,0] op_sel_hi:[1,1,0]
    v_pk_fma_f32 v[56:57], v[56:57], v[224:225], 1.0 op_sel:[0,1,0] op_sel_hi:[1,1,0]
    v_pk_fma_f32 v[58:59], v[58:59], v[224:225], 1.0 op_sel:[0,1,0] op_sel_hi:[1,1,0]
    v_exp_f32 v212, v212 clamp
    v_exp_f32 v213, v213 clamp
    v_exp_f32 v214, v214 clamp
    v_exp_f32 v215, v215 clamp
    v_exp_f32 v216, v216 clamp
    v_exp_f32 v217, v217 clamp
    v_exp_f32 v218, v218 clamp
    v_exp_f32 v219, v219 clamp
    v_max_f32 v40, v40, v212
    v_max_f32 v41, v41, v213
    v_max_f32 v42, v42, v214
    v_max_f32 v43, v43, v215
    v_max_f32 v56, v56, v216
    v_max_f32 v57, v57, v217
    v_max_f32 v58, v58, v218
    v_max_f32 v59, v59, v219
    v_pk_add_f32 v[40:41], v[40:41], v[210:211] op_sel:[0,1] op_sel_hi:[1,1]
    v_pk_add_f32 v[42:43], v[42:43], v[210:211] op_sel:[0,1] op_sel_hi:[1,1]
    v_pk_add_f32 v[56:57], v[56:57], v[210:211] op_sel:[0,1] op_sel_hi:[1,1]
    v_pk_add_f32 v[58:59], v[58:59], v[210:211] op_sel:[0,1] op_sel_hi:[1,1]
    v_cvt_pk_bf16_f32 v40, v40, v41
    v_cvt_pk_bf16_f32 v41, v42, v43
    v_cvt_pk_bf16_f32 v42, v56, v57
    v_cvt_pk_bf16_f32 v43, v58, v59
    buffer_store_dwordx4 v[40:43], v244, s[16:19], s66 offen offset:1024
    v_pk_mul_f32 v[212:213], v[44:45], v[226:227] op_sel_hi:[1,0]
    v_pk_mul_f32 v[214:215], v[46:47], v[226:227] op_sel_hi:[1,0]
    v_pk_mul_f32 v[216:217], v[60:61], v[226:227] op_sel_hi:[1,0]
    v_pk_mul_f32 v[218:219], v[62:63], v[226:227] op_sel_hi:[1,0]
    v_pk_fma_f32 v[44:45], v[44:45], v[226:227], 1.0 op_sel:[0,1,0] op_sel_hi:[1,1,0]
    v_pk_fma_f32 v[46:47], v[46:47], v[226:227], 1.0 op_sel:[0,1,0] op_sel_hi:[1,1,0]
    v_pk_fma_f32 v[60:61], v[60:61], v[226:227], 1.0 op_sel:[0,1,0] op_sel_hi:[1,1,0]
    v_pk_fma_f32 v[62:63], v[62:63], v[226:227], 1.0 op_sel:[0,1,0] op_sel_hi:[1,1,0]
    v_exp_f32 v212, v212 clamp
    v_exp_f32 v213, v213 clamp
    v_exp_f32 v214, v214 clamp
    v_exp_f32 v215, v215 clamp
    v_exp_f32 v216, v216 clamp
    v_exp_f32 v217, v217 clamp
    v_exp_f32 v218, v218 clamp
    v_exp_f32 v219, v219 clamp
    v_max_f32 v44, v44, v212
    v_max_f32 v45, v45, v213
    v_max_f32 v46, v46, v214
    v_max_f32 v47, v47, v215
    v_max_f32 v60, v60, v216
    v_max_f32 v61, v61, v217
    v_max_f32 v62, v62, v218
    v_max_f32 v63, v63, v219
    v_pk_add_f32 v[44:45], v[44:45], v[210:211] op_sel:[0,1] op_sel_hi:[1,1]
    v_pk_add_f32 v[46:47], v[46:47], v[210:211] op_sel:[0,1] op_sel_hi:[1,1]
    v_pk_add_f32 v[60:61], v[60:61], v[210:211] op_sel:[0,1] op_sel_hi:[1,1]
    v_pk_add_f32 v[62:63], v[62:63], v[210:211] op_sel:[0,1] op_sel_hi:[1,1]
    v_cvt_pk_bf16_f32 v44, v44, v45
    v_cvt_pk_bf16_f32 v45, v46, v47
    v_cvt_pk_bf16_f32 v46, v60, v61
    v_cvt_pk_bf16_f32 v47, v62, v63
    buffer_store_dwordx4 v[44:47], v244, s[16:19], s67 offen offset:1024
    v_bfe_u32 v212, v255, 2, 1
    v_lshlrev_b32 v212, 9, v212
    v_bfe_u32 v213, v255, 3, 1
    v_lshl_add_u32 v212, v213, 7, v212
    v_and_b32 v213, 3, v255
    v_lshl_add_u32 v212, v213, 5, v212
    v_bfe_u32 v213, v255, 5, 1
    v_lshl_add_u32 v212, v213, 4, v212
    v_bfe_u32 v213, v255, 4, 1
    v_lshl_add_u32 v245, v213, 8, v212
    v_lshl_add_u32 v246, v213, 3, v212
    v_add_u32 v245, 1024, v245
    s_mov_b32 s39, 0x40000
    s_nop 0
k1_kernel_O_poll:
    s_mov_b32 s35, s37
    buffer_load_dwordx2 v[0:1], v247, s[16:19], s35 offen sc1
    s_add_u32 s35, s35, 16384
    buffer_load_dwordx2 v[2:3], v247, s[16:19], s35 offen sc1
    s_add_u32 s35, s35, 16384
    buffer_load_dwordx2 v[4:5], v247, s[16:19], s35 offen sc1
    s_add_u32 s35, s35, 16384
    buffer_load_dwordx2 v[6:7], v247, s[16:19], s35 offen sc1
    s_add_u32 s35, s35, 16384
    buffer_load_dwordx2 v[8:9], v247, s[16:19], s35 offen sc1
    s_add_u32 s35, s35, 16384
    buffer_load_dwordx2 v[10:11], v247, s[16:19], s35 offen sc1
    s_add_u32 s35, s35, 16384
    buffer_load_dwordx2 v[12:13], v247, s[16:19], s35 offen sc1
    s_add_u32 s35, s35, 16384
    buffer_load_dwordx2 v[14:15], v247, s[16:19], s35 offen sc1
    s_add_u32 s35, s35, 16384
    buffer_load_dwordx2 v[16:17], v247, s[16:19], s35 offen sc1
    s_add_u32 s35, s35, 16384
    buffer_load_dwordx2 v[18:19], v247, s[16:19], s35 offen sc1
    s_add_u32 s35, s35, 16384
    buffer_load_dwordx2 v[20:21], v247, s[16:19], s35 offen sc1
    s_add_u32 s35, s35, 16384
    buffer_load_dwordx2 v[22:23], v247, s[16:19], s35 offen sc1
    s_add_u32 s35, s35, 16384
    buffer_load_dwordx2 v[24:25], v247, s[16:19], s35 offen sc1
    s_add_u32 s35, s35, 16384
    buffer_load_dwordx2 v[26:27], v247, s[16:19], s35 offen sc1
    s_add_u32 s35, s35, 16384
    buffer_load_dwordx2 v[28:29], v247, s[16:19], s35 offen sc1
    s_add_u32 s35, s35, 16384
    buffer_load_dwordx2 v[30:31], v247, s[16:19], s35 offen sc1
    s_waitcnt vmcnt(0)
k1_kernel_O_chk:
    v_max3_u32 v212, v0, v1, v2
    v_max3_u32 v212, v212, v3, v4
    v_max3_u32 v212, v212, v5, v6
    v_max3_u32 v212, v212, v7, v8
    v_max3_u32 v212, v212, v9, v10
    v_max3_u32 v212, v212, v11, v12
    v_max3_u32 v212, v212, v13, v14
    v_max3_u32 v212, v212, v15, v16
    v_max3_u32 v212, v212, v17, v18
    v_max3_u32 v212, v212, v19, v20
    v_max3_u32 v212, v212, v21, v22
    v_max3_u32 v212, v212, v23, v24
    v_max3_u32 v212, v212, v25, v26
    v_max3_u32 v212, v212, v27, v28
    v_max3_u32 v212, v212, v29, v30
    v_max_u32 v212, v212, v31
    v_cmp_eq_u32 vcc, -1, v212
    s_sub_u32 s39, s39, 1
    s_cbranch_scc1 k1_kernel_O_go
    s_cbranch_vccnz k1_kernel_O_poll
k1_kernel_O_go:
    v_pk_add_f32 v[0:1], v[0:1], v[16:17]
    v_pk_add_f32 v[2:3], v[2:3], v[18:19]
    v_pk_add_f32 v[4:5], v[4:5], v[20:21]
    v_pk_add_f32 v[6:7], v[6:7], v[22:23]
    v_pk_add_f32 v[8:9], v[8:9], v[24:25]
    v_pk_add_f32 v[10:11], v[10:11], v[26:27]
    v_pk_add_f32 v[12:13], v[12:13], v[28:29]
    v_pk_add_f32 v[14:15], v[14:15], v[30:31]
    v_pk_add_f32 v[0:1], v[0:1], v[8:9]
    v_pk_add_f32 v[2:3], v[2:3], v[10:11]
    v_pk_add_f32 v[4:5], v[4:5], v[12:13]
    v_pk_add_f32 v[6:7], v[6:7], v[14:15]
    v_pk_add_f32 v[0:1], v[0:1], v[4:5]
    v_pk_add_f32 v[2:3], v[2:3], v[6:7]
    v_pk_add_f32 v[0:1], v[0:1], v[2:3]
    v_mul_f32 v0, 0x3a124925, v0
    v_mul_f32 v1, 0x3a124925, v1
    v_fma_f32 v1, -v0, v0, v1
    v_max_f32 v1, 0, v1
    v_cvt_pk_bf16_f32 v1, v1, v1
    v_lshlrev_b32 v1, 16, v1
    v_add_f32 v1, 0x3727c5ac, v1
    v_cvt_pk_bf16_f32 v1, v1, v1
    v_lshlrev_b32 v1, 16, v1
    v_sqrt_f32 v1, v1
    v_cvt_pk_bf16_f32 v0, v0, v0
    v_lshlrev_b32 v0, 16, v0
    v_cvt_pk_bf16_f32 v1, v1, v1
    v_lshlrev_b32 v1, 16, v1
    v_rcp_f32 v1, v1
    s_nop 0
    v_mul_f32 v0, v0, v1
    v_mov_b32 v228, v1
    v_mov_b32 v232, v1
    v_sub_f32 v229, 0, v0
    v_sub_f32 v233, 0, v0
    s_nop 1
    v_permlane32_swap_b32 v228, v232
    v_permlane32_swap_b32 v229, v233
    v_mov_b32 v230, v228
    v_mov_b32 v231, v229
    v_mov_b32 v234, v232
    v_mov_b32 v235, v233
    s_nop 0
    v_permlane16_swap_b32 v228, v230
    v_permlane16_swap_b32 v229, v231
    v_permlane16_swap_b32 v232, v234
    v_permlane16_swap_b32 v233, v235
    v_pk_fma_f32 v[80:81], v[80:81], v[228:229], v[228:229] op_sel:[0,0,1] op_sel_hi:[1,0,1]
    v_pk_fma_f32 v[82:83], v[82:83], v[228:229], v[228:229] op_sel:[0,0,1] op_sel_hi:[1,0,1]
    v_pk_fma_f32 v[96:97], v[96:97], v[228:229], v[228:229] op_sel:[0,0,1] op_sel_hi:[1,0,1]
    v_pk_fma_f32 v[98:99], v[98:99], v[228:229], v[228:229] op_sel:[0,0,1] op_sel_hi:[1,0,1]
    v_pk_fma_f32 v[84:85], v[84:85], v[230:231], v[230:231] op_sel:[0,0,1] op_sel_hi:[1,0,1]
    v_pk_fma_f32 v[86:87], v[86:87], v[230:231], v[230:231] op_sel:[0,0,1] op_sel_hi:[1,0,1]
    v_pk_fma_f32 v[100:101], v[100:101], v[230:231], v[230:231] op_sel:[0,0,1] op_sel_hi:[1,0,1]
    v_pk_fma_f32 v[102:103], v[102:103], v[230:231], v[230:231] op_sel:[0,0,1] op_sel_hi:[1,0,1]
    v_pk_fma_f32 v[88:89], v[88:89], v[232:233], v[232:233] op_sel:[0,0,1] op_sel_hi:[1,0,1]
    v_pk_fma_f32 v[90:91], v[90:91], v[232:233], v[232:233] op_sel:[0,0,1] op_sel_hi:[1,0,1]
    v_pk_fma_f32 v[104:105], v[104:105], v[232:233], v[232:233] op_sel:[0,0,1] op_sel_hi:[1,0,1]
    v_pk_fma_f32 v[106:107], v[106:107], v[232:233], v[232:233] op_sel:[0,0,1] op_sel_hi:[1,0,1]
    v_pk_fma_f32 v[92:93], v[92:93], v[234:235], v[234:235] op_sel:[0,0,1] op_sel_hi:[1,0,1]
    v_pk_fma_f32 v[94:95], v[94:95], v[234:235], v[234:235] op_sel:[0,0,1] op_sel_hi:[1,0,1]
    v_pk_fma_f32 v[108:109], v[108:109], v[234:235], v[234:235] op_sel:[0,0,1] op_sel_hi:[1,0,1]
    v_pk_fma_f32 v[110:111], v[110:111], v[234:235], v[234:235] op_sel:[0,0,1] op_sel_hi:[1,0,1]
    v_cvt_pk_bf16_f32 v80, v80, v81
    v_cvt_pk_bf16_f32 v81, v82, v83
    v_cvt_pk_bf16_f32 v82, v96, v97
    v_cvt_pk_bf16_f32 v83, v98, v99
    v_cvt_pk_bf16_f32 v84, v84, v85
    v_cvt_pk_bf16_f32 v85, v86, v87
    v_cvt_pk_bf16_f32 v86, v100, v101
    v_cvt_pk_bf16_f32 v87, v102, v103
    v_cvt_pk_bf16_f32 v88, v88, v89
    v_cvt_pk_bf16_f32 v89, v90, v91
    v_cvt_pk_bf16_f32 v90, v104, v105
    v_cvt_pk_bf16_f32 v91, v106, v107
    v_cvt_pk_bf16_f32 v92, v92, v93
    v_cvt_pk_bf16_f32 v93, v94, v95
    v_cvt_pk_bf16_f32 v94, v108, v109
    v_cvt_pk_bf16_f32 v95, v110, v111
    s_nop 0
    v_permlane16_swap_b32 v80, v82
    v_permlane16_swap_b32 v81, v83
    buffer_store_dwordx4 v[80:83], v245, s[16:19], s60 offen offset:0
    v_permlane16_swap_b32 v84, v86
    v_permlane16_swap_b32 v85, v87
    buffer_store_dwordx4 v[84:87], v245, s[16:19], s61 offen offset:0
    v_permlane16_swap_b32 v88, v90
    v_permlane16_swap_b32 v89, v91
    buffer_store_dwordx4 v[88:91], v245, s[16:19], s62 offen offset:0
    v_permlane16_swap_b32 v92, v94
    v_permlane16_swap_b32 v93, v95
    buffer_store_dwordx4 v[92:95], v245, s[16:19], s63 offen offset:0
    v_pk_fma_f32 v[112:113], v[112:113], v[228:229], v[228:229] op_sel:[0,0,1] op_sel_hi:[1,0,1]
    v_pk_fma_f32 v[114:115], v[114:115], v[228:229], v[228:229] op_sel:[0,0,1] op_sel_hi:[1,0,1]
    v_pk_fma_f32 v[128:129], v[128:129], v[228:229], v[228:229] op_sel:[0,0,1] op_sel_hi:[1,0,1]
    v_pk_fma_f32 v[130:131], v[130:131], v[228:229], v[228:229] op_sel:[0,0,1] op_sel_hi:[1,0,1]
    v_pk_fma_f32 v[116:117], v[116:117], v[230:231], v[230:231] op_sel:[0,0,1] op_sel_hi:[1,0,1]
    v_pk_fma_f32 v[118:119], v[118:119], v[230:231], v[230:231] op_sel:[0,0,1] op_sel_hi:[1,0,1]
    v_pk_fma_f32 v[132:133], v[132:133], v[230:231], v[230:231] op_sel:[0,0,1] op_sel_hi:[1,0,1]
    v_pk_fma_f32 v[134:135], v[134:135], v[230:231], v[230:231] op_sel:[0,0,1] op_sel_hi:[1,0,1]
    v_pk_fma_f32 v[120:121], v[120:121], v[232:233], v[232:233] op_sel:[0,0,1] op_sel_hi:[1,0,1]
    v_pk_fma_f32 v[122:123], v[122:123], v[232:233], v[232:233] op_sel:[0,0,1] op_sel_hi:[1,0,1]
    v_pk_fma_f32 v[136:137], v[136:137], v[232:233], v[232:233] op_sel:[0,0,1] op_sel_hi:[1,0,1]
    v_pk_fma_f32 v[138:139], v[138:139], v[232:233], v[232:233] op_sel:[0,0,1] op_sel_hi:[1,0,1]
    v_pk_fma_f32 v[124:125], v[124:125], v[234:235], v[234:235] op_sel:[0,0,1] op_sel_hi:[1,0,1]
    v_pk_fma_f32 v[126:127], v[126:127], v[234:235], v[234:235] op_sel:[0,0,1] op_sel_hi:[1,0,1]
    v_pk_fma_f32 v[140:141], v[140:141], v[234:235], v[234:235] op_sel:[0,0,1] op_sel_hi:[1,0,1]
    v_pk_fma_f32 v[142:143], v[142:143], v[234:235], v[234:235] op_sel:[0,0,1] op_sel_hi:[1,0,1]
    v_cvt_pk_bf16_f32 v112, v112, v113
    v_cvt_pk_bf16_f32 v113, v114, v115
    v_cvt_pk_bf16_f32 v114, v128, v129
    v_cvt_pk_bf16_f32 v115, v130, v131
    v_cvt_pk_bf16_f32 v116, v116, v117
    v_cvt_pk_bf16_f32 v117, v118, v119
    v_cvt_pk_bf16_f32 v118, v132, v133
    v_cvt_pk_bf16_f32 v119, v134, v135
    v_cvt_pk_bf16_f32 v120, v120, v121
    v_cvt_pk_bf16_f32 v121, v122, v123
    v_cvt_pk_bf16_f32 v122, v136, v137
    v_cvt_pk_bf16_f32 v123, v138, v139
    v_cvt_pk_bf16_f32 v124, v124, v125
    v_cvt_pk_bf16_f32 v125, v126, v127
    v_cvt_pk_bf16_f32 v126, v140, v141
    v_cvt_pk_bf16_f32 v127, v142, v143
    s_nop 0
    v_permlane16_swap_b32 v112, v114
    v_permlane16_swap_b32 v113, v115
    buffer_store_dwordx4 v[112:115], v245, s[16:19], s60 offen offset:1024
    v_permlane16_swap_b32 v116, v118
    v_permlane16_swap_b32 v117, v119
    buffer_store_dwordx4 v[116:119], v245, s[16:19], s61 offen offset:1024
    v_permlane16_swap_b32 v120, v122
    v_permlane16_swap_b32 v121, v123
    buffer_store_dwordx4 v[120:123], v245, s[16:19], s62 offen offset:1024
    v_permlane16_swap_b32 v124, v126
    v_permlane16_swap_b32 v125, v127
    buffer_store_dwordx4 v[124:127], v245, s[16:19], s63 offen offset:1024
    v_pk_fma_f32 v[144:145], v[144:145], v[228:229], v[228:229] op_sel:[0,0,1] op_sel_hi:[1,0,1]
    v_pk_fma_f32 v[146:147], v[146:147], v[228:229], v[228:229] op_sel:[0,0,1] op_sel_hi:[1,0,1]
    v_pk_fma_f32 v[160:161], v[160:161], v[228:229], v[228:229] op_sel:[0,0,1] op_sel_hi:[1,0,1]
    v_pk_fma_f32 v[162:163], v[162:163], v[228:229], v[228:229] op_sel:[0,0,1] op_sel_hi:[1,0,1]
    v_pk_fma_f32 v[148:149], v[148:149], v[230:231], v[230:231] op_sel:[0,0,1] op_sel_hi:[1,0,1]
    v_pk_fma_f32 v[150:151], v[150:151], v[230:231], v[230:231] op_sel:[0,0,1] op_sel_hi:[1,0,1]
    v_pk_fma_f32 v[164:165], v[164:165], v[230:231], v[230:231] op_sel:[0,0,1] op_sel_hi:[1,0,1]
    v_pk_fma_f32 v[166:167], v[166:167], v[230:231], v[230:231] op_sel:[0,0,1] op_sel_hi:[1,0,1]
    v_pk_fma_f32 v[152:153], v[152:153], v[232:233], v[232:233] op_sel:[0,0,1] op_sel_hi:[1,0,1]
    v_pk_fma_f32 v[154:155], v[154:155], v[232:233], v[232:233] op_sel:[0,0,1] op_sel_hi:[1,0,1]
    v_pk_fma_f32 v[168:169], v[168:169], v[232:233], v[232:233] op_sel:[0,0,1] op_sel_hi:[1,0,1]
    v_pk_fma_f32 v[170:171], v[170:171], v[232:233], v[232:233] op_sel:[0,0,1] op_sel_hi:[1,0,1]
    v_pk_fma_f32 v[156:157], v[156:157], v[234:235], v[234:235] op_sel:[0,0,1] op_sel_hi:[1,0,1]
    v_pk_fma_f32 v[158:159], v[158:159], v[234:235], v[234:235] op_sel:[0,0,1] op_sel_hi:[1,0,1]
    v_pk_fma_f32 v[172:173], v[172:173], v[234:235], v[234:235] op_sel:[0,0,1] op_sel_hi:[1,0,1]
    v_pk_fma_f32 v[174:175], v[174:175], v[234:235], v[234:235] op_sel:[0,0,1] op_sel_hi:[1,0,1]
    v_cvt_pk_bf16_f32 v144, v144, v145
    v_cvt_pk_bf16_f32 v145, v146, v147
    v_cvt_pk_bf16_f32 v146, v160, v161
    v_cvt_pk_bf16_f32 v147, v162, v163
    v_cvt_pk_bf16_f32 v148, v148, v149
    v_cvt_pk_bf16_f32 v149, v150, v151
    v_cvt_pk_bf16_f32 v150, v164, v165
    v_cvt_pk_bf16_f32 v151, v166, v167
    v_cvt_pk_bf16_f32 v152, v152, v153
    v_cvt_pk_bf16_f32 v153, v154, v155
    v_cvt_pk_bf16_f32 v154, v168, v169
    v_cvt_pk_bf16_f32 v155, v170, v171
    v_cvt_pk_bf16_f32 v156, v156, v157
    v_cvt_pk_bf16_f32 v157, v158, v159
    v_cvt_pk_bf16_f32 v158, v172, v173
    v_cvt_pk_bf16_f32 v159, v174, v175
    s_nop 0
    v_permlane16_swap_b32 v144, v146
    v_permlane16_swap_b32 v145, v147
    buffer_store_dwordx4 v[144:147], v245, s[16:19], s60 offen offset:2048
    v_permlane16_swap_b32 v148, v150
    v_permlane16_swap_b32 v149, v151
    buffer_store_dwordx4 v[148:151], v245, s[16:19], s61 offen offset:2048
    v_permlane16_swap_b32 v152, v154
    v_permlane16_swap_b32 v153, v155
    buffer_store_dwordx4 v[152:155], v245, s[16:19], s62 offen offset:2048
    v_permlane16_swap_b32 v156, v158
    v_permlane16_swap_b32 v157, v159
    buffer_store_dwordx4 v[156:159], v245, s[16:19], s63 offen offset:2048
    v_pk_fma_f32 v[176:177], v[176:177], v[228:229], v[228:229] op_sel:[0,0,1] op_sel_hi:[1,0,1]
    v_pk_fma_f32 v[178:179], v[178:179], v[228:229], v[228:229] op_sel:[0,0,1] op_sel_hi:[1,0,1]
    v_pk_fma_f32 v[192:193], v[192:193], v[228:229], v[228:229] op_sel:[0,0,1] op_sel_hi:[1,0,1]
    v_pk_fma_f32 v[194:195], v[194:195], v[228:229], v[228:229] op_sel:[0,0,1] op_sel_hi:[1,0,1]
    v_pk_fma_f32 v[180:181], v[180:181], v[230:231], v[230:231] op_sel:[0,0,1] op_sel_hi:[1,0,1]
    v_pk_fma_f32 v[182:183], v[182:183], v[230:231], v[230:231] op_sel:[0,0,1] op_sel_hi:[1,0,1]
    v_pk_fma_f32 v[196:197], v[196:197], v[230:231], v[230:231] op_sel:[0,0,1] op_sel_hi:[1,0,1]
    v_pk_fma_f32 v[198:199], v[198:199], v[230:231], v[230:231] op_sel:[0,0,1] op_sel_hi:[1,0,1]
    v_pk_fma_f32 v[184:185], v[184:185], v[232:233], v[232:233] op_sel:[0,0,1] op_sel_hi:[1,0,1]
    v_pk_fma_f32 v[186:187], v[186:187], v[232:233], v[232:233] op_sel:[0,0,1] op_sel_hi:[1,0,1]
    v_pk_fma_f32 v[200:201], v[200:201], v[232:233], v[232:233] op_sel:[0,0,1] op_sel_hi:[1,0,1]
    v_pk_fma_f32 v[202:203], v[202:203], v[232:233], v[232:233] op_sel:[0,0,1] op_sel_hi:[1,0,1]
    v_pk_fma_f32 v[188:189], v[188:189], v[234:235], v[234:235] op_sel:[0,0,1] op_sel_hi:[1,0,1]
    v_pk_fma_f32 v[190:191], v[190:191], v[234:235], v[234:235] op_sel:[0,0,1] op_sel_hi:[1,0,1]
    v_pk_fma_f32 v[204:205], v[204:205], v[234:235], v[234:235] op_sel:[0,0,1] op_sel_hi:[1,0,1]
    v_pk_fma_f32 v[206:207], v[206:207], v[234:235], v[234:235] op_sel:[0,0,1] op_sel_hi:[1,0,1]
    v_cvt_pk_bf16_f32 v176, v176, v177
    v_cvt_pk_bf16_f32 v177, v178, v179
    v_cvt_pk_bf16_f32 v178, v192, v193
    v_cvt_pk_bf16_f32 v179, v194, v195
    v_cvt_pk_bf16_f32 v180, v180, v181
    v_cvt_pk_bf16_f32 v181, v182, v183
    v_cvt_pk_bf16_f32 v182, v196, v197
    v_cvt_pk_bf16_f32 v183, v198, v199
    v_cvt_pk_bf16_f32 v184, v184, v185
    v_cvt_pk_bf16_f32 v185, v186, v187
    v_cvt_pk_bf16_f32 v186, v200, v201
    v_cvt_pk_bf16_f32 v187, v202, v203
    v_cvt_pk_bf16_f32 v188, v188, v189
    v_cvt_pk_bf16_f32 v189, v190, v191
    v_cvt_pk_bf16_f32 v190, v204, v205
    v_cvt_pk_bf16_f32 v191, v206, v207
    s_nop 0
    v_permlane16_swap_b32 v176, v178
    v_permlane16_swap_b32 v177, v179
    buffer_store_dwordx4 v[176:179], v245, s[16:19], s60 offen offset:3072
    v_permlane16_swap_b32 v180, v182
    v_permlane16_swap_b32 v181, v183
    buffer_store_dwordx4 v[180:183], v245, s[16:19], s61 offen offset:3072
    v_permlane16_swap_b32 v184, v186
    v_permlane16_swap_b32 v185, v187
    buffer_store_dwordx4 v[184:187], v245, s[16:19], s62 offen offset:3072
    v_permlane16_swap_b32 v188, v190
    v_permlane16_swap_b32 v189, v191
    buffer_store_dwordx4 v[188:191], v245, s[16:19], s63 offen offset:3072
    v_pk_fma_f32 v[64:65], v[64:65], v[228:229], v[228:229] op_sel:[0,0,1] op_sel_hi:[1,0,1]
    v_pk_fma_f32 v[66:67], v[66:67], v[228:229], v[228:229] op_sel:[0,0,1] op_sel_hi:[1,0,1]
    v_pk_fma_f32 v[68:69], v[68:69], v[230:231], v[230:231] op_sel:[0,0,1] op_sel_hi:[1,0,1]
    v_pk_fma_f32 v[70:71], v[70:71], v[230:231], v[230:231] op_sel:[0,0,1] op_sel_hi:[1,0,1]
    v_pk_fma_f32 v[72:73], v[72:73], v[232:233], v[232:233] op_sel:[0,0,1] op_sel_hi:[1,0,1]
    v_pk_fma_f32 v[74:75], v[74:75], v[232:233], v[232:233] op_sel:[0,0,1] op_sel_hi:[1,0,1]
    v_pk_fma_f32 v[76:77], v[76:77], v[234:235], v[234:235] op_sel:[0,0,1] op_sel_hi:[1,0,1]
    v_pk_fma_f32 v[78:79], v[78:79], v[234:235], v[234:235] op_sel:[0,0,1] op_sel_hi:[1,0,1]
    v_cvt_pk_bf16_f32 v64, v64, v65
    v_cvt_pk_bf16_f32 v65, v66, v67
    v_cvt_pk_bf16_f32 v68, v68, v69
    v_cvt_pk_bf16_f32 v69, v70, v71
    v_cvt_pk_bf16_f32 v72, v72, v73
    v_cvt_pk_bf16_f32 v73, v74, v75
    v_cvt_pk_bf16_f32 v76, v76, v77
    v_cvt_pk_bf16_f32 v77, v78, v79
    buffer_store_dwordx2 v[64:65], v246, s[16:19], s60 offen offset:256
    buffer_store_dwordx2 v[68:69], v246, s[16:19], s61 offen offset:256
    buffer_store_dwordx2 v[72:73], v246, s[16:19], s62 offen offset:256
    buffer_store_dwordx2 v[76:77], v246, s[16:19], s63 offen offset:256
k1_kernel_O_done:
    s_endpgm
k1_kernel_O_sig:
    s_cmp_eq_u32 s56, 2
    s_cbranch_scc0 k1_kernel_O_sig1
    buffer_load_dword v253, v252, s[44:47], 0 offen sc1
    s_branch k1_kernel_O_sigd
k1_kernel_O_sig1:
    s_mov_b32 s56, 2
    v_mov_b32 v246, 1
    s_mov_b64 exec, 1
    buffer_atomic_add v246, off, s[44:47], s53 sc1
    s_mov_b64 exec, -1
    s_branch k1_kernel_O_sigd
k1_kernel_O_spin:
    s_mov_b32 s35, 0x40000
k1_kernel_O_spin1:
    buffer_load_dword v253, v252, s[44:47], 0 offen sc1
    s_waitcnt vmcnt(0)
    v_cmp_gt_u32 vcc, 32, v253
    s_sub_u32 s35, s35, 1
    s_cbranch_scc1 k1_kernel_O_spun
    s_cbranch_vccnz k1_kernel_O_spin1
    s_branch k1_kernel_O_spun
k1_kernel_O_cx:
    s_mov_b32 s35, 0x40000
k1_kernel_O_cx1:
    buffer_load_dwordx4 v[248:251], v252, s[16:19], s87 offen sc1
    s_waitcnt vmcnt(0)
    v_max3_u32 v209, v248, v249, v250
    v_max_u32 v209, v209, v251
    v_cmp_eq_u32 vcc, -1, v209
    s_sub_u32 s35, s35, 1
    s_cbranch_scc1 k1_kernel_O_cxd
    s_cbranch_vccnz k1_kernel_O_cx1
    s_branch k1_kernel_O_cxd
k1_kernel_end:
    s_endpgm
.globl k23_kernel
.p2align 8
.type k23_kernel,@function
k23_kernel:
    s_cmp_ge_u32 s2, 256
    s_cbranch_scc1 k23_kernel_end
    s_load_dwordx2 s[4:5], s[0:1], 80
    s_load_dwordx2 s[8:9], s[0:1], 40
    s_load_dwordx2 s[12:13], s[0:1], 48
    s_load_dwordx2 s[16:17], s[0:1], 0
    s_load_dwordx2 s[48:49], s[0:1], 16
    s_load_dwordx2 s[52:53], s[0:1], 56
    s_load_dwordx2 s[56:57], s[0:1], 64
    v_lshrrev_b32 v1, 6, v0
    v_and_b32 v191, 63, v0
    s_getpc_b64 s[94:95]
k23_kernel_pc0:
    v_and_b32 v227, 63, v0
    v_lshrrev_b32 v226, 6, v0
    v_min_u32 v227, 23, v227
    v_mad_u32_u24 v226, v226, 24, v227
    v_lshlrev_b32 v226, 7, v226
    v_mov_b32 v227, s95
    v_add_co_u32 v226, vcc, s94, v226
    v_addc_co_u32 v227, vcc, 0, v227, vcc
    global_load_dword v228, v[226:227], off
    s_mov_b32 s6, 268435456
    s_mov_b32 s7, 0x20000
    v_readfirstlane_b32 s21, v1
    s_mov_b32 s10, 8388608
    s_mov_b32 s11, 0x20000
    s_mov_b32 s14, 4096
    s_mov_b32 s15, 0x20000
    s_mov_b32 s18, 4194304
    s_mov_b32 s19, 0x20000
    s_mov_b32 s58, 4194304
    s_mov_b32 s59, 0x20000
    s_mov_b32 s50, 2097152
    s_mov_b32 s51, 0x20000
    s_mov_b32 s54, 3670016
    s_mov_b32 s55, 0x20000
    v_lshlrev_b32 v180, 4, v191
    v_add_u32 v181, 4096, v180
    s_lshr_b32 s30, s2, 3
    s_and_b32 s31, s2, 7
    s_and_b32 s32, s31, 3
    s_lshl_b32 s32, s32, 2
    s_and_b32 s33, s30, 3
    s_add_u32 s24, s32, s33
    s_lshr_b32 s32, s31, 2
    s_lshr_b32 s33, s30, 2
    s_lshl_b32 s34, s32, 3
    s_xor_b32 s35, s33, 4
    s_add_u32 s27, s34, s35
    s_mul_i32 s32, s32, 7
    s_add_u32 s25, s32, s33
    s_cmp_lt_u32 s30, 28
    s_cbranch_scc1 k23_kernel_main
    s_lshl_b32 s31, s31, 2
    s_add_u32 s37, s31, s30
    s_sub_u32 s37, s37, 28
    s_waitcnt lgkmcnt(0)
    s_mul_i32 s30, s37, 6144
    s_add_u32 s30, s30, 37748736
    buffer_load_dwordx4 v[24:27], v180, s[4:7], s30 offen offset:0
    buffer_load_dwordx4 v[28:31], v180, s[4:7], s30 offen offset:1024
    buffer_load_dwordx4 v[32:35], v180, s[4:7], s30 offen offset:2048
    buffer_load_dwordx4 v[36:39], v180, s[4:7], s30 offen offset:3072
    buffer_load_dwordx4 v[40:43], v181, s[4:7], s30 offen offset:0
    buffer_load_dwordx4 v[44:47], v181, s[4:7], s30 offen offset:1024
    s_add_u32 s30, s30, 196608
    buffer_load_dwordx4 v[48:51], v180, s[4:7], s30 offen offset:0
    buffer_load_dwordx4 v[52:55], v180, s[4:7], s30 offen offset:1024
    buffer_load_dwordx4 v[56:59], v180, s[4:7], s30 offen offset:2048
    buffer_load_dwordx4 v[60:63], v180, s[4:7], s30 offen offset:3072
    buffer_load_dwordx4 v[64:67], v181, s[4:7], s30 offen offset:0
    buffer_load_dwordx4 v[68:71], v181, s[4:7], s30 offen offset:1024
    s_add_u32 s30, s30, 196608
    buffer_load_dwordx4 v[72:75], v180, s[4:7], s30 offen offset:0
    buffer_load_dwordx4 v[76:79], v180, s[4:7], s30 offen offset:1024
    buffer_load_dwordx4 v[80:83], v180, s[4:7], s30 offen offset:2048
    buffer_load_dwordx4 v[84:87], v180, s[4:7], s30 offen offset:3072
    buffer_load_dwordx4 v[88:91], v181, s[4:7], s30 offen offset:0
    buffer_load_dwordx4 v[92:95], v181, s[4:7], s30 offen offset:1024
    s_add_u32 s30, s30, 196608
    buffer_load_dwordx4 v[96:99], v180, s[4:7], s30 offen offset:0
    buffer_load_dwordx4 v[100:103], v180, s[4:7], s30 offen offset:1024
    buffer_load_dwordx4 v[104:107], v180, s[4:7], s30 offen offset:2048
    buffer_load_dwordx4 v[108:111], v180, s[4:7], s30 offen offset:3072
    buffer_load_dwordx4 v[112:115], v181, s[4:7], s30 offen offset:0
    buffer_load_dwordx4 v[116:119], v181, s[4:7], s30 offen offset:1024
    s_add_u32 s30, s30, 196608
    s_waitcnt vmcnt(18)
    v_mov_b32 v0, v24
    v_mov_b32 v1, v25
    v_mov_b32 v2, v26
    v_mov_b32 v3, v27
    v_mov_b32 v4, v28
    v_mov_b32 v5, v29
    v_mov_b32 v6, v30
    v_mov_b32 v7, v31
    v_mov_b32 v8, v32
    v_mov_b32 v9, v33
    v_mov_b32 v10, v34
    v_mov_b32 v11, v35
    v_mov_b32 v12, v36
    v_mov_b32 v13, v37
    v_mov_b32 v14, v38
    v_mov_b32 v15, v39
    v_mov_b32 v16, v40
    v_mov_b32 v17, v41
    v_mov_b32 v18, v42
    v_mov_b32 v19, v43
    v_mov_b32 v20, v44
    v_mov_b32 v21, v45
    v_mov_b32 v22, v46
    v_mov_b32 v23, v47
    s_waitcnt vmcnt(12)
    v_pk_add_f32 v[0:1], v[0:1], v[48:49]
    v_pk_add_f32 v[2:3], v[2:3], v[50:51]
    v_pk_add_f32 v[4:5], v[4:5], v[52:53]
    v_pk_add_f32 v[6:7], v[6:7], v[54:55]
    v_pk_add_f32 v[8:9], v[8:9], v[56:57]
    v_pk_add_f32 v[10:11], v[10:11], v[58:59]
    v_pk_add_f32 v[12:13], v[12:13], v[60:61]
    v_pk_add_f32 v[14:15], v[14:15], v[62:63]
    v_pk_add_f32 v[16:17], v[16:17], v[64:65]
    v_pk_add_f32 v[18:19], v[18:19], v[66:67]
    v_pk_add_f32 v[20:21], v[20:21], v[68:69]
    v_pk_add_f32 v[22:23], v[22:23], v[70:71]
    s_waitcnt vmcnt(6)
    v_pk_add_f32 v[0:1], v[0:1], v[72:73]
    v_pk_add_f32 v[2:3], v[2:3], v[74:75]
    v_pk_add_f32 v[4:5], v[4:5], v[76:77]
    v_pk_add_f32 v[6:7], v[6:7], v[78:79]
    v_pk_add_f32 v[8:9], v[8:9], v[80:81]
    v_pk_add_f32 v[10:11], v[10:11], v[82:83]
    v_pk_add_f32 v[12:13], v[12:13], v[84:85]
    v_pk_add_f32 v[14:15], v[14:15], v[86:87]
    v_pk_add_f32 v[16:17], v[16:17], v[88:89]
    v_pk_add_f32 v[18:19], v[18:19], v[90:91]
    v_pk_add_f32 v[20:21], v[20:21], v[92:93]
    v_pk_add_f32 v[22:23], v[22:23], v[94:95]
    s_waitcnt vmcnt(0)
    v_pk_add_f32 v[0:1], v[0:1], v[96:97]
    v_pk_add_f32 v[2:3], v[2:3], v[98:99]
    v_pk_add_f32 v[4:5], v[4:5], v[100:101]
    v_pk_add_f32 v[6:7], v[6:7], v[102:103]
    v_pk_add_f32 v[8:9], v[8:9], v[104:105]
    v_pk_add_f32 v[10:11], v[10:11], v[106:107]
    v_pk_add_f32 v[12:13], v[12:13], v[108:109]
    v_pk_add_f32 v[14:15], v[14:15], v[110:111]
    v_pk_add_f32 v[16:17], v[16:17], v[112:113]
    v_pk_add_f32 v[18:19], v[18:19], v[114:115]
    v_pk_add_f32 v[20:21], v[20:21], v[116:117]
    v_pk_add_f32 v[22:23], v[22:23], v[118:119]
    buffer_load_dwordx4 v[24:27], v180, s[4:7], s30 offen offset:0
    buffer_load_dwordx4 v[28:31], v180, s[4:7], s30 offen offset:1024
    buffer_load_dwordx4 v[32:35], v180, s[4:7], s30 offen offset:2048
    buffer_load_dwordx4 v[36:39], v180, s[4:7], s30 offen offset:3072
    buffer_load_dwordx4 v[40:43], v181, s[4:7], s30 offen offset:0
    buffer_load_dwordx4 v[44:47], v181, s[4:7], s30 offen offset:1024
    s_add_u32 s30, s30, 196608
    buffer_load_dwordx4 v[48:51], v180, s[4:7], s30 offen offset:0
    buffer_load_dwordx4 v[52:55], v180, s[4:7], s30 offen offset:1024
    buffer_load_dwordx4 v[56:59], v180, s[4:7], s30 offen offset:2048
    buffer_load_dwordx4 v[60:63], v180, s[4:7], s30 offen offset:3072
    buffer_load_dwordx4 v[64:67], v181, s[4:7], s30 offen offset:0
    buffer_load_dwordx4 v[68:71], v181, s[4:7], s30 offen offset:1024
    s_add_u32 s30, s30, 196608
    buffer_load_dwordx4 v[72:75], v180, s[4:7], s30 offen offset:0
    buffer_load_dwordx4 v[76:79], v180, s[4:7], s30 offen offset:1024
    buffer_load_dwordx4 v[80:83], v180, s[4:7], s30 offen offset:2048
    buffer_load_dwordx4 v[84:87], v180, s[4:7], s30 offen offset:3072
    buffer_load_dwordx4 v[88:91], v181, s[4:7], s30 offen offset:0
    buffer_load_dwordx4 v[92:95], v181, s[4:7], s30 offen offset:1024
    s_add_u32 s30, s30, 196608
    buffer_load_dwordx4 v[96:99], v180, s[4:7], s30 offen offset:0
    buffer_load_dwordx4 v[100:103], v180, s[4:7], s30 offen offset:1024
    buffer_load_dwordx4 v[104:107], v180, s[4:7], s30 offen offset:2048
    buffer_load_dwordx4 v[108:111], v180, s[4:7], s30 offen offset:3072
    buffer_load_dwordx4 v[112:115], v181, s[4:7], s30 offen offset:0
    buffer_load_dwordx4 v[116:119], v181, s[4:7], s30 offen offset:1024
    s_add_u32 s30, s30, 196608
    s_waitcnt vmcnt(18)
    v_pk_add_f32 v[0:1], v[0:1], v[24:25]
    v_pk_add_f32 v[2:3], v[2:3], v[26:27]
    v_pk_add_f32 v[4:5], v[4:5], v[28:29]
    v_pk_add_f32 v[6:7], v[6:7], v[30:31]
    v_pk_add_f32 v[8:9], v[8:9], v[32:33]
    v_pk_add_f32 v[10:11], v[10:11], v[34:35]
    v_pk_add_f32 v[12:13], v[12:13], v[36:37]
    v_pk_add_f32 v[14:15], v[14:15], v[38:39]
    v_pk_add_f32 v[16:17], v[16:17], v[40:41]
    v_pk_add_f32 v[18:19], v[18:19], v[42:43]
    v_pk_add_f32 v[20:21], v[20:21], v[44:45]
    v_pk_add_f32 v[22:23], v[22:23], v[46:47]
    s_waitcnt vmcnt(12)
    v_pk_add_f32 v[0:1], v[0:1], v[48:49]
    v_pk_add_f32 v[2:3], v[2:3], v[50:51]
    v_pk_add_f32 v[4:5], v[4:5], v[52:53]
    v_pk_add_f32 v[6:7], v[6:7], v[54:55]
    v_pk_add_f32 v[8:9], v[8:9], v[56:57]
    v_pk_add_f32 v[10:11], v[10:11], v[58:59]
    v_pk_add_f32 v[12:13], v[12:13], v[60:61]
    v_pk_add_f32 v[14:15], v[14:15], v[62:63]
    v_pk_add_f32 v[16:17], v[16:17], v[64:65]
    v_pk_add_f32 v[18:19], v[18:19], v[66:67]
    v_pk_add_f32 v[20:21], v[20:21], v[68:69]
    v_pk_add_f32 v[22:23], v[22:23], v[70:71]
    s_waitcnt vmcnt(6)
    v_pk_add_f32 v[0:1], v[0:1], v[72:73]
    v_pk_add_f32 v[2:3], v[2:3], v[74:75]
    v_pk_add_f32 v[4:5], v[4:5], v[76:77]
    v_pk_add_f32 v[6:7], v[6:7], v[78:79]
    v_pk_add_f32 v[8:9], v[8:9], v[80:81]
    v_pk_add_f32 v[10:11], v[10:11], v[82:83]
    v_pk_add_f32 v[12:13], v[12:13], v[84:85]
    v_pk_add_f32 v[14:15], v[14:15], v[86:87]
    v_pk_add_f32 v[16:17], v[16:17], v[88:89]
    v_pk_add_f32 v[18:19], v[18:19], v[90:91]
    v_pk_add_f32 v[20:21], v[20:21], v[92:93]
    v_pk_add_f32 v[22:23], v[22:23], v[94:95]
    s_waitcnt vmcnt(0)
    v_pk_add_f32 v[0:1], v[0:1], v[96:97]
    v_pk_add_f32 v[2:3], v[2:3], v[98:99]
    v_pk_add_f32 v[4:5], v[4:5], v[100:101]
    v_pk_add_f32 v[6:7], v[6:7], v[102:103]
    v_pk_add_f32 v[8:9], v[8:9], v[104:105]
    v_pk_add_f32 v[10:11], v[10:11], v[106:107]
    v_pk_add_f32 v[12:13], v[12:13], v[108:109]
    v_pk_add_f32 v[14:15], v[14:15], v[110:111]
    v_pk_add_f32 v[16:17], v[16:17], v[112:113]
    v_pk_add_f32 v[18:19], v[18:19], v[114:115]
    v_pk_add_f32 v[20:21], v[20:21], v[116:117]
    v_pk_add_f32 v[22:23], v[22:23], v[118:119]
    v_cvt_pk_bf16_f32 v0, v0, v1
    v_cvt_pk_bf16_f32 v1, v2, v3
    v_cvt_pk_bf16_f32 v2, v12, v13
    v_cvt_pk_bf16_f32 v3, v14, v15
    v_cvt_pk_bf16_f32 v4, v4, v5
    v_cvt_pk_bf16_f32 v5, v6, v7
    v_cvt_pk_bf16_f32 v6, v16, v17
    v_cvt_pk_bf16_f32 v7, v18, v19
    v_cvt_pk_bf16_f32 v8, v8, v9
    v_cvt_pk_bf16_f32 v9, v10, v11
    v_cvt_pk_bf16_f32 v10, v20, v21
    v_cvt_pk_bf16_f32 v11, v22, v23
    s_lshl_b32 s30, s21, 20
    s_lshl_b32 s31, s37, 10
    s_add_u32 s30, s30, s31
    s_add_u32 s31, s30, 8388608
    s_add_u32 s30, s30, 4194304
    buffer_load_dwordx4 v[16:19], v180, s[4:7], s30 offen
    s_add_u32 s30, s30, 32768
    buffer_load_dwordx4 v[20:23], v180, s[4:7], s30 offen
    s_add_u32 s30, s30, 32768
    buffer_load_dwordx4 v[24:27], v180, s[4:7], s30 offen
    s_add_u32 s30, s30, 32768
    buffer_load_dwordx4 v[28:31], v180, s[4:7], s30 offen
    s_add_u32 s30, s30, 32768
    buffer_load_dwordx4 v[32:35], v180, s[4:7], s30 offen
    s_add_u32 s30, s30, 32768
    buffer_load_dwordx4 v[36:39], v180, s[4:7], s30 offen
    s_add_u32 s30, s30, 32768
    buffer_load_dwordx4 v[40:43], v180, s[4:7], s30 offen
    s_add_u32 s30, s30, 32768
    buffer_load_dwordx4 v[44:47], v180, s[4:7], s30 offen
    s_add_u32 s30, s30, 32768
    buffer_load_dwordx4 v[48:51], v180, s[4:7], s30 offen
    s_add_u32 s30, s30, 32768
    buffer_load_dwordx4 v[52:55], v180, s[4:7], s30 offen
    s_add_u32 s30, s30, 32768
    buffer_load_dwordx4 v[56:59], v180, s[4:7], s30 offen
    s_add_u32 s30, s30, 32768
    buffer_load_dwordx4 v[60:63], v180, s[4:7], s30 offen
    s_add_u32 s30, s30, 32768
    buffer_load_dwordx4 v[64:67], v180, s[4:7], s30 offen
    s_add_u32 s30, s30, 32768
    buffer_load_dwordx4 v[68:71], v180, s[4:7], s30 offen
    s_add_u32 s30, s30, 32768
    buffer_load_dwordx4 v[72:75], v180, s[4:7], s30 offen
    s_add_u32 s30, s30, 32768
    buffer_load_dwordx4 v[76:79], v180, s[4:7], s30 offen
    s_add_u32 s30, s30, 32768
    s_waitcnt vmcnt(8)
    v_mfma_f32_16x16x32_bf16 v[80:83], v[0:3], v[16:19], 0
    v_mfma_f32_16x16x32_bf16 v[84:87], v[4:7], v[16:19], 0
    v_mfma_f32_16x16x32_bf16 v[88:91], v[8:11], v[16:19], 0
    v_mfma_f32_16x16x32_bf16 v[92:95], v[0:3], v[20:23], 0
    v_mfma_f32_16x16x32_bf16 v[96:99], v[4:7], v[20:23], 0
    v_mfma_f32_16x16x32_bf16 v[100:103], v[8:11], v[20:23], 0
    v_mfma_f32_16x16x32_bf16 v[104:107], v[0:3], v[24:27], 0
    v_mfma_f32_16x16x32_bf16 v[108:111], v[4:7], v[24:27], 0
    v_mfma_f32_16x16x32_bf16 v[112:115], v[8:11], v[24:27], 0
    v_mfma_f32_16x16x32_bf16 v[116:119], v[0:3], v[28:31], 0
    v_mfma_f32_16x16x32_bf16 v[120:123], v[4:7], v[28:31], 0
    v_mfma_f32_16x16x32_bf16 v[124:127], v[8:11], v[28:31], 0
    v_mfma_f32_16x16x32_bf16 v[128:131], v[0:3], v[32:35], 0
    v_mfma_f32_16x16x32_bf16 v[132:135], v[4:7], v[32:35], 0
    v_mfma_f32_16x16x32_bf16 v[136:139], v[8:11], v[32:35], 0
    v_mfma_f32_16x16x32_bf16 v[140:143], v[0:3], v[36:39], 0
    v_mfma_f32_16x16x32_bf16 v[144:147], v[4:7], v[36:39], 0
    v_mfma_f32_16x16x32_bf16 v[148:151], v[8:11], v[36:39], 0
    v_mfma_f32_16x16x32_bf16 v[152:155], v[0:3], v[40:43], 0
    v_mfma_f32_16x16x32_bf16 v[156:159], v[4:7], v[40:43], 0
    v_mfma_f32_16x16x32_bf16 v[160:163], v[8:11], v[40:43], 0
    v_mfma_f32_16x16x32_bf16 v[164:167], v[0:3], v[44:47], 0
    v_mfma_f32_16x16x32_bf16 v[168:171], v[4:7], v[44:47], 0
    v_mfma_f32_16x16x32_bf16 v[172:175], v[8:11], v[44:47], 0
    s_nop 7
    v_add_f32 v88, 0x358637bd, v88
    v_add_f32 v100, 0x358637bd, v100
    v_add_f32 v112, 0x358637bd, v112
    v_add_f32 v124, 0x358637bd, v124
    v_add_f32 v136, 0x358637bd, v136
    v_add_f32 v148, 0x358637bd, v148
    v_add_f32 v160, 0x358637bd, v160
    v_add_f32 v172, 0x358637bd, v172
    v_rcp_f32 v88, v88
    v_rcp_f32 v100, v100
    v_rcp_f32 v112, v112
    v_rcp_f32 v124, v124
    v_rcp_f32 v136, v136
    v_rcp_f32 v148, v148
    v_rcp_f32 v160, v160
    v_rcp_f32 v172, v172
    v_pk_mul_f32 v[80:81], v[80:81], v[88:89] op_sel_hi:[1,0]
    v_pk_mul_f32 v[82:83], v[82:83], v[88:89] op_sel_hi:[1,0]
    v_pk_mul_f32 v[84:85], v[84:85], v[88:89] op_sel_hi:[1,0]
    v_pk_mul_f32 v[86:87], v[86:87], v[88:89] op_sel_hi:[1,0]
    v_cvt_pk_bf16_f32 v80, v80, v81
    v_cvt_pk_bf16_f32 v81, v82, v83
    v_cvt_pk_bf16_f32 v82, v84, v85
    v_cvt_pk_bf16_f32 v83, v86, v87
    buffer_store_dwordx4 v[80:83], v180, s[4:7], s31 offen sc1
    s_add_u32 s31, s31, 32768
    v_pk_mul_f32 v[92:93], v[92:93], v[100:101] op_sel_hi:[1,0]
    v_pk_mul_f32 v[94:95], v[94:95], v[100:101] op_sel_hi:[1,0]
    v_pk_mul_f32 v[96:97], v[96:97], v[100:101] op_sel_hi:[1,0]
    v_pk_mul_f32 v[98:99], v[98:99], v[100:101] op_sel_hi:[1,0]
    v_cvt_pk_bf16_f32 v92, v92, v93
    v_cvt_pk_bf16_f32 v93, v94, v95
    v_cvt_pk_bf16_f32 v94, v96, v97
    v_cvt_pk_bf16_f32 v95, v98, v99
    buffer_store_dwordx4 v[92:95], v180, s[4:7], s31 offen sc1
    s_add_u32 s31, s31, 32768
    v_pk_mul_f32 v[104:105], v[104:105], v[112:113] op_sel_hi:[1,0]
    v_pk_mul_f32 v[106:107], v[106:107], v[112:113] op_sel_hi:[1,0]
    v_pk_mul_f32 v[108:109], v[108:109], v[112:113] op_sel_hi:[1,0]
    v_pk_mul_f32 v[110:111], v[110:111], v[112:113] op_sel_hi:[1,0]
    v_cvt_pk_bf16_f32 v104, v104, v105
    v_cvt_pk_bf16_f32 v105, v106, v107
    v_cvt_pk_bf16_f32 v106, v108, v109
    v_cvt_pk_bf16_f32 v107, v110, v111
    buffer_store_dwordx4 v[104:107], v180, s[4:7], s31 offen sc1
    s_add_u32 s31, s31, 32768
    v_pk_mul_f32 v[116:117], v[116:117], v[124:125] op_sel_hi:[1,0]
    v_pk_mul_f32 v[118:119], v[118:119], v[124:125] op_sel_hi:[1,0]
    v_pk_mul_f32 v[120:121], v[120:121], v[124:125] op_sel_hi:[1,0]
    v_pk_mul_f32 v[122:123], v[122:123], v[124:125] op_sel_hi:[1,0]
    v_cvt_pk_bf16_f32 v116, v116, v117
    v_cvt_pk_bf16_f32 v117, v118, v119
    v_cvt_pk_bf16_f32 v118, v120, v121
    v_cvt_pk_bf16_f32 v119, v122, v123
    buffer_store_dwordx4 v[116:119], v180, s[4:7], s31 offen sc1
    s_add_u32 s31, s31, 32768
    v_pk_mul_f32 v[128:129], v[128:129], v[136:137] op_sel_hi:[1,0]
    v_pk_mul_f32 v[130:131], v[130:131], v[136:137] op_sel_hi:[1,0]
    v_pk_mul_f32 v[132:133], v[132:133], v[136:137] op_sel_hi:[1,0]
    v_pk_mul_f32 v[134:135], v[134:135], v[136:137] op_sel_hi:[1,0]
    v_cvt_pk_bf16_f32 v128, v128, v129
    v_cvt_pk_bf16_f32 v129, v130, v131
    v_cvt_pk_bf16_f32 v130, v132, v133
    v_cvt_pk_bf16_f32 v131, v134, v135
    buffer_store_dwordx4 v[128:131], v180, s[4:7], s31 offen sc1
    s_add_u32 s31, s31, 32768
    v_pk_mul_f32 v[140:141], v[140:141], v[148:149] op_sel_hi:[1,0]
    v_pk_mul_f32 v[142:143], v[142:143], v[148:149] op_sel_hi:[1,0]
    v_pk_mul_f32 v[144:145], v[144:145], v[148:149] op_sel_hi:[1,0]
    v_pk_mul_f32 v[146:147], v[146:147], v[148:149] op_sel_hi:[1,0]
    v_cvt_pk_bf16_f32 v140, v140, v141
    v_cvt_pk_bf16_f32 v141, v142, v143
    v_cvt_pk_bf16_f32 v142, v144, v145
    v_cvt_pk_bf16_f32 v143, v146, v147
    buffer_store_dwordx4 v[140:143], v180, s[4:7], s31 offen sc1
    s_add_u32 s31, s31, 32768
    v_pk_mul_f32 v[152:153], v[152:153], v[160:161] op_sel_hi:[1,0]
    v_pk_mul_f32 v[154:155], v[154:155], v[160:161] op_sel_hi:[1,0]
    v_pk_mul_f32 v[156:157], v[156:157], v[160:161] op_sel_hi:[1,0]
    v_pk_mul_f32 v[158:159], v[158:159], v[160:161] op_sel_hi:[1,0]
    v_cvt_pk_bf16_f32 v152, v152, v153
    v_cvt_pk_bf16_f32 v153, v154, v155
    v_cvt_pk_bf16_f32 v154, v156, v157
    v_cvt_pk_bf16_f32 v155, v158, v159
    buffer_store_dwordx4 v[152:155], v180, s[4:7], s31 offen sc1
    s_add_u32 s31, s31, 32768
    v_pk_mul_f32 v[164:165], v[164:165], v[172:173] op_sel_hi:[1,0]
    v_pk_mul_f32 v[166:167], v[166:167], v[172:173] op_sel_hi:[1,0]
    v_pk_mul_f32 v[168:169], v[168:169], v[172:173] op_sel_hi:[1,0]
    v_pk_mul_f32 v[170:171], v[170:171], v[172:173] op_sel_hi:[1,0]
    v_cvt_pk_bf16_f32 v164, v164, v165
    v_cvt_pk_bf16_f32 v165, v166, v167
    v_cvt_pk_bf16_f32 v166, v168, v169
    v_cvt_pk_bf16_f32 v167, v170, v171
    buffer_store_dwordx4 v[164:167], v180, s[4:7], s31 offen sc1
    s_add_u32 s31, s31, 32768
    s_nop 1
    buffer_load_dwordx4 v[16:19], v180, s[4:7], s30 offen
    s_add_u32 s30, s30, 32768
    buffer_load_dwordx4 v[20:23], v180, s[4:7], s30 offen
    s_add_u32 s30, s30, 32768
    buffer_load_dwordx4 v[24:27], v180, s[4:7], s30 offen
    s_add_u32 s30, s30, 32768
    buffer_load_dwordx4 v[28:31], v180, s[4:7], s30 offen
    s_add_u32 s30, s30, 32768
    buffer_load_dwordx4 v[32:35], v180, s[4:7], s30 offen
    s_add_u32 s30, s30, 32768
    buffer_load_dwordx4 v[36:39], v180, s[4:7], s30 offen
    s_add_u32 s30, s30, 32768
    buffer_load_dwordx4 v[40:43], v180, s[4:7], s30 offen
    s_add_u32 s30, s30, 32768
    buffer_load_dwordx4 v[44:47], v180, s[4:7], s30 offen
    s_add_u32 s30, s30, 32768
    s_waitcnt vmcnt(16)
    v_mfma_f32_16x16x32_bf16 v[80:83], v[0:3], v[48:51], 0
    v_mfma_f32_16x16x32_bf16 v[84:87], v[4:7], v[48:51], 0
    v_mfma_f32_16x16x32_bf16 v[88:91], v[8:11], v[48:51], 0
    v_mfma_f32_16x16x32_bf16 v[92:95], v[0:3], v[52:55], 0
    v_mfma_f32_16x16x32_bf16 v[96:99], v[4:7], v[52:55], 0
    v_mfma_f32_16x16x32_bf16 v[100:103], v[8:11], v[52:55], 0
    v_mfma_f32_16x16x32_bf16 v[104:107], v[0:3], v[56:59], 0
    v_mfma_f32_16x16x32_bf16 v[108:111], v[4:7], v[56:59], 0
    v_mfma_f32_16x16x32_bf16 v[112:115], v[8:11], v[56:59], 0
    v_mfma_f32_16x16x32_bf16 v[116:119], v[0:3], v[60:63], 0
    v_mfma_f32_16x16x32_bf16 v[120:123], v[4:7], v[60:63], 0
    v_mfma_f32_16x16x32_bf16 v[124:127], v[8:11], v[60:63], 0
    v_mfma_f32_16x16x32_bf16 v[128:131], v[0:3], v[64:67], 0
    v_mfma_f32_16x16x32_bf16 v[132:135], v[4:7], v[64:67], 0
    v_mfma_f32_16x16x32_bf16 v[136:139], v[8:11], v[64:67], 0
    v_mfma_f32_16x16x32_bf16 v[140:143], v[0:3], v[68:71], 0
    v_mfma_f32_16x16x32_bf16 v[144:147], v[4:7], v[68:71], 0
    v_mfma_f32_16x16x32_bf16 v[148:151], v[8:11], v[68:71], 0
    v_mfma_f32_16x16x32_bf16 v[152:155], v[0:3], v[72:75], 0
    v_mfma_f32_16x16x32_bf16 v[156:159], v[4:7], v[72:75], 0
    v_mfma_f32_16x16x32_bf16 v[160:163], v[8:11], v[72:75], 0
    v_mfma_f32_16x16x32_bf16 v[164:167], v[0:3], v[76:79], 0
    v_mfma_f32_16x16x32_bf16 v[168:171], v[4:7], v[76:79], 0
    v_mfma_f32_16x16x32_bf16 v[172:175], v[8:11], v[76:79], 0
    s_nop 7
    v_add_f32 v88, 0x358637bd, v88
    v_add_f32 v100, 0x358637bd, v100
    v_add_f32 v112, 0x358637bd, v112
    v_add_f32 v124, 0x358637bd, v124
    v_add_f32 v136, 0x358637bd, v136
    v_add_f32 v148, 0x358637bd, v148
    v_add_f32 v160, 0x358637bd, v160
    v_add_f32 v172, 0x358637bd, v172
    v_rcp_f32 v88, v88
    v_rcp_f32 v100, v100
    v_rcp_f32 v112, v112
    v_rcp_f32 v124, v124
    v_rcp_f32 v136, v136
    v_rcp_f32 v148, v148
    v_rcp_f32 v160, v160
    v_rcp_f32 v172, v172
    v_pk_mul_f32 v[80:81], v[80:81], v[88:89] op_sel_hi:[1,0]
    v_pk_mul_f32 v[82:83], v[82:83], v[88:89] op_sel_hi:[1,0]
    v_pk_mul_f32 v[84:85], v[84:85], v[88:89] op_sel_hi:[1,0]
    v_pk_mul_f32 v[86:87], v[86:87], v[88:89] op_sel_hi:[1,0]
    v_cvt_pk_bf16_f32 v80, v80, v81
    v_cvt_pk_bf16_f32 v81, v82, v83
    v_cvt_pk_bf16_f32 v82, v84, v85
    v_cvt_pk_bf16_f32 v83, v86, v87
    buffer_store_dwordx4 v[80:83], v180, s[4:7], s31 offen sc1
    s_add_u32 s31, s31, 32768
    v_pk_mul_f32 v[92:93], v[92:93], v[100:101] op_sel_hi:[1,0]
    v_pk_mul_f32 v[94:95], v[94:95], v[100:101] op_sel_hi:[1,0]
    v_pk_mul_f32 v[96:97], v[96:97], v[100:101] op_sel_hi:[1,0]
    v_pk_mul_f32 v[98:99], v[98:99], v[100:101] op_sel_hi:[1,0]
    v_cvt_pk_bf16_f32 v92, v92, v93
    v_cvt_pk_bf16_f32 v93, v94, v95
    v_cvt_pk_bf16_f32 v94, v96, v97
    v_cvt_pk_bf16_f32 v95, v98, v99
    buffer_store_dwordx4 v[92:95], v180, s[4:7], s31 offen sc1
    s_add_u32 s31, s31, 32768
    v_pk_mul_f32 v[104:105], v[104:105], v[112:113] op_sel_hi:[1,0]
    v_pk_mul_f32 v[106:107], v[106:107], v[112:113] op_sel_hi:[1,0]
    v_pk_mul_f32 v[108:109], v[108:109], v[112:113] op_sel_hi:[1,0]
    v_pk_mul_f32 v[110:111], v[110:111], v[112:113] op_sel_hi:[1,0]
    v_cvt_pk_bf16_f32 v104, v104, v105
    v_cvt_pk_bf16_f32 v105, v106, v107
    v_cvt_pk_bf16_f32 v106, v108, v109
    v_cvt_pk_bf16_f32 v107, v110, v111
    buffer_store_dwordx4 v[104:107], v180, s[4:7], s31 offen sc1
    s_add_u32 s31, s31, 32768
    v_pk_mul_f32 v[116:117], v[116:117], v[124:125] op_sel_hi:[1,0]
    v_pk_mul_f32 v[118:119], v[118:119], v[124:125] op_sel_hi:[1,0]
    v_pk_mul_f32 v[120:121], v[120:121], v[124:125] op_sel_hi:[1,0]
    v_pk_mul_f32 v[122:123], v[122:123], v[124:125] op_sel_hi:[1,0]
    v_cvt_pk_bf16_f32 v116, v116, v117
    v_cvt_pk_bf16_f32 v117, v118, v119
    v_cvt_pk_bf16_f32 v118, v120, v121
    v_cvt_pk_bf16_f32 v119, v122, v123
    buffer_store_dwordx4 v[116:119], v180, s[4:7], s31 offen sc1
    s_add_u32 s31, s31, 32768
    v_pk_mul_f32 v[128:129], v[128:129], v[136:137] op_sel_hi:[1,0]
    v_pk_mul_f32 v[130:131], v[130:131], v[136:137] op_sel_hi:[1,0]
    v_pk_mul_f32 v[132:133], v[132:133], v[136:137] op_sel_hi:[1,0]
    v_pk_mul_f32 v[134:135], v[134:135], v[136:137] op_sel_hi:[1,0]
    v_cvt_pk_bf16_f32 v128, v128, v129
    v_cvt_pk_bf16_f32 v129, v130, v131
    v_cvt_pk_bf16_f32 v130, v132, v133
    v_cvt_pk_bf16_f32 v131, v134, v135
    buffer_store_dwordx4 v[128:131], v180, s[4:7], s31 offen sc1
    s_add_u32 s31, s31, 32768
    v_pk_mul_f32 v[140:141], v[140:141], v[148:149] op_sel_hi:[1,0]
    v_pk_mul_f32 v[142:143], v[142:143], v[148:149] op_sel_hi:[1,0]
    v_pk_mul_f32 v[144:145], v[144:145], v[148:149] op_sel_hi:[1,0]
    v_pk_mul_f32 v[146:147], v[146:147], v[148:149] op_sel_hi:[1,0]
    v_cvt_pk_bf16_f32 v140, v140, v141
    v_cvt_pk_bf16_f32 v141, v142, v143
    v_cvt_pk_bf16_f32 v142, v144, v145
    v_cvt_pk_bf16_f32 v143, v146, v147
    buffer_store_dwordx4 v[140:143], v180, s[4:7], s31 offen sc1
    s_add_u32 s31, s31, 32768
    v_pk_mul_f32 v[152:153], v[152:153], v[160:161] op_sel_hi:[1,0]
    v_pk_mul_f32 v[154:155], v[154:155], v[160:161] op_sel_hi:[1,0]
    v_pk_mul_f32 v[156:157], v[156:157], v[160:161] op_sel_hi:[1,0]
    v_pk_mul_f32 v[158:159], v[158:159], v[160:161] op_sel_hi:[1,0]
    v_cvt_pk_bf16_f32 v152, v152, v153
    v_cvt_pk_bf16_f32 v153, v154, v155
    v_cvt_pk_bf16_f32 v154, v156, v157
    v_cvt_pk_bf16_f32 v155, v158, v159
    buffer_store_dwordx4 v[152:155], v180, s[4:7], s31 offen sc1
    s_add_u32 s31, s31, 32768
    v_pk_mul_f32 v[164:165], v[164:165], v[172:173] op_sel_hi:[1,0]
    v_pk_mul_f32 v[166:167], v[166:167], v[172:173] op_sel_hi:[1,0]
    v_pk_mul_f32 v[168:169], v[168:169], v[172:173] op_sel_hi:[1,0]
    v_pk_mul_f32 v[170:171], v[170:171], v[172:173] op_sel_hi:[1,0]
    v_cvt_pk_bf16_f32 v164, v164, v165
    v_cvt_pk_bf16_f32 v165, v166, v167
    v_cvt_pk_bf16_f32 v166, v168, v169
    v_cvt_pk_bf16_f32 v167, v170, v171
    buffer_store_dwordx4 v[164:167], v180, s[4:7], s31 offen sc1
    s_add_u32 s31, s31, 32768
    s_nop 1
    buffer_load_dwordx4 v[48:51], v180, s[4:7], s30 offen
    s_add_u32 s30, s30, 32768
    buffer_load_dwordx4 v[52:55], v180, s[4:7], s30 offen
    s_add_u32 s30, s30, 32768
    buffer_load_dwordx4 v[56:59], v180, s[4:7], s30 offen
    s_add_u32 s30, s30, 32768
    buffer_load_dwordx4 v[60:63], v180, s[4:7], s30 offen
    s_add_u32 s30, s30, 32768
    buffer_load_dwordx4 v[64:67], v180, s[4:7], s30 offen
    s_add_u32 s30, s30, 32768
    buffer_load_dwordx4 v[68:71], v180, s[4:7], s30 offen
    s_add_u32 s30, s30, 32768
    buffer_load_dwordx4 v[72:75], v180, s[4:7], s30 offen
    s_add_u32 s30, s30, 32768
    buffer_load_dwordx4 v[76:79], v180, s[4:7], s30 offen
    s_add_u32 s30, s30, 32768
    s_waitcnt vmcnt(16)
    v_mfma_f32_16x16x32_bf16 v[80:83], v[0:3], v[16:19], 0
    v_mfma_f32_16x16x32_bf16 v[84:87], v[4:7], v[16:19], 0
    v_mfma_f32_16x16x32_bf16 v[88:91], v[8:11], v[16:19], 0
    v_mfma_f32_16x16x32_bf16 v[92:95], v[0:3], v[20:23], 0
    v_mfma_f32_16x16x32_bf16 v[96:99], v[4:7], v[20:23], 0
    v_mfma_f32_16x16x32_bf16 v[100:103], v[8:11], v[20:23], 0
    v_mfma_f32_16x16x32_bf16 v[104:107], v[0:3], v[24:27], 0
    v_mfma_f32_16x16x32_bf16 v[108:111], v[4:7], v[24:27], 0
    v_mfma_f32_16x16x32_bf16 v[112:115], v[8:11], v[24:27], 0
    v_mfma_f32_16x16x32_bf16 v[116:119], v[0:3], v[28:31], 0
    v_mfma_f32_16x16x32_bf16 v[120:123], v[4:7], v[28:31], 0
    v_mfma_f32_16x16x32_bf16 v[124:127], v[8:11], v[28:31], 0
    v_mfma_f32_16x16x32_bf16 v[128:131], v[0:3], v[32:35], 0
    v_mfma_f32_16x16x32_bf16 v[132:135], v[4:7], v[32:35], 0
    v_mfma_f32_16x16x32_bf16 v[136:139], v[8:11], v[32:35], 0
    v_mfma_f32_16x16x32_bf16 v[140:143], v[0:3], v[36:39], 0
    v_mfma_f32_16x16x32_bf16 v[144:147], v[4:7], v[36:39], 0
    v_mfma_f32_16x16x32_bf16 v[148:151], v[8:11], v[36:39], 0
    v_mfma_f32_16x16x32_bf16 v[152:155], v[0:3], v[40:43], 0
    v_mfma_f32_16x16x32_bf16 v[156:159], v[4:7], v[40:43], 0
    v_mfma_f32_16x16x32_bf16 v[160:163], v[8:11], v[40:43], 0
    v_mfma_f32_16x16x32_bf16 v[164:167], v[0:3], v[44:47], 0
    v_mfma_f32_16x16x32_bf16 v[168:171], v[4:7], v[44:47], 0
    v_mfma_f32_16x16x32_bf16 v[172:175], v[8:11], v[44:47], 0
    s_nop 7
    v_add_f32 v88, 0x358637bd, v88
    v_add_f32 v100, 0x358637bd, v100
    v_add_f32 v112, 0x358637bd, v112
    v_add_f32 v124, 0x358637bd, v124
    v_add_f32 v136, 0x358637bd, v136
    v_add_f32 v148, 0x358637bd, v148
    v_add_f32 v160, 0x358637bd, v160
    v_add_f32 v172, 0x358637bd, v172
    v_rcp_f32 v88, v88
    v_rcp_f32 v100, v100
    v_rcp_f32 v112, v112
    v_rcp_f32 v124, v124
    v_rcp_f32 v136, v136
    v_rcp_f32 v148, v148
    v_rcp_f32 v160, v160
    v_rcp_f32 v172, v172
    v_pk_mul_f32 v[80:81], v[80:81], v[88:89] op_sel_hi:[1,0]
    v_pk_mul_f32 v[82:83], v[82:83], v[88:89] op_sel_hi:[1,0]
    v_pk_mul_f32 v[84:85], v[84:85], v[88:89] op_sel_hi:[1,0]
    v_pk_mul_f32 v[86:87], v[86:87], v[88:89] op_sel_hi:[1,0]
    v_cvt_pk_bf16_f32 v80, v80, v81
    v_cvt_pk_bf16_f32 v81, v82, v83
    v_cvt_pk_bf16_f32 v82, v84, v85
    v_cvt_pk_bf16_f32 v83, v86, v87
    buffer_store_dwordx4 v[80:83], v180, s[4:7], s31 offen sc1
    s_add_u32 s31, s31, 32768
    v_pk_mul_f32 v[92:93], v[92:93], v[100:101] op_sel_hi:[1,0]
    v_pk_mul_f32 v[94:95], v[94:95], v[100:101] op_sel_hi:[1,0]
    v_pk_mul_f32 v[96:97], v[96:97], v[100:101] op_sel_hi:[1,0]
    v_pk_mul_f32 v[98:99], v[98:99], v[100:101] op_sel_hi:[1,0]
    v_cvt_pk_bf16_f32 v92, v92, v93
    v_cvt_pk_bf16_f32 v93, v94, v95
    v_cvt_pk_bf16_f32 v94, v96, v97
    v_cvt_pk_bf16_f32 v95, v98, v99
    buffer_store_dwordx4 v[92:95], v180, s[4:7], s31 offen sc1
    s_add_u32 s31, s31, 32768
    v_pk_mul_f32 v[104:105], v[104:105], v[112:113] op_sel_hi:[1,0]
    v_pk_mul_f32 v[106:107], v[106:107], v[112:113] op_sel_hi:[1,0]
    v_pk_mul_f32 v[108:109], v[108:109], v[112:113] op_sel_hi:[1,0]
    v_pk_mul_f32 v[110:111], v[110:111], v[112:113] op_sel_hi:[1,0]
    v_cvt_pk_bf16_f32 v104, v104, v105
    v_cvt_pk_bf16_f32 v105, v106, v107
    v_cvt_pk_bf16_f32 v106, v108, v109
    v_cvt_pk_bf16_f32 v107, v110, v111
    buffer_store_dwordx4 v[104:107], v180, s[4:7], s31 offen sc1
    s_add_u32 s31, s31, 32768
    v_pk_mul_f32 v[116:117], v[116:117], v[124:125] op_sel_hi:[1,0]
    v_pk_mul_f32 v[118:119], v[118:119], v[124:125] op_sel_hi:[1,0]
    v_pk_mul_f32 v[120:121], v[120:121], v[124:125] op_sel_hi:[1,0]
    v_pk_mul_f32 v[122:123], v[122:123], v[124:125] op_sel_hi:[1,0]
    v_cvt_pk_bf16_f32 v116, v116, v117
    v_cvt_pk_bf16_f32 v117, v118, v119
    v_cvt_pk_bf16_f32 v118, v120, v121
    v_cvt_pk_bf16_f32 v119, v122, v123
    buffer_store_dwordx4 v[116:119], v180, s[4:7], s31 offen sc1
    s_add_u32 s31, s31, 32768
    v_pk_mul_f32 v[128:129], v[128:129], v[136:137] op_sel_hi:[1,0]
    v_pk_mul_f32 v[130:131], v[130:131], v[136:137] op_sel_hi:[1,0]
    v_pk_mul_f32 v[132:133], v[132:133], v[136:137] op_sel_hi:[1,0]
    v_pk_mul_f32 v[134:135], v[134:135], v[136:137] op_sel_hi:[1,0]
    v_cvt_pk_bf16_f32 v128, v128, v129
    v_cvt_pk_bf16_f32 v129, v130, v131
    v_cvt_pk_bf16_f32 v130, v132, v133
    v_cvt_pk_bf16_f32 v131, v134, v135
    buffer_store_dwordx4 v[128:131], v180, s[4:7], s31 offen sc1
    s_add_u32 s31, s31, 32768
    v_pk_mul_f32 v[140:141], v[140:141], v[148:149] op_sel_hi:[1,0]
    v_pk_mul_f32 v[142:143], v[142:143], v[148:149] op_sel_hi:[1,0]
    v_pk_mul_f32 v[144:145], v[144:145], v[148:149] op_sel_hi:[1,0]
    v_pk_mul_f32 v[146:147], v[146:147], v[148:149] op_sel_hi:[1,0]
    v_cvt_pk_bf16_f32 v140, v140, v141
    v_cvt_pk_bf16_f32 v141, v142, v143
    v_cvt_pk_bf16_f32 v142, v144, v145
    v_cvt_pk_bf16_f32 v143, v146, v147
    buffer_store_dwordx4 v[140:143], v180, s[4:7], s31 offen sc1
    s_add_u32 s31, s31, 32768
    v_pk_mul_f32 v[152:153], v[152:153], v[160:161] op_sel_hi:[1,0]
    v_pk_mul_f32 v[154:155], v[154:155], v[160:161] op_sel_hi:[1,0]
    v_pk_mul_f32 v[156:157], v[156:157], v[160:161] op_sel_hi:[1,0]
    v_pk_mul_f32 v[158:159], v[158:159], v[160:161] op_sel_hi:[1,0]
    v_cvt_pk_bf16_f32 v152, v152, v153
    v_cvt_pk_bf16_f32 v153, v154, v155
    v_cvt_pk_bf16_f32 v154, v156, v157
    v_cvt_pk_bf16_f32 v155, v158, v159
    buffer_store_dwordx4 v[152:155], v180, s[4:7], s31 offen sc1
    s_add_u32 s31, s31, 32768
    v_pk_mul_f32 v[164:165], v[164:165], v[172:173] op_sel_hi:[1,0]
    v_pk_mul_f32 v[166:167], v[166:167], v[172:173] op_sel_hi:[1,0]
    v_pk_mul_f32 v[168:169], v[168:169], v[172:173] op_sel_hi:[1,0]
    v_pk_mul_f32 v[170:171], v[170:171], v[172:173] op_sel_hi:[1,0]
    v_cvt_pk_bf16_f32 v164, v164, v165
    v_cvt_pk_bf16_f32 v165, v166, v167
    v_cvt_pk_bf16_f32 v166, v168, v169
    v_cvt_pk_bf16_f32 v167, v170, v171
    buffer_store_dwordx4 v[164:167], v180, s[4:7], s31 offen sc1
    s_add_u32 s31, s31, 32768
    s_nop 1
    s_waitcnt vmcnt(8)
    v_mfma_f32_16x16x32_bf16 v[80:83], v[0:3], v[48:51], 0
    v_mfma_f32_16x16x32_bf16 v[84:87], v[4:7], v[48:51], 0
    v_mfma_f32_16x16x32_bf16 v[88:91], v[8:11], v[48:51], 0
    v_mfma_f32_16x16x32_bf16 v[92:95], v[0:3], v[52:55], 0
    v_mfma_f32_16x16x32_bf16 v[96:99], v[4:7], v[52:55], 0
    v_mfma_f32_16x16x32_bf16 v[100:103], v[8:11], v[52:55], 0
    v_mfma_f32_16x16x32_bf16 v[104:107], v[0:3], v[56:59], 0
    v_mfma_f32_16x16x32_bf16 v[108:111], v[4:7], v[56:59], 0
    v_mfma_f32_16x16x32_bf16 v[112:115], v[8:11], v[56:59], 0
    v_mfma_f32_16x16x32_bf16 v[116:119], v[0:3], v[60:63], 0
    v_mfma_f32_16x16x32_bf16 v[120:123], v[4:7], v[60:63], 0
    v_mfma_f32_16x16x32_bf16 v[124:127], v[8:11], v[60:63], 0
    v_mfma_f32_16x16x32_bf16 v[128:131], v[0:3], v[64:67], 0
    v_mfma_f32_16x16x32_bf16 v[132:135], v[4:7], v[64:67], 0
    v_mfma_f32_16x16x32_bf16 v[136:139], v[8:11], v[64:67], 0
    v_mfma_f32_16x16x32_bf16 v[140:143], v[0:3], v[68:71], 0
    v_mfma_f32_16x16x32_bf16 v[144:147], v[4:7], v[68:71], 0
    v_mfma_f32_16x16x32_bf16 v[148:151], v[8:11], v[68:71], 0
    v_mfma_f32_16x16x32_bf16 v[152:155], v[0:3], v[72:75], 0
    v_mfma_f32_16x16x32_bf16 v[156:159], v[4:7], v[72:75], 0
    v_mfma_f32_16x16x32_bf16 v[160:163], v[8:11], v[72:75], 0
    v_mfma_f32_16x16x32_bf16 v[164:167], v[0:3], v[76:79], 0
    v_mfma_f32_16x16x32_bf16 v[168:171], v[4:7], v[76:79], 0
    v_mfma_f32_16x16x32_bf16 v[172:175], v[8:11], v[76:79], 0
    s_nop 7
    v_add_f32 v88, 0x358637bd, v88
    v_add_f32 v100, 0x358637bd, v100
    v_add_f32 v112, 0x358637bd, v112
    v_add_f32 v124, 0x358637bd, v124
    v_add_f32 v136, 0x358637bd, v136
    v_add_f32 v148, 0x358637bd, v148
    v_add_f32 v160, 0x358637bd, v160
    v_add_f32 v172, 0x358637bd, v172
    v_rcp_f32 v88, v88
    v_rcp_f32 v100, v100
    v_rcp_f32 v112, v112
    v_rcp_f32 v124, v124
    v_rcp_f32 v136, v136
    v_rcp_f32 v148, v148
    v_rcp_f32 v160, v160
    v_rcp_f32 v172, v172
    v_pk_mul_f32 v[80:81], v[80:81], v[88:89] op_sel_hi:[1,0]
    v_pk_mul_f32 v[82:83], v[82:83], v[88:89] op_sel_hi:[1,0]
    v_pk_mul_f32 v[84:85], v[84:85], v[88:89] op_sel_hi:[1,0]
    v_pk_mul_f32 v[86:87], v[86:87], v[88:89] op_sel_hi:[1,0]
    v_cvt_pk_bf16_f32 v80, v80, v81
    v_cvt_pk_bf16_f32 v81, v82, v83
    v_cvt_pk_bf16_f32 v82, v84, v85
    v_cvt_pk_bf16_f32 v83, v86, v87
    buffer_store_dwordx4 v[80:83], v180, s[4:7], s31 offen sc1
    s_add_u32 s31, s31, 32768
    v_pk_mul_f32 v[92:93], v[92:93], v[100:101] op_sel_hi:[1,0]
    v_pk_mul_f32 v[94:95], v[94:95], v[100:101] op_sel_hi:[1,0]
    v_pk_mul_f32 v[96:97], v[96:97], v[100:101] op_sel_hi:[1,0]
    v_pk_mul_f32 v[98:99], v[98:99], v[100:101] op_sel_hi:[1,0]
    v_cvt_pk_bf16_f32 v92, v92, v93
    v_cvt_pk_bf16_f32 v93, v94, v95
    v_cvt_pk_bf16_f32 v94, v96, v97
    v_cvt_pk_bf16_f32 v95, v98, v99
    buffer_store_dwordx4 v[92:95], v180, s[4:7], s31 offen sc1
    s_add_u32 s31, s31, 32768
    v_pk_mul_f32 v[104:105], v[104:105], v[112:113] op_sel_hi:[1,0]
    v_pk_mul_f32 v[106:107], v[106:107], v[112:113] op_sel_hi:[1,0]
    v_pk_mul_f32 v[108:109], v[108:109], v[112:113] op_sel_hi:[1,0]
    v_pk_mul_f32 v[110:111], v[110:111], v[112:113] op_sel_hi:[1,0]
    v_cvt_pk_bf16_f32 v104, v104, v105
    v_cvt_pk_bf16_f32 v105, v106, v107
    v_cvt_pk_bf16_f32 v106, v108, v109
    v_cvt_pk_bf16_f32 v107, v110, v111
    buffer_store_dwordx4 v[104:107], v180, s[4:7], s31 offen sc1
    s_add_u32 s31, s31, 32768
    v_pk_mul_f32 v[116:117], v[116:117], v[124:125] op_sel_hi:[1,0]
    v_pk_mul_f32 v[118:119], v[118:119], v[124:125] op_sel_hi:[1,0]
    v_pk_mul_f32 v[120:121], v[120:121], v[124:125] op_sel_hi:[1,0]
    v_pk_mul_f32 v[122:123], v[122:123], v[124:125] op_sel_hi:[1,0]
    v_cvt_pk_bf16_f32 v116, v116, v117
    v_cvt_pk_bf16_f32 v117, v118, v119
    v_cvt_pk_bf16_f32 v118, v120, v121
    v_cvt_pk_bf16_f32 v119, v122, v123
    buffer_store_dwordx4 v[116:119], v180, s[4:7], s31 offen sc1
    s_add_u32 s31, s31, 32768
    v_pk_mul_f32 v[128:129], v[128:129], v[136:137] op_sel_hi:[1,0]
    v_pk_mul_f32 v[130:131], v[130:131], v[136:137] op_sel_hi:[1,0]
    v_pk_mul_f32 v[132:133], v[132:133], v[136:137] op_sel_hi:[1,0]
    v_pk_mul_f32 v[134:135], v[134:135], v[136:137] op_sel_hi:[1,0]
    v_cvt_pk_bf16_f32 v128, v128, v129
    v_cvt_pk_bf16_f32 v129, v130, v131
    v_cvt_pk_bf16_f32 v130, v132, v133
    v_cvt_pk_bf16_f32 v131, v134, v135
    buffer_store_dwordx4 v[128:131], v180, s[4:7], s31 offen sc1
    s_add_u32 s31, s31, 32768
    v_pk_mul_f32 v[140:141], v[140:141], v[148:149] op_sel_hi:[1,0]
    v_pk_mul_f32 v[142:143], v[142:143], v[148:149] op_sel_hi:[1,0]
    v_pk_mul_f32 v[144:145], v[144:145], v[148:149] op_sel_hi:[1,0]
    v_pk_mul_f32 v[146:147], v[146:147], v[148:149] op_sel_hi:[1,0]
    v_cvt_pk_bf16_f32 v140, v140, v141
    v_cvt_pk_bf16_f32 v141, v142, v143
    v_cvt_pk_bf16_f32 v142, v144, v145
    v_cvt_pk_bf16_f32 v143, v146, v147
    buffer_store_dwordx4 v[140:143], v180, s[4:7], s31 offen sc1
    s_add_u32 s31, s31, 32768
    v_pk_mul_f32 v[152:153], v[152:153], v[160:161] op_sel_hi:[1,0]
    v_pk_mul_f32 v[154:155], v[154:155], v[160:161] op_sel_hi:[1,0]
    v_pk_mul_f32 v[156:157], v[156:157], v[160:161] op_sel_hi:[1,0]
    v_pk_mul_f32 v[158:159], v[158:159], v[160:161] op_sel_hi:[1,0]
    v_cvt_pk_bf16_f32 v152, v152, v153
    v_cvt_pk_bf16_f32 v153, v154, v155
    v_cvt_pk_bf16_f32 v154, v156, v157
    v_cvt_pk_bf16_f32 v155, v158, v159
    buffer_store_dwordx4 v[152:155], v180, s[4:7], s31 offen sc1
    s_add_u32 s31, s31, 32768
    v_pk_mul_f32 v[164:165], v[164:165], v[172:173] op_sel_hi:[1,0]
    v_pk_mul_f32 v[166:167], v[166:167], v[172:173] op_sel_hi:[1,0]
    v_pk_mul_f32 v[168:169], v[168:169], v[172:173] op_sel_hi:[1,0]
    v_pk_mul_f32 v[170:171], v[170:171], v[172:173] op_sel_hi:[1,0]
    v_cvt_pk_bf16_f32 v164, v164, v165
    v_cvt_pk_bf16_f32 v165, v166, v167
    v_cvt_pk_bf16_f32 v166, v168, v169
    v_cvt_pk_bf16_f32 v167, v170, v171
    buffer_store_dwordx4 v[164:167], v180, s[4:7], s31 offen sc1
    s_add_u32 s31, s31, 32768
    s_nop 1
    v_lshrrev_b32 v182, 3, v191
    v_bfe_u32 v183, v191, 4, 2
    v_bfe_u32 v184, v191, 1, 2
    v_xor_b32 v183, v183, v184
    v_and_b32 v184, 1, v191
    v_lshlrev_b32 v184, 4, v184
    v_lshl_add_u32 v183, v183, 5, v184
    v_lshl_add_u32 v183, v182, 11, v183
    s_lshl_b32 s32, s21, 15
    s_lshl_b32 s33, s27, 7
    s_add_u32 s32, s32, s33
    v_add_u32 v192, s32, v183
    v_add_u32 v193, 15360, v192
    s_mov_b32 s60, 0
    s_lshl_b32 s66, s21, 11
    v_lshrrev_b32 v182, 2, v191
    v_bfe_u32 v183, v191, 3, 2
    v_and_b32 v184, 3, v191
    v_lshlrev_b32 v184, 3, v184
    v_lshl_add_u32 v184, v182, 7, v184
    v_xor_b32 v186, 0, v183
    v_lshl_add_u32 v208, v186, 5, v184
    v_add_u32 v212, 0x10000, v208
    v_xor_b32 v186, 1, v183
    v_lshl_add_u32 v209, v186, 5, v184
    v_add_u32 v213, 0x10000, v209
    v_xor_b32 v186, 2, v183
    v_lshl_add_u32 v210, v186, 5, v184
    v_add_u32 v214, 0x10000, v210
    v_xor_b32 v186, 3, v183
    v_lshl_add_u32 v211, v186, 5, v184
    v_add_u32 v215, 0x10000, v211
    s_lshl_b32 s32, s24, 3
    s_lshl_b32 s33, s21, 1
    s_add_u32 s32, s32, s33
    s_lshl_b32 s33, s32, 15
    s_add_u32 s61, s33, 8388608
    s_add_u32 s62, s61, 32768
    s_mul_i32 s34, s32, 57344
    s_add_u32 s70, s34, 29360128
    s_add_u32 s71, s70, 57344
    s_lshl_b32 s34, s27, 7
    s_add_u32 s68, s33, s34
    s_add_u32 s69, s68, 32768
    v_and_b32 v182, 15, v191
    v_bfe_u32 v183, v191, 4, 1
    v_lshlrev_b32 v183, 5, v183
    v_lshl_add_u32 v182, v182, 11, v183
    v_lshrrev_b32 v183, 5, v191
    v_lshl_add_u32 v202, v183, 4, v182
    s_lshl_b32 s72, s21, 13
    s_add_u32 s72, s72, 131072
    v_add_u32 v216, s72, v180
    v_min_u32 v204, 31, v191
    v_lshlrev_b32 v204, 2, v204
    v_min_u32 v205, 27, v191
    v_lshlrev_b32 v205, 2, v205
    v_mov_b32 v206, 1
    v_mov_b32 v207, 0
    s_lshr_b32 s32, s24, 2
    s_lshl_b32 s32, s32, 7
    s_add_u32 s65, s32, 40898560
    s_lshl_b32 s32, s24, 8
    s_add_u32 s32, s32, 40894464
    s_lshr_b32 s33, s21, 1
    s_lshl_b32 s34, s33, 7
    s_add_u32 s64, s32, s34
    s_lshl_b32 s33, s33, 2
    s_add_u32 s32, s32, s33
    s_and_b32 s33, s21, 1
    s_lshl_b32 s33, s33, 7
    s_add_u32 s32, s32, s33
    s_lshl_b32 s33, s25, 3
    s_add_u32 s63, s32, s33
    s_lshl_b32 s32, s21, 7
    s_lshl_b32 s33, s37, 2
    s_add_u32 s32, s32, s33
    s_add_u32 s32, s32, 40898560
    s_mov_b32 s63, 40902656
    s_waitcnt vmcnt(0)
    s_mov_b64 exec, 1
    buffer_store_dword v206, v207, s[4:7], s32 offen sc1
    s_mov_b64 exec, -1
    s_getpc_b64 s[94:95]
k23_kernel_pc:
    s_add_u32 s94, s94, k23_kernel_end - 32768 - k23_kernel_pc
    s_addc_u32 s95, s95, -1
    v_lshlrev_b32 v220, 7, v191
    s_sub_u32 s34, s21, 0
    s_max_i32 s34, s34, 0
    v_mov_b32 v221, s34
    v_lshl_add_u32 v220, v221, 13, v220
    v_mov_b32 v221, s95
    v_add_co_u32 v220, vcc, s94, v220
    v_addc_co_u32 v221, vcc, 0, v221, vcc
    global_load_dword v222, v[220:221], off
    s_sub_u32 s32, s30, 28
    s_lshl_b32 s32, s32, 2
    s_add_u32 s32, s32, s21
    s_lshl_b32 s32, s32, 14
    s_bfe_u32 s33, s2, 0x10002
    s_lshl_b32 s33, s33, 10
    s_add_u32 s32, s32, s33
    v_lshrrev_b32 v223, 3, v191
    v_and_b32 v224, 7, v191
    v_lshlrev_b32 v224, 7, v224
    v_lshl_add_u32 v223, v223, 11, v224
    s_add_u32 s33, s32, 0
    buffer_load_dword v222, v223, s[48:51], s33 offen
    s_add_u32 s33, s32, 262144
    buffer_load_dword v222, v223, s[48:51], s33 offen
    s_add_u32 s33, s32, 524288
    buffer_load_dword v222, v223, s[48:51], s33 offen
    s_add_u32 s33, s32, 786432
    buffer_load_dword v222, v223, s[48:51], s33 offen
    s_add_u32 s33, s32, 1048576
    buffer_load_dword v222, v223, s[48:51], s33 offen
    s_add_u32 s33, s32, 1310720
    buffer_load_dword v222, v223, s[48:51], s33 offen
    s_add_u32 s33, s32, 1572864
    buffer_load_dword v222, v223, s[48:51], s33 offen
    s_add_u32 s33, s32, 1835008
    buffer_load_dword v222, v223, s[48:51], s33 offen
    s_add_u32 s33, s32, 0
    buffer_load_dword v222, v223, s[52:55], s33 offen
    s_add_u32 s33, s32, 262144
    buffer_load_dword v222, v223, s[52:55], s33 offen
    s_add_u32 s33, s32, 524288
    buffer_load_dword v222, v223, s[52:55], s33 offen
    s_add_u32 s33, s32, 786432
    buffer_load_dword v222, v223, s[52:55], s33 offen
    s_add_u32 s33, s32, 1048576
    buffer_load_dword v222, v223, s[52:55], s33 offen
    s_add_u32 s33, s32, 1310720
    buffer_load_dword v222, v223, s[52:55], s33 offen
    s_add_u32 s33, s32, 1572864
    buffer_load_dword v222, v223, s[52:55], s33 offen
    s_add_u32 s33, s32, 1835008
    buffer_load_dword v222, v223, s[52:55], s33 offen
    s_add_u32 s33, s32, 2097152
    buffer_load_dword v222, v223, s[52:55], s33 offen
    s_add_u32 s33, s32, 2359296
    buffer_load_dword v222, v223, s[52:55], s33 offen
    s_add_u32 s33, s32, 2621440
    buffer_load_dword v222, v223, s[52:55], s33 offen
    s_add_u32 s33, s32, 2883584
    buffer_load_dword v222, v223, s[52:55], s33 offen
    s_add_u32 s33, s32, 3145728
    buffer_load_dword v222, v223, s[52:55], s33 offen
    s_add_u32 s33, s32, 3407872
    buffer_load_dword v222, v223, s[52:55], s33 offen
    buffer_load_dword v203, v204, s[4:7], s65 offen sc1
    s_waitcnt vmcnt(0)
    v_cmp_eq_u32 vcc, 0, v203
    s_mov_b32 s36, 0x40000
    s_nop 0
    s_cbranch_vccz k23_kernel_os_got
k23_kernel_os_spin:
    buffer_load_dword v203, v204, s[4:7], s65 offen sc1
    s_waitcnt vmcnt(0)
    v_cmp_eq_u32 vcc, 0, v203
    s_sub_u32 s36, s36, 1
    s_cbranch_scc1 k23_kernel_os_got
    s_cbranch_vccz k23_kernel_os_got
    s_sleep 2
    s_branch k23_kernel_os_spin
k23_kernel_os_got:
    s_add_u32 m0, s66, 0
    s_nop 0
    buffer_load_dwordx4 v192, s[48:51], s60 offen offset:0 lds
    buffer_load_dwordx4 v193, s[48:51], s60 offen offset:1024 lds
    s_add_u32 s60, s60, 131072
    s_add_u32 m0, s66, 8192
    s_nop 0
    buffer_load_dwordx4 v192, s[48:51], s60 offen offset:0 lds
    buffer_load_dwordx4 v193, s[48:51], s60 offen offset:1024 lds
    s_add_u32 s60, s60, 131072
    buffer_load_dwordx4 a[0:3], v180, s[4:7], s61 offen offset:0
    buffer_load_dwordx4 a[8:11], v180, s[4:7], s61 offen offset:1024
    s_add_u32 s61, s61, 2048
    buffer_load_dwordx4 a[4:7], v180, s[4:7], s62 offen offset:0
    buffer_load_dwordx4 a[12:15], v180, s[4:7], s62 offen offset:1024
    s_add_u32 s62, s62, 2048
    s_add_u32 m0, s66, 16384
    s_nop 0
    buffer_load_dwordx4 v192, s[48:51], s60 offen offset:0 lds
    buffer_load_dwordx4 v193, s[48:51], s60 offen offset:1024 lds
    s_add_u32 s60, s60, 131072
    buffer_load_dwordx4 a[16:19], v180, s[4:7], s61 offen offset:0
    buffer_load_dwordx4 a[24:27], v180, s[4:7], s61 offen offset:1024
    s_add_u32 s61, s61, 2048
    buffer_load_dwordx4 a[20:23], v180, s[4:7], s62 offen offset:0
    buffer_load_dwordx4 a[28:31], v180, s[4:7], s62 offen offset:1024
    s_add_u32 s62, s62, 2048
    s_add_u32 m0, s66, 24576
    s_nop 0
    buffer_load_dwordx4 v192, s[48:51], s60 offen offset:0 lds
    buffer_load_dwordx4 v193, s[48:51], s60 offen offset:1024 lds
    s_add_u32 s60, s60, 131072
    buffer_load_dwordx4 a[32:35], v180, s[4:7], s61 offen offset:0
    buffer_load_dwordx4 a[40:43], v180, s[4:7], s61 offen offset:1024
    s_add_u32 s61, s61, 2048
    buffer_load_dwordx4 a[36:39], v180, s[4:7], s62 offen offset:0
    buffer_load_dwordx4 a[44:47], v180, s[4:7], s62 offen offset:1024
    s_add_u32 s62, s62, 2048
    s_add_u32 m0, s66, 32768
    s_nop 0
    buffer_load_dwordx4 v192, s[48:51], s60 offen offset:0 lds
    buffer_load_dwordx4 v193, s[48:51], s60 offen offset:1024 lds
    s_add_u32 s60, s60, 131072
    buffer_load_dwordx4 a[48:51], v180, s[4:7], s61 offen offset:0
    buffer_load_dwordx4 a[56:59], v180, s[4:7], s61 offen offset:1024
    s_add_u32 s61, s61, 2048
    buffer_load_dwordx4 a[52:55], v180, s[4:7], s62 offen offset:0
    buffer_load_dwordx4 a[60:63], v180, s[4:7], s62 offen offset:1024
    s_add_u32 s62, s62, 2048
    s_add_u32 m0, s66, 40960
    s_nop 0
    buffer_load_dwordx4 v192, s[48:51], s60 offen offset:0 lds
    buffer_load_dwordx4 v193, s[48:51], s60 offen offset:1024 lds
    s_add_u32 s60, s60, 131072
    buffer_load_dwordx4 a[64:67], v180, s[4:7], s61 offen offset:0
    buffer_load_dwordx4 a[72:75], v180, s[4:7], s61 offen offset:1024
    s_add_u32 s61, s61, 2048
    buffer_load_dwordx4 a[68:71], v180, s[4:7], s62 offen offset:0
    buffer_load_dwordx4 a[76:79], v180, s[4:7], s62 offen offset:1024
    s_add_u32 s62, s62, 2048
    s_add_u32 m0, s66, 49152
    s_nop 0
    buffer_load_dwordx4 v192, s[48:51], s60 offen offset:0 lds
    buffer_load_dwordx4 v193, s[48:51], s60 offen offset:1024 lds
    s_add_u32 s60, s60, 131072
    s_waitcnt vmcnt(0)
    s_branch k23_kernel_J
k23_kernel_main:
    s_lshl_b32 s20, s21, 12
    s_mul_i32 s32, s21, 57344
    s_lshl_b32 s33, s25, 12
    s_add_u32 s32, s32, s33
    v_add_u32 v128, s32, v180
    s_mov_b32 s22, 20971520
    s_mov_b32 s23, 0
    v_lshrrev_b32 v182, 3, v191
    v_and_b32 v183, 7, v191
    v_xor_b32 v183, v182, v183
    v_lshlrev_b32 v183, 4, v183
    v_lshl_add_u32 v183, v182, 12, v183
    s_lshl_b32 s32, s24, 19
    s_lshl_b32 s33, s21, 17
    s_add_u32 s32, s32, s33
    v_add_u32 v129, s32, v183
    v_add_u32 v130, 31744, v129
    v_add_u32 v131, 63488, v129
    v_add_u32 v132, 95232, v129
    s_waitcnt lgkmcnt(0)
    s_add_u32 m0, s20, 0
    s_nop 0
    buffer_load_dwordx4 v128, s[4:7], s22 offen offset:0 lds
    buffer_load_dwordx4 v128, s[4:7], s22 offen offset:1024 lds
    buffer_load_dwordx4 v128, s[4:7], s22 offen offset:2048 lds
    buffer_load_dwordx4 v128, s[4:7], s22 offen offset:3072 lds
    s_add_u32 s22, s22, 229376
    s_add_u32 m0, s20, 16384
    s_nop 0
    buffer_load_dwordx4 v129, s[8:11], s23 offen offset:0 lds
    buffer_load_dwordx4 v130, s[8:11], s23 offen offset:1024 lds
    buffer_load_dwordx4 v131, s[8:11], s23 offen offset:2048 lds
    buffer_load_dwordx4 v132, s[8:11], s23 offen offset:3072 lds
    s_add_u32 s23, s23, 128
    s_add_u32 m0, s20, 32768
    s_nop 0
    buffer_load_dwordx4 v128, s[4:7], s22 offen offset:0 lds
    buffer_load_dwordx4 v128, s[4:7], s22 offen offset:1024 lds
    buffer_load_dwordx4 v128, s[4:7], s22 offen offset:2048 lds
    buffer_load_dwordx4 v128, s[4:7], s22 offen offset:3072 lds
    s_add_u32 s22, s22, 229376
    s_add_u32 m0, s20, 49152
    s_nop 0
    buffer_load_dwordx4 v129, s[8:11], s23 offen offset:0 lds
    buffer_load_dwordx4 v130, s[8:11], s23 offen offset:1024 lds
    buffer_load_dwordx4 v131, s[8:11], s23 offen offset:2048 lds
    buffer_load_dwordx4 v132, s[8:11], s23 offen offset:3072 lds
    s_add_u32 s23, s23, 128
    s_add_u32 m0, s20, 65536
    s_nop 0
    buffer_load_dwordx4 v128, s[4:7], s22 offen offset:0 lds
    buffer_load_dwordx4 v128, s[4:7], s22 offen offset:1024 lds
    buffer_load_dwordx4 v128, s[4:7], s22 offen offset:2048 lds
    buffer_load_dwordx4 v128, s[4:7], s22 offen offset:3072 lds
    s_add_u32 s22, s22, 229376
    s_add_u32 m0, s20, 81920
    s_nop 0
    buffer_load_dwordx4 v129, s[8:11], s23 offen offset:0 lds
    buffer_load_dwordx4 v130, s[8:11], s23 offen offset:1024 lds
    buffer_load_dwordx4 v131, s[8:11], s23 offen offset:2048 lds
    buffer_load_dwordx4 v132, s[8:11], s23 offen offset:3072 lds
    s_add_u32 s23, s23, 128
    s_add_u32 m0, s20, 98304
    s_nop 0
    buffer_load_dwordx4 v128, s[4:7], s22 offen offset:0 lds
    buffer_load_dwordx4 v128, s[4:7], s22 offen offset:1024 lds
    buffer_load_dwordx4 v128, s[4:7], s22 offen offset:2048 lds
    buffer_load_dwordx4 v128, s[4:7], s22 offen offset:3072 lds
    s_add_u32 s22, s22, 229376
    s_add_u32 m0, s20, 114688
    s_nop 0
    buffer_load_dwordx4 v129, s[8:11], s23 offen offset:0 lds
    buffer_load_dwordx4 v130, s[8:11], s23 offen offset:1024 lds
    buffer_load_dwordx4 v131, s[8:11], s23 offen offset:2048 lds
    buffer_load_dwordx4 v132, s[8:11], s23 offen offset:3072 lds
    s_add_u32 s23, s23, 128
    v_lshrrev_b32 v182, 3, v191
    v_bfe_u32 v183, v191, 4, 2
    v_bfe_u32 v184, v191, 1, 2
    v_xor_b32 v183, v183, v184
    v_and_b32 v184, 1, v191
    v_lshlrev_b32 v184, 4, v184
    v_lshl_add_u32 v183, v183, 5, v184
    v_lshl_add_u32 v183, v182, 11, v183
    s_lshl_b32 s32, s21, 15
    s_lshl_b32 s33, s27, 7
    s_add_u32 s32, s32, s33
    v_add_u32 v192, s32, v183
    v_add_u32 v193, 15360, v192
    s_mov_b32 s60, 0
    s_lshl_b32 s66, s21, 11
    v_lshrrev_b32 v182, 2, v191
    v_bfe_u32 v183, v191, 3, 2
    v_and_b32 v184, 3, v191
    v_lshlrev_b32 v184, 3, v184
    v_lshl_add_u32 v184, v182, 7, v184
    v_xor_b32 v186, 0, v183
    v_lshl_add_u32 v208, v186, 5, v184
    v_add_u32 v212, 0x10000, v208
    v_xor_b32 v186, 1, v183
    v_lshl_add_u32 v209, v186, 5, v184
    v_add_u32 v213, 0x10000, v209
    v_xor_b32 v186, 2, v183
    v_lshl_add_u32 v210, v186, 5, v184
    v_add_u32 v214, 0x10000, v210
    v_xor_b32 v186, 3, v183
    v_lshl_add_u32 v211, v186, 5, v184
    v_add_u32 v215, 0x10000, v211
    s_lshl_b32 s32, s24, 3
    s_lshl_b32 s33, s21, 1
    s_add_u32 s32, s32, s33
    s_lshl_b32 s33, s32, 15
    s_add_u32 s61, s33, 8388608
    s_add_u32 s62, s61, 32768
    s_mul_i32 s34, s32, 57344
    s_add_u32 s70, s34, 29360128
    s_add_u32 s71, s70, 57344
    s_lshl_b32 s34, s27, 7
    s_add_u32 s68, s33, s34
    s_add_u32 s69, s68, 32768
    v_and_b32 v182, 15, v191
    v_bfe_u32 v183, v191, 4, 1
    v_lshlrev_b32 v183, 5, v183
    v_lshl_add_u32 v182, v182, 11, v183
    v_lshrrev_b32 v183, 5, v191
    v_lshl_add_u32 v202, v183, 4, v182
    s_lshl_b32 s72, s21, 13
    s_add_u32 s72, s72, 131072
    v_add_u32 v216, s72, v180
    v_min_u32 v204, 31, v191
    v_lshlrev_b32 v204, 2, v204
    v_min_u32 v205, 27, v191
    v_lshlrev_b32 v205, 2, v205
    v_mov_b32 v206, 1
    v_mov_b32 v207, 0
    s_lshr_b32 s32, s24, 2
    s_lshl_b32 s32, s32, 7
    s_add_u32 s65, s32, 40898560
    s_lshl_b32 s32, s24, 8
    s_add_u32 s32, s32, 40894464
    s_lshr_b32 s33, s21, 1
    s_lshl_b32 s34, s33, 7
    s_add_u32 s64, s32, s34
    s_lshl_b32 s33, s33, 2
    s_add_u32 s32, s32, s33
    s_and_b32 s33, s21, 1
    s_lshl_b32 s33, s33, 7
    s_add_u32 s32, s32, s33
    s_lshl_b32 s33, s25, 3
    s_add_u32 s63, s32, s33
    v_lshrrev_b32 v182, 5, v191
    v_lshlrev_b32 v182, 12, v182
    v_bfe_u32 v183, v191, 2, 3
    v_lshl_add_u32 v182, v183, 5, v182
    v_and_b32 v183, 3, v191
    v_lshl_add_u32 v182, v183, 3, v182
    s_lshr_b32 s32, s21, 1
    s_lshl_b32 s32, s32, 11
    v_add_u32 v133, s32, v182
    v_add_u32 v134, 0x10000, v133
    v_and_b32 v182, 15, v191
    v_lshrrev_b32 v183, 4, v191
    v_and_b32 v184, 7, v191
    v_xor_b32 v183, v183, v184
    v_lshlrev_b32 v183, 4, v183
    v_lshl_add_u32 v183, v182, 7, v183
    s_and_b32 s33, s21, 1
    s_lshl_b32 s32, s33, 13
    v_add_u32 v135, s32, v183
    v_xor_b32 v136, 64, v135
    v_add_u32 v137, 0x10000, v135
    v_add_u32 v138, 0x10000, v136
    v_lshlrev_b32 v185, 1, v182
    s_lshl_b32 s32, s24, 8
    s_lshl_b32 s34, s33, 7
    s_add_u32 s40, s32, s34
    s_lshl_b32 s32, s24, 3
    s_lshl_b32 s34, s33, 2
    s_add_u32 s32, s32, s34
    s_mul_i32 s32, s32, 56
    s_lshl_b32 s34, s25, 2
    s_add_u32 s32, s32, s34
    s_and_b32 s34, s21, 2
    s_add_u32 s32, s32, s34
    s_lshl_b32 s32, s32, 10
    s_add_u32 s44, s32, 12582912
    s_add_u32 s45, s44, 57344
    s_add_u32 s46, s45, 57344
    s_add_u32 s47, s46, 57344
    s_mov_b32 s73, s44
    v_mov_b32 v0, 0
    v_mov_b32 v1, 0
    v_mov_b32 v2, 0
    v_mov_b32 v3, 0
    v_mov_b32 v4, 0
    v_mov_b32 v5, 0
    v_mov_b32 v6, 0
    v_mov_b32 v7, 0
    v_mov_b32 v8, 0
    v_mov_b32 v9, 0
    v_mov_b32 v10, 0
    v_mov_b32 v11, 0
    v_mov_b32 v12, 0
    v_mov_b32 v13, 0
    v_mov_b32 v14, 0
    v_mov_b32 v15, 0
    v_mov_b32 v16, 0
    v_mov_b32 v17, 0
    v_mov_b32 v18, 0
    v_mov_b32 v19, 0
    v_mov_b32 v20, 0
    v_mov_b32 v21, 0
    v_mov_b32 v22, 0
    v_mov_b32 v23, 0
    v_mov_b32 v24, 0
    v_mov_b32 v25, 0
    v_mov_b32 v26, 0
    v_mov_b32 v27, 0
    v_mov_b32 v28, 0
    v_mov_b32 v29, 0
    v_mov_b32 v30, 0
    v_mov_b32 v31, 0
    v_mov_b32 v32, 0
    v_mov_b32 v33, 0
    v_mov_b32 v34, 0
    v_mov_b32 v35, 0
    v_mov_b32 v36, 0
    v_mov_b32 v37, 0
    v_mov_b32 v38, 0
    v_mov_b32 v39, 0
    v_mov_b32 v40, 0
    v_mov_b32 v41, 0
    v_mov_b32 v42, 0
    v_mov_b32 v43, 0
    v_mov_b32 v44, 0
    v_mov_b32 v45, 0
    v_mov_b32 v46, 0
    v_mov_b32 v47, 0
    v_mov_b32 v48, 0
    v_mov_b32 v49, 0
    v_mov_b32 v50, 0
    v_mov_b32 v51, 0
    v_mov_b32 v52, 0
    v_mov_b32 v53, 0
    v_mov_b32 v54, 0
    v_mov_b32 v55, 0
    v_mov_b32 v56, 0
    v_mov_b32 v57, 0
    v_mov_b32 v58, 0
    v_mov_b32 v59, 0
    v_mov_b32 v60, 0
    v_mov_b32 v61, 0
    v_mov_b32 v62, 0
    v_mov_b32 v63, 0
    s_waitcnt vmcnt(24)
    s_barrier
    ds_read_b128 v[96:99], v135 offset:16384
    ds_read_b64_tr_b16 v[64:65], v133 offset:0
    ds_read_b64_tr_b16 v[66:67], v133 offset:512
    ds_read_b128 v[100:103], v135 offset:18432
    ds_read_b128 v[104:107], v135 offset:20480
    ds_read_b128 v[108:111], v135 offset:22528
    ds_read_b64_tr_b16 v[68:69], v133 offset:256
    ds_read_b64_tr_b16 v[70:71], v133 offset:768
    ds_read_b64_tr_b16 v[72:73], v133 offset:1024
    ds_read_b64_tr_b16 v[74:75], v133 offset:1536
    ds_read_b64_tr_b16 v[76:77], v133 offset:1280
    ds_read_b64_tr_b16 v[78:79], v133 offset:1792
    s_waitcnt lgkmcnt(9)
    v_mfma_f32_16x16x32_bf16 v[0:3], v[64:67], v[96:99], v[0:3]
    ds_read_b128 v[112:115], v136 offset:16384
    s_waitcnt lgkmcnt(9)
    v_mfma_f32_16x16x32_bf16 v[4:7], v[64:67], v[100:103], v[4:7]
    ds_read_b64_tr_b16 v[80:81], v133 offset:8192
    s_waitcnt lgkmcnt(9)
    v_mfma_f32_16x16x32_bf16 v[8:11], v[64:67], v[104:107], v[8:11]
    ds_read_b64_tr_b16 v[82:83], v133 offset:8704
    s_waitcnt lgkmcnt(9)
    v_mfma_f32_16x16x32_bf16 v[12:15], v[64:67], v[108:111], v[12:15]
    ds_read_b128 v[116:119], v136 offset:18432
    s_waitcnt lgkmcnt(8)
    v_mfma_f32_16x16x32_bf16 v[28:31], v[68:71], v[108:111], v[28:31]
    ds_read_b128 v[120:123], v136 offset:20480
    v_mfma_f32_16x16x32_bf16 v[24:27], v[68:71], v[104:107], v[24:27]
    ds_read_b128 v[124:127], v136 offset:22528
    v_mfma_f32_16x16x32_bf16 v[20:23], v[68:71], v[100:103], v[20:23]
    ds_read_b64_tr_b16 v[84:85], v133 offset:8448
    v_mfma_f32_16x16x32_bf16 v[16:19], v[68:71], v[96:99], v[16:19]
    ds_read_b64_tr_b16 v[86:87], v133 offset:8960
    s_waitcnt lgkmcnt(10)
    v_mfma_f32_16x16x32_bf16 v[32:35], v[72:75], v[96:99], v[32:35]
    ds_read_b64_tr_b16 v[88:89], v133 offset:9216
    v_mfma_f32_16x16x32_bf16 v[36:39], v[72:75], v[100:103], v[36:39]
    ds_read_b64_tr_b16 v[90:91], v133 offset:9728
    v_mfma_f32_16x16x32_bf16 v[40:43], v[72:75], v[104:107], v[40:43]
    ds_read_b64_tr_b16 v[92:93], v133 offset:9472
    v_mfma_f32_16x16x32_bf16 v[44:47], v[72:75], v[108:111], v[44:47]
    ds_read_b64_tr_b16 v[94:95], v133 offset:9984
    s_waitcnt lgkmcnt(12)
    v_mfma_f32_16x16x32_bf16 v[60:63], v[76:79], v[108:111], v[60:63]
    v_mfma_f32_16x16x32_bf16 v[56:59], v[76:79], v[104:107], v[56:59]
    v_mfma_f32_16x16x32_bf16 v[52:55], v[76:79], v[100:103], v[52:55]
    v_mfma_f32_16x16x32_bf16 v[48:51], v[76:79], v[96:99], v[48:51]
    s_waitcnt lgkmcnt(9)
    v_mfma_f32_16x16x32_bf16 v[0:3], v[80:83], v[112:115], v[0:3]
    s_waitcnt lgkmcnt(8)
    v_mfma_f32_16x16x32_bf16 v[4:7], v[80:83], v[116:119], v[4:7]
    s_waitcnt vmcnt(16) lgkmcnt(0)
    s_barrier
    v_mfma_f32_16x16x32_bf16 v[8:11], v[80:83], v[120:123], v[8:11]
    ds_read_b128 v[96:99], v135 offset:49152
    s_add_u32 m0, s20, 0
    v_mfma_f32_16x16x32_bf16 v[12:15], v[80:83], v[124:127], v[12:15]
    ds_read_b64_tr_b16 v[64:65], v133 offset:32768
    buffer_load_dwordx4 v128, s[4:7], s22 offen offset:0 lds
    v_mfma_f32_16x16x32_bf16 v[28:31], v[84:87], v[124:127], v[28:31]
    ds_read_b64_tr_b16 v[66:67], v133 offset:33280
    v_mfma_f32_16x16x32_bf16 v[24:27], v[84:87], v[120:123], v[24:27]
    ds_read_b128 v[100:103], v135 offset:51200
    v_mfma_f32_16x16x32_bf16 v[20:23], v[84:87], v[116:119], v[20:23]
    ds_read_b128 v[104:107], v135 offset:53248
    buffer_load_dwordx4 v128, s[4:7], s22 offen offset:1024 lds
    v_mfma_f32_16x16x32_bf16 v[16:19], v[84:87], v[112:115], v[16:19]
    ds_read_b128 v[108:111], v135 offset:55296
    v_mfma_f32_16x16x32_bf16 v[32:35], v[88:91], v[112:115], v[32:35]
    ds_read_b64_tr_b16 v[68:69], v133 offset:33024
    v_mfma_f32_16x16x32_bf16 v[36:39], v[88:91], v[116:119], v[36:39]
    ds_read_b64_tr_b16 v[70:71], v133 offset:33536
    buffer_load_dwordx4 v128, s[4:7], s22 offen offset:2048 lds
    v_mfma_f32_16x16x32_bf16 v[40:43], v[88:91], v[120:123], v[40:43]
    ds_read_b64_tr_b16 v[72:73], v133 offset:33792
    v_mfma_f32_16x16x32_bf16 v[44:47], v[88:91], v[124:127], v[44:47]
    ds_read_b64_tr_b16 v[74:75], v133 offset:34304
    v_mfma_f32_16x16x32_bf16 v[60:63], v[92:95], v[124:127], v[60:63]
    ds_read_b64_tr_b16 v[76:77], v133 offset:34048
    buffer_load_dwordx4 v128, s[4:7], s22 offen offset:3072 lds
    v_mfma_f32_16x16x32_bf16 v[56:59], v[92:95], v[120:123], v[56:59]
    ds_read_b64_tr_b16 v[78:79], v133 offset:34560
    v_mfma_f32_16x16x32_bf16 v[52:55], v[92:95], v[116:119], v[52:55]
    s_add_u32 s22, s22, 229376
    v_mfma_f32_16x16x32_bf16 v[48:51], v[92:95], v[112:115], v[48:51]
    s_mov_b32 s26, 6
    .p2align 4
k23_kernel_loop_1:
    s_waitcnt lgkmcnt(9)
    v_mfma_f32_16x16x32_bf16 v[0:3], v[64:67], v[96:99], v[0:3]
    ds_read_b128 v[112:115], v136 offset:49152
    s_add_u32 m0, s20, 16384
    s_waitcnt lgkmcnt(9)
    v_mfma_f32_16x16x32_bf16 v[4:7], v[64:67], v[100:103], v[4:7]
    ds_read_b64_tr_b16 v[80:81], v133 offset:40960
    buffer_load_dwordx4 v129, s[8:11], s23 offen offset:0 lds
    s_waitcnt lgkmcnt(9)
    v_mfma_f32_16x16x32_bf16 v[8:11], v[64:67], v[104:107], v[8:11]
    ds_read_b64_tr_b16 v[82:83], v133 offset:41472
    s_waitcnt lgkmcnt(9)
    v_mfma_f32_16x16x32_bf16 v[12:15], v[64:67], v[108:111], v[12:15]
    ds_read_b128 v[116:119], v136 offset:51200
    s_waitcnt lgkmcnt(8)
    v_mfma_f32_16x16x32_bf16 v[28:31], v[68:71], v[108:111], v[28:31]
    ds_read_b128 v[120:123], v136 offset:53248
    v_mfma_f32_16x16x32_bf16 v[24:27], v[68:71], v[104:107], v[24:27]
    ds_read_b128 v[124:127], v136 offset:55296
    buffer_load_dwordx4 v130, s[8:11], s23 offen offset:1024 lds
    v_mfma_f32_16x16x32_bf16 v[20:23], v[68:71], v[100:103], v[20:23]
    ds_read_b64_tr_b16 v[84:85], v133 offset:41216
    v_mfma_f32_16x16x32_bf16 v[16:19], v[68:71], v[96:99], v[16:19]
    ds_read_b64_tr_b16 v[86:87], v133 offset:41728
    s_waitcnt lgkmcnt(10)
    v_mfma_f32_16x16x32_bf16 v[32:35], v[72:75], v[96:99], v[32:35]
    ds_read_b64_tr_b16 v[88:89], v133 offset:41984
    v_mfma_f32_16x16x32_bf16 v[36:39], v[72:75], v[100:103], v[36:39]
    ds_read_b64_tr_b16 v[90:91], v133 offset:42496
    buffer_load_dwordx4 v131, s[8:11], s23 offen offset:2048 lds
    v_mfma_f32_16x16x32_bf16 v[40:43], v[72:75], v[104:107], v[40:43]
    ds_read_b64_tr_b16 v[92:93], v133 offset:42240
    v_mfma_f32_16x16x32_bf16 v[44:47], v[72:75], v[108:111], v[44:47]
    ds_read_b64_tr_b16 v[94:95], v133 offset:42752
    s_waitcnt lgkmcnt(12)
    v_mfma_f32_16x16x32_bf16 v[60:63], v[76:79], v[108:111], v[60:63]
    v_mfma_f32_16x16x32_bf16 v[56:59], v[76:79], v[104:107], v[56:59]
    buffer_load_dwordx4 v132, s[8:11], s23 offen offset:3072 lds
    v_mfma_f32_16x16x32_bf16 v[52:55], v[76:79], v[100:103], v[52:55]
    v_mfma_f32_16x16x32_bf16 v[48:51], v[76:79], v[96:99], v[48:51]
    s_add_u32 s23, s23, 128
    s_waitcnt lgkmcnt(9)
    v_mfma_f32_16x16x32_bf16 v[0:3], v[80:83], v[112:115], v[0:3]
    s_waitcnt lgkmcnt(8)
    v_mfma_f32_16x16x32_bf16 v[4:7], v[80:83], v[116:119], v[4:7]
    s_waitcnt vmcnt(16) lgkmcnt(0)
    s_barrier
    v_mfma_f32_16x16x32_bf16 v[8:11], v[80:83], v[120:123], v[8:11]
    ds_read_b128 v[96:99], v137 offset:16384
    s_add_u32 m0, s20, 32768
    v_mfma_f32_16x16x32_bf16 v[12:15], v[80:83], v[124:127], v[12:15]
    ds_read_b64_tr_b16 v[64:65], v134 offset:0
    buffer_load_dwordx4 v128, s[4:7], s22 offen offset:0 lds
    v_mfma_f32_16x16x32_bf16 v[28:31], v[84:87], v[124:127], v[28:31]
    ds_read_b64_tr_b16 v[66:67], v134 offset:512
    v_mfma_f32_16x16x32_bf16 v[24:27], v[84:87], v[120:123], v[24:27]
    ds_read_b128 v[100:103], v137 offset:18432
    v_mfma_f32_16x16x32_bf16 v[20:23], v[84:87], v[116:119], v[20:23]
    ds_read_b128 v[104:107], v137 offset:20480
    buffer_load_dwordx4 v128, s[4:7], s22 offen offset:1024 lds
    v_mfma_f32_16x16x32_bf16 v[16:19], v[84:87], v[112:115], v[16:19]
    ds_read_b128 v[108:111], v137 offset:22528
    v_mfma_f32_16x16x32_bf16 v[32:35], v[88:91], v[112:115], v[32:35]
    ds_read_b64_tr_b16 v[68:69], v134 offset:256
    v_mfma_f32_16x16x32_bf16 v[36:39], v[88:91], v[116:119], v[36:39]
    ds_read_b64_tr_b16 v[70:71], v134 offset:768
    buffer_load_dwordx4 v128, s[4:7], s22 offen offset:2048 lds
    v_mfma_f32_16x16x32_bf16 v[40:43], v[88:91], v[120:123], v[40:43]
    ds_read_b64_tr_b16 v[72:73], v134 offset:1024
    v_mfma_f32_16x16x32_bf16 v[44:47], v[88:91], v[124:127], v[44:47]
    ds_read_b64_tr_b16 v[74:75], v134 offset:1536
    v_mfma_f32_16x16x32_bf16 v[60:63], v[92:95], v[124:127], v[60:63]
    ds_read_b64_tr_b16 v[76:77], v134 offset:1280
    buffer_load_dwordx4 v128, s[4:7], s22 offen offset:3072 lds
    v_mfma_f32_16x16x32_bf16 v[56:59], v[92:95], v[120:123], v[56:59]
    ds_read_b64_tr_b16 v[78:79], v134 offset:1792
    v_mfma_f32_16x16x32_bf16 v[52:55], v[92:95], v[116:119], v[52:55]
    s_add_u32 s22, s22, 229376
    v_mfma_f32_16x16x32_bf16 v[48:51], v[92:95], v[112:115], v[48:51]
    s_waitcnt lgkmcnt(9)
    v_mfma_f32_16x16x32_bf16 v[0:3], v[64:67], v[96:99], v[0:3]
    ds_read_b128 v[112:115], v138 offset:16384
    s_add_u32 m0, s20, 49152
    s_waitcnt lgkmcnt(9)
    v_mfma_f32_16x16x32_bf16 v[4:7], v[64:67], v[100:103], v[4:7]
    ds_read_b64_tr_b16 v[80:81], v134 offset:8192
    buffer_load_dwordx4 v129, s[8:11], s23 offen offset:0 lds
    s_waitcnt lgkmcnt(9)
    v_mfma_f32_16x16x32_bf16 v[8:11], v[64:67], v[104:107], v[8:11]
    ds_read_b64_tr_b16 v[82:83], v134 offset:8704
    s_waitcnt lgkmcnt(9)
    v_mfma_f32_16x16x32_bf16 v[12:15], v[64:67], v[108:111], v[12:15]
    ds_read_b128 v[116:119], v138 offset:18432
    s_waitcnt lgkmcnt(8)
    v_mfma_f32_16x16x32_bf16 v[28:31], v[68:71], v[108:111], v[28:31]
    ds_read_b128 v[120:123], v138 offset:20480
    v_mfma_f32_16x16x32_bf16 v[24:27], v[68:71], v[104:107], v[24:27]
    ds_read_b128 v[124:127], v138 offset:22528
    buffer_load_dwordx4 v130, s[8:11], s23 offen offset:1024 lds
    v_mfma_f32_16x16x32_bf16 v[20:23], v[68:71], v[100:103], v[20:23]
    ds_read_b64_tr_b16 v[84:85], v134 offset:8448
    v_mfma_f32_16x16x32_bf16 v[16:19], v[68:71], v[96:99], v[16:19]
    ds_read_b64_tr_b16 v[86:87], v134 offset:8960
    s_waitcnt lgkmcnt(10)
    v_mfma_f32_16x16x32_bf16 v[32:35], v[72:75], v[96:99], v[32:35]
    ds_read_b64_tr_b16 v[88:89], v134 offset:9216
    v_mfma_f32_16x16x32_bf16 v[36:39], v[72:75], v[100:103], v[36:39]
    ds_read_b64_tr_b16 v[90:91], v134 offset:9728
    buffer_load_dwordx4 v131, s[8:11], s23 offen offset:2048 lds
    v_mfma_f32_16x16x32_bf16 v[40:43], v[72:75], v[104:107], v[40:43]
    ds_read_b64_tr_b16 v[92:93], v134 offset:9472
    v_mfma_f32_16x16x32_bf16 v[44:47], v[72:75], v[108:111], v[44:47]
    ds_read_b64_tr_b16 v[94:95], v134 offset:9984
    s_waitcnt lgkmcnt(12)
    v_mfma_f32_16x16x32_bf16 v[60:63], v[76:79], v[108:111], v[60:63]
    v_mfma_f32_16x16x32_bf16 v[56:59], v[76:79], v[104:107], v[56:59]
    buffer_load_dwordx4 v132, s[8:11], s23 offen offset:3072 lds
    v_mfma_f32_16x16x32_bf16 v[52:55], v[76:79], v[100:103], v[52:55]
    v_mfma_f32_16x16x32_bf16 v[48:51], v[76:79], v[96:99], v[48:51]
    s_add_u32 s23, s23, 128
    s_waitcnt lgkmcnt(9)
    v_mfma_f32_16x16x32_bf16 v[0:3], v[80:83], v[112:115], v[0:3]
    s_waitcnt lgkmcnt(8)
    v_mfma_f32_16x16x32_bf16 v[4:7], v[80:83], v[116:119], v[4:7]
    s_waitcnt vmcnt(16) lgkmcnt(0)
    s_barrier
    v_mfma_f32_16x16x32_bf16 v[8:11], v[80:83], v[120:123], v[8:11]
    ds_read_b128 v[96:99], v137 offset:49152
    s_add_u32 m0, s20, 65536
    v_mfma_f32_16x16x32_bf16 v[12:15], v[80:83], v[124:127], v[12:15]
    ds_read_b64_tr_b16 v[64:65], v134 offset:32768
    buffer_load_dwordx4 v128, s[4:7], s22 offen offset:0 lds
    v_mfma_f32_16x16x32_bf16 v[28:31], v[84:87], v[124:127], v[28:31]
    ds_read_b64_tr_b16 v[66:67], v134 offset:33280
    v_mfma_f32_16x16x32_bf16 v[24:27], v[84:87], v[120:123], v[24:27]
    ds_read_b128 v[100:103], v137 offset:51200
    v_mfma_f32_16x16x32_bf16 v[20:23], v[84:87], v[116:119], v[20:23]
    ds_read_b128 v[104:107], v137 offset:53248
    buffer_load_dwordx4 v128, s[4:7], s22 offen offset:1024 lds
    v_mfma_f32_16x16x32_bf16 v[16:19], v[84:87], v[112:115], v[16:19]
    ds_read_b128 v[108:111], v137 offset:55296
    v_mfma_f32_16x16x32_bf16 v[32:35], v[88:91], v[112:115], v[32:35]
    ds_read_b64_tr_b16 v[68:69], v134 offset:33024
    v_mfma_f32_16x16x32_bf16 v[36:39], v[88:91], v[116:119], v[36:39]
    ds_read_b64_tr_b16 v[70:71], v134 offset:33536
    buffer_load_dwordx4 v128, s[4:7], s22 offen offset:2048 lds
    v_mfma_f32_16x16x32_bf16 v[40:43], v[88:91], v[120:123], v[40:43]
    ds_read_b64_tr_b16 v[72:73], v134 offset:33792
    v_mfma_f32_16x16x32_bf16 v[44:47], v[88:91], v[124:127], v[44:47]
    ds_read_b64_tr_b16 v[74:75], v134 offset:34304
    v_mfma_f32_16x16x32_bf16 v[60:63], v[92:95], v[124:127], v[60:63]
    ds_read_b64_tr_b16 v[76:77], v134 offset:34048
    buffer_load_dwordx4 v128, s[4:7], s22 offen offset:3072 lds
    v_mfma_f32_16x16x32_bf16 v[56:59], v[92:95], v[120:123], v[56:59]
    ds_read_b64_tr_b16 v[78:79], v134 offset:34560
    v_mfma_f32_16x16x32_bf16 v[52:55], v[92:95], v[116:119], v[52:55]
    s_add_u32 s22, s22, 229376
    v_mfma_f32_16x16x32_bf16 v[48:51], v[92:95], v[112:115], v[48:51]
    s_waitcnt lgkmcnt(9)
    v_mfma_f32_16x16x32_bf16 v[0:3], v[64:67], v[96:99], v[0:3]
    ds_read_b128 v[112:115], v138 offset:49152
    s_add_u32 m0, s20, 81920
    s_waitcnt lgkmcnt(9)
    v_mfma_f32_16x16x32_bf16 v[4:7], v[64:67], v[100:103], v[4:7]
    ds_read_b64_tr_b16 v[80:81], v134 offset:40960
    buffer_load_dwordx4 v129, s[8:11], s23 offen offset:0 lds
    s_waitcnt lgkmcnt(9)
    v_mfma_f32_16x16x32_bf16 v[8:11], v[64:67], v[104:107], v[8:11]
    ds_read_b64_tr_b16 v[82:83], v134 offset:41472
    s_waitcnt lgkmcnt(9)
    v_mfma_f32_16x16x32_bf16 v[12:15], v[64:67], v[108:111], v[12:15]
    ds_read_b128 v[116:119], v138 offset:51200
    s_waitcnt lgkmcnt(8)
    v_mfma_f32_16x16x32_bf16 v[28:31], v[68:71], v[108:111], v[28:31]
    ds_read_b128 v[120:123], v138 offset:53248
    v_mfma_f32_16x16x32_bf16 v[24:27], v[68:71], v[104:107], v[24:27]
    ds_read_b128 v[124:127], v138 offset:55296
    buffer_load_dwordx4 v130, s[8:11], s23 offen offset:1024 lds
    v_mfma_f32_16x16x32_bf16 v[20:23], v[68:71], v[100:103], v[20:23]
    ds_read_b64_tr_b16 v[84:85], v134 offset:41216
    v_mfma_f32_16x16x32_bf16 v[16:19], v[68:71], v[96:99], v[16:19]
    ds_read_b64_tr_b16 v[86:87], v134 offset:41728
    s_waitcnt lgkmcnt(10)
    v_mfma_f32_16x16x32_bf16 v[32:35], v[72:75], v[96:99], v[32:35]
    ds_read_b64_tr_b16 v[88:89], v134 offset:41984
    v_mfma_f32_16x16x32_bf16 v[36:39], v[72:75], v[100:103], v[36:39]
    ds_read_b64_tr_b16 v[90:91], v134 offset:42496
    buffer_load_dwordx4 v131, s[8:11], s23 offen offset:2048 lds
    v_mfma_f32_16x16x32_bf16 v[40:43], v[72:75], v[104:107], v[40:43]
    ds_read_b64_tr_b16 v[92:93], v134 offset:42240
    v_mfma_f32_16x16x32_bf16 v[44:47], v[72:75], v[108:111], v[44:47]
    ds_read_b64_tr_b16 v[94:95], v134 offset:42752
    s_waitcnt lgkmcnt(12)
    v_mfma_f32_16x16x32_bf16 v[60:63], v[76:79], v[108:111], v[60:63]
    v_mfma_f32_16x16x32_bf16 v[56:59], v[76:79], v[104:107], v[56:59]
    buffer_load_dwordx4 v132, s[8:11], s23 offen offset:3072 lds
    v_mfma_f32_16x16x32_bf16 v[52:55], v[76:79], v[100:103], v[52:55]
    v_mfma_f32_16x16x32_bf16 v[48:51], v[76:79], v[96:99], v[48:51]
    s_add_u32 s23, s23, 128
    s_waitcnt lgkmcnt(9)
    v_mfma_f32_16x16x32_bf16 v[0:3], v[80:83], v[112:115], v[0:3]
    s_cmp_gt_u32 s26, 4
    s_cbranch_scc1 k23_kernel_zskip
    s_mov_b32 m0, s72
    s_add_u32 s72, s72, 2048
    buffer_load_dwordx4 v180, s[4:7], s73 offen lds
    buffer_load_dwordx4 v180, s[4:7], s73 offen offset:1024 lds
    s_add_u32 s73, s73, 57344
k23_kernel_zskip:
    s_waitcnt lgkmcnt(8)
    v_mfma_f32_16x16x32_bf16 v[4:7], v[80:83], v[116:119], v[4:7]
    s_waitcnt vmcnt(16) lgkmcnt(0)
    s_barrier
    v_mfma_f32_16x16x32_bf16 v[8:11], v[80:83], v[120:123], v[8:11]
    ds_read_b128 v[96:99], v135 offset:16384
    s_add_u32 m0, s20, 98304
    v_mfma_f32_16x16x32_bf16 v[12:15], v[80:83], v[124:127], v[12:15]
    ds_read_b64_tr_b16 v[64:65], v133 offset:0
    buffer_load_dwordx4 v128, s[4:7], s22 offen offset:0 lds
    v_mfma_f32_16x16x32_bf16 v[28:31], v[84:87], v[124:127], v[28:31]
    ds_read_b64_tr_b16 v[66:67], v133 offset:512
    v_mfma_f32_16x16x32_bf16 v[24:27], v[84:87], v[120:123], v[24:27]
    ds_read_b128 v[100:103], v135 offset:18432
    v_mfma_f32_16x16x32_bf16 v[20:23], v[84:87], v[116:119], v[20:23]
    ds_read_b128 v[104:107], v135 offset:20480
    buffer_load_dwordx4 v128, s[4:7], s22 offen offset:1024 lds
    v_mfma_f32_16x16x32_bf16 v[16:19], v[84:87], v[112:115], v[16:19]
    ds_read_b128 v[108:111], v135 offset:22528
    v_mfma_f32_16x16x32_bf16 v[32:35], v[88:91], v[112:115], v[32:35]
    ds_read_b64_tr_b16 v[68:69], v133 offset:256
    v_mfma_f32_16x16x32_bf16 v[36:39], v[88:91], v[116:119], v[36:39]
    ds_read_b64_tr_b16 v[70:71], v133 offset:768
    buffer_load_dwordx4 v128, s[4:7], s22 offen offset:2048 lds
    v_mfma_f32_16x16x32_bf16 v[40:43], v[88:91], v[120:123], v[40:43]
    ds_read_b64_tr_b16 v[72:73], v133 offset:1024
    v_mfma_f32_16x16x32_bf16 v[44:47], v[88:91], v[124:127], v[44:47]
    ds_read_b64_tr_b16 v[74:75], v133 offset:1536
    v_mfma_f32_16x16x32_bf16 v[60:63], v[92:95], v[124:127], v[60:63]
    ds_read_b64_tr_b16 v[76:77], v133 offset:1280
    buffer_load_dwordx4 v128, s[4:7], s22 offen offset:3072 lds
    v_mfma_f32_16x16x32_bf16 v[56:59], v[92:95], v[120:123], v[56:59]
    ds_read_b64_tr_b16 v[78:79], v133 offset:1792
    v_mfma_f32_16x16x32_bf16 v[52:55], v[92:95], v[116:119], v[52:55]
    s_add_u32 s22, s22, 229376
    v_mfma_f32_16x16x32_bf16 v[48:51], v[92:95], v[112:115], v[48:51]
    s_waitcnt lgkmcnt(9)
    v_mfma_f32_16x16x32_bf16 v[0:3], v[64:67], v[96:99], v[0:3]
    ds_read_b128 v[112:115], v136 offset:16384
    s_add_u32 m0, s20, 114688
    s_waitcnt lgkmcnt(9)
    v_mfma_f32_16x16x32_bf16 v[4:7], v[64:67], v[100:103], v[4:7]
    ds_read_b64_tr_b16 v[80:81], v133 offset:8192
    buffer_load_dwordx4 v129, s[8:11], s23 offen offset:0 lds
    s_waitcnt lgkmcnt(9)
    v_mfma_f32_16x16x32_bf16 v[8:11], v[64:67], v[104:107], v[8:11]
    ds_read_b64_tr_b16 v[82:83], v133 offset:8704
    s_waitcnt lgkmcnt(9)
    v_mfma_f32_16x16x32_bf16 v[12:15], v[64:67], v[108:111], v[12:15]
    ds_read_b128 v[116:119], v136 offset:18432
    s_waitcnt lgkmcnt(8)
    v_mfma_f32_16x16x32_bf16 v[28:31], v[68:71], v[108:111], v[28:31]
    ds_read_b128 v[120:123], v136 offset:20480
    v_mfma_f32_16x16x32_bf16 v[24:27], v[68:71], v[104:107], v[24:27]
    ds_read_b128 v[124:127], v136 offset:22528
    buffer_load_dwordx4 v130, s[8:11], s23 offen offset:1024 lds
    v_mfma_f32_16x16x32_bf16 v[20:23], v[68:71], v[100:103], v[20:23]
    ds_read_b64_tr_b16 v[84:85], v133 offset:8448
    v_mfma_f32_16x16x32_bf16 v[16:19], v[68:71], v[96:99], v[16:19]
    ds_read_b64_tr_b16 v[86:87], v133 offset:8960
    s_waitcnt lgkmcnt(10)
    v_mfma_f32_16x16x32_bf16 v[32:35], v[72:75], v[96:99], v[32:35]
    ds_read_b64_tr_b16 v[88:89], v133 offset:9216
    v_mfma_f32_16x16x32_bf16 v[36:39], v[72:75], v[100:103], v[36:39]
    ds_read_b64_tr_b16 v[90:91], v133 offset:9728
    buffer_load_dwordx4 v131, s[8:11], s23 offen offset:2048 lds
    v_mfma_f32_16x16x32_bf16 v[40:43], v[72:75], v[104:107], v[40:43]
    ds_read_b64_tr_b16 v[92:93], v133 offset:9472
    v_mfma_f32_16x16x32_bf16 v[44:47], v[72:75], v[108:111], v[44:47]
    ds_read_b64_tr_b16 v[94:95], v133 offset:9984
    s_waitcnt lgkmcnt(12)
    v_mfma_f32_16x16x32_bf16 v[60:63], v[76:79], v[108:111], v[60:63]
    v_mfma_f32_16x16x32_bf16 v[56:59], v[76:79], v[104:107], v[56:59]
    buffer_load_dwordx4 v132, s[8:11], s23 offen offset:3072 lds
    v_mfma_f32_16x16x32_bf16 v[52:55], v[76:79], v[100:103], v[52:55]
    v_mfma_f32_16x16x32_bf16 v[48:51], v[76:79], v[96:99], v[48:51]
    s_add_u32 s23, s23, 128
    s_waitcnt lgkmcnt(9)
    v_mfma_f32_16x16x32_bf16 v[0:3], v[80:83], v[112:115], v[0:3]
    s_waitcnt lgkmcnt(8)
    v_mfma_f32_16x16x32_bf16 v[4:7], v[80:83], v[116:119], v[4:7]
    s_waitcnt vmcnt(16) lgkmcnt(0)
    s_barrier
    v_mfma_f32_16x16x32_bf16 v[8:11], v[80:83], v[120:123], v[8:11]
    ds_read_b128 v[96:99], v135 offset:49152
    s_add_u32 m0, s20, 0
    v_mfma_f32_16x16x32_bf16 v[12:15], v[80:83], v[124:127], v[12:15]
    ds_read_b64_tr_b16 v[64:65], v133 offset:32768
    buffer_load_dwordx4 v128, s[4:7], s22 offen offset:0 lds
    v_mfma_f32_16x16x32_bf16 v[28:31], v[84:87], v[124:127], v[28:31]
    ds_read_b64_tr_b16 v[66:67], v133 offset:33280
    v_mfma_f32_16x16x32_bf16 v[24:27], v[84:87], v[120:123], v[24:27]
    ds_read_b128 v[100:103], v135 offset:51200
    v_mfma_f32_16x16x32_bf16 v[20:23], v[84:87], v[116:119], v[20:23]
    ds_read_b128 v[104:107], v135 offset:53248
    buffer_load_dwordx4 v128, s[4:7], s22 offen offset:1024 lds
    v_mfma_f32_16x16x32_bf16 v[16:19], v[84:87], v[112:115], v[16:19]
    ds_read_b128 v[108:111], v135 offset:55296
    v_mfma_f32_16x16x32_bf16 v[32:35], v[88:91], v[112:115], v[32:35]
    ds_read_b64_tr_b16 v[68:69], v133 offset:33024
    v_mfma_f32_16x16x32_bf16 v[36:39], v[88:91], v[116:119], v[36:39]
    ds_read_b64_tr_b16 v[70:71], v133 offset:33536
    buffer_load_dwordx4 v128, s[4:7], s22 offen offset:2048 lds
    v_mfma_f32_16x16x32_bf16 v[40:43], v[88:91], v[120:123], v[40:43]
    ds_read_b64_tr_b16 v[72:73], v133 offset:33792
    v_mfma_f32_16x16x32_bf16 v[44:47], v[88:91], v[124:127], v[44:47]
    ds_read_b64_tr_b16 v[74:75], v133 offset:34304
    v_mfma_f32_16x16x32_bf16 v[60:63], v[92:95], v[124:127], v[60:63]
    ds_read_b64_tr_b16 v[76:77], v133 offset:34048
    buffer_load_dwordx4 v128, s[4:7], s22 offen offset:3072 lds
    v_mfma_f32_16x16x32_bf16 v[56:59], v[92:95], v[120:123], v[56:59]
    ds_read_b64_tr_b16 v[78:79], v133 offset:34560
    v_mfma_f32_16x16x32_bf16 v[52:55], v[92:95], v[116:119], v[52:55]
    s_add_u32 s22, s22, 229376
    v_mfma_f32_16x16x32_bf16 v[48:51], v[92:95], v[112:115], v[48:51]
    s_sub_u32 s26, s26, 1
    s_cmp_lg_u32 s26, 0
    s_cbranch_scc1 k23_kernel_loop_1
    s_waitcnt lgkmcnt(9)
    v_mfma_f32_16x16x32_bf16 v[0:3], v[64:67], v[96:99], v[0:3]
    ds_read_b128 v[112:115], v136 offset:49152
    s_add_u32 m0, s20, 16384
    s_waitcnt lgkmcnt(9)
    v_mfma_f32_16x16x32_bf16 v[4:7], v[64:67], v[100:103], v[4:7]
    ds_read_b64_tr_b16 v[80:81], v133 offset:40960
    buffer_load_dwordx4 v129, s[8:11], s23 offen offset:0 lds
    s_waitcnt lgkmcnt(9)
    v_mfma_f32_16x16x32_bf16 v[8:11], v[64:67], v[104:107], v[8:11]
    ds_read_b64_tr_b16 v[82:83], v133 offset:41472
    s_waitcnt lgkmcnt(9)
    v_mfma_f32_16x16x32_bf16 v[12:15], v[64:67], v[108:111], v[12:15]
    ds_read_b128 v[116:119], v136 offset:51200
    s_waitcnt lgkmcnt(8)
    v_mfma_f32_16x16x32_bf16 v[28:31], v[68:71], v[108:111], v[28:31]
    ds_read_b128 v[120:123], v136 offset:53248
    v_mfma_f32_16x16x32_bf16 v[24:27], v[68:71], v[104:107], v[24:27]
    ds_read_b128 v[124:127], v136 offset:55296
    buffer_load_dwordx4 v130, s[8:11], s23 offen offset:1024 lds
    v_mfma_f32_16x16x32_bf16 v[20:23], v[68:71], v[100:103], v[20:23]
    ds_read_b64_tr_b16 v[84:85], v133 offset:41216
    v_mfma_f32_16x16x32_bf16 v[16:19], v[68:71], v[96:99], v[16:19]
    ds_read_b64_tr_b16 v[86:87], v133 offset:41728
    s_waitcnt lgkmcnt(10)
    v_mfma_f32_16x16x32_bf16 v[32:35], v[72:75], v[96:99], v[32:35]
    ds_read_b64_tr_b16 v[88:89], v133 offset:41984
    v_mfma_f32_16x16x32_bf16 v[36:39], v[72:75], v[100:103], v[36:39]
    ds_read_b64_tr_b16 v[90:91], v133 offset:42496
    buffer_load_dwordx4 v131, s[8:11], s23 offen offset:2048 lds
    v_mfma_f32_16x16x32_bf16 v[40:43], v[72:75], v[104:107], v[40:43]
    ds_read_b64_tr_b16 v[92:93], v133 offset:42240
    v_mfma_f32_16x16x32_bf16 v[44:47], v[72:75], v[108:111], v[44:47]
    ds_read_b64_tr_b16 v[94:95], v133 offset:42752
    s_waitcnt lgkmcnt(12)
    v_mfma_f32_16x16x32_bf16 v[60:63], v[76:79], v[108:111], v[60:63]
    v_mfma_f32_16x16x32_bf16 v[56:59], v[76:79], v[104:107], v[56:59]
    buffer_load_dwordx4 v132, s[8:11], s23 offen offset:3072 lds
    v_mfma_f32_16x16x32_bf16 v[52:55], v[76:79], v[100:103], v[52:55]
    v_mfma_f32_16x16x32_bf16 v[48:51], v[76:79], v[96:99], v[48:51]
    s_add_u32 s23, s23, 128
    s_waitcnt lgkmcnt(9)
    v_mfma_f32_16x16x32_bf16 v[0:3], v[80:83], v[112:115], v[0:3]
    s_waitcnt lgkmcnt(8)
    v_mfma_f32_16x16x32_bf16 v[4:7], v[80:83], v[116:119], v[4:7]
    s_waitcnt vmcnt(16) lgkmcnt(0)
    s_barrier
    v_mfma_f32_16x16x32_bf16 v[8:11], v[80:83], v[120:123], v[8:11]
    ds_read_b128 v[96:99], v137 offset:16384
    s_add_u32 m0, s20, 32768
    v_mfma_f32_16x16x32_bf16 v[12:15], v[80:83], v[124:127], v[12:15]
    ds_read_b64_tr_b16 v[64:65], v134 offset:0
    buffer_load_dwordx4 v128, s[4:7], s22 offen offset:0 lds
    v_mfma_f32_16x16x32_bf16 v[28:31], v[84:87], v[124:127], v[28:31]
    ds_read_b64_tr_b16 v[66:67], v134 offset:512
    v_mfma_f32_16x16x32_bf16 v[24:27], v[84:87], v[120:123], v[24:27]
    ds_read_b128 v[100:103], v137 offset:18432
    v_mfma_f32_16x16x32_bf16 v[20:23], v[84:87], v[116:119], v[20:23]
    ds_read_b128 v[104:107], v137 offset:20480
    buffer_load_dwordx4 v128, s[4:7], s22 offen offset:1024 lds
    v_mfma_f32_16x16x32_bf16 v[16:19], v[84:87], v[112:115], v[16:19]
    ds_read_b128 v[108:111], v137 offset:22528
    v_mfma_f32_16x16x32_bf16 v[32:35], v[88:91], v[112:115], v[32:35]
    ds_read_b64_tr_b16 v[68:69], v134 offset:256
    v_mfma_f32_16x16x32_bf16 v[36:39], v[88:91], v[116:119], v[36:39]
    ds_read_b64_tr_b16 v[70:71], v134 offset:768
    buffer_load_dwordx4 v128, s[4:7], s22 offen offset:2048 lds
    v_mfma_f32_16x16x32_bf16 v[40:43], v[88:91], v[120:123], v[40:43]
    ds_read_b64_tr_b16 v[72:73], v134 offset:1024
    v_mfma_f32_16x16x32_bf16 v[44:47], v[88:91], v[124:127], v[44:47]
    ds_read_b64_tr_b16 v[74:75], v134 offset:1536
    v_mfma_f32_16x16x32_bf16 v[60:63], v[92:95], v[124:127], v[60:63]
    ds_read_b64_tr_b16 v[76:77], v134 offset:1280
    buffer_load_dwordx4 v128, s[4:7], s22 offen offset:3072 lds
    v_mfma_f32_16x16x32_bf16 v[56:59], v[92:95], v[120:123], v[56:59]
    ds_read_b64_tr_b16 v[78:79], v134 offset:1792
    v_mfma_f32_16x16x32_bf16 v[52:55], v[92:95], v[116:119], v[52:55]
    s_add_u32 s22, s22, 229376
    v_mfma_f32_16x16x32_bf16 v[48:51], v[92:95], v[112:115], v[48:51]
    s_waitcnt lgkmcnt(9)
    v_mfma_f32_16x16x32_bf16 v[0:3], v[64:67], v[96:99], v[0:3]
    ds_read_b128 v[112:115], v138 offset:16384
    s_add_u32 m0, s20, 49152
    s_waitcnt lgkmcnt(9)
    v_mfma_f32_16x16x32_bf16 v[4:7], v[64:67], v[100:103], v[4:7]
    ds_read_b64_tr_b16 v[80:81], v134 offset:8192
    buffer_load_dwordx4 v129, s[8:11], s23 offen offset:0 lds
    s_waitcnt lgkmcnt(9)
    v_mfma_f32_16x16x32_bf16 v[8:11], v[64:67], v[104:107], v[8:11]
    ds_read_b64_tr_b16 v[82:83], v134 offset:8704
    s_waitcnt lgkmcnt(9)
    v_mfma_f32_16x16x32_bf16 v[12:15], v[64:67], v[108:111], v[12:15]
    ds_read_b128 v[116:119], v138 offset:18432
    s_waitcnt lgkmcnt(8)
    v_mfma_f32_16x16x32_bf16 v[28:31], v[68:71], v[108:111], v[28:31]
    ds_read_b128 v[120:123], v138 offset:20480
    v_mfma_f32_16x16x32_bf16 v[24:27], v[68:71], v[104:107], v[24:27]
    ds_read_b128 v[124:127], v138 offset:22528
    buffer_load_dwordx4 v130, s[8:11], s23 offen offset:1024 lds
    v_mfma_f32_16x16x32_bf16 v[20:23], v[68:71], v[100:103], v[20:23]
    ds_read_b64_tr_b16 v[84:85], v134 offset:8448
    v_mfma_f32_16x16x32_bf16 v[16:19], v[68:71], v[96:99], v[16:19]
    ds_read_b64_tr_b16 v[86:87], v134 offset:8960
    s_waitcnt lgkmcnt(10)
    v_mfma_f32_16x16x32_bf16 v[32:35], v[72:75], v[96:99], v[32:35]
    ds_read_b64_tr_b16 v[88:89], v134 offset:9216
    v_mfma_f32_16x16x32_bf16 v[36:39], v[72:75], v[100:103], v[36:39]
    ds_read_b64_tr_b16 v[90:91], v134 offset:9728
    buffer_load_dwordx4 v131, s[8:11], s23 offen offset:2048 lds
    v_mfma_f32_16x16x32_bf16 v[40:43], v[72:75], v[104:107], v[40:43]
    ds_read_b64_tr_b16 v[92:93], v134 offset:9472
    v_mfma_f32_16x16x32_bf16 v[44:47], v[72:75], v[108:111], v[44:47]
    ds_read_b64_tr_b16 v[94:95], v134 offset:9984
    s_waitcnt lgkmcnt(12)
    v_mfma_f32_16x16x32_bf16 v[60:63], v[76:79], v[108:111], v[60:63]
    v_mfma_f32_16x16x32_bf16 v[56:59], v[76:79], v[104:107], v[56:59]
    buffer_load_dwordx4 v132, s[8:11], s23 offen offset:3072 lds
    v_mfma_f32_16x16x32_bf16 v[52:55], v[76:79], v[100:103], v[52:55]
    v_mfma_f32_16x16x32_bf16 v[48:51], v[76:79], v[96:99], v[48:51]
    s_add_u32 s23, s23, 128
    s_waitcnt lgkmcnt(9)
    v_mfma_f32_16x16x32_bf16 v[0:3], v[80:83], v[112:115], v[0:3]
    s_waitcnt lgkmcnt(8)
    v_mfma_f32_16x16x32_bf16 v[4:7], v[80:83], v[116:119], v[4:7]
    s_waitcnt vmcnt(16) lgkmcnt(0)
    s_barrier
    v_mfma_f32_16x16x32_bf16 v[8:11], v[80:83], v[120:123], v[8:11]
    ds_read_b128 v[96:99], v137 offset:49152
    s_add_u32 m0, s20, 65536
    v_mfma_f32_16x16x32_bf16 v[12:15], v[80:83], v[124:127], v[12:15]
    ds_read_b64_tr_b16 v[64:65], v134 offset:32768
    buffer_load_dwordx4 v128, s[4:7], s22 offen offset:0 lds
    v_mfma_f32_16x16x32_bf16 v[28:31], v[84:87], v[124:127], v[28:31]
    ds_read_b64_tr_b16 v[66:67], v134 offset:33280
    v_mfma_f32_16x16x32_bf16 v[24:27], v[84:87], v[120:123], v[24:27]
    ds_read_b128 v[100:103], v137 offset:51200
    v_mfma_f32_16x16x32_bf16 v[20:23], v[84:87], v[116:119], v[20:23]
    ds_read_b128 v[104:107], v137 offset:53248
    buffer_load_dwordx4 v128, s[4:7], s22 offen offset:1024 lds
    v_mfma_f32_16x16x32_bf16 v[16:19], v[84:87], v[112:115], v[16:19]
    ds_read_b128 v[108:111], v137 offset:55296
    v_mfma_f32_16x16x32_bf16 v[32:35], v[88:91], v[112:115], v[32:35]
    ds_read_b64_tr_b16 v[68:69], v134 offset:33024
    v_mfma_f32_16x16x32_bf16 v[36:39], v[88:91], v[116:119], v[36:39]
    ds_read_b64_tr_b16 v[70:71], v134 offset:33536
    buffer_load_dwordx4 v128, s[4:7], s22 offen offset:2048 lds
    v_mfma_f32_16x16x32_bf16 v[40:43], v[88:91], v[120:123], v[40:43]
    ds_read_b64_tr_b16 v[72:73], v134 offset:33792
    v_mfma_f32_16x16x32_bf16 v[44:47], v[88:91], v[124:127], v[44:47]
    ds_read_b64_tr_b16 v[74:75], v134 offset:34304
    v_mfma_f32_16x16x32_bf16 v[60:63], v[92:95], v[124:127], v[60:63]
    ds_read_b64_tr_b16 v[76:77], v134 offset:34048
    buffer_load_dwordx4 v128, s[4:7], s22 offen offset:3072 lds
    v_mfma_f32_16x16x32_bf16 v[56:59], v[92:95], v[120:123], v[56:59]
    ds_read_b64_tr_b16 v[78:79], v134 offset:34560
    v_mfma_f32_16x16x32_bf16 v[52:55], v[92:95], v[116:119], v[52:55]
    s_add_u32 s22, s22, 229376
    v_mfma_f32_16x16x32_bf16 v[48:51], v[92:95], v[112:115], v[48:51]
    s_waitcnt lgkmcnt(9)
    v_mfma_f32_16x16x32_bf16 v[0:3], v[64:67], v[96:99], v[0:3]
    ds_read_b128 v[112:115], v138 offset:49152
    s_add_u32 m0, s20, 81920
    s_waitcnt lgkmcnt(9)
    v_mfma_f32_16x16x32_bf16 v[4:7], v[64:67], v[100:103], v[4:7]
    ds_read_b64_tr_b16 v[80:81], v134 offset:40960
    buffer_load_dwordx4 v129, s[8:11], s23 offen offset:0 lds
    s_waitcnt lgkmcnt(9)
    v_mfma_f32_16x16x32_bf16 v[8:11], v[64:67], v[104:107], v[8:11]
    ds_read_b64_tr_b16 v[82:83], v134 offset:41472
    s_waitcnt lgkmcnt(9)
    v_mfma_f32_16x16x32_bf16 v[12:15], v[64:67], v[108:111], v[12:15]
    ds_read_b128 v[116:119], v138 offset:51200
    buffer_load_dword v203, v204, s[4:7], s65 offen sc1
    s_waitcnt lgkmcnt(8)
    v_mfma_f32_16x16x32_bf16 v[28:31], v[68:71], v[108:111], v[28:31]
    ds_read_b128 v[120:123], v138 offset:53248
    v_mfma_f32_16x16x32_bf16 v[24:27], v[68:71], v[104:107], v[24:27]
    ds_read_b128 v[124:127], v138 offset:55296
    buffer_load_dwordx4 v130, s[8:11], s23 offen offset:1024 lds
    buffer_load_ushort v176, v185, s[12:15], s40 offen offset:0
    v_mfma_f32_16x16x32_bf16 v[20:23], v[68:71], v[100:103], v[20:23]
    ds_read_b64_tr_b16 v[84:85], v134 offset:41216
    v_mfma_f32_16x16x32_bf16 v[16:19], v[68:71], v[96:99], v[16:19]
    ds_read_b64_tr_b16 v[86:87], v134 offset:41728
    buffer_load_ushort v177, v185, s[12:15], s40 offen offset:32
    s_waitcnt lgkmcnt(10)
    v_mfma_f32_16x16x32_bf16 v[32:35], v[72:75], v[96:99], v[32:35]
    ds_read_b64_tr_b16 v[88:89], v134 offset:41984
    v_mfma_f32_16x16x32_bf16 v[36:39], v[72:75], v[100:103], v[36:39]
    ds_read_b64_tr_b16 v[90:91], v134 offset:42496
    buffer_load_dwordx4 v131, s[8:11], s23 offen offset:2048 lds
    buffer_load_ushort v178, v185, s[12:15], s40 offen offset:64
    v_mfma_f32_16x16x32_bf16 v[40:43], v[72:75], v[104:107], v[40:43]
    ds_read_b64_tr_b16 v[92:93], v134 offset:42240
    v_mfma_f32_16x16x32_bf16 v[44:47], v[72:75], v[108:111], v[44:47]
    ds_read_b64_tr_b16 v[94:95], v134 offset:42752
    buffer_load_ushort v179, v185, s[12:15], s40 offen offset:96
    s_waitcnt lgkmcnt(12)
    v_mfma_f32_16x16x32_bf16 v[60:63], v[76:79], v[108:111], v[60:63]
    v_mfma_f32_16x16x32_bf16 v[56:59], v[76:79], v[104:107], v[56:59]
    buffer_load_dwordx4 v132, s[8:11], s23 offen offset:3072 lds
    v_mfma_f32_16x16x32_bf16 v[52:55], v[76:79], v[100:103], v[52:55]
    v_mfma_f32_16x16x32_bf16 v[48:51], v[76:79], v[96:99], v[48:51]
    s_add_u32 s23, s23, 128
    s_waitcnt lgkmcnt(9)
    v_mfma_f32_16x16x32_bf16 v[0:3], v[80:83], v[112:115], v[0:3]
    s_waitcnt lgkmcnt(8)
    v_mfma_f32_16x16x32_bf16 v[4:7], v[80:83], v[116:119], v[4:7]
    s_waitcnt vmcnt(21) lgkmcnt(0)
    s_barrier
    v_mfma_f32_16x16x32_bf16 v[8:11], v[80:83], v[120:123], v[8:11]
    ds_read_b128 v[96:99], v135 offset:16384
    s_add_u32 m0, s20, 98304
    v_mfma_f32_16x16x32_bf16 v[12:15], v[80:83], v[124:127], v[12:15]
    ds_read_b64_tr_b16 v[64:65], v133 offset:0
    buffer_load_dwordx4 v128, s[4:7], s22 offen offset:0 lds
    v_mfma_f32_16x16x32_bf16 v[28:31], v[84:87], v[124:127], v[28:31]
    ds_read_b64_tr_b16 v[66:67], v133 offset:512
    v_mfma_f32_16x16x32_bf16 v[24:27], v[84:87], v[120:123], v[24:27]
    ds_read_b128 v[100:103], v135 offset:18432
    v_mfma_f32_16x16x32_bf16 v[20:23], v[84:87], v[116:119], v[20:23]
    ds_read_b128 v[104:107], v135 offset:20480
    buffer_load_dwordx4 v128, s[4:7], s22 offen offset:1024 lds
    v_mfma_f32_16x16x32_bf16 v[16:19], v[84:87], v[112:115], v[16:19]
    ds_read_b128 v[108:111], v135 offset:22528
    v_mfma_f32_16x16x32_bf16 v[32:35], v[88:91], v[112:115], v[32:35]
    ds_read_b64_tr_b16 v[68:69], v133 offset:256
    v_mfma_f32_16x16x32_bf16 v[36:39], v[88:91], v[116:119], v[36:39]
    ds_read_b64_tr_b16 v[70:71], v133 offset:768
    buffer_load_dwordx4 v128, s[4:7], s22 offen offset:2048 lds
    v_mfma_f32_16x16x32_bf16 v[40:43], v[88:91], v[120:123], v[40:43]
    ds_read_b64_tr_b16 v[72:73], v133 offset:1024
    v_mfma_f32_16x16x32_bf16 v[44:47], v[88:91], v[124:127], v[44:47]
    ds_read_b64_tr_b16 v[74:75], v133 offset:1536
    v_mfma_f32_16x16x32_bf16 v[60:63], v[92:95], v[124:127], v[60:63]
    ds_read_b64_tr_b16 v[76:77], v133 offset:1280
    buffer_load_dwordx4 v128, s[4:7], s22 offen offset:3072 lds
    v_mfma_f32_16x16x32_bf16 v[56:59], v[92:95], v[120:123], v[56:59]
    ds_read_b64_tr_b16 v[78:79], v133 offset:1792
    v_mfma_f32_16x16x32_bf16 v[52:55], v[92:95], v[116:119], v[52:55]
    s_add_u32 s22, s22, 229376
    v_mfma_f32_16x16x32_bf16 v[48:51], v[92:95], v[112:115], v[48:51]
    s_waitcnt lgkmcnt(9)
    v_mfma_f32_16x16x32_bf16 v[0:3], v[64:67], v[96:99], v[0:3]
    ds_read_b128 v[112:115], v136 offset:16384
    s_add_u32 m0, s20, 114688
    s_waitcnt lgkmcnt(9)
    v_mfma_f32_16x16x32_bf16 v[4:7], v[64:67], v[100:103], v[4:7]
    ds_read_b64_tr_b16 v[80:81], v133 offset:8192
    buffer_load_dwordx4 v129, s[8:11], s23 offen offset:0 lds
    s_waitcnt lgkmcnt(9)
    v_mfma_f32_16x16x32_bf16 v[8:11], v[64:67], v[104:107], v[8:11]
    ds_read_b64_tr_b16 v[82:83], v133 offset:8704
    s_waitcnt lgkmcnt(9)
    v_mfma_f32_16x16x32_bf16 v[12:15], v[64:67], v[108:111], v[12:15]
    ds_read_b128 v[116:119], v136 offset:18432
    s_waitcnt lgkmcnt(8)
    v_mfma_f32_16x16x32_bf16 v[28:31], v[68:71], v[108:111], v[28:31]
    ds_read_b128 v[120:123], v136 offset:20480
    v_mfma_f32_16x16x32_bf16 v[24:27], v[68:71], v[104:107], v[24:27]
    ds_read_b128 v[124:127], v136 offset:22528
    buffer_load_dwordx4 v130, s[8:11], s23 offen offset:1024 lds
    v_mfma_f32_16x16x32_bf16 v[20:23], v[68:71], v[100:103], v[20:23]
    ds_read_b64_tr_b16 v[84:85], v133 offset:8448
    v_mfma_f32_16x16x32_bf16 v[16:19], v[68:71], v[96:99], v[16:19]
    ds_read_b64_tr_b16 v[86:87], v133 offset:8960
    s_waitcnt lgkmcnt(10)
    v_mfma_f32_16x16x32_bf16 v[32:35], v[72:75], v[96:99], v[32:35]
    ds_read_b64_tr_b16 v[88:89], v133 offset:9216
    v_mfma_f32_16x16x32_bf16 v[36:39], v[72:75], v[100:103], v[36:39]
    ds_read_b64_tr_b16 v[90:91], v133 offset:9728
    buffer_load_dwordx4 v131, s[8:11], s23 offen offset:2048 lds
    v_mfma_f32_16x16x32_bf16 v[40:43], v[72:75], v[104:107], v[40:43]
    ds_read_b64_tr_b16 v[92:93], v133 offset:9472
    v_mfma_f32_16x16x32_bf16 v[44:47], v[72:75], v[108:111], v[44:47]
    ds_read_b64_tr_b16 v[94:95], v133 offset:9984
    s_waitcnt lgkmcnt(12)
    v_mfma_f32_16x16x32_bf16 v[60:63], v[76:79], v[108:111], v[60:63]
    v_mfma_f32_16x16x32_bf16 v[56:59], v[76:79], v[104:107], v[56:59]
    buffer_load_dwordx4 v132, s[8:11], s23 offen offset:3072 lds
    v_mfma_f32_16x16x32_bf16 v[52:55], v[76:79], v[100:103], v[52:55]
    v_mfma_f32_16x16x32_bf16 v[48:51], v[76:79], v[96:99], v[48:51]
    s_add_u32 s23, s23, 128
    s_waitcnt lgkmcnt(9)
    v_mfma_f32_16x16x32_bf16 v[0:3], v[80:83], v[112:115], v[0:3]
    s_waitcnt vmcnt(15)
    v_cmp_eq_u32 vcc, 0, v203
    s_mov_b32 s36, 0x40000
    s_nop 0
    s_cbranch_vccz k23_kernel_o_got
k23_kernel_o_spin:
    buffer_load_dword v203, v204, s[4:7], s65 offen sc1
    s_waitcnt vmcnt(0)
    v_cmp_eq_u32 vcc, 0, v203
    s_sub_u32 s36, s36, 1
    s_cbranch_scc1 k23_kernel_o_got
    s_cbranch_vccz k23_kernel_o_got
    s_sleep 2
    s_branch k23_kernel_o_spin
k23_kernel_o_got:
    s_waitcnt lgkmcnt(8)
    v_mfma_f32_16x16x32_bf16 v[4:7], v[80:83], v[116:119], v[4:7]
    s_waitcnt lgkmcnt(0)
    s_barrier
    v_mfma_f32_16x16x32_bf16 v[8:11], v[80:83], v[120:123], v[8:11]
    ds_read_b128 v[96:99], v135 offset:49152
    s_add_u32 m0, s66, 0
    v_mfma_f32_16x16x32_bf16 v[12:15], v[80:83], v[124:127], v[12:15]
    ds_read_b64_tr_b16 v[64:65], v133 offset:32768
    buffer_load_dwordx4 v192, s[48:51], s60 offen offset:0 lds
    v_mfma_f32_16x16x32_bf16 v[28:31], v[84:87], v[124:127], v[28:31]
    ds_read_b64_tr_b16 v[66:67], v133 offset:33280
    v_mfma_f32_16x16x32_bf16 v[24:27], v[84:87], v[120:123], v[24:27]
    ds_read_b128 v[100:103], v135 offset:51200
    v_mfma_f32_16x16x32_bf16 v[20:23], v[84:87], v[116:119], v[20:23]
    ds_read_b128 v[104:107], v135 offset:53248
    v_mfma_f32_16x16x32_bf16 v[16:19], v[84:87], v[112:115], v[16:19]
    ds_read_b128 v[108:111], v135 offset:55296
    buffer_load_dwordx4 v193, s[48:51], s60 offen offset:1024 lds
    s_add_u32 s60, s60, 131072
    v_mfma_f32_16x16x32_bf16 v[32:35], v[88:91], v[112:115], v[32:35]
    ds_read_b64_tr_b16 v[68:69], v133 offset:33024
    v_mfma_f32_16x16x32_bf16 v[36:39], v[88:91], v[116:119], v[36:39]
    ds_read_b64_tr_b16 v[70:71], v133 offset:33536
    v_mfma_f32_16x16x32_bf16 v[40:43], v[88:91], v[120:123], v[40:43]
    ds_read_b64_tr_b16 v[72:73], v133 offset:33792
    s_add_u32 m0, s66, 8192
    v_mfma_f32_16x16x32_bf16 v[44:47], v[88:91], v[124:127], v[44:47]
    ds_read_b64_tr_b16 v[74:75], v133 offset:34304
    buffer_load_dwordx4 v192, s[48:51], s60 offen offset:0 lds
    v_mfma_f32_16x16x32_bf16 v[60:63], v[92:95], v[124:127], v[60:63]
    ds_read_b64_tr_b16 v[76:77], v133 offset:34048
    v_mfma_f32_16x16x32_bf16 v[56:59], v[92:95], v[120:123], v[56:59]
    ds_read_b64_tr_b16 v[78:79], v133 offset:34560
    v_mfma_f32_16x16x32_bf16 v[52:55], v[92:95], v[116:119], v[52:55]
    v_mfma_f32_16x16x32_bf16 v[48:51], v[92:95], v[112:115], v[48:51]
    buffer_load_dwordx4 v193, s[48:51], s60 offen offset:1024 lds
    s_add_u32 s60, s60, 131072
    s_waitcnt lgkmcnt(9)
    v_mfma_f32_16x16x32_bf16 v[0:3], v[64:67], v[96:99], v[0:3]
    ds_read_b128 v[112:115], v136 offset:49152
    s_waitcnt lgkmcnt(9)
    v_mfma_f32_16x16x32_bf16 v[4:7], v[64:67], v[100:103], v[4:7]
    ds_read_b64_tr_b16 v[80:81], v133 offset:40960
    s_waitcnt lgkmcnt(9)
    v_mfma_f32_16x16x32_bf16 v[8:11], v[64:67], v[104:107], v[8:11]
    ds_read_b64_tr_b16 v[82:83], v133 offset:41472
    buffer_load_dwordx4 a[0:3], v180, s[4:7], s61 offen offset:0
    s_waitcnt lgkmcnt(9)
    v_mfma_f32_16x16x32_bf16 v[12:15], v[64:67], v[108:111], v[12:15]
    ds_read_b128 v[116:119], v136 offset:51200
    s_waitcnt lgkmcnt(8)
    v_mfma_f32_16x16x32_bf16 v[28:31], v[68:71], v[108:111], v[28:31]
    ds_read_b128 v[120:123], v136 offset:53248
    v_mfma_f32_16x16x32_bf16 v[24:27], v[68:71], v[104:107], v[24:27]
    ds_read_b128 v[124:127], v136 offset:55296
    v_mfma_f32_16x16x32_bf16 v[20:23], v[68:71], v[100:103], v[20:23]
    ds_read_b64_tr_b16 v[84:85], v133 offset:41216
    buffer_load_dwordx4 a[8:11], v180, s[4:7], s61 offen offset:1024
    s_add_u32 s61, s61, 2048
    v_mfma_f32_16x16x32_bf16 v[16:19], v[68:71], v[96:99], v[16:19]
    ds_read_b64_tr_b16 v[86:87], v133 offset:41728
    s_waitcnt lgkmcnt(10)
    v_mfma_f32_16x16x32_bf16 v[32:35], v[72:75], v[96:99], v[32:35]
    ds_read_b64_tr_b16 v[88:89], v133 offset:41984
    v_mfma_f32_16x16x32_bf16 v[36:39], v[72:75], v[100:103], v[36:39]
    ds_read_b64_tr_b16 v[90:91], v133 offset:42496
    v_mfma_f32_16x16x32_bf16 v[40:43], v[72:75], v[104:107], v[40:43]
    ds_read_b64_tr_b16 v[92:93], v133 offset:42240
    buffer_load_dwordx4 a[4:7], v180, s[4:7], s62 offen offset:0
    v_mfma_f32_16x16x32_bf16 v[44:47], v[72:75], v[108:111], v[44:47]
    ds_read_b64_tr_b16 v[94:95], v133 offset:42752
    s_waitcnt lgkmcnt(12)
    v_mfma_f32_16x16x32_bf16 v[60:63], v[76:79], v[108:111], v[60:63]
    v_mfma_f32_16x16x32_bf16 v[56:59], v[76:79], v[104:107], v[56:59]
    v_mfma_f32_16x16x32_bf16 v[52:55], v[76:79], v[100:103], v[52:55]
    buffer_load_dwordx4 a[12:15], v180, s[4:7], s62 offen offset:1024
    s_add_u32 s62, s62, 2048
    v_mfma_f32_16x16x32_bf16 v[48:51], v[76:79], v[96:99], v[48:51]
    s_waitcnt lgkmcnt(9)
    v_mfma_f32_16x16x32_bf16 v[0:3], v[80:83], v[112:115], v[0:3]
    s_waitcnt lgkmcnt(8)
    v_mfma_f32_16x16x32_bf16 v[4:7], v[80:83], v[116:119], v[4:7]
    s_waitcnt vmcnt(16) lgkmcnt(0)
    s_barrier
    v_mfma_f32_16x16x32_bf16 v[8:11], v[80:83], v[120:123], v[8:11]
    ds_read_b128 v[96:99], v137 offset:16384
    s_add_u32 m0, s66, 16384
    v_mfma_f32_16x16x32_bf16 v[12:15], v[80:83], v[124:127], v[12:15]
    ds_read_b64_tr_b16 v[64:65], v134 offset:0
    buffer_load_dwordx4 v192, s[48:51], s60 offen offset:0 lds
    v_mfma_f32_16x16x32_bf16 v[28:31], v[84:87], v[124:127], v[28:31]
    ds_read_b64_tr_b16 v[66:67], v134 offset:512
    v_mfma_f32_16x16x32_bf16 v[24:27], v[84:87], v[120:123], v[24:27]
    ds_read_b128 v[100:103], v137 offset:18432
    v_mfma_f32_16x16x32_bf16 v[20:23], v[84:87], v[116:119], v[20:23]
    ds_read_b128 v[104:107], v137 offset:20480
    v_mfma_f32_16x16x32_bf16 v[16:19], v[84:87], v[112:115], v[16:19]
    ds_read_b128 v[108:111], v137 offset:22528
    buffer_load_dwordx4 v193, s[48:51], s60 offen offset:1024 lds
    s_add_u32 s60, s60, 131072
    v_mfma_f32_16x16x32_bf16 v[32:35], v[88:91], v[112:115], v[32:35]
    ds_read_b64_tr_b16 v[68:69], v134 offset:256
    v_mfma_f32_16x16x32_bf16 v[36:39], v[88:91], v[116:119], v[36:39]
    ds_read_b64_tr_b16 v[70:71], v134 offset:768
    v_mfma_f32_16x16x32_bf16 v[40:43], v[88:91], v[120:123], v[40:43]
    ds_read_b64_tr_b16 v[72:73], v134 offset:1024
    v_mfma_f32_16x16x32_bf16 v[44:47], v[88:91], v[124:127], v[44:47]
    ds_read_b64_tr_b16 v[74:75], v134 offset:1536
    buffer_load_dwordx4 a[16:19], v180, s[4:7], s61 offen offset:0
    v_mfma_f32_16x16x32_bf16 v[60:63], v[92:95], v[124:127], v[60:63]
    ds_read_b64_tr_b16 v[76:77], v134 offset:1280
    v_mfma_f32_16x16x32_bf16 v[56:59], v[92:95], v[120:123], v[56:59]
    ds_read_b64_tr_b16 v[78:79], v134 offset:1792
    v_mfma_f32_16x16x32_bf16 v[52:55], v[92:95], v[116:119], v[52:55]
    v_mfma_f32_16x16x32_bf16 v[48:51], v[92:95], v[112:115], v[48:51]
    buffer_load_dwordx4 a[24:27], v180, s[4:7], s61 offen offset:1024
    s_add_u32 s61, s61, 2048
    s_waitcnt lgkmcnt(9)
    v_mfma_f32_16x16x32_bf16 v[0:3], v[64:67], v[96:99], v[0:3]
    ds_read_b128 v[112:115], v138 offset:16384
    s_waitcnt lgkmcnt(9)
    v_mfma_f32_16x16x32_bf16 v[4:7], v[64:67], v[100:103], v[4:7]
    ds_read_b64_tr_b16 v[80:81], v134 offset:8192
    s_waitcnt lgkmcnt(9)
    v_mfma_f32_16x16x32_bf16 v[8:11], v[64:67], v[104:107], v[8:11]
    ds_read_b64_tr_b16 v[82:83], v134 offset:8704
    buffer_load_dwordx4 a[20:23], v180, s[4:7], s62 offen offset:0
    s_waitcnt lgkmcnt(9)
    v_mfma_f32_16x16x32_bf16 v[12:15], v[64:67], v[108:111], v[12:15]
    ds_read_b128 v[116:119], v138 offset:18432
    s_waitcnt lgkmcnt(8)
    v_mfma_f32_16x16x32_bf16 v[28:31], v[68:71], v[108:111], v[28:31]
    ds_read_b128 v[120:123], v138 offset:20480
    v_mfma_f32_16x16x32_bf16 v[24:27], v[68:71], v[104:107], v[24:27]
    ds_read_b128 v[124:127], v138 offset:22528
    v_mfma_f32_16x16x32_bf16 v[20:23], v[68:71], v[100:103], v[20:23]
    ds_read_b64_tr_b16 v[84:85], v134 offset:8448
    buffer_load_dwordx4 a[28:31], v180, s[4:7], s62 offen offset:1024
    s_add_u32 s62, s62, 2048
    v_mfma_f32_16x16x32_bf16 v[16:19], v[68:71], v[96:99], v[16:19]
    ds_read_b64_tr_b16 v[86:87], v134 offset:8960
    s_waitcnt lgkmcnt(10)
    v_mfma_f32_16x16x32_bf16 v[32:35], v[72:75], v[96:99], v[32:35]
    ds_read_b64_tr_b16 v[88:89], v134 offset:9216
    v_mfma_f32_16x16x32_bf16 v[36:39], v[72:75], v[100:103], v[36:39]
    ds_read_b64_tr_b16 v[90:91], v134 offset:9728
    s_add_u32 m0, s66, 24576
    v_mfma_f32_16x16x32_bf16 v[40:43], v[72:75], v[104:107], v[40:43]
    ds_read_b64_tr_b16 v[92:93], v134 offset:9472
    buffer_load_dwordx4 v192, s[48:51], s60 offen offset:0 lds
    v_mfma_f32_16x16x32_bf16 v[44:47], v[72:75], v[108:111], v[44:47]
    ds_read_b64_tr_b16 v[94:95], v134 offset:9984
    s_waitcnt lgkmcnt(12)
    v_mfma_f32_16x16x32_bf16 v[60:63], v[76:79], v[108:111], v[60:63]
    v_mfma_f32_16x16x32_bf16 v[56:59], v[76:79], v[104:107], v[56:59]
    v_mfma_f32_16x16x32_bf16 v[52:55], v[76:79], v[100:103], v[52:55]
    buffer_load_dwordx4 v193, s[48:51], s60 offen offset:1024 lds
    s_add_u32 s60, s60, 131072
    v_mfma_f32_16x16x32_bf16 v[48:51], v[76:79], v[96:99], v[48:51]
    s_waitcnt lgkmcnt(9)
    v_mfma_f32_16x16x32_bf16 v[0:3], v[80:83], v[112:115], v[0:3]
    s_waitcnt lgkmcnt(8)
    v_mfma_f32_16x16x32_bf16 v[4:7], v[80:83], v[116:119], v[4:7]
    s_waitcnt vmcnt(16) lgkmcnt(0)
    s_barrier
    v_mfma_f32_16x16x32_bf16 v[8:11], v[80:83], v[120:123], v[8:11]
    ds_read_b128 v[96:99], v137 offset:49152
    v_mfma_f32_16x16x32_bf16 v[12:15], v[80:83], v[124:127], v[12:15]
    ds_read_b64_tr_b16 v[64:65], v134 offset:32768
    buffer_load_dwordx4 a[32:35], v180, s[4:7], s61 offen offset:0
    v_mfma_f32_16x16x32_bf16 v[28:31], v[84:87], v[124:127], v[28:31]
    ds_read_b64_tr_b16 v[66:67], v134 offset:33280
    v_mfma_f32_16x16x32_bf16 v[24:27], v[84:87], v[120:123], v[24:27]
    ds_read_b128 v[100:103], v137 offset:51200
    v_mfma_f32_16x16x32_bf16 v[20:23], v[84:87], v[116:119], v[20:23]
    ds_read_b128 v[104:107], v137 offset:53248
    v_mfma_f32_16x16x32_bf16 v[16:19], v[84:87], v[112:115], v[16:19]
    ds_read_b128 v[108:111], v137 offset:55296
    buffer_load_dwordx4 a[40:43], v180, s[4:7], s61 offen offset:1024
    s_add_u32 s61, s61, 2048
    v_mfma_f32_16x16x32_bf16 v[32:35], v[88:91], v[112:115], v[32:35]
    ds_read_b64_tr_b16 v[68:69], v134 offset:33024
    v_mfma_f32_16x16x32_bf16 v[36:39], v[88:91], v[116:119], v[36:39]
    ds_read_b64_tr_b16 v[70:71], v134 offset:33536
    v_mfma_f32_16x16x32_bf16 v[40:43], v[88:91], v[120:123], v[40:43]
    ds_read_b64_tr_b16 v[72:73], v134 offset:33792
    v_mfma_f32_16x16x32_bf16 v[44:47], v[88:91], v[124:127], v[44:47]
    ds_read_b64_tr_b16 v[74:75], v134 offset:34304
    buffer_load_dwordx4 a[36:39], v180, s[4:7], s62 offen offset:0
    v_mfma_f32_16x16x32_bf16 v[60:63], v[92:95], v[124:127], v[60:63]
    ds_read_b64_tr_b16 v[76:77], v134 offset:34048
    v_mfma_f32_16x16x32_bf16 v[56:59], v[92:95], v[120:123], v[56:59]
    ds_read_b64_tr_b16 v[78:79], v134 offset:34560
    v_mfma_f32_16x16x32_bf16 v[52:55], v[92:95], v[116:119], v[52:55]
    v_mfma_f32_16x16x32_bf16 v[48:51], v[92:95], v[112:115], v[48:51]
    buffer_load_dwordx4 a[44:47], v180, s[4:7], s62 offen offset:1024
    s_add_u32 s62, s62, 2048
    s_waitcnt lgkmcnt(9)
    v_mfma_f32_16x16x32_bf16 v[0:3], v[64:67], v[96:99], v[0:3]
    ds_read_b128 v[112:115], v138 offset:49152
    s_waitcnt lgkmcnt(9)
    v_mfma_f32_16x16x32_bf16 v[4:7], v[64:67], v[100:103], v[4:7]
    ds_read_b64_tr_b16 v[80:81], v134 offset:40960
    s_add_u32 m0, s66, 32768
    s_waitcnt lgkmcnt(9)
    v_mfma_f32_16x16x32_bf16 v[8:11], v[64:67], v[104:107], v[8:11]
    ds_read_b64_tr_b16 v[82:83], v134 offset:41472
    buffer_load_dwordx4 v192, s[48:51], s60 offen offset:0 lds
    s_waitcnt lgkmcnt(9)
    v_mfma_f32_16x16x32_bf16 v[12:15], v[64:67], v[108:111], v[12:15]
    ds_read_b128 v[116:119], v138 offset:51200
    s_waitcnt lgkmcnt(8)
    v_mfma_f32_16x16x32_bf16 v[28:31], v[68:71], v[108:111], v[28:31]
    ds_read_b128 v[120:123], v138 offset:53248
    v_mfma_f32_16x16x32_bf16 v[24:27], v[68:71], v[104:107], v[24:27]
    ds_read_b128 v[124:127], v138 offset:55296
    v_mfma_f32_16x16x32_bf16 v[20:23], v[68:71], v[100:103], v[20:23]
    ds_read_b64_tr_b16 v[84:85], v134 offset:41216
    buffer_load_dwordx4 v193, s[48:51], s60 offen offset:1024 lds
    s_add_u32 s60, s60, 131072
    v_mfma_f32_16x16x32_bf16 v[16:19], v[68:71], v[96:99], v[16:19]
    ds_read_b64_tr_b16 v[86:87], v134 offset:41728
    s_waitcnt lgkmcnt(10)
    v_mfma_f32_16x16x32_bf16 v[32:35], v[72:75], v[96:99], v[32:35]
    ds_read_b64_tr_b16 v[88:89], v134 offset:41984
    v_mfma_f32_16x16x32_bf16 v[36:39], v[72:75], v[100:103], v[36:39]
    ds_read_b64_tr_b16 v[90:91], v134 offset:42496
    v_mfma_f32_16x16x32_bf16 v[40:43], v[72:75], v[104:107], v[40:43]
    ds_read_b64_tr_b16 v[92:93], v134 offset:42240
    buffer_load_dwordx4 a[48:51], v180, s[4:7], s61 offen offset:0
    v_mfma_f32_16x16x32_bf16 v[44:47], v[72:75], v[108:111], v[44:47]
    ds_read_b64_tr_b16 v[94:95], v134 offset:42752
    s_waitcnt lgkmcnt(12)
    v_mfma_f32_16x16x32_bf16 v[60:63], v[76:79], v[108:111], v[60:63]
    v_mfma_f32_16x16x32_bf16 v[56:59], v[76:79], v[104:107], v[56:59]
    v_mfma_f32_16x16x32_bf16 v[52:55], v[76:79], v[100:103], v[52:55]
    buffer_load_dwordx4 a[56:59], v180, s[4:7], s61 offen offset:1024
    s_add_u32 s61, s61, 2048
    v_mfma_f32_16x16x32_bf16 v[48:51], v[76:79], v[96:99], v[48:51]
    s_waitcnt lgkmcnt(9)
    v_mfma_f32_16x16x32_bf16 v[0:3], v[80:83], v[112:115], v[0:3]
    ds_read_b128 v[144:147], v216 offset:0
    s_waitcnt lgkmcnt(9)
    v_mfma_f32_16x16x32_bf16 v[4:7], v[80:83], v[116:119], v[4:7]
    s_waitcnt lgkmcnt(8)
    v_mfma_f32_16x16x32_bf16 v[8:11], v[80:83], v[120:123], v[8:11]
    ds_read_b128 v[148:151], v216 offset:1024
    s_waitcnt lgkmcnt(8)
    v_mfma_f32_16x16x32_bf16 v[12:15], v[80:83], v[124:127], v[12:15]
    buffer_load_dwordx4 a[52:55], v180, s[4:7], s62 offen offset:0
    s_waitcnt lgkmcnt(6)
    v_mfma_f32_16x16x32_bf16 v[28:31], v[84:87], v[124:127], v[28:31]
    ds_read_b128 v[152:155], v216 offset:2048
    v_mfma_f32_16x16x32_bf16 v[24:27], v[84:87], v[120:123], v[24:27]
    v_mfma_f32_16x16x32_bf16 v[20:23], v[84:87], v[116:119], v[20:23]
    ds_read_b128 v[156:159], v216 offset:3072
    v_mfma_f32_16x16x32_bf16 v[16:19], v[84:87], v[112:115], v[16:19]
    buffer_load_dwordx4 a[60:63], v180, s[4:7], s62 offen offset:1024
    s_add_u32 s62, s62, 2048
    s_waitcnt lgkmcnt(6)
    v_mfma_f32_16x16x32_bf16 v[32:35], v[88:91], v[112:115], v[32:35]
    ds_read_b128 v[160:163], v216 offset:4096
    v_mfma_f32_16x16x32_bf16 v[36:39], v[88:91], v[116:119], v[36:39]
    v_mfma_f32_16x16x32_bf16 v[40:43], v[88:91], v[120:123], v[40:43]
    ds_read_b128 v[164:167], v216 offset:5120
    s_add_u32 m0, s66, 40960
    v_mfma_f32_16x16x32_bf16 v[44:47], v[88:91], v[124:127], v[44:47]
    buffer_load_dwordx4 v192, s[48:51], s60 offen offset:0 lds
    s_waitcnt lgkmcnt(6)
    v_mfma_f32_16x16x32_bf16 v[60:63], v[92:95], v[124:127], v[60:63]
    ds_read_b128 v[168:171], v216 offset:6144
    v_mfma_f32_16x16x32_bf16 v[56:59], v[92:95], v[120:123], v[56:59]
    v_mfma_f32_16x16x32_bf16 v[52:55], v[92:95], v[116:119], v[52:55]
    ds_read_b128 v[172:175], v216 offset:7168
    v_mfma_f32_16x16x32_bf16 v[48:51], v[92:95], v[112:115], v[48:51]
    buffer_load_dwordx4 v193, s[48:51], s60 offen offset:1024 lds
    s_add_u32 s60, s60, 131072
    s_waitcnt lgkmcnt(0)
    s_add_u32 s44, s44, 16777216
    s_add_u32 s45, s45, 16777216
    s_add_u32 s46, s46, 16777216
    s_add_u32 s47, s47, 16777216
    v_lshlrev_b32 v176, 16, v176
    v_lshlrev_b32 v177, 16, v177
    v_lshlrev_b32 v178, 16, v178
    v_lshlrev_b32 v179, 16, v179
    v_lshlrev_b32 v64, 16, v144
    v_and_b32 v65, 0xffff0000, v144
    v_pk_add_f32 v[0:1], v[0:1], v[176:177] op_sel:[0,0] op_sel_hi:[1,0]
    v_lshlrev_b32 v66, 16, v145
    v_and_b32 v67, 0xffff0000, v145
    v_pk_add_f32 v[2:3], v[2:3], v[176:177] op_sel:[0,0] op_sel_hi:[1,0]
    v_lshlrev_b32 v68, 16, v146
    v_and_b32 v69, 0xffff0000, v146
    v_pk_add_f32 v[16:17], v[16:17], v[176:177] op_sel:[0,0] op_sel_hi:[1,0]
    v_lshlrev_b32 v70, 16, v147
    v_and_b32 v71, 0xffff0000, v147
    v_pk_add_f32 v[18:19], v[18:19], v[176:177] op_sel:[0,0] op_sel_hi:[1,0]
    v_pk_mul_f32 v[0:1], v[0:1], v[64:65]
    v_pk_mul_f32 v[2:3], v[2:3], v[66:67]
    v_pk_mul_f32 v[16:17], v[16:17], v[68:69]
    v_pk_mul_f32 v[18:19], v[18:19], v[70:71]
    v_cvt_pk_bf16_f32 v144, v0, v1
    v_cvt_pk_bf16_f32 v145, v2, v3
    v_cvt_pk_bf16_f32 v146, v16, v17
    v_cvt_pk_bf16_f32 v147, v18, v19
    buffer_load_dwordx4 a[64:67], v180, s[4:7], s61 offen offset:0
    buffer_store_dwordx4 v[144:147], v180, s[4:7], s44 offen offset:0 sc1
    v_lshlrev_b32 v72, 16, v148
    v_and_b32 v73, 0xffff0000, v148
    v_pk_add_f32 v[32:33], v[32:33], v[176:177] op_sel:[0,0] op_sel_hi:[1,0]
    v_lshlrev_b32 v74, 16, v149
    v_and_b32 v75, 0xffff0000, v149
    v_pk_add_f32 v[34:35], v[34:35], v[176:177] op_sel:[0,0] op_sel_hi:[1,0]
    v_lshlrev_b32 v76, 16, v150
    v_and_b32 v77, 0xffff0000, v150
    v_pk_add_f32 v[48:49], v[48:49], v[176:177] op_sel:[0,0] op_sel_hi:[1,0]
    v_lshlrev_b32 v78, 16, v151
    v_and_b32 v79, 0xffff0000, v151
    v_pk_add_f32 v[50:51], v[50:51], v[176:177] op_sel:[0,0] op_sel_hi:[1,0]
    v_pk_mul_f32 v[32:33], v[32:33], v[72:73]
    v_pk_mul_f32 v[34:35], v[34:35], v[74:75]
    v_pk_mul_f32 v[48:49], v[48:49], v[76:77]
    v_pk_mul_f32 v[50:51], v[50:51], v[78:79]
    v_cvt_pk_bf16_f32 v148, v32, v33
    v_cvt_pk_bf16_f32 v149, v34, v35
    v_cvt_pk_bf16_f32 v150, v48, v49
    v_cvt_pk_bf16_f32 v151, v50, v51
    buffer_load_dwordx4 a[72:75], v180, s[4:7], s61 offen offset:1024
    s_add_u32 s61, s61, 2048
    buffer_store_dwordx4 v[148:151], v180, s[4:7], s44 offen offset:1024 sc1
    v_lshlrev_b32 v64, 16, v152
    v_and_b32 v65, 0xffff0000, v152
    v_pk_add_f32 v[4:5], v[4:5], v[176:177] op_sel:[0,1] op_sel_hi:[1,1]
    v_lshlrev_b32 v66, 16, v153
    v_and_b32 v67, 0xffff0000, v153
    v_pk_add_f32 v[6:7], v[6:7], v[176:177] op_sel:[0,1] op_sel_hi:[1,1]
    v_lshlrev_b32 v68, 16, v154
    v_and_b32 v69, 0xffff0000, v154
    v_pk_add_f32 v[20:21], v[20:21], v[176:177] op_sel:[0,1] op_sel_hi:[1,1]
    v_lshlrev_b32 v70, 16, v155
    v_and_b32 v71, 0xffff0000, v155
    v_pk_add_f32 v[22:23], v[22:23], v[176:177] op_sel:[0,1] op_sel_hi:[1,1]
    v_pk_mul_f32 v[4:5], v[4:5], v[64:65]
    v_pk_mul_f32 v[6:7], v[6:7], v[66:67]
    v_pk_mul_f32 v[20:21], v[20:21], v[68:69]
    v_pk_mul_f32 v[22:23], v[22:23], v[70:71]
    v_cvt_pk_bf16_f32 v152, v4, v5
    v_cvt_pk_bf16_f32 v153, v6, v7
    v_cvt_pk_bf16_f32 v154, v20, v21
    v_cvt_pk_bf16_f32 v155, v22, v23
    buffer_load_dwordx4 a[68:71], v180, s[4:7], s62 offen offset:0
    buffer_store_dwordx4 v[152:155], v180, s[4:7], s45 offen offset:0 sc1
    v_lshlrev_b32 v72, 16, v156
    v_and_b32 v73, 0xffff0000, v156
    v_pk_add_f32 v[36:37], v[36:37], v[176:177] op_sel:[0,1] op_sel_hi:[1,1]
    v_lshlrev_b32 v74, 16, v157
    v_and_b32 v75, 0xffff0000, v157
    v_pk_add_f32 v[38:39], v[38:39], v[176:177] op_sel:[0,1] op_sel_hi:[1,1]
    v_lshlrev_b32 v76, 16, v158
    v_and_b32 v77, 0xffff0000, v158
    v_pk_add_f32 v[52:53], v[52:53], v[176:177] op_sel:[0,1] op_sel_hi:[1,1]
    v_lshlrev_b32 v78, 16, v159
    v_and_b32 v79, 0xffff0000, v159
    v_pk_add_f32 v[54:55], v[54:55], v[176:177] op_sel:[0,1] op_sel_hi:[1,1]
    v_pk_mul_f32 v[36:37], v[36:37], v[72:73]
    v_pk_mul_f32 v[38:39], v[38:39], v[74:75]
    v_pk_mul_f32 v[52:53], v[52:53], v[76:77]
    v_pk_mul_f32 v[54:55], v[54:55], v[78:79]
    v_cvt_pk_bf16_f32 v156, v36, v37
    v_cvt_pk_bf16_f32 v157, v38, v39
    v_cvt_pk_bf16_f32 v158, v52, v53
    v_cvt_pk_bf16_f32 v159, v54, v55
    buffer_load_dwordx4 a[76:79], v180, s[4:7], s62 offen offset:1024
    s_add_u32 s62, s62, 2048
    buffer_store_dwordx4 v[156:159], v180, s[4:7], s45 offen offset:1024 sc1
    v_lshlrev_b32 v64, 16, v160
    v_and_b32 v65, 0xffff0000, v160
    v_pk_add_f32 v[8:9], v[8:9], v[178:179] op_sel:[0,0] op_sel_hi:[1,0]
    v_lshlrev_b32 v66, 16, v161
    v_and_b32 v67, 0xffff0000, v161
    v_pk_add_f32 v[10:11], v[10:11], v[178:179] op_sel:[0,0] op_sel_hi:[1,0]
    v_lshlrev_b32 v68, 16, v162
    v_and_b32 v69, 0xffff0000, v162
    v_pk_add_f32 v[24:25], v[24:25], v[178:179] op_sel:[0,0] op_sel_hi:[1,0]
    v_lshlrev_b32 v70, 16, v163
    v_and_b32 v71, 0xffff0000, v163
    v_pk_add_f32 v[26:27], v[26:27], v[178:179] op_sel:[0,0] op_sel_hi:[1,0]
    v_pk_mul_f32 v[8:9], v[8:9], v[64:65]
    v_pk_mul_f32 v[10:11], v[10:11], v[66:67]
    v_pk_mul_f32 v[24:25], v[24:25], v[68:69]
    v_pk_mul_f32 v[26:27], v[26:27], v[70:71]
    v_cvt_pk_bf16_f32 v160, v8, v9
    v_cvt_pk_bf16_f32 v161, v10, v11
    v_cvt_pk_bf16_f32 v162, v24, v25
    v_cvt_pk_bf16_f32 v163, v26, v27
    s_add_u32 m0, s66, 49152
    s_nop 0
    buffer_load_dwordx4 v192, s[48:51], s60 offen offset:0 lds
    buffer_store_dwordx4 v[160:163], v180, s[4:7], s46 offen offset:0 sc1
    v_lshlrev_b32 v72, 16, v164
    v_and_b32 v73, 0xffff0000, v164
    v_pk_add_f32 v[40:41], v[40:41], v[178:179] op_sel:[0,0] op_sel_hi:[1,0]
    v_lshlrev_b32 v74, 16, v165
    v_and_b32 v75, 0xffff0000, v165
    v_pk_add_f32 v[42:43], v[42:43], v[178:179] op_sel:[0,0] op_sel_hi:[1,0]
    v_lshlrev_b32 v76, 16, v166
    v_and_b32 v77, 0xffff0000, v166
    v_pk_add_f32 v[56:57], v[56:57], v[178:179] op_sel:[0,0] op_sel_hi:[1,0]
    v_lshlrev_b32 v78, 16, v167
    v_and_b32 v79, 0xffff0000, v167
    v_pk_add_f32 v[58:59], v[58:59], v[178:179] op_sel:[0,0] op_sel_hi:[1,0]
    v_pk_mul_f32 v[40:41], v[40:41], v[72:73]
    v_pk_mul_f32 v[42:43], v[42:43], v[74:75]
    v_pk_mul_f32 v[56:57], v[56:57], v[76:77]
    v_pk_mul_f32 v[58:59], v[58:59], v[78:79]
    v_cvt_pk_bf16_f32 v164, v40, v41
    v_cvt_pk_bf16_f32 v165, v42, v43
    v_cvt_pk_bf16_f32 v166, v56, v57
    v_cvt_pk_bf16_f32 v167, v58, v59
    buffer_load_dwordx4 v193, s[48:51], s60 offen offset:1024 lds
    s_add_u32 s60, s60, 131072
    buffer_store_dwordx4 v[164:167], v180, s[4:7], s46 offen offset:1024 sc1
    v_lshlrev_b32 v64, 16, v168
    v_and_b32 v65, 0xffff0000, v168
    v_pk_add_f32 v[12:13], v[12:13], v[178:179] op_sel:[0,1] op_sel_hi:[1,1]
    v_lshlrev_b32 v66, 16, v169
    v_and_b32 v67, 0xffff0000, v169
    v_pk_add_f32 v[14:15], v[14:15], v[178:179] op_sel:[0,1] op_sel_hi:[1,1]
    v_lshlrev_b32 v68, 16, v170
    v_and_b32 v69, 0xffff0000, v170
    v_pk_add_f32 v[28:29], v[28:29], v[178:179] op_sel:[0,1] op_sel_hi:[1,1]
    v_lshlrev_b32 v70, 16, v171
    v_and_b32 v71, 0xffff0000, v171
    v_pk_add_f32 v[30:31], v[30:31], v[178:179] op_sel:[0,1] op_sel_hi:[1,1]
    v_pk_mul_f32 v[12:13], v[12:13], v[64:65]
    v_pk_mul_f32 v[14:15], v[14:15], v[66:67]
    v_pk_mul_f32 v[28:29], v[28:29], v[68:69]
    v_pk_mul_f32 v[30:31], v[30:31], v[70:71]
    v_cvt_pk_bf16_f32 v168, v12, v13
    v_cvt_pk_bf16_f32 v169, v14, v15
    v_cvt_pk_bf16_f32 v170, v28, v29
    v_cvt_pk_bf16_f32 v171, v30, v31
    buffer_store_dwordx4 v[168:171], v180, s[4:7], s47 offen offset:0 sc1
    v_lshlrev_b32 v72, 16, v172
    v_and_b32 v73, 0xffff0000, v172
    v_pk_add_f32 v[44:45], v[44:45], v[178:179] op_sel:[0,1] op_sel_hi:[1,1]
    v_lshlrev_b32 v74, 16, v173
    v_and_b32 v75, 0xffff0000, v173
    v_pk_add_f32 v[46:47], v[46:47], v[178:179] op_sel:[0,1] op_sel_hi:[1,1]
    v_lshlrev_b32 v76, 16, v174
    v_and_b32 v77, 0xffff0000, v174
    v_pk_add_f32 v[60:61], v[60:61], v[178:179] op_sel:[0,1] op_sel_hi:[1,1]
    v_lshlrev_b32 v78, 16, v175
    v_and_b32 v79, 0xffff0000, v175
    v_pk_add_f32 v[62:63], v[62:63], v[178:179] op_sel:[0,1] op_sel_hi:[1,1]
    v_pk_mul_f32 v[44:45], v[44:45], v[72:73]
    v_pk_mul_f32 v[46:47], v[46:47], v[74:75]
    v_pk_mul_f32 v[60:61], v[60:61], v[76:77]
    v_pk_mul_f32 v[62:63], v[62:63], v[78:79]
    v_cvt_pk_bf16_f32 v172, v44, v45
    v_cvt_pk_bf16_f32 v173, v46, v47
    v_cvt_pk_bf16_f32 v174, v60, v61
    v_cvt_pk_bf16_f32 v175, v62, v63
    buffer_store_dwordx4 v[172:175], v180, s[4:7], s47 offen offset:1024 sc1
k23_kernel_J:
    s_waitcnt vmcnt(40)
    s_barrier
    ds_read_b64_tr_b16 v[64:65], v208 offset:0
    ds_read_b64_tr_b16 v[66:67], v208 offset:2048
    ds_read_b64_tr_b16 v[68:69], v209 offset:0
    ds_read_b64_tr_b16 v[70:71], v209 offset:2048
    ds_read_b64_tr_b16 v[72:73], v210 offset:0
    ds_read_b64_tr_b16 v[74:75], v210 offset:2048
    ds_read_b64_tr_b16 v[76:77], v211 offset:0
    ds_read_b64_tr_b16 v[78:79], v211 offset:2048
    buffer_load_dwordx4 a[80:83], v180, s[4:7], s61 offen offset:0
    buffer_load_dwordx4 a[88:91], v180, s[4:7], s61 offen offset:1024
    s_add_u32 s61, s61, 2048
    buffer_load_dwordx4 a[84:87], v180, s[4:7], s62 offen offset:0
    buffer_load_dwordx4 a[92:95], v180, s[4:7], s62 offen offset:1024
    s_add_u32 s62, s62, 2048
    s_add_u32 m0, s66, 57344
    s_nop 0
    buffer_load_dwordx4 v192, s[48:51], s60 offen offset:0 lds
    buffer_load_dwordx4 v193, s[48:51], s60 offen offset:1024 lds
    s_add_u32 s60, s60, 131072
    buffer_load_dwordx4 a[96:99], v180, s[4:7], s61 offen offset:0
    buffer_load_dwordx4 a[104:107], v180, s[4:7], s61 offen offset:1024
    s_add_u32 s61, s61, 2048
    buffer_load_dwordx4 a[100:103], v180, s[4:7], s62 offen offset:0
    buffer_load_dwordx4 a[108:111], v180, s[4:7], s62 offen offset:1024
    s_add_u32 s62, s62, 2048
    s_add_u32 m0, s66, 65536
    s_nop 0
    buffer_load_dwordx4 v192, s[48:51], s60 offen offset:0 lds
    buffer_load_dwordx4 v193, s[48:51], s60 offen offset:1024 lds
    s_add_u32 s60, s60, 131072
    s_waitcnt vmcnt(46) lgkmcnt(6)
    v_mfma_f32_16x16x32_bf16 v[0:3], v[64:67], a[0:3], 0
    ds_read_b64_tr_b16 v[80:81], v208 offset:4096
    v_mfma_f32_16x16x32_bf16 v[4:7], v[64:67], a[4:7], 0
    ds_read_b64_tr_b16 v[82:83], v208 offset:6144
    buffer_load_dwordx4 a[112:115], v180, s[4:7], s61 offen offset:0
    s_waitcnt lgkmcnt(6)
    v_mfma_f32_16x16x32_bf16 v[12:15], v[68:71], a[4:7], 0
    ds_read_b64_tr_b16 v[84:85], v209 offset:4096
    v_mfma_f32_16x16x32_bf16 v[8:11], v[68:71], a[0:3], 0
    ds_read_b64_tr_b16 v[86:87], v209 offset:6144
    s_waitcnt lgkmcnt(6)
    v_mfma_f32_16x16x32_bf16 v[16:19], v[72:75], a[0:3], 0
    ds_read_b64_tr_b16 v[88:89], v210 offset:4096
    buffer_load_dwordx4 a[120:123], v180, s[4:7], s61 offen offset:1024
    s_add_u32 s61, s61, 2048
    v_mfma_f32_16x16x32_bf16 v[20:23], v[72:75], a[4:7], 0
    ds_read_b64_tr_b16 v[90:91], v210 offset:6144
    s_waitcnt lgkmcnt(6)
    v_mfma_f32_16x16x32_bf16 v[28:31], v[76:79], a[4:7], 0
    ds_read_b64_tr_b16 v[92:93], v211 offset:4096
    v_mfma_f32_16x16x32_bf16 v[24:27], v[76:79], a[0:3], 0
    ds_read_b64_tr_b16 v[94:95], v211 offset:6144
    buffer_load_dwordx4 a[116:119], v180, s[4:7], s62 offen offset:0
    s_waitcnt lgkmcnt(6)
    v_mfma_f32_16x16x32_bf16 v[0:3], v[80:83], a[8:11], v[0:3]
    s_waitcnt lgkmcnt(0)
    s_barrier
    ds_read_b64_tr_b16 v[64:65], v208 offset:8192
    v_mfma_f32_16x16x32_bf16 v[4:7], v[80:83], a[12:15], v[4:7]
    ds_read_b64_tr_b16 v[66:67], v208 offset:10240
    v_mfma_f32_16x16x32_bf16 v[12:15], v[84:87], a[12:15], v[12:15]
    ds_read_b64_tr_b16 v[68:69], v209 offset:8192
    buffer_load_dwordx4 a[124:127], v180, s[4:7], s62 offen offset:1024
    s_add_u32 s62, s62, 2048
    v_mfma_f32_16x16x32_bf16 v[8:11], v[84:87], a[8:11], v[8:11]
    ds_read_b64_tr_b16 v[70:71], v209 offset:10240
    v_mfma_f32_16x16x32_bf16 v[16:19], v[88:91], a[8:11], v[16:19]
    ds_read_b64_tr_b16 v[72:73], v210 offset:8192
    s_add_u32 m0, s66, 73728
    v_mfma_f32_16x16x32_bf16 v[20:23], v[88:91], a[12:15], v[20:23]
    ds_read_b64_tr_b16 v[74:75], v210 offset:10240
    buffer_load_dwordx4 v192, s[48:51], s60 offen offset:0 lds
    v_mfma_f32_16x16x32_bf16 v[28:31], v[92:95], a[12:15], v[28:31]
    ds_read_b64_tr_b16 v[76:77], v211 offset:8192
    v_mfma_f32_16x16x32_bf16 v[24:27], v[92:95], a[8:11], v[24:27]
    ds_read_b64_tr_b16 v[78:79], v211 offset:10240
    buffer_load_dwordx4 v193, s[48:51], s60 offen offset:1024 lds
    s_add_u32 s60, s60, 131072
    s_waitcnt vmcnt(46) lgkmcnt(6)
    v_mfma_f32_16x16x32_bf16 v[0:3], v[64:67], a[16:19], v[0:3]
    ds_read_b64_tr_b16 v[80:81], v208 offset:12288
    v_mfma_f32_16x16x32_bf16 v[4:7], v[64:67], a[20:23], v[4:7]
    ds_read_b64_tr_b16 v[82:83], v208 offset:14336
    buffer_load_dwordx4 a[0:3], v180, s[4:7], s61 offen offset:0
    s_waitcnt lgkmcnt(6)
    v_mfma_f32_16x16x32_bf16 v[12:15], v[68:71], a[20:23], v[12:15]
    ds_read_b64_tr_b16 v[84:85], v209 offset:12288
    v_mfma_f32_16x16x32_bf16 v[8:11], v[68:71], a[16:19], v[8:11]
    ds_read_b64_tr_b16 v[86:87], v209 offset:14336
    s_waitcnt lgkmcnt(6)
    v_mfma_f32_16x16x32_bf16 v[16:19], v[72:75], a[16:19], v[16:19]
    ds_read_b64_tr_b16 v[88:89], v210 offset:12288
    buffer_load_dwordx4 a[8:11], v180, s[4:7], s61 offen offset:1024
    s_add_u32 s61, s61, 2048
    v_mfma_f32_16x16x32_bf16 v[20:23], v[72:75], a[20:23], v[20:23]
    ds_read_b64_tr_b16 v[90:91], v210 offset:14336
    s_waitcnt lgkmcnt(6)
    v_mfma_f32_16x16x32_bf16 v[28:31], v[76:79], a[20:23], v[28:31]
    ds_read_b64_tr_b16 v[92:93], v211 offset:12288
    v_mfma_f32_16x16x32_bf16 v[24:27], v[76:79], a[16:19], v[24:27]
    ds_read_b64_tr_b16 v[94:95], v211 offset:14336
    buffer_load_dwordx4 a[4:7], v180, s[4:7], s62 offen offset:0
    s_waitcnt lgkmcnt(6)
    v_mfma_f32_16x16x32_bf16 v[0:3], v[80:83], a[24:27], v[0:3]
    s_waitcnt lgkmcnt(0)
    s_barrier
    ds_read_b64_tr_b16 v[64:65], v208 offset:16384
    v_mfma_f32_16x16x32_bf16 v[4:7], v[80:83], a[28:31], v[4:7]
    ds_read_b64_tr_b16 v[66:67], v208 offset:18432
    v_mfma_f32_16x16x32_bf16 v[12:15], v[84:87], a[28:31], v[12:15]
    ds_read_b64_tr_b16 v[68:69], v209 offset:16384
    buffer_load_dwordx4 a[12:15], v180, s[4:7], s62 offen offset:1024
    s_add_u32 s62, s62, 2048
    v_mfma_f32_16x16x32_bf16 v[8:11], v[84:87], a[24:27], v[8:11]
    ds_read_b64_tr_b16 v[70:71], v209 offset:18432
    v_mfma_f32_16x16x32_bf16 v[16:19], v[88:91], a[24:27], v[16:19]
    ds_read_b64_tr_b16 v[72:73], v210 offset:16384
    s_add_u32 m0, s66, 81920
    v_mfma_f32_16x16x32_bf16 v[20:23], v[88:91], a[28:31], v[20:23]
    ds_read_b64_tr_b16 v[74:75], v210 offset:18432
    buffer_load_dwordx4 v192, s[48:51], s60 offen offset:0 lds
    v_mfma_f32_16x16x32_bf16 v[28:31], v[92:95], a[28:31], v[28:31]
    ds_read_b64_tr_b16 v[76:77], v211 offset:16384
    v_mfma_f32_16x16x32_bf16 v[24:27], v[92:95], a[24:27], v[24:27]
    ds_read_b64_tr_b16 v[78:79], v211 offset:18432
    buffer_load_dwordx4 v193, s[48:51], s60 offen offset:1024 lds
    s_add_u32 s60, s60, 131072
    s_waitcnt vmcnt(24)
    s_mov_b64 exec, 1
    buffer_store_dword v206, v207, s[4:7], s63 offen sc1
    s_mov_b64 exec, -1
    s_waitcnt lgkmcnt(6)
    v_mfma_f32_16x16x32_bf16 v[0:3], v[64:67], a[32:35], v[0:3]
    ds_read_b64_tr_b16 v[80:81], v208 offset:20480
    v_mfma_f32_16x16x32_bf16 v[4:7], v[64:67], a[36:39], v[4:7]
    ds_read_b64_tr_b16 v[82:83], v208 offset:22528
    buffer_load_dwordx4 a[16:19], v180, s[4:7], s61 offen offset:0
    s_waitcnt lgkmcnt(6)
    v_mfma_f32_16x16x32_bf16 v[12:15], v[68:71], a[36:39], v[12:15]
    ds_read_b64_tr_b16 v[84:85], v209 offset:20480
    v_mfma_f32_16x16x32_bf16 v[8:11], v[68:71], a[32:35], v[8:11]
    ds_read_b64_tr_b16 v[86:87], v209 offset:22528
    s_waitcnt lgkmcnt(6)
    v_mfma_f32_16x16x32_bf16 v[16:19], v[72:75], a[32:35], v[16:19]
    ds_read_b64_tr_b16 v[88:89], v210 offset:20480
    buffer_load_dwordx4 a[24:27], v180, s[4:7], s61 offen offset:1024
    s_add_u32 s61, s61, 2048
    v_mfma_f32_16x16x32_bf16 v[20:23], v[72:75], a[36:39], v[20:23]
    ds_read_b64_tr_b16 v[90:91], v210 offset:22528
    s_waitcnt lgkmcnt(6)
    v_mfma_f32_16x16x32_bf16 v[28:31], v[76:79], a[36:39], v[28:31]
    ds_read_b64_tr_b16 v[92:93], v211 offset:20480
    v_mfma_f32_16x16x32_bf16 v[24:27], v[76:79], a[32:35], v[24:27]
    ds_read_b64_tr_b16 v[94:95], v211 offset:22528
    buffer_load_dwordx4 a[20:23], v180, s[4:7], s62 offen offset:0
    s_waitcnt lgkmcnt(6)
    v_mfma_f32_16x16x32_bf16 v[0:3], v[80:83], a[40:43], v[0:3]
    s_waitcnt lgkmcnt(0)
    s_barrier
    ds_read_b64_tr_b16 v[64:65], v208 offset:24576
    v_mfma_f32_16x16x32_bf16 v[4:7], v[80:83], a[44:47], v[4:7]
    ds_read_b64_tr_b16 v[66:67], v208 offset:26624
    v_mfma_f32_16x16x32_bf16 v[12:15], v[84:87], a[44:47], v[12:15]
    ds_read_b64_tr_b16 v[68:69], v209 offset:24576
    buffer_load_dwordx4 a[28:31], v180, s[4:7], s62 offen offset:1024
    s_add_u32 s62, s62, 2048
    v_mfma_f32_16x16x32_bf16 v[8:11], v[84:87], a[40:43], v[8:11]
    ds_read_b64_tr_b16 v[70:71], v209 offset:26624
    v_mfma_f32_16x16x32_bf16 v[16:19], v[88:91], a[40:43], v[16:19]
    ds_read_b64_tr_b16 v[72:73], v210 offset:24576
    s_add_u32 m0, s66, 90112
    v_mfma_f32_16x16x32_bf16 v[20:23], v[88:91], a[44:47], v[20:23]
    ds_read_b64_tr_b16 v[74:75], v210 offset:26624
    buffer_load_dwordx4 v192, s[48:51], s60 offen offset:0 lds
    v_mfma_f32_16x16x32_bf16 v[28:31], v[92:95], a[44:47], v[28:31]
    ds_read_b64_tr_b16 v[76:77], v211 offset:24576
    v_mfma_f32_16x16x32_bf16 v[24:27], v[92:95], a[40:43], v[24:27]
    ds_read_b64_tr_b16 v[78:79], v211 offset:26624
    buffer_load_dwordx4 v193, s[48:51], s60 offen offset:1024 lds
    s_add_u32 s60, s60, 131072
    s_waitcnt lgkmcnt(6)
    v_mfma_f32_16x16x32_bf16 v[0:3], v[64:67], a[48:51], v[0:3]
    ds_read_b64_tr_b16 v[80:81], v208 offset:28672
    v_mfma_f32_16x16x32_bf16 v[4:7], v[64:67], a[52:55], v[4:7]
    ds_read_b64_tr_b16 v[82:83], v208 offset:30720
    buffer_load_dwordx4 a[32:35], v180, s[4:7], s61 offen offset:0
    s_waitcnt lgkmcnt(6)
    v_mfma_f32_16x16x32_bf16 v[12:15], v[68:71], a[52:55], v[12:15]
    ds_read_b64_tr_b16 v[84:85], v209 offset:28672
    v_mfma_f32_16x16x32_bf16 v[8:11], v[68:71], a[48:51], v[8:11]
    ds_read_b64_tr_b16 v[86:87], v209 offset:30720
    s_waitcnt lgkmcnt(6)
    v_mfma_f32_16x16x32_bf16 v[16:19], v[72:75], a[48:51], v[16:19]
    ds_read_b64_tr_b16 v[88:89], v210 offset:28672
    buffer_load_dwordx4 a[40:43], v180, s[4:7], s61 offen offset:1024
    s_add_u32 s61, s61, 2048
    v_mfma_f32_16x16x32_bf16 v[20:23], v[72:75], a[52:55], v[20:23]
    ds_read_b64_tr_b16 v[90:91], v210 offset:30720
    s_waitcnt lgkmcnt(6)
    v_mfma_f32_16x16x32_bf16 v[28:31], v[76:79], a[52:55], v[28:31]
    ds_read_b64_tr_b16 v[92:93], v211 offset:28672
    v_mfma_f32_16x16x32_bf16 v[24:27], v[76:79], a[48:51], v[24:27]
    ds_read_b64_tr_b16 v[94:95], v211 offset:30720
    buffer_load_dwordx4 a[36:39], v180, s[4:7], s62 offen offset:0
    s_waitcnt lgkmcnt(6)
    v_mfma_f32_16x16x32_bf16 v[0:3], v[80:83], a[56:59], v[0:3]
    s_waitcnt lgkmcnt(0)
    s_barrier
    ds_read_b64_tr_b16 v[64:65], v208 offset:32768
    v_mfma_f32_16x16x32_bf16 v[4:7], v[80:83], a[60:63], v[4:7]
    ds_read_b64_tr_b16 v[66:67], v208 offset:34816
    v_mfma_f32_16x16x32_bf16 v[12:15], v[84:87], a[60:63], v[12:15]
    ds_read_b64_tr_b16 v[68:69], v209 offset:32768
    buffer_load_dwordx4 a[44:47], v180, s[4:7], s62 offen offset:1024
    s_add_u32 s62, s62, 2048
    v_mfma_f32_16x16x32_bf16 v[8:11], v[84:87], a[56:59], v[8:11]
    ds_read_b64_tr_b16 v[70:71], v209 offset:34816
    v_mfma_f32_16x16x32_bf16 v[16:19], v[88:91], a[56:59], v[16:19]
    ds_read_b64_tr_b16 v[72:73], v210 offset:32768
    s_add_u32 m0, s66, 98304
    v_mfma_f32_16x16x32_bf16 v[20:23], v[88:91], a[60:63], v[20:23]
    ds_read_b64_tr_b16 v[74:75], v210 offset:34816
    buffer_load_dwordx4 v192, s[48:51], s60 offen offset:0 lds
    v_mfma_f32_16x16x32_bf16 v[28:31], v[92:95], a[60:63], v[28:31]
    ds_read_b64_tr_b16 v[76:77], v211 offset:32768
    v_mfma_f32_16x16x32_bf16 v[24:27], v[92:95], a[56:59], v[24:27]
    ds_read_b64_tr_b16 v[78:79], v211 offset:34816
    buffer_load_dwordx4 v193, s[48:51], s60 offen offset:1024 lds
    s_add_u32 s60, s60, 131072
    s_waitcnt lgkmcnt(6)
    v_mfma_f32_16x16x32_bf16 v[0:3], v[64:67], a[64:67], v[0:3]
    ds_read_b64_tr_b16 v[80:81], v208 offset:36864
    v_mfma_f32_16x16x32_bf16 v[4:7], v[64:67], a[68:71], v[4:7]
    ds_read_b64_tr_b16 v[82:83], v208 offset:38912
    buffer_load_dwordx4 a[48:51], v180, s[4:7], s61 offen offset:0
    s_waitcnt lgkmcnt(6)
    v_mfma_f32_16x16x32_bf16 v[12:15], v[68:71], a[68:71], v[12:15]
    ds_read_b64_tr_b16 v[84:85], v209 offset:36864
    v_mfma_f32_16x16x32_bf16 v[8:11], v[68:71], a[64:67], v[8:11]
    ds_read_b64_tr_b16 v[86:87], v209 offset:38912
    s_waitcnt lgkmcnt(6)
    v_mfma_f32_16x16x32_bf16 v[16:19], v[72:75], a[64:67], v[16:19]
    ds_read_b64_tr_b16 v[88:89], v210 offset:36864
    buffer_load_dwordx4 a[56:59], v180, s[4:7], s61 offen offset:1024
    s_add_u32 s61, s61, 2048
    v_mfma_f32_16x16x32_bf16 v[20:23], v[72:75], a[68:71], v[20:23]
    ds_read_b64_tr_b16 v[90:91], v210 offset:38912
    s_waitcnt lgkmcnt(6)
    v_mfma_f32_16x16x32_bf16 v[28:31], v[76:79], a[68:71], v[28:31]
    ds_read_b64_tr_b16 v[92:93], v211 offset:36864
    v_mfma_f32_16x16x32_bf16 v[24:27], v[76:79], a[64:67], v[24:27]
    ds_read_b64_tr_b16 v[94:95], v211 offset:38912
    buffer_load_dwordx4 a[52:55], v180, s[4:7], s62 offen offset:0
    s_waitcnt lgkmcnt(6)
    v_mfma_f32_16x16x32_bf16 v[0:3], v[80:83], a[72:75], v[0:3]
    s_waitcnt lgkmcnt(0)
    s_barrier
    ds_read_b64_tr_b16 v[64:65], v208 offset:40960
    v_mfma_f32_16x16x32_bf16 v[4:7], v[80:83], a[76:79], v[4:7]
    ds_read_b64_tr_b16 v[66:67], v208 offset:43008
    v_mfma_f32_16x16x32_bf16 v[12:15], v[84:87], a[76:79], v[12:15]
    ds_read_b64_tr_b16 v[68:69], v209 offset:40960
    buffer_load_dwordx4 a[60:63], v180, s[4:7], s62 offen offset:1024
    s_add_u32 s62, s62, 2048
    v_mfma_f32_16x16x32_bf16 v[8:11], v[84:87], a[72:75], v[8:11]
    ds_read_b64_tr_b16 v[70:71], v209 offset:43008
    v_mfma_f32_16x16x32_bf16 v[16:19], v[88:91], a[72:75], v[16:19]
    ds_read_b64_tr_b16 v[72:73], v210 offset:40960
    s_add_u32 m0, s66, 106496
    v_mfma_f32_16x16x32_bf16 v[20:23], v[88:91], a[76:79], v[20:23]
    ds_read_b64_tr_b16 v[74:75], v210 offset:43008
    buffer_load_dwordx4 v192, s[48:51], s60 offen offset:0 lds
    v_mfma_f32_16x16x32_bf16 v[28:31], v[92:95], a[76:79], v[28:31]
    ds_read_b64_tr_b16 v[76:77], v211 offset:40960
    v_mfma_f32_16x16x32_bf16 v[24:27], v[92:95], a[72:75], v[24:27]
    ds_read_b64_tr_b16 v[78:79], v211 offset:43008
    buffer_load_dwordx4 v193, s[48:51], s60 offen offset:1024 lds
    s_add_u32 s60, s60, 131072
    s_waitcnt vmcnt(39) lgkmcnt(6)
    v_mfma_f32_16x16x32_bf16 v[0:3], v[64:67], a[80:83], v[0:3]
    ds_read_b64_tr_b16 v[80:81], v208 offset:45056
    v_mfma_f32_16x16x32_bf16 v[4:7], v[64:67], a[84:87], v[4:7]
    ds_read_b64_tr_b16 v[82:83], v208 offset:47104
    buffer_load_dwordx4 a[64:67], v180, s[4:7], s61 offen offset:0
    s_waitcnt lgkmcnt(6)
    v_mfma_f32_16x16x32_bf16 v[12:15], v[68:71], a[84:87], v[12:15]
    ds_read_b64_tr_b16 v[84:85], v209 offset:45056
    v_mfma_f32_16x16x32_bf16 v[8:11], v[68:71], a[80:83], v[8:11]
    ds_read_b64_tr_b16 v[86:87], v209 offset:47104
    s_waitcnt lgkmcnt(6)
    v_mfma_f32_16x16x32_bf16 v[16:19], v[72:75], a[80:83], v[16:19]
    ds_read_b64_tr_b16 v[88:89], v210 offset:45056
    buffer_load_dwordx4 a[72:75], v180, s[4:7], s61 offen offset:1024
    s_add_u32 s61, s61, 2048
    v_mfma_f32_16x16x32_bf16 v[20:23], v[72:75], a[84:87], v[20:23]
    ds_read_b64_tr_b16 v[90:91], v210 offset:47104
    s_waitcnt lgkmcnt(6)
    v_mfma_f32_16x16x32_bf16 v[28:31], v[76:79], a[84:87], v[28:31]
    ds_read_b64_tr_b16 v[92:93], v211 offset:45056
    v_mfma_f32_16x16x32_bf16 v[24:27], v[76:79], a[80:83], v[24:27]
    ds_read_b64_tr_b16 v[94:95], v211 offset:47104
    buffer_load_dwordx4 a[68:71], v180, s[4:7], s62 offen offset:0
    s_waitcnt lgkmcnt(6)
    v_mfma_f32_16x16x32_bf16 v[0:3], v[80:83], a[88:91], v[0:3]
    s_waitcnt lgkmcnt(0)
    s_barrier
    ds_read_b64_tr_b16 v[64:65], v208 offset:49152
    v_mfma_f32_16x16x32_bf16 v[4:7], v[80:83], a[92:95], v[4:7]
    ds_read_b64_tr_b16 v[66:67], v208 offset:51200
    v_mfma_f32_16x16x32_bf16 v[12:15], v[84:87], a[92:95], v[12:15]
    ds_read_b64_tr_b16 v[68:69], v209 offset:49152
    buffer_load_dwordx4 a[76:79], v180, s[4:7], s62 offen offset:1024
    s_add_u32 s62, s62, 2048
    v_mfma_f32_16x16x32_bf16 v[8:11], v[84:87], a[88:91], v[8:11]
    ds_read_b64_tr_b16 v[70:71], v209 offset:51200
    v_mfma_f32_16x16x32_bf16 v[16:19], v[88:91], a[88:91], v[16:19]
    ds_read_b64_tr_b16 v[72:73], v210 offset:49152
    s_add_u32 m0, s66, 114688
    v_mfma_f32_16x16x32_bf16 v[20:23], v[88:91], a[92:95], v[20:23]
    ds_read_b64_tr_b16 v[74:75], v210 offset:51200
    buffer_load_dwordx4 v192, s[48:51], s60 offen offset:0 lds
    v_mfma_f32_16x16x32_bf16 v[28:31], v[92:95], a[92:95], v[28:31]
    ds_read_b64_tr_b16 v[76:77], v211 offset:49152
    v_mfma_f32_16x16x32_bf16 v[24:27], v[92:95], a[88:91], v[24:27]
    ds_read_b64_tr_b16 v[78:79], v211 offset:51200
    buffer_load_dwordx4 v193, s[48:51], s60 offen offset:1024 lds
    s_add_u32 s60, s60, 131072
    s_waitcnt vmcnt(39) lgkmcnt(6)
    v_mfma_f32_16x16x32_bf16 v[0:3], v[64:67], a[96:99], v[0:3]
    ds_read_b64_tr_b16 v[80:81], v208 offset:53248
    v_mfma_f32_16x16x32_bf16 v[4:7], v[64:67], a[100:103], v[4:7]
    ds_read_b64_tr_b16 v[82:83], v208 offset:55296
    buffer_load_dwordx4 a[80:83], v180, s[4:7], s61 offen offset:0
    s_waitcnt lgkmcnt(6)
    v_mfma_f32_16x16x32_bf16 v[12:15], v[68:71], a[100:103], v[12:15]
    ds_read_b64_tr_b16 v[84:85], v209 offset:53248
    v_mfma_f32_16x16x32_bf16 v[8:11], v[68:71], a[96:99], v[8:11]
    ds_read_b64_tr_b16 v[86:87], v209 offset:55296
    s_waitcnt lgkmcnt(6)
    v_mfma_f32_16x16x32_bf16 v[16:19], v[72:75], a[96:99], v[16:19]
    ds_read_b64_tr_b16 v[88:89], v210 offset:53248
    buffer_load_dwordx4 a[88:91], v180, s[4:7], s61 offen offset:1024
    s_add_u32 s61, s61, 2048
    v_mfma_f32_16x16x32_bf16 v[20:23], v[72:75], a[100:103], v[20:23]
    ds_read_b64_tr_b16 v[90:91], v210 offset:55296
    s_waitcnt lgkmcnt(6)
    v_mfma_f32_16x16x32_bf16 v[28:31], v[76:79], a[100:103], v[28:31]
    ds_read_b64_tr_b16 v[92:93], v211 offset:53248
    v_mfma_f32_16x16x32_bf16 v[24:27], v[76:79], a[96:99], v[24:27]
    ds_read_b64_tr_b16 v[94:95], v211 offset:55296
    buffer_load_dwordx4 a[84:87], v180, s[4:7], s62 offen offset:0
    s_waitcnt lgkmcnt(6)
    v_mfma_f32_16x16x32_bf16 v[0:3], v[80:83], a[104:107], v[0:3]
    s_waitcnt lgkmcnt(0)
    s_barrier
    ds_read_b64_tr_b16 v[64:65], v208 offset:57344
    v_mfma_f32_16x16x32_bf16 v[4:7], v[80:83], a[108:111], v[4:7]
    ds_read_b64_tr_b16 v[66:67], v208 offset:59392
    v_mfma_f32_16x16x32_bf16 v[12:15], v[84:87], a[108:111], v[12:15]
    ds_read_b64_tr_b16 v[68:69], v209 offset:57344
    buffer_load_dwordx4 a[92:95], v180, s[4:7], s62 offen offset:1024
    s_add_u32 s62, s62, 2048
    v_mfma_f32_16x16x32_bf16 v[8:11], v[84:87], a[104:107], v[8:11]
    ds_read_b64_tr_b16 v[70:71], v209 offset:59392
    v_mfma_f32_16x16x32_bf16 v[16:19], v[88:91], a[104:107], v[16:19]
    ds_read_b64_tr_b16 v[72:73], v210 offset:57344
    s_add_u32 m0, s66, 122880
    v_mfma_f32_16x16x32_bf16 v[20:23], v[88:91], a[108:111], v[20:23]
    ds_read_b64_tr_b16 v[74:75], v210 offset:59392
    buffer_load_dwordx4 v192, s[48:51], s60 offen offset:0 lds
    v_mfma_f32_16x16x32_bf16 v[28:31], v[92:95], a[108:111], v[28:31]
    ds_read_b64_tr_b16 v[76:77], v211 offset:57344
    v_mfma_f32_16x16x32_bf16 v[24:27], v[92:95], a[104:107], v[24:27]
    ds_read_b64_tr_b16 v[78:79], v211 offset:59392
    buffer_load_dwordx4 v193, s[48:51], s60 offen offset:1024 lds
    s_add_u32 s60, s60, 131072
    s_waitcnt vmcnt(39) lgkmcnt(6)
    v_mfma_f32_16x16x32_bf16 v[0:3], v[64:67], a[112:115], v[0:3]
    ds_read_b64_tr_b16 v[80:81], v208 offset:61440
    v_mfma_f32_16x16x32_bf16 v[4:7], v[64:67], a[116:119], v[4:7]
    ds_read_b64_tr_b16 v[82:83], v208 offset:63488
    buffer_load_dwordx4 a[96:99], v180, s[4:7], s61 offen offset:0
    s_waitcnt lgkmcnt(6)
    v_mfma_f32_16x16x32_bf16 v[12:15], v[68:71], a[116:119], v[12:15]
    ds_read_b64_tr_b16 v[84:85], v209 offset:61440
    v_mfma_f32_16x16x32_bf16 v[8:11], v[68:71], a[112:115], v[8:11]
    ds_read_b64_tr_b16 v[86:87], v209 offset:63488
    s_waitcnt lgkmcnt(6)
    v_mfma_f32_16x16x32_bf16 v[16:19], v[72:75], a[112:115], v[16:19]
    ds_read_b64_tr_b16 v[88:89], v210 offset:61440
    buffer_load_dwordx4 a[104:107], v180, s[4:7], s61 offen offset:1024
    s_add_u32 s61, s61, 2048
    v_mfma_f32_16x16x32_bf16 v[20:23], v[72:75], a[116:119], v[20:23]
    ds_read_b64_tr_b16 v[90:91], v210 offset:63488
    s_waitcnt lgkmcnt(6)
    v_mfma_f32_16x16x32_bf16 v[28:31], v[76:79], a[116:119], v[28:31]
    ds_read_b64_tr_b16 v[92:93], v211 offset:61440
    v_mfma_f32_16x16x32_bf16 v[24:27], v[76:79], a[112:115], v[24:27]
    ds_read_b64_tr_b16 v[94:95], v211 offset:63488
    buffer_load_dwordx4 a[100:103], v180, s[4:7], s62 offen offset:0
    s_waitcnt lgkmcnt(6)
    v_mfma_f32_16x16x32_bf16 v[0:3], v[80:83], a[120:123], v[0:3]
    s_waitcnt lgkmcnt(0)
    s_barrier
    ds_read_b64_tr_b16 v[64:65], v212 offset:0
    v_mfma_f32_16x16x32_bf16 v[4:7], v[80:83], a[124:127], v[4:7]
    ds_read_b64_tr_b16 v[66:67], v212 offset:2048
    v_mfma_f32_16x16x32_bf16 v[12:15], v[84:87], a[124:127], v[12:15]
    ds_read_b64_tr_b16 v[68:69], v213 offset:0
    buffer_load_dwordx4 a[108:111], v180, s[4:7], s62 offen offset:1024
    s_add_u32 s62, s62, 2048
    v_mfma_f32_16x16x32_bf16 v[8:11], v[84:87], a[120:123], v[8:11]
    ds_read_b64_tr_b16 v[70:71], v213 offset:2048
    v_mfma_f32_16x16x32_bf16 v[16:19], v[88:91], a[120:123], v[16:19]
    ds_read_b64_tr_b16 v[72:73], v214 offset:0
    s_add_u32 m0, s66, 0
    s_mov_b32 s60, 0
    v_mfma_f32_16x16x32_bf16 v[20:23], v[88:91], a[124:127], v[20:23]
    ds_read_b64_tr_b16 v[74:75], v214 offset:2048
    buffer_load_dwordx4 v192, s[52:55], s60 offen offset:0 lds
    v_mfma_f32_16x16x32_bf16 v[28:31], v[92:95], a[124:127], v[28:31]
    ds_read_b64_tr_b16 v[76:77], v215 offset:0
    v_mfma_f32_16x16x32_bf16 v[24:27], v[92:95], a[120:123], v[24:27]
    ds_read_b64_tr_b16 v[78:79], v215 offset:2048
    buffer_load_dwordx4 v193, s[52:55], s60 offen offset:1024 lds
    s_add_u32 s60, s60, 131072
    s_waitcnt vmcnt(39) lgkmcnt(6)
    v_mfma_f32_16x16x32_bf16 v[0:3], v[64:67], a[0:3], v[0:3]
    ds_read_b64_tr_b16 v[80:81], v212 offset:4096
    v_mfma_f32_16x16x32_bf16 v[4:7], v[64:67], a[4:7], v[4:7]
    ds_read_b64_tr_b16 v[82:83], v212 offset:6144
    buffer_load_dwordx4 a[112:115], v180, s[4:7], s61 offen offset:0
    s_waitcnt lgkmcnt(6)
    v_mfma_f32_16x16x32_bf16 v[12:15], v[68:71], a[4:7], v[12:15]
    ds_read_b64_tr_b16 v[84:85], v213 offset:4096
    v_mfma_f32_16x16x32_bf16 v[8:11], v[68:71], a[0:3], v[8:11]
    ds_read_b64_tr_b16 v[86:87], v213 offset:6144
    s_waitcnt lgkmcnt(6)
    v_mfma_f32_16x16x32_bf16 v[16:19], v[72:75], a[0:3], v[16:19]
    ds_read_b64_tr_b16 v[88:89], v214 offset:4096
    buffer_load_dwordx4 a[120:123], v180, s[4:7], s61 offen offset:1024
    s_add_u32 s61, s61, 2048
    v_mfma_f32_16x16x32_bf16 v[20:23], v[72:75], a[4:7], v[20:23]
    ds_read_b64_tr_b16 v[90:91], v214 offset:6144
    s_waitcnt lgkmcnt(6)
    v_mfma_f32_16x16x32_bf16 v[28:31], v[76:79], a[4:7], v[28:31]
    ds_read_b64_tr_b16 v[92:93], v215 offset:4096
    v_mfma_f32_16x16x32_bf16 v[24:27], v[76:79], a[0:3], v[24:27]
    ds_read_b64_tr_b16 v[94:95], v215 offset:6144
    buffer_load_dwordx4 a[116:119], v180, s[4:7], s62 offen offset:0
    s_waitcnt lgkmcnt(6)
    v_mfma_f32_16x16x32_bf16 v[0:3], v[80:83], a[8:11], v[0:3]
    s_waitcnt lgkmcnt(0)
    s_barrier
    ds_read_b64_tr_b16 v[64:65], v212 offset:8192
    v_mfma_f32_16x16x32_bf16 v[4:7], v[80:83], a[12:15], v[4:7]
    ds_read_b64_tr_b16 v[66:67], v212 offset:10240
    v_mfma_f32_16x16x32_bf16 v[12:15], v[84:87], a[12:15], v[12:15]
    ds_read_b64_tr_b16 v[68:69], v213 offset:8192
    buffer_load_dwordx4 a[124:127], v180, s[4:7], s62 offen offset:1024
    s_add_u32 s62, s62, 2048
    v_mfma_f32_16x16x32_bf16 v[8:11], v[84:87], a[8:11], v[8:11]
    ds_read_b64_tr_b16 v[70:71], v213 offset:10240
    v_mfma_f32_16x16x32_bf16 v[16:19], v[88:91], a[8:11], v[16:19]
    ds_read_b64_tr_b16 v[72:73], v214 offset:8192
    s_add_u32 m0, s66, 8192
    v_mfma_f32_16x16x32_bf16 v[20:23], v[88:91], a[12:15], v[20:23]
    ds_read_b64_tr_b16 v[74:75], v214 offset:10240
    buffer_load_dwordx4 v192, s[52:55], s60 offen offset:0 lds
    v_mfma_f32_16x16x32_bf16 v[28:31], v[92:95], a[12:15], v[28:31]
    ds_read_b64_tr_b16 v[76:77], v215 offset:8192
    v_mfma_f32_16x16x32_bf16 v[24:27], v[92:95], a[8:11], v[24:27]
    ds_read_b64_tr_b16 v[78:79], v215 offset:10240
    buffer_load_dwordx4 v193, s[52:55], s60 offen offset:1024 lds
    s_add_u32 s60, s60, 131072
    s_waitcnt vmcnt(38) lgkmcnt(6)
    v_mfma_f32_16x16x32_bf16 v[0:3], v[64:67], a[16:19], v[0:3]
    ds_read_b64_tr_b16 v[80:81], v212 offset:12288
    s_add_u32 m0, s66, 16384
    v_mfma_f32_16x16x32_bf16 v[4:7], v[64:67], a[20:23], v[4:7]
    ds_read_b64_tr_b16 v[82:83], v212 offset:14336
    buffer_load_dwordx4 v192, s[52:55], s60 offen offset:0 lds
    s_waitcnt lgkmcnt(6)
    v_mfma_f32_16x16x32_bf16 v[12:15], v[68:71], a[20:23], v[12:15]
    ds_read_b64_tr_b16 v[84:85], v213 offset:12288
    v_mfma_f32_16x16x32_bf16 v[8:11], v[68:71], a[16:19], v[8:11]
    ds_read_b64_tr_b16 v[86:87], v213 offset:14336
    s_waitcnt lgkmcnt(6)
    v_mfma_f32_16x16x32_bf16 v[16:19], v[72:75], a[16:19], v[16:19]
    ds_read_b64_tr_b16 v[88:89], v214 offset:12288
    buffer_load_dwordx4 v193, s[52:55], s60 offen offset:1024 lds
    s_add_u32 s60, s60, 131072
    v_mfma_f32_16x16x32_bf16 v[20:23], v[72:75], a[20:23], v[20:23]
    ds_read_b64_tr_b16 v[90:91], v214 offset:14336
    s_waitcnt lgkmcnt(6)
    v_mfma_f32_16x16x32_bf16 v[28:31], v[76:79], a[20:23], v[28:31]
    ds_read_b64_tr_b16 v[92:93], v215 offset:12288
    s_add_u32 m0, s66, 24576
    v_mfma_f32_16x16x32_bf16 v[24:27], v[76:79], a[16:19], v[24:27]
    ds_read_b64_tr_b16 v[94:95], v215 offset:14336
    buffer_load_dwordx4 v192, s[52:55], s60 offen offset:0 lds
    s_waitcnt lgkmcnt(6)
    v_mfma_f32_16x16x32_bf16 v[0:3], v[80:83], a[24:27], v[0:3]
    s_waitcnt lgkmcnt(0)
    s_barrier
    ds_read_b64_tr_b16 v[64:65], v212 offset:16384
    v_mfma_f32_16x16x32_bf16 v[4:7], v[80:83], a[28:31], v[4:7]
    ds_read_b64_tr_b16 v[66:67], v212 offset:18432
    v_mfma_f32_16x16x32_bf16 v[12:15], v[84:87], a[28:31], v[12:15]
    ds_read_b64_tr_b16 v[68:69], v213 offset:16384
    buffer_load_dwordx4 v193, s[52:55], s60 offen offset:1024 lds
    s_add_u32 s60, s60, 131072
    v_mfma_f32_16x16x32_bf16 v[8:11], v[84:87], a[24:27], v[8:11]
    ds_read_b64_tr_b16 v[70:71], v213 offset:18432
    v_mfma_f32_16x16x32_bf16 v[16:19], v[88:91], a[24:27], v[16:19]
    ds_read_b64_tr_b16 v[72:73], v214 offset:16384
    s_add_u32 m0, s66, 32768
    v_mfma_f32_16x16x32_bf16 v[20:23], v[88:91], a[28:31], v[20:23]
    ds_read_b64_tr_b16 v[74:75], v214 offset:18432
    buffer_load_dwordx4 v192, s[52:55], s60 offen offset:0 lds
    v_mfma_f32_16x16x32_bf16 v[28:31], v[92:95], a[28:31], v[28:31]
    ds_read_b64_tr_b16 v[76:77], v215 offset:16384
    v_mfma_f32_16x16x32_bf16 v[24:27], v[92:95], a[24:27], v[24:27]
    ds_read_b64_tr_b16 v[78:79], v215 offset:18432
    buffer_load_dwordx4 v193, s[52:55], s60 offen offset:1024 lds
    s_add_u32 s60, s60, 131072
    s_waitcnt vmcnt(38) lgkmcnt(6)
    v_mfma_f32_16x16x32_bf16 v[0:3], v[64:67], a[32:35], v[0:3]
    ds_read_b64_tr_b16 v[80:81], v212 offset:20480
    s_add_u32 m0, s66, 40960
    v_mfma_f32_16x16x32_bf16 v[4:7], v[64:67], a[36:39], v[4:7]
    ds_read_b64_tr_b16 v[82:83], v212 offset:22528
    buffer_load_dwordx4 v192, s[52:55], s60 offen offset:0 lds
    s_waitcnt lgkmcnt(6)
    v_mfma_f32_16x16x32_bf16 v[12:15], v[68:71], a[36:39], v[12:15]
    ds_read_b64_tr_b16 v[84:85], v213 offset:20480
    buffer_load_dword v203, v205, s[4:7], s64 offen sc1
    v_mfma_f32_16x16x32_bf16 v[8:11], v[68:71], a[32:35], v[8:11]
    ds_read_b64_tr_b16 v[86:87], v213 offset:22528
    s_waitcnt lgkmcnt(6)
    v_mfma_f32_16x16x32_bf16 v[16:19], v[72:75], a[32:35], v[16:19]
    ds_read_b64_tr_b16 v[88:89], v214 offset:20480
    buffer_load_dwordx4 v193, s[52:55], s60 offen offset:1024 lds
    s_add_u32 s60, s60, 131072
    v_mfma_f32_16x16x32_bf16 v[20:23], v[72:75], a[36:39], v[20:23]
    ds_read_b64_tr_b16 v[90:91], v214 offset:22528
    s_waitcnt lgkmcnt(6)
    v_mfma_f32_16x16x32_bf16 v[28:31], v[76:79], a[36:39], v[28:31]
    ds_read_b64_tr_b16 v[92:93], v215 offset:20480
    s_add_u32 m0, s66, 49152
    v_mfma_f32_16x16x32_bf16 v[24:27], v[76:79], a[32:35], v[24:27]
    ds_read_b64_tr_b16 v[94:95], v215 offset:22528
    buffer_load_dwordx4 v192, s[52:55], s60 offen offset:0 lds
    s_waitcnt lgkmcnt(6)
    v_mfma_f32_16x16x32_bf16 v[0:3], v[80:83], a[40:43], v[0:3]
    s_waitcnt lgkmcnt(0)
    s_barrier
    ds_read_b64_tr_b16 v[64:65], v212 offset:24576
    v_mfma_f32_16x16x32_bf16 v[4:7], v[80:83], a[44:47], v[4:7]
    ds_read_b64_tr_b16 v[66:67], v212 offset:26624
    v_mfma_f32_16x16x32_bf16 v[12:15], v[84:87], a[44:47], v[12:15]
    ds_read_b64_tr_b16 v[68:69], v213 offset:24576
    buffer_load_dwordx4 v193, s[52:55], s60 offen offset:1024 lds
    s_add_u32 s60, s60, 131072
    v_mfma_f32_16x16x32_bf16 v[8:11], v[84:87], a[40:43], v[8:11]
    ds_read_b64_tr_b16 v[70:71], v213 offset:26624
    v_mfma_f32_16x16x32_bf16 v[16:19], v[88:91], a[40:43], v[16:19]
    ds_read_b64_tr_b16 v[72:73], v214 offset:24576
    s_add_u32 m0, s66, 57344
    v_mfma_f32_16x16x32_bf16 v[20:23], v[88:91], a[44:47], v[20:23]
    ds_read_b64_tr_b16 v[74:75], v214 offset:26624
    buffer_load_dwordx4 v192, s[52:55], s60 offen offset:0 lds
    v_mfma_f32_16x16x32_bf16 v[28:31], v[92:95], a[44:47], v[28:31]
    ds_read_b64_tr_b16 v[76:77], v215 offset:24576
    v_mfma_f32_16x16x32_bf16 v[24:27], v[92:95], a[40:43], v[24:27]
    ds_read_b64_tr_b16 v[78:79], v215 offset:26624
    buffer_load_dwordx4 v193, s[52:55], s60 offen offset:1024 lds
    s_add_u32 s60, s60, 131072
    s_waitcnt vmcnt(39) lgkmcnt(6)
    v_mfma_f32_16x16x32_bf16 v[0:3], v[64:67], a[48:51], v[0:3]
    ds_read_b64_tr_b16 v[80:81], v212 offset:28672
    s_add_u32 m0, s66, 65536
    v_mfma_f32_16x16x32_bf16 v[4:7], v[64:67], a[52:55], v[4:7]
    ds_read_b64_tr_b16 v[82:83], v212 offset:30720
    buffer_load_dwordx4 v192, s[52:55], s60 offen offset:0 lds
    s_waitcnt lgkmcnt(6)
    v_mfma_f32_16x16x32_bf16 v[12:15], v[68:71], a[52:55], v[12:15]
    ds_read_b64_tr_b16 v[84:85], v213 offset:28672
    v_mfma_f32_16x16x32_bf16 v[8:11], v[68:71], a[48:51], v[8:11]
    ds_read_b64_tr_b16 v[86:87], v213 offset:30720
    s_waitcnt lgkmcnt(6)
    v_mfma_f32_16x16x32_bf16 v[16:19], v[72:75], a[48:51], v[16:19]
    ds_read_b64_tr_b16 v[88:89], v214 offset:28672
    buffer_load_dwordx4 v193, s[52:55], s60 offen offset:1024 lds
    s_add_u32 s60, s60, 131072
    v_mfma_f32_16x16x32_bf16 v[20:23], v[72:75], a[52:55], v[20:23]
    ds_read_b64_tr_b16 v[90:91], v214 offset:30720
    s_waitcnt lgkmcnt(6)
    v_mfma_f32_16x16x32_bf16 v[28:31], v[76:79], a[52:55], v[28:31]
    ds_read_b64_tr_b16 v[92:93], v215 offset:28672
    s_add_u32 m0, s66, 73728
    v_mfma_f32_16x16x32_bf16 v[24:27], v[76:79], a[48:51], v[24:27]
    ds_read_b64_tr_b16 v[94:95], v215 offset:30720
    buffer_load_dwordx4 v192, s[52:55], s60 offen offset:0 lds
    s_waitcnt lgkmcnt(6)
    v_mfma_f32_16x16x32_bf16 v[0:3], v[80:83], a[56:59], v[0:3]
    s_waitcnt lgkmcnt(0)
    s_barrier
    ds_read_b64_tr_b16 v[64:65], v212 offset:32768
    v_mfma_f32_16x16x32_bf16 v[4:7], v[80:83], a[60:63], v[4:7]
    ds_read_b64_tr_b16 v[66:67], v212 offset:34816
    v_mfma_f32_16x16x32_bf16 v[12:15], v[84:87], a[60:63], v[12:15]
    ds_read_b64_tr_b16 v[68:69], v213 offset:32768
    buffer_load_dwordx4 v193, s[52:55], s60 offen offset:1024 lds
    s_add_u32 s60, s60, 131072
    v_mfma_f32_16x16x32_bf16 v[8:11], v[84:87], a[56:59], v[8:11]
    ds_read_b64_tr_b16 v[70:71], v213 offset:34816
    v_mfma_f32_16x16x32_bf16 v[16:19], v[88:91], a[56:59], v[16:19]
    ds_read_b64_tr_b16 v[72:73], v214 offset:32768
    s_add_u32 m0, s66, 81920
    v_mfma_f32_16x16x32_bf16 v[20:23], v[88:91], a[60:63], v[20:23]
    ds_read_b64_tr_b16 v[74:75], v214 offset:34816
    buffer_load_dwordx4 v192, s[52:55], s60 offen offset:0 lds
    v_mfma_f32_16x16x32_bf16 v[28:31], v[92:95], a[60:63], v[28:31]
    ds_read_b64_tr_b16 v[76:77], v215 offset:32768
    v_mfma_f32_16x16x32_bf16 v[24:27], v[92:95], a[56:59], v[24:27]
    ds_read_b64_tr_b16 v[78:79], v215 offset:34816
    buffer_load_dwordx4 v193, s[52:55], s60 offen offset:1024 lds
    s_add_u32 s60, s60, 131072
    s_waitcnt vmcnt(11)
    v_cmp_eq_u32 vcc, 0, v203
    s_mov_b32 s36, 0x40000
    s_nop 0
    s_cbranch_vccz k23_kernel_u_got
k23_kernel_u_spin:
    buffer_load_dword v203, v205, s[4:7], s64 offen sc1
    s_waitcnt vmcnt(0)
    v_cmp_eq_u32 vcc, 0, v203
    s_sub_u32 s36, s36, 1
    s_cbranch_scc1 k23_kernel_u_got
    s_cbranch_vccz k23_kernel_u_got
    s_sleep 2
    s_branch k23_kernel_u_spin
k23_kernel_u_got:
    s_waitcnt lgkmcnt(6)
    v_mfma_f32_16x16x32_bf16 v[0:3], v[64:67], a[64:67], v[0:3]
    ds_read_b64_tr_b16 v[80:81], v212 offset:36864
    s_mov_b32 s61, s70
    s_mov_b32 s62, s71
    v_mfma_f32_16x16x32_bf16 v[4:7], v[64:67], a[68:71], v[4:7]
    ds_read_b64_tr_b16 v[82:83], v212 offset:38912
    buffer_load_dwordx4 a[0:3], v180, s[4:7], s61 offen offset:0
    s_waitcnt lgkmcnt(6)
    v_mfma_f32_16x16x32_bf16 v[12:15], v[68:71], a[68:71], v[12:15]
    ds_read_b64_tr_b16 v[84:85], v213 offset:36864
    v_mfma_f32_16x16x32_bf16 v[8:11], v[68:71], a[64:67], v[8:11]
    ds_read_b64_tr_b16 v[86:87], v213 offset:38912
    s_waitcnt lgkmcnt(6)
    v_mfma_f32_16x16x32_bf16 v[16:19], v[72:75], a[64:67], v[16:19]
    ds_read_b64_tr_b16 v[88:89], v214 offset:36864
    buffer_load_dwordx4 a[8:11], v180, s[4:7], s61 offen offset:1024
    s_add_u32 s61, s61, 2048
    v_mfma_f32_16x16x32_bf16 v[20:23], v[72:75], a[68:71], v[20:23]
    ds_read_b64_tr_b16 v[90:91], v214 offset:38912
    s_waitcnt lgkmcnt(6)
    v_mfma_f32_16x16x32_bf16 v[28:31], v[76:79], a[68:71], v[28:31]
    ds_read_b64_tr_b16 v[92:93], v215 offset:36864
    v_mfma_f32_16x16x32_bf16 v[24:27], v[76:79], a[64:67], v[24:27]
    ds_read_b64_tr_b16 v[94:95], v215 offset:38912
    buffer_load_dwordx4 a[4:7], v180, s[4:7], s62 offen offset:0
    s_waitcnt lgkmcnt(6)
    v_mfma_f32_16x16x32_bf16 v[0:3], v[80:83], a[72:75], v[0:3]
    s_waitcnt lgkmcnt(0)
    s_barrier
    ds_read_b64_tr_b16 v[64:65], v212 offset:40960
    v_mfma_f32_16x16x32_bf16 v[4:7], v[80:83], a[76:79], v[4:7]
    ds_read_b64_tr_b16 v[66:67], v212 offset:43008
    v_mfma_f32_16x16x32_bf16 v[12:15], v[84:87], a[76:79], v[12:15]
    ds_read_b64_tr_b16 v[68:69], v213 offset:40960
    buffer_load_dwordx4 a[12:15], v180, s[4:7], s62 offen offset:1024
    s_add_u32 s62, s62, 2048
    v_mfma_f32_16x16x32_bf16 v[8:11], v[84:87], a[72:75], v[8:11]
    ds_read_b64_tr_b16 v[70:71], v213 offset:43008
    v_mfma_f32_16x16x32_bf16 v[16:19], v[88:91], a[72:75], v[16:19]
    ds_read_b64_tr_b16 v[72:73], v214 offset:40960
    v_mfma_f32_16x16x32_bf16 v[20:23], v[88:91], a[76:79], v[20:23]
    ds_read_b64_tr_b16 v[74:75], v214 offset:43008
    buffer_load_dwordx4 a[16:19], v180, s[4:7], s61 offen offset:0
    v_mfma_f32_16x16x32_bf16 v[28:31], v[92:95], a[76:79], v[28:31]
    ds_read_b64_tr_b16 v[76:77], v215 offset:40960
    v_mfma_f32_16x16x32_bf16 v[24:27], v[92:95], a[72:75], v[24:27]
    ds_read_b64_tr_b16 v[78:79], v215 offset:43008
    buffer_load_dwordx4 a[24:27], v180, s[4:7], s61 offen offset:1024
    s_add_u32 s61, s61, 2048
    s_waitcnt lgkmcnt(6)
    v_mfma_f32_16x16x32_bf16 v[0:3], v[64:67], a[80:83], v[0:3]
    ds_read_b64_tr_b16 v[80:81], v212 offset:45056
    v_mfma_f32_16x16x32_bf16 v[4:7], v[64:67], a[84:87], v[4:7]
    ds_read_b64_tr_b16 v[82:83], v212 offset:47104
    buffer_load_dwordx4 a[20:23], v180, s[4:7], s62 offen offset:0
    s_waitcnt lgkmcnt(6)
    v_mfma_f32_16x16x32_bf16 v[12:15], v[68:71], a[84:87], v[12:15]
    ds_read_b64_tr_b16 v[84:85], v213 offset:45056
    v_mfma_f32_16x16x32_bf16 v[8:11], v[68:71], a[80:83], v[8:11]
    ds_read_b64_tr_b16 v[86:87], v213 offset:47104
    s_waitcnt lgkmcnt(6)
    v_mfma_f32_16x16x32_bf16 v[16:19], v[72:75], a[80:83], v[16:19]
    ds_read_b64_tr_b16 v[88:89], v214 offset:45056
    buffer_load_dwordx4 a[28:31], v180, s[4:7], s62 offen offset:1024
    s_add_u32 s62, s62, 2048
    v_mfma_f32_16x16x32_bf16 v[20:23], v[72:75], a[84:87], v[20:23]
    ds_read_b64_tr_b16 v[90:91], v214 offset:47104
    s_waitcnt lgkmcnt(6)
    v_mfma_f32_16x16x32_bf16 v[28:31], v[76:79], a[84:87], v[28:31]
    ds_read_b64_tr_b16 v[92:93], v215 offset:45056
    v_mfma_f32_16x16x32_bf16 v[24:27], v[76:79], a[80:83], v[24:27]
    ds_read_b64_tr_b16 v[94:95], v215 offset:47104
    buffer_load_dwordx4 a[32:35], v180, s[4:7], s61 offen offset:0
    s_waitcnt lgkmcnt(6)
    v_mfma_f32_16x16x32_bf16 v[0:3], v[80:83], a[88:91], v[0:3]
    s_waitcnt lgkmcnt(0)
    s_barrier
    ds_read_b64_tr_b16 v[64:65], v212 offset:49152
    v_mfma_f32_16x16x32_bf16 v[4:7], v[80:83], a[92:95], v[4:7]
    ds_read_b64_tr_b16 v[66:67], v212 offset:51200
    v_mfma_f32_16x16x32_bf16 v[12:15], v[84:87], a[92:95], v[12:15]
    ds_read_b64_tr_b16 v[68:69], v213 offset:49152
    buffer_load_dwordx4 a[40:43], v180, s[4:7], s61 offen offset:1024
    s_add_u32 s61, s61, 2048
    v_mfma_f32_16x16x32_bf16 v[8:11], v[84:87], a[88:91], v[8:11]
    ds_read_b64_tr_b16 v[70:71], v213 offset:51200
    v_mfma_f32_16x16x32_bf16 v[16:19], v[88:91], a[88:91], v[16:19]
    ds_read_b64_tr_b16 v[72:73], v214 offset:49152
    v_mfma_f32_16x16x32_bf16 v[20:23], v[88:91], a[92:95], v[20:23]
    ds_read_b64_tr_b16 v[74:75], v214 offset:51200
    buffer_load_dwordx4 a[36:39], v180, s[4:7], s62 offen offset:0
    v_mfma_f32_16x16x32_bf16 v[28:31], v[92:95], a[92:95], v[28:31]
    ds_read_b64_tr_b16 v[76:77], v215 offset:49152
    v_mfma_f32_16x16x32_bf16 v[24:27], v[92:95], a[88:91], v[24:27]
    ds_read_b64_tr_b16 v[78:79], v215 offset:51200
    buffer_load_dwordx4 a[44:47], v180, s[4:7], s62 offen offset:1024
    s_add_u32 s62, s62, 2048
    s_waitcnt lgkmcnt(6)
    v_mfma_f32_16x16x32_bf16 v[0:3], v[64:67], a[96:99], v[0:3]
    ds_read_b64_tr_b16 v[80:81], v212 offset:53248
    v_mfma_f32_16x16x32_bf16 v[4:7], v[64:67], a[100:103], v[4:7]
    ds_read_b64_tr_b16 v[82:83], v212 offset:55296
    buffer_load_dwordx4 a[48:51], v180, s[4:7], s61 offen offset:0
    s_waitcnt lgkmcnt(6)
    v_mfma_f32_16x16x32_bf16 v[12:15], v[68:71], a[100:103], v[12:15]
    ds_read_b64_tr_b16 v[84:85], v213 offset:53248
    v_mfma_f32_16x16x32_bf16 v[8:11], v[68:71], a[96:99], v[8:11]
    ds_read_b64_tr_b16 v[86:87], v213 offset:55296
    s_waitcnt lgkmcnt(6)
    v_mfma_f32_16x16x32_bf16 v[16:19], v[72:75], a[96:99], v[16:19]
    ds_read_b64_tr_b16 v[88:89], v214 offset:53248
    buffer_load_dwordx4 a[56:59], v180, s[4:7], s61 offen offset:1024
    s_add_u32 s61, s61, 2048
    v_mfma_f32_16x16x32_bf16 v[20:23], v[72:75], a[100:103], v[20:23]
    ds_read_b64_tr_b16 v[90:91], v214 offset:55296
    s_waitcnt lgkmcnt(6)
    v_mfma_f32_16x16x32_bf16 v[28:31], v[76:79], a[100:103], v[28:31]
    ds_read_b64_tr_b16 v[92:93], v215 offset:53248
    v_mfma_f32_16x16x32_bf16 v[24:27], v[76:79], a[96:99], v[24:27]
    ds_read_b64_tr_b16 v[94:95], v215 offset:55296
    buffer_load_dwordx4 a[52:55], v180, s[4:7], s62 offen offset:0
    s_waitcnt lgkmcnt(6)
    v_mfma_f32_16x16x32_bf16 v[0:3], v[80:83], a[104:107], v[0:3]
    s_waitcnt lgkmcnt(0)
    s_barrier
    ds_read_b64_tr_b16 v[64:65], v212 offset:57344
    v_mfma_f32_16x16x32_bf16 v[4:7], v[80:83], a[108:111], v[4:7]
    ds_read_b64_tr_b16 v[66:67], v212 offset:59392
    v_mfma_f32_16x16x32_bf16 v[12:15], v[84:87], a[108:111], v[12:15]
    ds_read_b64_tr_b16 v[68:69], v213 offset:57344
    buffer_load_dwordx4 a[60:63], v180, s[4:7], s62 offen offset:1024
    s_add_u32 s62, s62, 2048
    v_mfma_f32_16x16x32_bf16 v[8:11], v[84:87], a[104:107], v[8:11]
    ds_read_b64_tr_b16 v[70:71], v213 offset:59392
    v_mfma_f32_16x16x32_bf16 v[16:19], v[88:91], a[104:107], v[16:19]
    ds_read_b64_tr_b16 v[72:73], v214 offset:57344
    v_mfma_f32_16x16x32_bf16 v[20:23], v[88:91], a[108:111], v[20:23]
    ds_read_b64_tr_b16 v[74:75], v214 offset:59392
    buffer_load_dwordx4 a[64:67], v180, s[4:7], s61 offen offset:0
    v_mfma_f32_16x16x32_bf16 v[28:31], v[92:95], a[108:111], v[28:31]
    ds_read_b64_tr_b16 v[76:77], v215 offset:57344
    v_mfma_f32_16x16x32_bf16 v[24:27], v[92:95], a[104:107], v[24:27]
    ds_read_b64_tr_b16 v[78:79], v215 offset:59392
    buffer_load_dwordx4 a[72:75], v180, s[4:7], s61 offen offset:1024
    s_add_u32 s61, s61, 2048
    s_waitcnt lgkmcnt(6)
    v_mfma_f32_16x16x32_bf16 v[0:3], v[64:67], a[112:115], v[0:3]
    ds_read_b64_tr_b16 v[80:81], v212 offset:61440
    v_mfma_f32_16x16x32_bf16 v[4:7], v[64:67], a[116:119], v[4:7]
    ds_read_b64_tr_b16 v[82:83], v212 offset:63488
    buffer_load_dwordx4 a[68:71], v180, s[4:7], s62 offen offset:0
    s_waitcnt lgkmcnt(6)
    v_mfma_f32_16x16x32_bf16 v[12:15], v[68:71], a[116:119], v[12:15]
    ds_read_b64_tr_b16 v[84:85], v213 offset:61440
    v_mfma_f32_16x16x32_bf16 v[8:11], v[68:71], a[112:115], v[8:11]
    ds_read_b64_tr_b16 v[86:87], v213 offset:63488
    s_waitcnt lgkmcnt(6)
    v_mfma_f32_16x16x32_bf16 v[16:19], v[72:75], a[112:115], v[16:19]
    ds_read_b64_tr_b16 v[88:89], v214 offset:61440
    buffer_load_dwordx4 a[76:79], v180, s[4:7], s62 offen offset:1024
    s_add_u32 s62, s62, 2048
    v_mfma_f32_16x16x32_bf16 v[20:23], v[72:75], a[116:119], v[20:23]
    ds_read_b64_tr_b16 v[90:91], v214 offset:63488
    s_waitcnt lgkmcnt(6)
    v_mfma_f32_16x16x32_bf16 v[28:31], v[76:79], a[116:119], v[28:31]
    ds_read_b64_tr_b16 v[92:93], v215 offset:61440
    v_mfma_f32_16x16x32_bf16 v[24:27], v[76:79], a[112:115], v[24:27]
    ds_read_b64_tr_b16 v[94:95], v215 offset:63488
    buffer_load_dwordx4 a[80:83], v180, s[4:7], s61 offen offset:0
    s_waitcnt lgkmcnt(6)
    v_mfma_f32_16x16x32_bf16 v[0:3], v[80:83], a[120:123], v[0:3]
    s_waitcnt lgkmcnt(0)
    s_barrier
    ds_read_b64_tr_b16 v[64:65], v208 offset:0
    v_mfma_f32_16x16x32_bf16 v[4:7], v[80:83], a[124:127], v[4:7]
    ds_read_b64_tr_b16 v[66:67], v208 offset:2048
    v_mfma_f32_16x16x32_bf16 v[12:15], v[84:87], a[124:127], v[12:15]
    ds_read_b64_tr_b16 v[68:69], v209 offset:0
    buffer_load_dwordx4 a[88:91], v180, s[4:7], s61 offen offset:1024
    s_add_u32 s61, s61, 2048
    v_mfma_f32_16x16x32_bf16 v[8:11], v[84:87], a[120:123], v[8:11]
    ds_read_b64_tr_b16 v[70:71], v209 offset:2048
    v_mfma_f32_16x16x32_bf16 v[16:19], v[88:91], a[120:123], v[16:19]
    ds_read_b64_tr_b16 v[72:73], v210 offset:0
    v_mfma_f32_16x16x32_bf16 v[20:23], v[88:91], a[124:127], v[20:23]
    ds_read_b64_tr_b16 v[74:75], v210 offset:2048
    buffer_load_dwordx4 a[84:87], v180, s[4:7], s62 offen offset:0
    v_mfma_f32_16x16x32_bf16 v[28:31], v[92:95], a[124:127], v[28:31]
    ds_read_b64_tr_b16 v[76:77], v211 offset:0
    v_mfma_f32_16x16x32_bf16 v[24:27], v[92:95], a[120:123], v[24:27]
    ds_read_b64_tr_b16 v[78:79], v211 offset:2048
    buffer_load_dwordx4 a[92:95], v180, s[4:7], s62 offen offset:1024
    s_add_u32 s62, s62, 2048
    s_waitcnt vmcnt(20) lgkmcnt(6)
    v_mfma_f32_16x16x32_bf16 v[32:35], v[64:67], a[0:3], 0
    ds_read_b64_tr_b16 v[80:81], v208 offset:4096
    v_mfma_f32_16x16x32_bf16 v[36:39], v[64:67], a[4:7], 0
    ds_read_b64_tr_b16 v[82:83], v208 offset:6144
    buffer_load_dwordx4 a[96:99], v180, s[4:7], s61 offen offset:0
    s_waitcnt lgkmcnt(6)
    v_mfma_f32_16x16x32_bf16 v[44:47], v[68:71], a[4:7], 0
    ds_read_b64_tr_b16 v[84:85], v209 offset:4096
    v_mfma_f32_16x16x32_bf16 v[40:43], v[68:71], a[0:3], 0
    ds_read_b64_tr_b16 v[86:87], v209 offset:6144
    s_waitcnt lgkmcnt(6)
    v_mfma_f32_16x16x32_bf16 v[48:51], v[72:75], a[0:3], 0
    ds_read_b64_tr_b16 v[88:89], v210 offset:4096
    buffer_load_dwordx4 a[104:107], v180, s[4:7], s61 offen offset:1024
    s_add_u32 s61, s61, 2048
    v_mfma_f32_16x16x32_bf16 v[52:55], v[72:75], a[4:7], 0
    ds_read_b64_tr_b16 v[90:91], v210 offset:6144
    s_waitcnt lgkmcnt(6)
    v_mfma_f32_16x16x32_bf16 v[60:63], v[76:79], a[4:7], 0
    ds_read_b64_tr_b16 v[92:93], v211 offset:4096
    v_mfma_f32_16x16x32_bf16 v[56:59], v[76:79], a[0:3], 0
    ds_read_b64_tr_b16 v[94:95], v211 offset:6144
    buffer_load_dwordx4 a[100:103], v180, s[4:7], s62 offen offset:0
    s_waitcnt lgkmcnt(6)
    v_mfma_f32_16x16x32_bf16 v[32:35], v[80:83], a[8:11], v[32:35]
    s_waitcnt lgkmcnt(0)
    s_barrier
    ds_read_b64_tr_b16 v[64:65], v208 offset:8192
    v_mfma_f32_16x16x32_bf16 v[36:39], v[80:83], a[12:15], v[36:39]
    ds_read_b64_tr_b16 v[66:67], v208 offset:10240
    v_mfma_f32_16x16x32_bf16 v[44:47], v[84:87], a[12:15], v[44:47]
    ds_read_b64_tr_b16 v[68:69], v209 offset:8192
    buffer_load_dwordx4 a[108:111], v180, s[4:7], s62 offen offset:1024
    s_add_u32 s62, s62, 2048
    v_mfma_f32_16x16x32_bf16 v[40:43], v[84:87], a[8:11], v[40:43]
    ds_read_b64_tr_b16 v[70:71], v209 offset:10240
    v_mfma_f32_16x16x32_bf16 v[48:51], v[88:91], a[8:11], v[48:51]
    ds_read_b64_tr_b16 v[72:73], v210 offset:8192
    v_mfma_f32_16x16x32_bf16 v[52:55], v[88:91], a[12:15], v[52:55]
    ds_read_b64_tr_b16 v[74:75], v210 offset:10240
    buffer_load_dwordx4 a[112:115], v180, s[4:7], s61 offen offset:0
    v_mfma_f32_16x16x32_bf16 v[60:63], v[92:95], a[12:15], v[60:63]
    ds_read_b64_tr_b16 v[76:77], v211 offset:8192
    v_mfma_f32_16x16x32_bf16 v[56:59], v[92:95], a[8:11], v[56:59]
    ds_read_b64_tr_b16 v[78:79], v211 offset:10240
    buffer_load_dwordx4 a[120:123], v180, s[4:7], s61 offen offset:1024
    s_add_u32 s61, s61, 2048
    s_waitcnt vmcnt(22) lgkmcnt(6)
    v_mfma_f32_16x16x32_bf16 v[32:35], v[64:67], a[16:19], v[32:35]
    ds_read_b64_tr_b16 v[80:81], v208 offset:12288
    v_mfma_f32_16x16x32_bf16 v[36:39], v[64:67], a[20:23], v[36:39]
    ds_read_b64_tr_b16 v[82:83], v208 offset:14336
    buffer_load_dwordx4 a[116:119], v180, s[4:7], s62 offen offset:0
    s_waitcnt lgkmcnt(6)
    v_mfma_f32_16x16x32_bf16 v[44:47], v[68:71], a[20:23], v[44:47]
    ds_read_b64_tr_b16 v[84:85], v209 offset:12288
    v_mfma_f32_16x16x32_bf16 v[40:43], v[68:71], a[16:19], v[40:43]
    ds_read_b64_tr_b16 v[86:87], v209 offset:14336
    s_waitcnt lgkmcnt(6)
    v_mfma_f32_16x16x32_bf16 v[48:51], v[72:75], a[16:19], v[48:51]
    ds_read_b64_tr_b16 v[88:89], v210 offset:12288
    buffer_load_dwordx4 a[124:127], v180, s[4:7], s62 offen offset:1024
    s_add_u32 s62, s62, 2048
    v_mfma_f32_16x16x32_bf16 v[52:55], v[72:75], a[20:23], v[52:55]
    ds_read_b64_tr_b16 v[90:91], v210 offset:14336
    s_waitcnt lgkmcnt(6)
    v_mfma_f32_16x16x32_bf16 v[60:63], v[76:79], a[20:23], v[60:63]
    ds_read_b64_tr_b16 v[92:93], v211 offset:12288
    v_mfma_f32_16x16x32_bf16 v[56:59], v[76:79], a[16:19], v[56:59]
    ds_read_b64_tr_b16 v[94:95], v211 offset:14336
    buffer_load_dwordx4 a[0:3], v180, s[4:7], s61 offen offset:0
    s_waitcnt lgkmcnt(6)
    v_mfma_f32_16x16x32_bf16 v[32:35], v[80:83], a[24:27], v[32:35]
    s_waitcnt lgkmcnt(0)
    s_barrier
    ds_read_b64_tr_b16 v[64:65], v208 offset:16384
    v_mfma_f32_16x16x32_bf16 v[36:39], v[80:83], a[28:31], v[36:39]
    ds_read_b64_tr_b16 v[66:67], v208 offset:18432
    v_mfma_f32_16x16x32_bf16 v[44:47], v[84:87], a[28:31], v[44:47]
    ds_read_b64_tr_b16 v[68:69], v209 offset:16384
    buffer_load_dwordx4 a[8:11], v180, s[4:7], s61 offen offset:1024
    s_add_u32 s61, s61, 2048
    v_mfma_f32_16x16x32_bf16 v[40:43], v[84:87], a[24:27], v[40:43]
    ds_read_b64_tr_b16 v[70:71], v209 offset:18432
    v_mfma_f32_16x16x32_bf16 v[48:51], v[88:91], a[24:27], v[48:51]
    ds_read_b64_tr_b16 v[72:73], v210 offset:16384
    v_mfma_f32_16x16x32_bf16 v[52:55], v[88:91], a[28:31], v[52:55]
    ds_read_b64_tr_b16 v[74:75], v210 offset:18432
    buffer_load_dwordx4 a[4:7], v180, s[4:7], s62 offen offset:0
    v_mfma_f32_16x16x32_bf16 v[60:63], v[92:95], a[28:31], v[60:63]
    ds_read_b64_tr_b16 v[76:77], v211 offset:16384
    v_mfma_f32_16x16x32_bf16 v[56:59], v[92:95], a[24:27], v[56:59]
    ds_read_b64_tr_b16 v[78:79], v211 offset:18432
    buffer_load_dwordx4 a[12:15], v180, s[4:7], s62 offen offset:1024
    s_add_u32 s62, s62, 2048
    s_waitcnt vmcnt(24) lgkmcnt(6)
    v_mfma_f32_16x16x32_bf16 v[32:35], v[64:67], a[32:35], v[32:35]
    ds_read_b64_tr_b16 v[80:81], v208 offset:20480
    v_mfma_f32_16x16x32_bf16 v[36:39], v[64:67], a[36:39], v[36:39]
    ds_read_b64_tr_b16 v[82:83], v208 offset:22528
    buffer_load_dwordx4 a[16:19], v180, s[4:7], s61 offen offset:0
    s_waitcnt lgkmcnt(6)
    v_mfma_f32_16x16x32_bf16 v[44:47], v[68:71], a[36:39], v[44:47]
    ds_read_b64_tr_b16 v[84:85], v209 offset:20480
    v_mfma_f32_16x16x32_bf16 v[40:43], v[68:71], a[32:35], v[40:43]
    ds_read_b64_tr_b16 v[86:87], v209 offset:22528
    s_waitcnt lgkmcnt(6)
    v_mfma_f32_16x16x32_bf16 v[48:51], v[72:75], a[32:35], v[48:51]
    ds_read_b64_tr_b16 v[88:89], v210 offset:20480
    buffer_load_dwordx4 a[24:27], v180, s[4:7], s61 offen offset:1024
    s_add_u32 s61, s61, 2048
    v_mfma_f32_16x16x32_bf16 v[52:55], v[72:75], a[36:39], v[52:55]
    ds_read_b64_tr_b16 v[90:91], v210 offset:22528
    s_waitcnt lgkmcnt(6)
    v_mfma_f32_16x16x32_bf16 v[60:63], v[76:79], a[36:39], v[60:63]
    ds_read_b64_tr_b16 v[92:93], v211 offset:20480
    v_mfma_f32_16x16x32_bf16 v[56:59], v[76:79], a[32:35], v[56:59]
    ds_read_b64_tr_b16 v[94:95], v211 offset:22528
    buffer_load_dwordx4 a[20:23], v180, s[4:7], s62 offen offset:0
    s_waitcnt lgkmcnt(6)
    v_mfma_f32_16x16x32_bf16 v[32:35], v[80:83], a[40:43], v[32:35]
    s_waitcnt lgkmcnt(0)
    s_barrier
    ds_read_b64_tr_b16 v[64:65], v208 offset:24576
    v_mfma_f32_16x16x32_bf16 v[36:39], v[80:83], a[44:47], v[36:39]
    ds_read_b64_tr_b16 v[66:67], v208 offset:26624
    v_mfma_f32_16x16x32_bf16 v[44:47], v[84:87], a[44:47], v[44:47]
    ds_read_b64_tr_b16 v[68:69], v209 offset:24576
    buffer_load_dwordx4 a[28:31], v180, s[4:7], s62 offen offset:1024
    s_add_u32 s62, s62, 2048
    v_mfma_f32_16x16x32_bf16 v[40:43], v[84:87], a[40:43], v[40:43]
    ds_read_b64_tr_b16 v[70:71], v209 offset:26624
    v_mfma_f32_16x16x32_bf16 v[48:51], v[88:91], a[40:43], v[48:51]
    ds_read_b64_tr_b16 v[72:73], v210 offset:24576
    s_add_u32 m0, s66, 90112
    v_mfma_f32_16x16x32_bf16 v[52:55], v[88:91], a[44:47], v[52:55]
    ds_read_b64_tr_b16 v[74:75], v210 offset:26624
    buffer_load_dwordx4 v192, s[52:55], s60 offen offset:0 lds
    v_mfma_f32_16x16x32_bf16 v[60:63], v[92:95], a[44:47], v[60:63]
    ds_read_b64_tr_b16 v[76:77], v211 offset:24576
    v_mfma_f32_16x16x32_bf16 v[56:59], v[92:95], a[40:43], v[56:59]
    ds_read_b64_tr_b16 v[78:79], v211 offset:26624
    buffer_load_dwordx4 v193, s[52:55], s60 offen offset:1024 lds
    s_add_u32 s60, s60, 131072
    s_waitcnt vmcnt(26) lgkmcnt(6)
    v_mfma_f32_16x16x32_bf16 v[32:35], v[64:67], a[48:51], v[32:35]
    ds_read_b64_tr_b16 v[80:81], v208 offset:28672
    v_mfma_f32_16x16x32_bf16 v[36:39], v[64:67], a[52:55], v[36:39]
    ds_read_b64_tr_b16 v[82:83], v208 offset:30720
    buffer_load_dwordx4 a[32:35], v180, s[4:7], s61 offen offset:0
    s_waitcnt lgkmcnt(6)
    v_mfma_f32_16x16x32_bf16 v[44:47], v[68:71], a[52:55], v[44:47]
    ds_read_b64_tr_b16 v[84:85], v209 offset:28672
    v_mfma_f32_16x16x32_bf16 v[40:43], v[68:71], a[48:51], v[40:43]
    ds_read_b64_tr_b16 v[86:87], v209 offset:30720
    s_waitcnt lgkmcnt(6)
    v_mfma_f32_16x16x32_bf16 v[48:51], v[72:75], a[48:51], v[48:51]
    ds_read_b64_tr_b16 v[88:89], v210 offset:28672
    buffer_load_dwordx4 a[40:43], v180, s[4:7], s61 offen offset:1024
    s_add_u32 s61, s61, 2048
    v_mfma_f32_16x16x32_bf16 v[52:55], v[72:75], a[52:55], v[52:55]
    ds_read_b64_tr_b16 v[90:91], v210 offset:30720
    s_waitcnt lgkmcnt(6)
    v_mfma_f32_16x16x32_bf16 v[60:63], v[76:79], a[52:55], v[60:63]
    ds_read_b64_tr_b16 v[92:93], v211 offset:28672
    v_mfma_f32_16x16x32_bf16 v[56:59], v[76:79], a[48:51], v[56:59]
    ds_read_b64_tr_b16 v[94:95], v211 offset:30720
    buffer_load_dwordx4 a[36:39], v180, s[4:7], s62 offen offset:0
    s_waitcnt lgkmcnt(6)
    v_mfma_f32_16x16x32_bf16 v[32:35], v[80:83], a[56:59], v[32:35]
    s_waitcnt lgkmcnt(0)
    s_barrier
    ds_read_b64_tr_b16 v[64:65], v208 offset:32768
    v_mfma_f32_16x16x32_bf16 v[36:39], v[80:83], a[60:63], v[36:39]
    ds_read_b64_tr_b16 v[66:67], v208 offset:34816
    v_mfma_f32_16x16x32_bf16 v[44:47], v[84:87], a[60:63], v[44:47]
    ds_read_b64_tr_b16 v[68:69], v209 offset:32768
    buffer_load_dwordx4 a[44:47], v180, s[4:7], s62 offen offset:1024
    s_add_u32 s62, s62, 2048
    v_mfma_f32_16x16x32_bf16 v[40:43], v[84:87], a[56:59], v[40:43]
    ds_read_b64_tr_b16 v[70:71], v209 offset:34816
    v_mfma_f32_16x16x32_bf16 v[48:51], v[88:91], a[56:59], v[48:51]
    ds_read_b64_tr_b16 v[72:73], v210 offset:32768
    s_add_u32 m0, s66, 98304
    v_mfma_f32_16x16x32_bf16 v[52:55], v[88:91], a[60:63], v[52:55]
    ds_read_b64_tr_b16 v[74:75], v210 offset:34816
    buffer_load_dwordx4 v192, s[52:55], s60 offen offset:0 lds
    v_mfma_f32_16x16x32_bf16 v[60:63], v[92:95], a[60:63], v[60:63]
    ds_read_b64_tr_b16 v[76:77], v211 offset:32768
    v_mfma_f32_16x16x32_bf16 v[56:59], v[92:95], a[56:59], v[56:59]
    ds_read_b64_tr_b16 v[78:79], v211 offset:34816
    buffer_load_dwordx4 v193, s[52:55], s60 offen offset:1024 lds
    s_add_u32 s60, s60, 131072
    s_waitcnt vmcnt(28) lgkmcnt(6)
    v_mfma_f32_16x16x32_bf16 v[32:35], v[64:67], a[64:67], v[32:35]
    ds_read_b64_tr_b16 v[80:81], v208 offset:36864
    v_mfma_f32_16x16x32_bf16 v[36:39], v[64:67], a[68:71], v[36:39]
    ds_read_b64_tr_b16 v[82:83], v208 offset:38912
    buffer_load_dwordx4 a[48:51], v180, s[4:7], s61 offen offset:0
    s_waitcnt lgkmcnt(6)
    v_mfma_f32_16x16x32_bf16 v[44:47], v[68:71], a[68:71], v[44:47]
    ds_read_b64_tr_b16 v[84:85], v209 offset:36864
    v_mfma_f32_16x16x32_bf16 v[40:43], v[68:71], a[64:67], v[40:43]
    ds_read_b64_tr_b16 v[86:87], v209 offset:38912
    s_waitcnt lgkmcnt(6)
    v_mfma_f32_16x16x32_bf16 v[48:51], v[72:75], a[64:67], v[48:51]
    ds_read_b64_tr_b16 v[88:89], v210 offset:36864
    buffer_load_dwordx4 a[56:59], v180, s[4:7], s61 offen offset:1024
    s_add_u32 s61, s61, 2048
    v_mfma_f32_16x16x32_bf16 v[52:55], v[72:75], a[68:71], v[52:55]
    ds_read_b64_tr_b16 v[90:91], v210 offset:38912
    s_waitcnt lgkmcnt(6)
    v_mfma_f32_16x16x32_bf16 v[60:63], v[76:79], a[68:71], v[60:63]
    ds_read_b64_tr_b16 v[92:93], v211 offset:36864
    v_mfma_f32_16x16x32_bf16 v[56:59], v[76:79], a[64:67], v[56:59]
    ds_read_b64_tr_b16 v[94:95], v211 offset:38912
    buffer_load_dwordx4 a[52:55], v180, s[4:7], s62 offen offset:0
    s_waitcnt lgkmcnt(6)
    v_mfma_f32_16x16x32_bf16 v[32:35], v[80:83], a[72:75], v[32:35]
    s_waitcnt lgkmcnt(0)
    s_barrier
    ds_read_b64_tr_b16 v[64:65], v208 offset:40960
    v_mfma_f32_16x16x32_bf16 v[36:39], v[80:83], a[76:79], v[36:39]
    ds_read_b64_tr_b16 v[66:67], v208 offset:43008
    v_mfma_f32_16x16x32_bf16 v[44:47], v[84:87], a[76:79], v[44:47]
    ds_read_b64_tr_b16 v[68:69], v209 offset:40960
    buffer_load_dwordx4 a[60:63], v180, s[4:7], s62 offen offset:1024
    s_add_u32 s62, s62, 2048
    v_mfma_f32_16x16x32_bf16 v[40:43], v[84:87], a[72:75], v[40:43]
    ds_read_b64_tr_b16 v[70:71], v209 offset:43008
    v_mfma_f32_16x16x32_bf16 v[48:51], v[88:91], a[72:75], v[48:51]
    ds_read_b64_tr_b16 v[72:73], v210 offset:40960
    s_add_u32 m0, s66, 106496
    v_mfma_f32_16x16x32_bf16 v[52:55], v[88:91], a[76:79], v[52:55]
    ds_read_b64_tr_b16 v[74:75], v210 offset:43008
    buffer_load_dwordx4 v192, s[52:55], s60 offen offset:0 lds
    v_mfma_f32_16x16x32_bf16 v[60:63], v[92:95], a[76:79], v[60:63]
    ds_read_b64_tr_b16 v[76:77], v211 offset:40960
    v_mfma_f32_16x16x32_bf16 v[56:59], v[92:95], a[72:75], v[56:59]
    ds_read_b64_tr_b16 v[78:79], v211 offset:43008
    buffer_load_dwordx4 v193, s[52:55], s60 offen offset:1024 lds
    s_add_u32 s60, s60, 131072
    s_waitcnt vmcnt(30) lgkmcnt(6)
    v_mfma_f32_16x16x32_bf16 v[32:35], v[64:67], a[80:83], v[32:35]
    ds_read_b64_tr_b16 v[80:81], v208 offset:45056
    v_mfma_f32_16x16x32_bf16 v[36:39], v[64:67], a[84:87], v[36:39]
    ds_read_b64_tr_b16 v[82:83], v208 offset:47104
    buffer_load_dwordx4 a[64:67], v180, s[4:7], s61 offen offset:0
    s_waitcnt lgkmcnt(6)
    v_mfma_f32_16x16x32_bf16 v[44:47], v[68:71], a[84:87], v[44:47]
    ds_read_b64_tr_b16 v[84:85], v209 offset:45056
    v_mfma_f32_16x16x32_bf16 v[40:43], v[68:71], a[80:83], v[40:43]
    ds_read_b64_tr_b16 v[86:87], v209 offset:47104
    s_waitcnt lgkmcnt(6)
    v_mfma_f32_16x16x32_bf16 v[48:51], v[72:75], a[80:83], v[48:51]
    ds_read_b64_tr_b16 v[88:89], v210 offset:45056
    buffer_load_dwordx4 a[72:75], v180, s[4:7], s61 offen offset:1024
    s_add_u32 s61, s61, 2048
    v_mfma_f32_16x16x32_bf16 v[52:55], v[72:75], a[84:87], v[52:55]
    ds_read_b64_tr_b16 v[90:91], v210 offset:47104
    s_waitcnt lgkmcnt(6)
    v_mfma_f32_16x16x32_bf16 v[60:63], v[76:79], a[84:87], v[60:63]
    ds_read_b64_tr_b16 v[92:93], v211 offset:45056
    v_mfma_f32_16x16x32_bf16 v[56:59], v[76:79], a[80:83], v[56:59]
    ds_read_b64_tr_b16 v[94:95], v211 offset:47104
    buffer_load_dwordx4 a[68:71], v180, s[4:7], s62 offen offset:0
    s_waitcnt lgkmcnt(6)
    v_mfma_f32_16x16x32_bf16 v[32:35], v[80:83], a[88:91], v[32:35]
    s_waitcnt lgkmcnt(0)
    s_barrier
    ds_read_b64_tr_b16 v[64:65], v208 offset:49152
    v_mfma_f32_16x16x32_bf16 v[36:39], v[80:83], a[92:95], v[36:39]
    ds_read_b64_tr_b16 v[66:67], v208 offset:51200
    v_mfma_f32_16x16x32_bf16 v[44:47], v[84:87], a[92:95], v[44:47]
    ds_read_b64_tr_b16 v[68:69], v209 offset:49152
    buffer_load_dwordx4 a[76:79], v180, s[4:7], s62 offen offset:1024
    s_add_u32 s62, s62, 2048
    v_mfma_f32_16x16x32_bf16 v[40:43], v[84:87], a[88:91], v[40:43]
    ds_read_b64_tr_b16 v[70:71], v209 offset:51200
    v_mfma_f32_16x16x32_bf16 v[48:51], v[88:91], a[88:91], v[48:51]
    ds_read_b64_tr_b16 v[72:73], v210 offset:49152
    s_add_u32 m0, s66, 114688
    v_mfma_f32_16x16x32_bf16 v[52:55], v[88:91], a[92:95], v[52:55]
    ds_read_b64_tr_b16 v[74:75], v210 offset:51200
    buffer_load_dwordx4 v192, s[52:55], s60 offen offset:0 lds
    v_mfma_f32_16x16x32_bf16 v[60:63], v[92:95], a[92:95], v[60:63]
    ds_read_b64_tr_b16 v[76:77], v211 offset:49152
    v_mfma_f32_16x16x32_bf16 v[56:59], v[92:95], a[88:91], v[56:59]
    ds_read_b64_tr_b16 v[78:79], v211 offset:51200
    buffer_load_dwordx4 v193, s[52:55], s60 offen offset:1024 lds
    s_add_u32 s60, s60, 131072
    s_waitcnt vmcnt(32) lgkmcnt(6)
    v_mfma_f32_16x16x32_bf16 v[32:35], v[64:67], a[96:99], v[32:35]
    ds_read_b64_tr_b16 v[80:81], v208 offset:53248
    v_mfma_f32_16x16x32_bf16 v[36:39], v[64:67], a[100:103], v[36:39]
    ds_read_b64_tr_b16 v[82:83], v208 offset:55296
    buffer_load_dwordx4 a[80:83], v180, s[4:7], s61 offen offset:0
    s_waitcnt lgkmcnt(6)
    v_mfma_f32_16x16x32_bf16 v[44:47], v[68:71], a[100:103], v[44:47]
    ds_read_b64_tr_b16 v[84:85], v209 offset:53248
    v_mfma_f32_16x16x32_bf16 v[40:43], v[68:71], a[96:99], v[40:43]
    ds_read_b64_tr_b16 v[86:87], v209 offset:55296
    s_waitcnt lgkmcnt(6)
    v_mfma_f32_16x16x32_bf16 v[48:51], v[72:75], a[96:99], v[48:51]
    ds_read_b64_tr_b16 v[88:89], v210 offset:53248
    buffer_load_dwordx4 a[88:91], v180, s[4:7], s61 offen offset:1024
    s_add_u32 s61, s61, 2048
    v_mfma_f32_16x16x32_bf16 v[52:55], v[72:75], a[100:103], v[52:55]
    ds_read_b64_tr_b16 v[90:91], v210 offset:55296
    s_waitcnt lgkmcnt(6)
    v_mfma_f32_16x16x32_bf16 v[60:63], v[76:79], a[100:103], v[60:63]
    ds_read_b64_tr_b16 v[92:93], v211 offset:53248
    v_mfma_f32_16x16x32_bf16 v[56:59], v[76:79], a[96:99], v[56:59]
    ds_read_b64_tr_b16 v[94:95], v211 offset:55296
    buffer_load_dwordx4 a[84:87], v180, s[4:7], s62 offen offset:0
    s_waitcnt lgkmcnt(6)
    v_mfma_f32_16x16x32_bf16 v[32:35], v[80:83], a[104:107], v[32:35]
    s_waitcnt lgkmcnt(0)
    s_barrier
    ds_read_b64_tr_b16 v[64:65], v208 offset:57344
    v_mfma_f32_16x16x32_bf16 v[36:39], v[80:83], a[108:111], v[36:39]
    ds_read_b64_tr_b16 v[66:67], v208 offset:59392
    v_mfma_f32_16x16x32_bf16 v[44:47], v[84:87], a[108:111], v[44:47]
    ds_read_b64_tr_b16 v[68:69], v209 offset:57344
    buffer_load_dwordx4 a[92:95], v180, s[4:7], s62 offen offset:1024
    s_add_u32 s62, s62, 2048
    v_mfma_f32_16x16x32_bf16 v[40:43], v[84:87], a[104:107], v[40:43]
    ds_read_b64_tr_b16 v[70:71], v209 offset:59392
    v_mfma_f32_16x16x32_bf16 v[48:51], v[88:91], a[104:107], v[48:51]
    ds_read_b64_tr_b16 v[72:73], v210 offset:57344
    s_add_u32 m0, s66, 122880
    v_mfma_f32_16x16x32_bf16 v[52:55], v[88:91], a[108:111], v[52:55]
    ds_read_b64_tr_b16 v[74:75], v210 offset:59392
    buffer_load_dwordx4 v192, s[52:55], s60 offen offset:0 lds
    v_mfma_f32_16x16x32_bf16 v[60:63], v[92:95], a[108:111], v[60:63]
    ds_read_b64_tr_b16 v[76:77], v211 offset:57344
    v_mfma_f32_16x16x32_bf16 v[56:59], v[92:95], a[104:107], v[56:59]
    ds_read_b64_tr_b16 v[78:79], v211 offset:59392
    buffer_load_dwordx4 v193, s[52:55], s60 offen offset:1024 lds
    s_add_u32 s60, s60, 131072
    s_waitcnt vmcnt(34) lgkmcnt(6)
    v_mfma_f32_16x16x32_bf16 v[32:35], v[64:67], a[112:115], v[32:35]
    ds_read_b64_tr_b16 v[80:81], v208 offset:61440
    v_mfma_f32_16x16x32_bf16 v[36:39], v[64:67], a[116:119], v[36:39]
    ds_read_b64_tr_b16 v[82:83], v208 offset:63488
    buffer_load_dwordx4 a[96:99], v180, s[4:7], s61 offen offset:0
    s_waitcnt lgkmcnt(6)
    v_mfma_f32_16x16x32_bf16 v[44:47], v[68:71], a[116:119], v[44:47]
    ds_read_b64_tr_b16 v[84:85], v209 offset:61440
    v_mfma_f32_16x16x32_bf16 v[40:43], v[68:71], a[112:115], v[40:43]
    ds_read_b64_tr_b16 v[86:87], v209 offset:63488
    s_waitcnt lgkmcnt(6)
    v_mfma_f32_16x16x32_bf16 v[48:51], v[72:75], a[112:115], v[48:51]
    ds_read_b64_tr_b16 v[88:89], v210 offset:61440
    buffer_load_dwordx4 a[104:107], v180, s[4:7], s61 offen offset:1024
    s_add_u32 s61, s61, 2048
    v_mfma_f32_16x16x32_bf16 v[52:55], v[72:75], a[116:119], v[52:55]
    ds_read_b64_tr_b16 v[90:91], v210 offset:63488
    s_waitcnt lgkmcnt(6)
    v_mfma_f32_16x16x32_bf16 v[60:63], v[76:79], a[116:119], v[60:63]
    ds_read_b64_tr_b16 v[92:93], v211 offset:61440
    v_mfma_f32_16x16x32_bf16 v[56:59], v[76:79], a[112:115], v[56:59]
    ds_read_b64_tr_b16 v[94:95], v211 offset:63488
    buffer_load_dwordx4 a[100:103], v180, s[4:7], s62 offen offset:0
    s_waitcnt lgkmcnt(6)
    v_mfma_f32_16x16x32_bf16 v[32:35], v[80:83], a[120:123], v[32:35]
    s_waitcnt lgkmcnt(0)
    s_barrier
    ds_read_b64_tr_b16 v[64:65], v212 offset:0
    v_mfma_f32_16x16x32_bf16 v[36:39], v[80:83], a[124:127], v[36:39]
    ds_read_b64_tr_b16 v[66:67], v212 offset:2048
    v_mfma_f32_16x16x32_bf16 v[44:47], v[84:87], a[124:127], v[44:47]
    ds_read_b64_tr_b16 v[68:69], v213 offset:0
    buffer_load_dwordx4 a[108:111], v180, s[4:7], s62 offen offset:1024
    s_add_u32 s62, s62, 2048
    v_mfma_f32_16x16x32_bf16 v[40:43], v[84:87], a[120:123], v[40:43]
    ds_read_b64_tr_b16 v[70:71], v213 offset:2048
    v_mfma_f32_16x16x32_bf16 v[48:51], v[88:91], a[120:123], v[48:51]
    ds_read_b64_tr_b16 v[72:73], v214 offset:0
    s_add_u32 m0, s66, 0
    v_mfma_f32_16x16x32_bf16 v[52:55], v[88:91], a[124:127], v[52:55]
    ds_read_b64_tr_b16 v[74:75], v214 offset:2048
    buffer_load_dwordx4 v192, s[52:55], s60 offen offset:0 lds
    v_mfma_f32_16x16x32_bf16 v[60:63], v[92:95], a[124:127], v[60:63]
    ds_read_b64_tr_b16 v[76:77], v215 offset:0
    v_mfma_f32_16x16x32_bf16 v[56:59], v[92:95], a[120:123], v[56:59]
    ds_read_b64_tr_b16 v[78:79], v215 offset:2048
    buffer_load_dwordx4 v193, s[52:55], s60 offen offset:1024 lds
    s_add_u32 s60, s60, 131072
    s_waitcnt vmcnt(36) lgkmcnt(6)
    v_mfma_f32_16x16x32_bf16 v[32:35], v[64:67], a[0:3], v[32:35]
    ds_read_b64_tr_b16 v[80:81], v212 offset:4096
    v_mfma_f32_16x16x32_bf16 v[36:39], v[64:67], a[4:7], v[36:39]
    ds_read_b64_tr_b16 v[82:83], v212 offset:6144
    buffer_load_dwordx4 a[112:115], v180, s[4:7], s61 offen offset:0
    s_waitcnt lgkmcnt(6)
    v_mfma_f32_16x16x32_bf16 v[44:47], v[68:71], a[4:7], v[44:47]
    ds_read_b64_tr_b16 v[84:85], v213 offset:4096
    v_mfma_f32_16x16x32_bf16 v[40:43], v[68:71], a[0:3], v[40:43]
    ds_read_b64_tr_b16 v[86:87], v213 offset:6144
    s_waitcnt lgkmcnt(6)
    v_mfma_f32_16x16x32_bf16 v[48:51], v[72:75], a[0:3], v[48:51]
    ds_read_b64_tr_b16 v[88:89], v214 offset:4096
    buffer_load_dwordx4 a[120:123], v180, s[4:7], s61 offen offset:1024
    s_add_u32 s61, s61, 2048
    v_mfma_f32_16x16x32_bf16 v[52:55], v[72:75], a[4:7], v[52:55]
    ds_read_b64_tr_b16 v[90:91], v214 offset:6144
    s_waitcnt lgkmcnt(6)
    v_mfma_f32_16x16x32_bf16 v[60:63], v[76:79], a[4:7], v[60:63]
    ds_read_b64_tr_b16 v[92:93], v215 offset:4096
    v_mfma_f32_16x16x32_bf16 v[56:59], v[76:79], a[0:3], v[56:59]
    ds_read_b64_tr_b16 v[94:95], v215 offset:6144
    buffer_load_dwordx4 a[116:119], v180, s[4:7], s62 offen offset:0
    s_waitcnt lgkmcnt(6)
    v_mfma_f32_16x16x32_bf16 v[32:35], v[80:83], a[8:11], v[32:35]
    s_waitcnt lgkmcnt(0)
    s_barrier
    ds_read_b64_tr_b16 v[64:65], v212 offset:8192
    v_mfma_f32_16x16x32_bf16 v[36:39], v[80:83], a[12:15], v[36:39]
    ds_read_b64_tr_b16 v[66:67], v212 offset:10240
    v_mfma_f32_16x16x32_bf16 v[44:47], v[84:87], a[12:15], v[44:47]
    ds_read_b64_tr_b16 v[68:69], v213 offset:8192
    buffer_load_dwordx4 a[124:127], v180, s[4:7], s62 offen offset:1024
    s_add_u32 s62, s62, 2048
    v_mfma_f32_16x16x32_bf16 v[40:43], v[84:87], a[8:11], v[40:43]
    ds_read_b64_tr_b16 v[70:71], v213 offset:10240
    v_mfma_f32_16x16x32_bf16 v[48:51], v[88:91], a[8:11], v[48:51]
    ds_read_b64_tr_b16 v[72:73], v214 offset:8192
    s_add_u32 m0, s66, 8192
    v_mfma_f32_16x16x32_bf16 v[52:55], v[88:91], a[12:15], v[52:55]
    ds_read_b64_tr_b16 v[74:75], v214 offset:10240
    buffer_load_dwordx4 v192, s[52:55], s60 offen offset:0 lds
    v_mfma_f32_16x16x32_bf16 v[60:63], v[92:95], a[12:15], v[60:63]
    ds_read_b64_tr_b16 v[76:77], v215 offset:8192
    v_mfma_f32_16x16x32_bf16 v[56:59], v[92:95], a[8:11], v[56:59]
    ds_read_b64_tr_b16 v[78:79], v215 offset:10240
    buffer_load_dwordx4 v193, s[52:55], s60 offen offset:1024 lds
    s_add_u32 s60, s60, 131072
    s_waitcnt vmcnt(38) lgkmcnt(6)
    v_mfma_f32_16x16x32_bf16 v[32:35], v[64:67], a[16:19], v[32:35]
    ds_read_b64_tr_b16 v[80:81], v212 offset:12288
    v_mfma_f32_16x16x32_bf16 v[36:39], v[64:67], a[20:23], v[36:39]
    ds_read_b64_tr_b16 v[82:83], v212 offset:14336
    buffer_load_dwordx4 a[0:3], v180, s[4:7], s61 offen offset:0
    s_waitcnt lgkmcnt(6)
    v_mfma_f32_16x16x32_bf16 v[44:47], v[68:71], a[20:23], v[44:47]
    ds_read_b64_tr_b16 v[84:85], v213 offset:12288
    v_mfma_f32_16x16x32_bf16 v[40:43], v[68:71], a[16:19], v[40:43]
    ds_read_b64_tr_b16 v[86:87], v213 offset:14336
    s_waitcnt lgkmcnt(6)
    v_mfma_f32_16x16x32_bf16 v[48:51], v[72:75], a[16:19], v[48:51]
    ds_read_b64_tr_b16 v[88:89], v214 offset:12288
    buffer_load_dwordx4 a[8:11], v180, s[4:7], s61 offen offset:1024
    s_add_u32 s61, s61, 2048
    v_mfma_f32_16x16x32_bf16 v[52:55], v[72:75], a[20:23], v[52:55]
    ds_read_b64_tr_b16 v[90:91], v214 offset:14336
    s_waitcnt lgkmcnt(6)
    v_mfma_f32_16x16x32_bf16 v[60:63], v[76:79], a[20:23], v[60:63]
    ds_read_b64_tr_b16 v[92:93], v215 offset:12288
    v_mfma_f32_16x16x32_bf16 v[56:59], v[76:79], a[16:19], v[56:59]
    ds_read_b64_tr_b16 v[94:95], v215 offset:14336
    buffer_load_dwordx4 a[4:7], v180, s[4:7], s62 offen offset:0
    s_waitcnt lgkmcnt(6)
    v_mfma_f32_16x16x32_bf16 v[32:35], v[80:83], a[24:27], v[32:35]
    s_waitcnt lgkmcnt(0)
    s_barrier
    ds_read_b64_tr_b16 v[64:65], v212 offset:16384
    v_mfma_f32_16x16x32_bf16 v[36:39], v[80:83], a[28:31], v[36:39]
    ds_read_b64_tr_b16 v[66:67], v212 offset:18432
    v_mfma_f32_16x16x32_bf16 v[44:47], v[84:87], a[28:31], v[44:47]
    ds_read_b64_tr_b16 v[68:69], v213 offset:16384
    buffer_load_dwordx4 a[12:15], v180, s[4:7], s62 offen offset:1024
    s_add_u32 s62, s62, 2048
    v_mfma_f32_16x16x32_bf16 v[40:43], v[84:87], a[24:27], v[40:43]
    ds_read_b64_tr_b16 v[70:71], v213 offset:18432
    v_mfma_f32_16x16x32_bf16 v[48:51], v[88:91], a[24:27], v[48:51]
    ds_read_b64_tr_b16 v[72:73], v214 offset:16384
    s_add_u32 m0, s66, 16384
    v_mfma_f32_16x16x32_bf16 v[52:55], v[88:91], a[28:31], v[52:55]
    ds_read_b64_tr_b16 v[74:75], v214 offset:18432
    buffer_load_dwordx4 v192, s[52:55], s60 offen offset:0 lds
    v_mfma_f32_16x16x32_bf16 v[60:63], v[92:95], a[28:31], v[60:63]
    ds_read_b64_tr_b16 v[76:77], v215 offset:16384
    v_mfma_f32_16x16x32_bf16 v[56:59], v[92:95], a[24:27], v[56:59]
    ds_read_b64_tr_b16 v[78:79], v215 offset:18432
    buffer_load_dwordx4 v193, s[52:55], s60 offen offset:1024 lds
    s_add_u32 s60, s60, 131072
    s_waitcnt vmcnt(38) lgkmcnt(6)
    v_mfma_f32_16x16x32_bf16 v[32:35], v[64:67], a[32:35], v[32:35]
    ds_read_b64_tr_b16 v[80:81], v212 offset:20480
    v_mfma_f32_16x16x32_bf16 v[36:39], v[64:67], a[36:39], v[36:39]
    ds_read_b64_tr_b16 v[82:83], v212 offset:22528
    buffer_load_dwordx4 a[16:19], v180, s[4:7], s61 offen offset:0
    s_waitcnt lgkmcnt(6)
    v_mfma_f32_16x16x32_bf16 v[44:47], v[68:71], a[36:39], v[44:47]
    ds_read_b64_tr_b16 v[84:85], v213 offset:20480
    v_mfma_f32_16x16x32_bf16 v[40:43], v[68:71], a[32:35], v[40:43]
    ds_read_b64_tr_b16 v[86:87], v213 offset:22528
    s_waitcnt lgkmcnt(6)
    v_mfma_f32_16x16x32_bf16 v[48:51], v[72:75], a[32:35], v[48:51]
    ds_read_b64_tr_b16 v[88:89], v214 offset:20480
    buffer_load_dwordx4 a[24:27], v180, s[4:7], s61 offen offset:1024
    s_add_u32 s61, s61, 2048
    v_mfma_f32_16x16x32_bf16 v[52:55], v[72:75], a[36:39], v[52:55]
    ds_read_b64_tr_b16 v[90:91], v214 offset:22528
    s_waitcnt lgkmcnt(6)
    v_mfma_f32_16x16x32_bf16 v[60:63], v[76:79], a[36:39], v[60:63]
    ds_read_b64_tr_b16 v[92:93], v215 offset:20480
    v_mfma_f32_16x16x32_bf16 v[56:59], v[76:79], a[32:35], v[56:59]
    ds_read_b64_tr_b16 v[94:95], v215 offset:22528
    buffer_load_dwordx4 a[20:23], v180, s[4:7], s62 offen offset:0
    s_waitcnt lgkmcnt(6)
    v_mfma_f32_16x16x32_bf16 v[32:35], v[80:83], a[40:43], v[32:35]
    s_waitcnt lgkmcnt(0)
    s_barrier
    ds_read_b64_tr_b16 v[64:65], v212 offset:24576
    v_mfma_f32_16x16x32_bf16 v[36:39], v[80:83], a[44:47], v[36:39]
    ds_read_b64_tr_b16 v[66:67], v212 offset:26624
    v_mfma_f32_16x16x32_bf16 v[44:47], v[84:87], a[44:47], v[44:47]
    ds_read_b64_tr_b16 v[68:69], v213 offset:24576
    buffer_load_dwordx4 a[28:31], v180, s[4:7], s62 offen offset:1024
    s_add_u32 s62, s62, 2048
    v_mfma_f32_16x16x32_bf16 v[40:43], v[84:87], a[40:43], v[40:43]
    ds_read_b64_tr_b16 v[70:71], v213 offset:26624
    v_mfma_f32_16x16x32_bf16 v[48:51], v[88:91], a[40:43], v[48:51]
    ds_read_b64_tr_b16 v[72:73], v214 offset:24576
    s_add_u32 m0, s66, 24576
    v_mfma_f32_16x16x32_bf16 v[52:55], v[88:91], a[44:47], v[52:55]
    ds_read_b64_tr_b16 v[74:75], v214 offset:26624
    buffer_load_dwordx4 v192, s[52:55], s60 offen offset:0 lds
    v_mfma_f32_16x16x32_bf16 v[60:63], v[92:95], a[44:47], v[60:63]
    ds_read_b64_tr_b16 v[76:77], v215 offset:24576
    v_mfma_f32_16x16x32_bf16 v[56:59], v[92:95], a[40:43], v[56:59]
    ds_read_b64_tr_b16 v[78:79], v215 offset:26624
    buffer_load_dwordx4 v193, s[52:55], s60 offen offset:1024 lds
    s_add_u32 s60, s60, 131072
    s_waitcnt vmcnt(38) lgkmcnt(6)
    v_mfma_f32_16x16x32_bf16 v[32:35], v[64:67], a[48:51], v[32:35]
    ds_read_b64_tr_b16 v[80:81], v212 offset:28672
    v_mfma_f32_16x16x32_bf16 v[36:39], v[64:67], a[52:55], v[36:39]
    ds_read_b64_tr_b16 v[82:83], v212 offset:30720
    buffer_load_dwordx4 a[32:35], v180, s[4:7], s61 offen offset:0
    s_waitcnt lgkmcnt(6)
    v_mfma_f32_16x16x32_bf16 v[44:47], v[68:71], a[52:55], v[44:47]
    ds_read_b64_tr_b16 v[84:85], v213 offset:28672
    v_mfma_f32_16x16x32_bf16 v[40:43], v[68:71], a[48:51], v[40:43]
    ds_read_b64_tr_b16 v[86:87], v213 offset:30720
    s_waitcnt lgkmcnt(6)
    v_mfma_f32_16x16x32_bf16 v[48:51], v[72:75], a[48:51], v[48:51]
    ds_read_b64_tr_b16 v[88:89], v214 offset:28672
    buffer_load_dwordx4 a[40:43], v180, s[4:7], s61 offen offset:1024
    s_add_u32 s61, s61, 2048
    v_mfma_f32_16x16x32_bf16 v[52:55], v[72:75], a[52:55], v[52:55]
    ds_read_b64_tr_b16 v[90:91], v214 offset:30720
    s_waitcnt lgkmcnt(6)
    v_mfma_f32_16x16x32_bf16 v[60:63], v[76:79], a[52:55], v[60:63]
    ds_read_b64_tr_b16 v[92:93], v215 offset:28672
    v_mfma_f32_16x16x32_bf16 v[56:59], v[76:79], a[48:51], v[56:59]
    ds_read_b64_tr_b16 v[94:95], v215 offset:30720
    buffer_load_dwordx4 a[36:39], v180, s[4:7], s62 offen offset:0
    s_waitcnt lgkmcnt(6)
    v_mfma_f32_16x16x32_bf16 v[32:35], v[80:83], a[56:59], v[32:35]
    s_waitcnt lgkmcnt(0)
    s_barrier
    ds_read_b64_tr_b16 v[64:65], v212 offset:32768
    v_mfma_f32_16x16x32_bf16 v[36:39], v[80:83], a[60:63], v[36:39]
    ds_read_b64_tr_b16 v[66:67], v212 offset:34816
    v_mfma_f32_16x16x32_bf16 v[44:47], v[84:87], a[60:63], v[44:47]
    ds_read_b64_tr_b16 v[68:69], v213 offset:32768
    buffer_load_dwordx4 a[44:47], v180, s[4:7], s62 offen offset:1024
    s_add_u32 s62, s62, 2048
    v_mfma_f32_16x16x32_bf16 v[40:43], v[84:87], a[56:59], v[40:43]
    ds_read_b64_tr_b16 v[70:71], v213 offset:34816
    v_mfma_f32_16x16x32_bf16 v[48:51], v[88:91], a[56:59], v[48:51]
    ds_read_b64_tr_b16 v[72:73], v214 offset:32768
    s_add_u32 m0, s66, 32768
    v_mfma_f32_16x16x32_bf16 v[52:55], v[88:91], a[60:63], v[52:55]
    ds_read_b64_tr_b16 v[74:75], v214 offset:34816
    buffer_load_dwordx4 v192, s[52:55], s60 offen offset:0 lds
    v_mfma_f32_16x16x32_bf16 v[60:63], v[92:95], a[60:63], v[60:63]
    ds_read_b64_tr_b16 v[76:77], v215 offset:32768
    v_mfma_f32_16x16x32_bf16 v[56:59], v[92:95], a[56:59], v[56:59]
    ds_read_b64_tr_b16 v[78:79], v215 offset:34816
    buffer_load_dwordx4 v193, s[52:55], s60 offen offset:1024 lds
    s_add_u32 s60, s60, 131072
    s_waitcnt vmcnt(38) lgkmcnt(6)
    v_mfma_f32_16x16x32_bf16 v[32:35], v[64:67], a[64:67], v[32:35]
    ds_read_b64_tr_b16 v[80:81], v212 offset:36864
    v_mfma_f32_16x16x32_bf16 v[36:39], v[64:67], a[68:71], v[36:39]
    ds_read_b64_tr_b16 v[82:83], v212 offset:38912
    buffer_load_dwordx4 a[48:51], v180, s[4:7], s61 offen offset:0
    s_waitcnt lgkmcnt(6)
    v_mfma_f32_16x16x32_bf16 v[44:47], v[68:71], a[68:71], v[44:47]
    ds_read_b64_tr_b16 v[84:85], v213 offset:36864
    v_mfma_f32_16x16x32_bf16 v[40:43], v[68:71], a[64:67], v[40:43]
    ds_read_b64_tr_b16 v[86:87], v213 offset:38912
    s_waitcnt lgkmcnt(6)
    v_mfma_f32_16x16x32_bf16 v[48:51], v[72:75], a[64:67], v[48:51]
    ds_read_b64_tr_b16 v[88:89], v214 offset:36864
    buffer_load_dwordx4 a[56:59], v180, s[4:7], s61 offen offset:1024
    s_add_u32 s61, s61, 2048
    v_mfma_f32_16x16x32_bf16 v[52:55], v[72:75], a[68:71], v[52:55]
    ds_read_b64_tr_b16 v[90:91], v214 offset:38912
    s_waitcnt lgkmcnt(6)
    v_mfma_f32_16x16x32_bf16 v[60:63], v[76:79], a[68:71], v[60:63]
    ds_read_b64_tr_b16 v[92:93], v215 offset:36864
    v_mfma_f32_16x16x32_bf16 v[56:59], v[76:79], a[64:67], v[56:59]
    ds_read_b64_tr_b16 v[94:95], v215 offset:38912
    buffer_load_dwordx4 a[52:55], v180, s[4:7], s62 offen offset:0
    s_waitcnt lgkmcnt(6)
    v_mfma_f32_16x16x32_bf16 v[32:35], v[80:83], a[72:75], v[32:35]
    s_waitcnt lgkmcnt(0)
    s_barrier
    ds_read_b64_tr_b16 v[64:65], v212 offset:40960
    v_mfma_f32_16x16x32_bf16 v[36:39], v[80:83], a[76:79], v[36:39]
    ds_read_b64_tr_b16 v[66:67], v212 offset:43008
    v_mfma_f32_16x16x32_bf16 v[44:47], v[84:87], a[76:79], v[44:47]
    ds_read_b64_tr_b16 v[68:69], v213 offset:40960
    buffer_load_dwordx4 a[60:63], v180, s[4:7], s62 offen offset:1024
    s_add_u32 s62, s62, 2048
    v_mfma_f32_16x16x32_bf16 v[40:43], v[84:87], a[72:75], v[40:43]
    ds_read_b64_tr_b16 v[70:71], v213 offset:43008
    v_mfma_f32_16x16x32_bf16 v[48:51], v[88:91], a[72:75], v[48:51]
    ds_read_b64_tr_b16 v[72:73], v214 offset:40960
    s_add_u32 m0, s66, 40960
    v_mfma_f32_16x16x32_bf16 v[52:55], v[88:91], a[76:79], v[52:55]
    ds_read_b64_tr_b16 v[74:75], v214 offset:43008
    buffer_load_dwordx4 v192, s[52:55], s60 offen offset:0 lds
    v_mfma_f32_16x16x32_bf16 v[60:63], v[92:95], a[76:79], v[60:63]
    ds_read_b64_tr_b16 v[76:77], v215 offset:40960
    v_mfma_f32_16x16x32_bf16 v[56:59], v[92:95], a[72:75], v[56:59]
    ds_read_b64_tr_b16 v[78:79], v215 offset:43008
    buffer_load_dwordx4 v193, s[52:55], s60 offen offset:1024 lds
    s_add_u32 s60, s60, 131072
    s_waitcnt vmcnt(38) lgkmcnt(6)
    v_mfma_f32_16x16x32_bf16 v[32:35], v[64:67], a[80:83], v[32:35]
    ds_read_b64_tr_b16 v[80:81], v212 offset:45056
    v_mfma_f32_16x16x32_bf16 v[36:39], v[64:67], a[84:87], v[36:39]
    ds_read_b64_tr_b16 v[82:83], v212 offset:47104
    buffer_load_dwordx4 a[64:67], v180, s[4:7], s61 offen offset:0
    s_waitcnt lgkmcnt(6)
    v_mfma_f32_16x16x32_bf16 v[44:47], v[68:71], a[84:87], v[44:47]
    ds_read_b64_tr_b16 v[84:85], v213 offset:45056
    v_mfma_f32_16x16x32_bf16 v[40:43], v[68:71], a[80:83], v[40:43]
    ds_read_b64_tr_b16 v[86:87], v213 offset:47104
    s_waitcnt lgkmcnt(6)
    v_mfma_f32_16x16x32_bf16 v[48:51], v[72:75], a[80:83], v[48:51]
    ds_read_b64_tr_b16 v[88:89], v214 offset:45056
    buffer_load_dwordx4 a[72:75], v180, s[4:7], s61 offen offset:1024
    s_add_u32 s61, s61, 2048
    v_mfma_f32_16x16x32_bf16 v[52:55], v[72:75], a[84:87], v[52:55]
    ds_read_b64_tr_b16 v[90:91], v214 offset:47104
    s_waitcnt lgkmcnt(6)
    v_mfma_f32_16x16x32_bf16 v[60:63], v[76:79], a[84:87], v[60:63]
    ds_read_b64_tr_b16 v[92:93], v215 offset:45056
    v_mfma_f32_16x16x32_bf16 v[56:59], v[76:79], a[80:83], v[56:59]
    ds_read_b64_tr_b16 v[94:95], v215 offset:47104
    buffer_load_dwordx4 a[68:71], v180, s[4:7], s62 offen offset:0
    s_waitcnt lgkmcnt(6)
    v_mfma_f32_16x16x32_bf16 v[32:35], v[80:83], a[88:91], v[32:35]
    s_waitcnt lgkmcnt(0)
    s_barrier
    ds_read_b64_tr_b16 v[64:65], v212 offset:49152
    v_mfma_f32_16x16x32_bf16 v[36:39], v[80:83], a[92:95], v[36:39]
    ds_read_b64_tr_b16 v[66:67], v212 offset:51200
    v_mfma_f32_16x16x32_bf16 v[44:47], v[84:87], a[92:95], v[44:47]
    ds_read_b64_tr_b16 v[68:69], v213 offset:49152
    buffer_load_dwordx4 a[76:79], v180, s[4:7], s62 offen offset:1024
    s_add_u32 s62, s62, 2048
    v_mfma_f32_16x16x32_bf16 v[40:43], v[84:87], a[88:91], v[40:43]
    ds_read_b64_tr_b16 v[70:71], v213 offset:51200
    v_mfma_f32_16x16x32_bf16 v[48:51], v[88:91], a[88:91], v[48:51]
    ds_read_b64_tr_b16 v[72:73], v214 offset:49152
    s_add_u32 m0, s66, 49152
    v_mfma_f32_16x16x32_bf16 v[52:55], v[88:91], a[92:95], v[52:55]
    ds_read_b64_tr_b16 v[74:75], v214 offset:51200
    buffer_load_dwordx4 v192, s[52:55], s60 offen offset:0 lds
    v_mfma_f32_16x16x32_bf16 v[60:63], v[92:95], a[92:95], v[60:63]
    ds_read_b64_tr_b16 v[76:77], v215 offset:49152
    v_mfma_f32_16x16x32_bf16 v[56:59], v[92:95], a[88:91], v[56:59]
    ds_read_b64_tr_b16 v[78:79], v215 offset:51200
    buffer_load_dwordx4 v193, s[52:55], s60 offen offset:1024 lds
    s_add_u32 s60, s60, 131072
    s_waitcnt vmcnt(38) lgkmcnt(6)
    v_mfma_f32_16x16x32_bf16 v[32:35], v[64:67], a[96:99], v[32:35]
    ds_read_b64_tr_b16 v[80:81], v212 offset:53248
    v_mfma_f32_16x16x32_bf16 v[36:39], v[64:67], a[100:103], v[36:39]
    ds_read_b64_tr_b16 v[82:83], v212 offset:55296
    buffer_load_dwordx4 a[80:83], v180, s[4:7], s61 offen offset:0
    s_waitcnt lgkmcnt(6)
    v_mfma_f32_16x16x32_bf16 v[44:47], v[68:71], a[100:103], v[44:47]
    ds_read_b64_tr_b16 v[84:85], v213 offset:53248
    v_mfma_f32_16x16x32_bf16 v[40:43], v[68:71], a[96:99], v[40:43]
    ds_read_b64_tr_b16 v[86:87], v213 offset:55296
    s_waitcnt lgkmcnt(6)
    v_mfma_f32_16x16x32_bf16 v[48:51], v[72:75], a[96:99], v[48:51]
    ds_read_b64_tr_b16 v[88:89], v214 offset:53248
    buffer_load_dwordx4 a[88:91], v180, s[4:7], s61 offen offset:1024
    s_add_u32 s61, s61, 2048
    v_mfma_f32_16x16x32_bf16 v[52:55], v[72:75], a[100:103], v[52:55]
    ds_read_b64_tr_b16 v[90:91], v214 offset:55296
    s_waitcnt lgkmcnt(6)
    v_mfma_f32_16x16x32_bf16 v[60:63], v[76:79], a[100:103], v[60:63]
    ds_read_b64_tr_b16 v[92:93], v215 offset:53248
    v_mfma_f32_16x16x32_bf16 v[56:59], v[76:79], a[96:99], v[56:59]
    ds_read_b64_tr_b16 v[94:95], v215 offset:55296
    buffer_load_dwordx4 a[84:87], v180, s[4:7], s62 offen offset:0
    s_waitcnt lgkmcnt(6)
    v_mfma_f32_16x16x32_bf16 v[32:35], v[80:83], a[104:107], v[32:35]
    s_waitcnt lgkmcnt(0)
    s_barrier
    ds_read_b64_tr_b16 v[64:65], v212 offset:57344
    v_mfma_f32_16x16x32_bf16 v[36:39], v[80:83], a[108:111], v[36:39]
    ds_read_b64_tr_b16 v[66:67], v212 offset:59392
    v_mfma_f32_16x16x32_bf16 v[44:47], v[84:87], a[108:111], v[44:47]
    ds_read_b64_tr_b16 v[68:69], v213 offset:57344
    buffer_load_dwordx4 a[92:95], v180, s[4:7], s62 offen offset:1024
    s_add_u32 s62, s62, 2048
    v_mfma_f32_16x16x32_bf16 v[40:43], v[84:87], a[104:107], v[40:43]
    ds_read_b64_tr_b16 v[70:71], v213 offset:59392
    v_mfma_f32_16x16x32_bf16 v[48:51], v[88:91], a[104:107], v[48:51]
    ds_read_b64_tr_b16 v[72:73], v214 offset:57344
    s_add_u32 m0, s66, 57344
    v_mfma_f32_16x16x32_bf16 v[52:55], v[88:91], a[108:111], v[52:55]
    ds_read_b64_tr_b16 v[74:75], v214 offset:59392
    buffer_load_dwordx4 v192, s[52:55], s60 offen offset:0 lds
    v_mfma_f32_16x16x32_bf16 v[60:63], v[92:95], a[108:111], v[60:63]
    ds_read_b64_tr_b16 v[76:77], v215 offset:57344
    v_mfma_f32_16x16x32_bf16 v[56:59], v[92:95], a[104:107], v[56:59]
    ds_read_b64_tr_b16 v[78:79], v215 offset:59392
    buffer_load_dwordx4 v193, s[52:55], s60 offen offset:1024 lds
    s_add_u32 s60, s60, 131072
    s_waitcnt vmcnt(38) lgkmcnt(6)
    v_mfma_f32_16x16x32_bf16 v[32:35], v[64:67], a[112:115], v[32:35]
    ds_read_b64_tr_b16 v[80:81], v212 offset:61440
    v_mfma_f32_16x16x32_bf16 v[36:39], v[64:67], a[116:119], v[36:39]
    ds_read_b64_tr_b16 v[82:83], v212 offset:63488
    buffer_load_dwordx4 a[96:99], v180, s[4:7], s61 offen offset:0
    s_waitcnt lgkmcnt(6)
    v_mfma_f32_16x16x32_bf16 v[44:47], v[68:71], a[116:119], v[44:47]
    ds_read_b64_tr_b16 v[84:85], v213 offset:61440
    v_mfma_f32_16x16x32_bf16 v[40:43], v[68:71], a[112:115], v[40:43]
    ds_read_b64_tr_b16 v[86:87], v213 offset:63488
    s_waitcnt lgkmcnt(6)
    v_mfma_f32_16x16x32_bf16 v[48:51], v[72:75], a[112:115], v[48:51]
    ds_read_b64_tr_b16 v[88:89], v214 offset:61440
    buffer_load_dwordx4 a[104:107], v180, s[4:7], s61 offen offset:1024
    s_add_u32 s61, s61, 2048
    v_mfma_f32_16x16x32_bf16 v[52:55], v[72:75], a[116:119], v[52:55]
    ds_read_b64_tr_b16 v[90:91], v214 offset:63488
    s_waitcnt lgkmcnt(6)
    v_mfma_f32_16x16x32_bf16 v[60:63], v[76:79], a[116:119], v[60:63]
    ds_read_b64_tr_b16 v[92:93], v215 offset:61440
    v_mfma_f32_16x16x32_bf16 v[56:59], v[76:79], a[112:115], v[56:59]
    ds_read_b64_tr_b16 v[94:95], v215 offset:63488
    buffer_load_dwordx4 a[100:103], v180, s[4:7], s62 offen offset:0
    s_waitcnt lgkmcnt(6)
    v_mfma_f32_16x16x32_bf16 v[32:35], v[80:83], a[120:123], v[32:35]
    s_waitcnt lgkmcnt(0)
    s_barrier
    ds_read_b64_tr_b16 v[64:65], v208 offset:0
    v_mfma_f32_16x16x32_bf16 v[36:39], v[80:83], a[124:127], v[36:39]
    ds_read_b64_tr_b16 v[66:67], v208 offset:2048
    v_mfma_f32_16x16x32_bf16 v[44:47], v[84:87], a[124:127], v[44:47]
    ds_read_b64_tr_b16 v[68:69], v209 offset:0
    buffer_load_dwordx4 a[108:111], v180, s[4:7], s62 offen offset:1024
    s_add_u32 s62, s62, 2048
    v_mfma_f32_16x16x32_bf16 v[40:43], v[84:87], a[120:123], v[40:43]
    ds_read_b64_tr_b16 v[70:71], v209 offset:2048
    v_mfma_f32_16x16x32_bf16 v[48:51], v[88:91], a[120:123], v[48:51]
    ds_read_b64_tr_b16 v[72:73], v210 offset:0
    s_add_u32 m0, s66, 65536
    v_mfma_f32_16x16x32_bf16 v[52:55], v[88:91], a[124:127], v[52:55]
    ds_read_b64_tr_b16 v[74:75], v210 offset:2048
    buffer_load_dwordx4 v192, s[52:55], s60 offen offset:0 lds
    v_mfma_f32_16x16x32_bf16 v[60:63], v[92:95], a[124:127], v[60:63]
    ds_read_b64_tr_b16 v[76:77], v211 offset:0
    v_mfma_f32_16x16x32_bf16 v[56:59], v[92:95], a[120:123], v[56:59]
    ds_read_b64_tr_b16 v[78:79], v211 offset:2048
    buffer_load_dwordx4 v193, s[52:55], s60 offen offset:1024 lds
    s_add_u32 s60, s60, 131072
    s_waitcnt vmcnt(38) lgkmcnt(6)
    v_mfma_f32_16x16x32_bf16 v[32:35], v[64:67], a[0:3], v[32:35]
    ds_read_b64_tr_b16 v[80:81], v208 offset:4096
    v_mfma_f32_16x16x32_bf16 v[36:39], v[64:67], a[4:7], v[36:39]
    ds_read_b64_tr_b16 v[82:83], v208 offset:6144
    buffer_load_dwordx4 a[112:115], v180, s[4:7], s61 offen offset:0
    s_waitcnt lgkmcnt(6)
    v_mfma_f32_16x16x32_bf16 v[44:47], v[68:71], a[4:7], v[44:47]
    ds_read_b64_tr_b16 v[84:85], v209 offset:4096
    v_mfma_f32_16x16x32_bf16 v[40:43], v[68:71], a[0:3], v[40:43]
    ds_read_b64_tr_b16 v[86:87], v209 offset:6144
    s_waitcnt lgkmcnt(6)
    v_mfma_f32_16x16x32_bf16 v[48:51], v[72:75], a[0:3], v[48:51]
    ds_read_b64_tr_b16 v[88:89], v210 offset:4096
    buffer_load_dwordx4 a[120:123], v180, s[4:7], s61 offen offset:1024
    s_add_u32 s61, s61, 2048
    v_mfma_f32_16x16x32_bf16 v[52:55], v[72:75], a[4:7], v[52:55]
    ds_read_b64_tr_b16 v[90:91], v210 offset:6144
    s_waitcnt lgkmcnt(6)
    v_mfma_f32_16x16x32_bf16 v[60:63], v[76:79], a[4:7], v[60:63]
    ds_read_b64_tr_b16 v[92:93], v211 offset:4096
    v_mfma_f32_16x16x32_bf16 v[56:59], v[76:79], a[0:3], v[56:59]
    ds_read_b64_tr_b16 v[94:95], v211 offset:6144
    buffer_load_dwordx4 a[116:119], v180, s[4:7], s62 offen offset:0
    s_waitcnt lgkmcnt(6)
    v_mfma_f32_16x16x32_bf16 v[32:35], v[80:83], a[8:11], v[32:35]
    s_waitcnt lgkmcnt(0)
    s_barrier
    ds_read_b64_tr_b16 v[64:65], v208 offset:8192
    v_mfma_f32_16x16x32_bf16 v[36:39], v[80:83], a[12:15], v[36:39]
    ds_read_b64_tr_b16 v[66:67], v208 offset:10240
    v_mfma_f32_16x16x32_bf16 v[44:47], v[84:87], a[12:15], v[44:47]
    ds_read_b64_tr_b16 v[68:69], v209 offset:8192
    buffer_load_dwordx4 a[124:127], v180, s[4:7], s62 offen offset:1024
    s_add_u32 s62, s62, 2048
    v_mfma_f32_16x16x32_bf16 v[40:43], v[84:87], a[8:11], v[40:43]
    ds_read_b64_tr_b16 v[70:71], v209 offset:10240
    v_mfma_f32_16x16x32_bf16 v[48:51], v[88:91], a[8:11], v[48:51]
    ds_read_b64_tr_b16 v[72:73], v210 offset:8192
    s_add_u32 m0, s66, 73728
    v_mfma_f32_16x16x32_bf16 v[52:55], v[88:91], a[12:15], v[52:55]
    ds_read_b64_tr_b16 v[74:75], v210 offset:10240
    buffer_load_dwordx4 v192, s[52:55], s60 offen offset:0 lds
    v_mfma_f32_16x16x32_bf16 v[60:63], v[92:95], a[12:15], v[60:63]
    ds_read_b64_tr_b16 v[76:77], v211 offset:8192
    v_mfma_f32_16x16x32_bf16 v[56:59], v[92:95], a[8:11], v[56:59]
    ds_read_b64_tr_b16 v[78:79], v211 offset:10240
    buffer_load_dwordx4 v193, s[52:55], s60 offen offset:1024 lds
    s_add_u32 s60, s60, 131072
    s_waitcnt vmcnt(38) lgkmcnt(6)
    v_mfma_f32_16x16x32_bf16 v[32:35], v[64:67], a[16:19], v[32:35]
    ds_read_b64_tr_b16 v[80:81], v208 offset:12288
    v_mfma_f32_16x16x32_bf16 v[36:39], v[64:67], a[20:23], v[36:39]
    ds_read_b64_tr_b16 v[82:83], v208 offset:14336
    buffer_load_dwordx4 a[0:3], v180, s[4:7], s61 offen offset:0
    s_waitcnt lgkmcnt(6)
    v_mfma_f32_16x16x32_bf16 v[44:47], v[68:71], a[20:23], v[44:47]
    ds_read_b64_tr_b16 v[84:85], v209 offset:12288
    v_mfma_f32_16x16x32_bf16 v[40:43], v[68:71], a[16:19], v[40:43]
    ds_read_b64_tr_b16 v[86:87], v209 offset:14336
    s_waitcnt lgkmcnt(6)
    v_mfma_f32_16x16x32_bf16 v[48:51], v[72:75], a[16:19], v[48:51]
    ds_read_b64_tr_b16 v[88:89], v210 offset:12288
    buffer_load_dwordx4 a[8:11], v180, s[4:7], s61 offen offset:1024
    s_add_u32 s61, s61, 2048
    v_mfma_f32_16x16x32_bf16 v[52:55], v[72:75], a[20:23], v[52:55]
    ds_read_b64_tr_b16 v[90:91], v210 offset:14336
    s_waitcnt lgkmcnt(6)
    v_mfma_f32_16x16x32_bf16 v[60:63], v[76:79], a[20:23], v[60:63]
    ds_read_b64_tr_b16 v[92:93], v211 offset:12288
    v_mfma_f32_16x16x32_bf16 v[56:59], v[76:79], a[16:19], v[56:59]
    ds_read_b64_tr_b16 v[94:95], v211 offset:14336
    buffer_load_dwordx4 a[4:7], v180, s[4:7], s62 offen offset:0
    s_waitcnt lgkmcnt(6)
    v_mfma_f32_16x16x32_bf16 v[32:35], v[80:83], a[24:27], v[32:35]
    s_waitcnt lgkmcnt(0)
    s_barrier
    ds_read_b64_tr_b16 v[64:65], v208 offset:16384
    v_mfma_f32_16x16x32_bf16 v[36:39], v[80:83], a[28:31], v[36:39]
    ds_read_b64_tr_b16 v[66:67], v208 offset:18432
    v_mfma_f32_16x16x32_bf16 v[44:47], v[84:87], a[28:31], v[44:47]
    ds_read_b64_tr_b16 v[68:69], v209 offset:16384
    buffer_load_dwordx4 a[12:15], v180, s[4:7], s62 offen offset:1024
    s_add_u32 s62, s62, 2048
    v_mfma_f32_16x16x32_bf16 v[40:43], v[84:87], a[24:27], v[40:43]
    ds_read_b64_tr_b16 v[70:71], v209 offset:18432
    v_mfma_f32_16x16x32_bf16 v[48:51], v[88:91], a[24:27], v[48:51]
    ds_read_b64_tr_b16 v[72:73], v210 offset:16384
    s_add_u32 m0, s66, 81920
    v_mfma_f32_16x16x32_bf16 v[52:55], v[88:91], a[28:31], v[52:55]
    ds_read_b64_tr_b16 v[74:75], v210 offset:18432
    buffer_load_dwordx4 v192, s[52:55], s60 offen offset:0 lds
    v_mfma_f32_16x16x32_bf16 v[60:63], v[92:95], a[28:31], v[60:63]
    ds_read_b64_tr_b16 v[76:77], v211 offset:16384
    v_mfma_f32_16x16x32_bf16 v[56:59], v[92:95], a[24:27], v[56:59]
    ds_read_b64_tr_b16 v[78:79], v211 offset:18432
    buffer_load_dwordx4 v193, s[52:55], s60 offen offset:1024 lds
    s_add_u32 s60, s60, 131072
    s_waitcnt vmcnt(38) lgkmcnt(6)
    v_mfma_f32_16x16x32_bf16 v[32:35], v[64:67], a[32:35], v[32:35]
    ds_read_b64_tr_b16 v[80:81], v208 offset:20480
    v_mfma_f32_16x16x32_bf16 v[36:39], v[64:67], a[36:39], v[36:39]
    ds_read_b64_tr_b16 v[82:83], v208 offset:22528
    buffer_load_dwordx4 a[16:19], v180, s[4:7], s61 offen offset:0
    s_waitcnt lgkmcnt(6)
    v_mfma_f32_16x16x32_bf16 v[44:47], v[68:71], a[36:39], v[44:47]
    ds_read_b64_tr_b16 v[84:85], v209 offset:20480
    v_mfma_f32_16x16x32_bf16 v[40:43], v[68:71], a[32:35], v[40:43]
    ds_read_b64_tr_b16 v[86:87], v209 offset:22528
    s_waitcnt lgkmcnt(6)
    v_mfma_f32_16x16x32_bf16 v[48:51], v[72:75], a[32:35], v[48:51]
    ds_read_b64_tr_b16 v[88:89], v210 offset:20480
    buffer_load_dwordx4 a[24:27], v180, s[4:7], s61 offen offset:1024
    s_add_u32 s61, s61, 2048
    v_mfma_f32_16x16x32_bf16 v[52:55], v[72:75], a[36:39], v[52:55]
    ds_read_b64_tr_b16 v[90:91], v210 offset:22528
    s_waitcnt lgkmcnt(6)
    v_mfma_f32_16x16x32_bf16 v[60:63], v[76:79], a[36:39], v[60:63]
    ds_read_b64_tr_b16 v[92:93], v211 offset:20480
    v_mfma_f32_16x16x32_bf16 v[56:59], v[76:79], a[32:35], v[56:59]
    ds_read_b64_tr_b16 v[94:95], v211 offset:22528
    buffer_load_dwordx4 a[20:23], v180, s[4:7], s62 offen offset:0
    s_waitcnt lgkmcnt(6)
    v_mfma_f32_16x16x32_bf16 v[32:35], v[80:83], a[40:43], v[32:35]
    s_waitcnt lgkmcnt(0)
    s_barrier
    ds_read_b64_tr_b16 v[64:65], v208 offset:24576
    v_mfma_f32_16x16x32_bf16 v[36:39], v[80:83], a[44:47], v[36:39]
    ds_read_b64_tr_b16 v[66:67], v208 offset:26624
    v_mfma_f32_16x16x32_bf16 v[44:47], v[84:87], a[44:47], v[44:47]
    ds_read_b64_tr_b16 v[68:69], v209 offset:24576
    buffer_load_dwordx4 a[28:31], v180, s[4:7], s62 offen offset:1024
    s_add_u32 s62, s62, 2048
    v_mfma_f32_16x16x32_bf16 v[40:43], v[84:87], a[40:43], v[40:43]
    ds_read_b64_tr_b16 v[70:71], v209 offset:26624
    v_mfma_f32_16x16x32_bf16 v[48:51], v[88:91], a[40:43], v[48:51]
    ds_read_b64_tr_b16 v[72:73], v210 offset:24576
    s_add_u32 m0, s66, 90112
    v_mfma_f32_16x16x32_bf16 v[52:55], v[88:91], a[44:47], v[52:55]
    ds_read_b64_tr_b16 v[74:75], v210 offset:26624
    buffer_load_dwordx4 v192, s[52:55], s60 offen offset:0 lds
    v_mfma_f32_16x16x32_bf16 v[60:63], v[92:95], a[44:47], v[60:63]
    ds_read_b64_tr_b16 v[76:77], v211 offset:24576
    v_mfma_f32_16x16x32_bf16 v[56:59], v[92:95], a[40:43], v[56:59]
    ds_read_b64_tr_b16 v[78:79], v211 offset:26624
    buffer_load_dwordx4 v193, s[52:55], s60 offen offset:1024 lds
    s_add_u32 s60, s60, 131072
    s_waitcnt vmcnt(38) lgkmcnt(6)
    v_mfma_f32_16x16x32_bf16 v[32:35], v[64:67], a[48:51], v[32:35]
    ds_read_b64_tr_b16 v[80:81], v208 offset:28672
    v_mfma_f32_16x16x32_bf16 v[36:39], v[64:67], a[52:55], v[36:39]
    ds_read_b64_tr_b16 v[82:83], v208 offset:30720
    buffer_load_dwordx4 a[32:35], v180, s[4:7], s61 offen offset:0
    s_waitcnt lgkmcnt(6)
    v_mfma_f32_16x16x32_bf16 v[44:47], v[68:71], a[52:55], v[44:47]
    ds_read_b64_tr_b16 v[84:85], v209 offset:28672
    v_mfma_f32_16x16x32_bf16 v[40:43], v[68:71], a[48:51], v[40:43]
    ds_read_b64_tr_b16 v[86:87], v209 offset:30720
    s_waitcnt lgkmcnt(6)
    v_mfma_f32_16x16x32_bf16 v[48:51], v[72:75], a[48:51], v[48:51]
    ds_read_b64_tr_b16 v[88:89], v210 offset:28672
    buffer_load_dwordx4 a[40:43], v180, s[4:7], s61 offen offset:1024
    s_add_u32 s61, s61, 2048
    v_mfma_f32_16x16x32_bf16 v[52:55], v[72:75], a[52:55], v[52:55]
    ds_read_b64_tr_b16 v[90:91], v210 offset:30720
    s_waitcnt lgkmcnt(6)
    v_mfma_f32_16x16x32_bf16 v[60:63], v[76:79], a[52:55], v[60:63]
    ds_read_b64_tr_b16 v[92:93], v211 offset:28672
    v_mfma_f32_16x16x32_bf16 v[56:59], v[76:79], a[48:51], v[56:59]
    ds_read_b64_tr_b16 v[94:95], v211 offset:30720
    buffer_load_dwordx4 a[36:39], v180, s[4:7], s62 offen offset:0
    s_waitcnt lgkmcnt(6)
    v_mfma_f32_16x16x32_bf16 v[32:35], v[80:83], a[56:59], v[32:35]
    s_waitcnt lgkmcnt(0)
    s_barrier
    ds_read_b64_tr_b16 v[64:65], v208 offset:32768
    v_mfma_f32_16x16x32_bf16 v[36:39], v[80:83], a[60:63], v[36:39]
    ds_read_b64_tr_b16 v[66:67], v208 offset:34816
    v_mfma_f32_16x16x32_bf16 v[44:47], v[84:87], a[60:63], v[44:47]
    ds_read_b64_tr_b16 v[68:69], v209 offset:32768
    buffer_load_dwordx4 a[44:47], v180, s[4:7], s62 offen offset:1024
    s_add_u32 s62, s62, 2048
    v_mfma_f32_16x16x32_bf16 v[40:43], v[84:87], a[56:59], v[40:43]
    ds_read_b64_tr_b16 v[70:71], v209 offset:34816
    v_mfma_f32_16x16x32_bf16 v[48:51], v[88:91], a[56:59], v[48:51]
    ds_read_b64_tr_b16 v[72:73], v210 offset:32768
    v_mfma_f32_16x16x32_bf16 v[52:55], v[88:91], a[60:63], v[52:55]
    ds_read_b64_tr_b16 v[74:75], v210 offset:34816
    v_mfma_f32_16x16x32_bf16 v[60:63], v[92:95], a[60:63], v[60:63]
    ds_read_b64_tr_b16 v[76:77], v211 offset:32768
    v_mfma_f32_16x16x32_bf16 v[56:59], v[92:95], a[56:59], v[56:59]
    ds_read_b64_tr_b16 v[78:79], v211 offset:34816
    s_waitcnt vmcnt(36) lgkmcnt(6)
    v_mfma_f32_16x16x32_bf16 v[32:35], v[64:67], a[64:67], v[32:35]
    ds_read_b64_tr_b16 v[80:81], v208 offset:36864
    v_mfma_f32_16x16x32_bf16 v[36:39], v[64:67], a[68:71], v[36:39]
    ds_read_b64_tr_b16 v[82:83], v208 offset:38912
    buffer_load_dwordx4 a[48:51], v180, s[4:7], s61 offen offset:0
    s_waitcnt lgkmcnt(6)
    v_mfma_f32_16x16x32_bf16 v[44:47], v[68:71], a[68:71], v[44:47]
    ds_read_b64_tr_b16 v[84:85], v209 offset:36864
    v_mfma_f32_16x16x32_bf16 v[40:43], v[68:71], a[64:67], v[40:43]
    ds_read_b64_tr_b16 v[86:87], v209 offset:38912
    s_waitcnt lgkmcnt(6)
    v_mfma_f32_16x16x32_bf16 v[48:51], v[72:75], a[64:67], v[48:51]
    ds_read_b64_tr_b16 v[88:89], v210 offset:36864
    buffer_load_dwordx4 a[56:59], v180, s[4:7], s61 offen offset:1024
    s_add_u32 s61, s61, 2048
    v_mfma_f32_16x16x32_bf16 v[52:55], v[72:75], a[68:71], v[52:55]
    ds_read_b64_tr_b16 v[90:91], v210 offset:38912
    s_waitcnt lgkmcnt(6)
    v_mfma_f32_16x16x32_bf16 v[60:63], v[76:79], a[68:71], v[60:63]
    ds_read_b64_tr_b16 v[92:93], v211 offset:36864
    v_mfma_f32_16x16x32_bf16 v[56:59], v[76:79], a[64:67], v[56:59]
    ds_read_b64_tr_b16 v[94:95], v211 offset:38912
    buffer_load_dwordx4 a[52:55], v180, s[4:7], s62 offen offset:0
    s_waitcnt lgkmcnt(6)
    v_mfma_f32_16x16x32_bf16 v[32:35], v[80:83], a[72:75], v[32:35]
    s_waitcnt lgkmcnt(0)
    s_barrier
    ds_read_b64_tr_b16 v[64:65], v208 offset:40960
    v_mfma_f32_16x16x32_bf16 v[36:39], v[80:83], a[76:79], v[36:39]
    ds_read_b64_tr_b16 v[66:67], v208 offset:43008
    v_mfma_f32_16x16x32_bf16 v[44:47], v[84:87], a[76:79], v[44:47]
    ds_read_b64_tr_b16 v[68:69], v209 offset:40960
    buffer_load_dwordx4 a[60:63], v180, s[4:7], s62 offen offset:1024
    s_add_u32 s62, s62, 2048
    v_mfma_f32_16x16x32_bf16 v[40:43], v[84:87], a[72:75], v[40:43]
    ds_read_b64_tr_b16 v[70:71], v209 offset:43008
    v_mfma_f32_16x16x32_bf16 v[48:51], v[88:91], a[72:75], v[48:51]
    ds_read_b64_tr_b16 v[72:73], v210 offset:40960
    v_mfma_f32_16x16x32_bf16 v[52:55], v[88:91], a[76:79], v[52:55]
    ds_read_b64_tr_b16 v[74:75], v210 offset:43008
    v_mfma_f32_16x16x32_bf16 v[60:63], v[92:95], a[76:79], v[60:63]
    ds_read_b64_tr_b16 v[76:77], v211 offset:40960
    v_mfma_f32_16x16x32_bf16 v[56:59], v[92:95], a[72:75], v[56:59]
    ds_read_b64_tr_b16 v[78:79], v211 offset:43008
    s_waitcnt vmcnt(34) lgkmcnt(6)
    v_mfma_f32_16x16x32_bf16 v[32:35], v[64:67], a[80:83], v[32:35]
    ds_read_b64_tr_b16 v[80:81], v208 offset:45056
    v_mfma_f32_16x16x32_bf16 v[36:39], v[64:67], a[84:87], v[36:39]
    ds_read_b64_tr_b16 v[82:83], v208 offset:47104
    s_waitcnt lgkmcnt(6)
    v_mfma_f32_16x16x32_bf16 v[44:47], v[68:71], a[84:87], v[44:47]
    ds_read_b64_tr_b16 v[84:85], v209 offset:45056
    v_mfma_f32_16x16x32_bf16 v[40:43], v[68:71], a[80:83], v[40:43]
    ds_read_b64_tr_b16 v[86:87], v209 offset:47104
    s_waitcnt lgkmcnt(6)
    v_mfma_f32_16x16x32_bf16 v[48:51], v[72:75], a[80:83], v[48:51]
    ds_read_b64_tr_b16 v[88:89], v210 offset:45056
    v_mfma_f32_16x16x32_bf16 v[52:55], v[72:75], a[84:87], v[52:55]
    ds_read_b64_tr_b16 v[90:91], v210 offset:47104
    s_waitcnt lgkmcnt(6)
    v_mfma_f32_16x16x32_bf16 v[60:63], v[76:79], a[84:87], v[60:63]
    ds_read_b64_tr_b16 v[92:93], v211 offset:45056
    v_mfma_f32_16x16x32_bf16 v[56:59], v[76:79], a[80:83], v[56:59]
    ds_read_b64_tr_b16 v[94:95], v211 offset:47104
    s_waitcnt lgkmcnt(6)
    v_mfma_f32_16x16x32_bf16 v[32:35], v[80:83], a[88:91], v[32:35]
    s_waitcnt lgkmcnt(0)
    s_barrier
    ds_read_b64_tr_b16 v[64:65], v208 offset:49152
    v_mfma_f32_16x16x32_bf16 v[36:39], v[80:83], a[92:95], v[36:39]
    ds_read_b64_tr_b16 v[66:67], v208 offset:51200
    v_mfma_f32_16x16x32_bf16 v[44:47], v[84:87], a[92:95], v[44:47]
    ds_read_b64_tr_b16 v[68:69], v209 offset:49152
    v_mfma_f32_16x16x32_bf16 v[40:43], v[84:87], a[88:91], v[40:43]
    ds_read_b64_tr_b16 v[70:71], v209 offset:51200
    v_mfma_f32_16x16x32_bf16 v[48:51], v[88:91], a[88:91], v[48:51]
    ds_read_b64_tr_b16 v[72:73], v210 offset:49152
    v_mfma_f32_16x16x32_bf16 v[52:55], v[88:91], a[92:95], v[52:55]
    ds_read_b64_tr_b16 v[74:75], v210 offset:51200
    v_mfma_f32_16x16x32_bf16 v[60:63], v[92:95], a[92:95], v[60:63]
    ds_read_b64_tr_b16 v[76:77], v211 offset:49152
    v_mfma_f32_16x16x32_bf16 v[56:59], v[92:95], a[88:91], v[56:59]
    ds_read_b64_tr_b16 v[78:79], v211 offset:51200
    s_waitcnt vmcnt(28) lgkmcnt(6)
    v_mfma_f32_16x16x32_bf16 v[32:35], v[64:67], a[96:99], v[32:35]
    ds_read_b64_tr_b16 v[80:81], v208 offset:53248
    v_mfma_f32_16x16x32_bf16 v[36:39], v[64:67], a[100:103], v[36:39]
    ds_read_b64_tr_b16 v[82:83], v208 offset:55296
    s_waitcnt lgkmcnt(6)
    v_mfma_f32_16x16x32_bf16 v[44:47], v[68:71], a[100:103], v[44:47]
    ds_read_b64_tr_b16 v[84:85], v209 offset:53248
    v_mfma_f32_16x16x32_bf16 v[40:43], v[68:71], a[96:99], v[40:43]
    ds_read_b64_tr_b16 v[86:87], v209 offset:55296
    s_waitcnt lgkmcnt(6)
    v_mfma_f32_16x16x32_bf16 v[48:51], v[72:75], a[96:99], v[48:51]
    ds_read_b64_tr_b16 v[88:89], v210 offset:53248
    v_mfma_f32_16x16x32_bf16 v[52:55], v[72:75], a[100:103], v[52:55]
    ds_read_b64_tr_b16 v[90:91], v210 offset:55296
    s_waitcnt lgkmcnt(6)
    v_mfma_f32_16x16x32_bf16 v[60:63], v[76:79], a[100:103], v[60:63]
    ds_read_b64_tr_b16 v[92:93], v211 offset:53248
    v_mfma_f32_16x16x32_bf16 v[56:59], v[76:79], a[96:99], v[56:59]
    ds_read_b64_tr_b16 v[94:95], v211 offset:55296
    s_waitcnt lgkmcnt(6)
    v_mfma_f32_16x16x32_bf16 v[32:35], v[80:83], a[104:107], v[32:35]
    s_waitcnt lgkmcnt(0)
    s_barrier
    ds_read_b64_tr_b16 v[64:65], v208 offset:57344
    v_mfma_f32_16x16x32_bf16 v[36:39], v[80:83], a[108:111], v[36:39]
    ds_read_b64_tr_b16 v[66:67], v208 offset:59392
    v_mfma_f32_16x16x32_bf16 v[44:47], v[84:87], a[108:111], v[44:47]
    ds_read_b64_tr_b16 v[68:69], v209 offset:57344
    v_mfma_f32_16x16x32_bf16 v[40:43], v[84:87], a[104:107], v[40:43]
    ds_read_b64_tr_b16 v[70:71], v209 offset:59392
    v_mfma_f32_16x16x32_bf16 v[48:51], v[88:91], a[104:107], v[48:51]
    ds_read_b64_tr_b16 v[72:73], v210 offset:57344
    v_mfma_f32_16x16x32_bf16 v[52:55], v[88:91], a[108:111], v[52:55]
    ds_read_b64_tr_b16 v[74:75], v210 offset:59392
    v_mfma_f32_16x16x32_bf16 v[60:63], v[92:95], a[108:111], v[60:63]
    ds_read_b64_tr_b16 v[76:77], v211 offset:57344
    v_mfma_f32_16x16x32_bf16 v[56:59], v[92:95], a[104:107], v[56:59]
    ds_read_b64_tr_b16 v[78:79], v211 offset:59392
    s_waitcnt vmcnt(22) lgkmcnt(6)
    v_mfma_f32_16x16x32_bf16 v[32:35], v[64:67], a[112:115], v[32:35]
    ds_read_b64_tr_b16 v[80:81], v208 offset:61440
    v_mfma_f32_16x16x32_bf16 v[36:39], v[64:67], a[116:119], v[36:39]
    ds_read_b64_tr_b16 v[82:83], v208 offset:63488
    s_waitcnt lgkmcnt(6)
    v_mfma_f32_16x16x32_bf16 v[44:47], v[68:71], a[116:119], v[44:47]
    ds_read_b64_tr_b16 v[84:85], v209 offset:61440
    v_mfma_f32_16x16x32_bf16 v[40:43], v[68:71], a[112:115], v[40:43]
    ds_read_b64_tr_b16 v[86:87], v209 offset:63488
    s_waitcnt lgkmcnt(6)
    v_mfma_f32_16x16x32_bf16 v[48:51], v[72:75], a[112:115], v[48:51]
    ds_read_b64_tr_b16 v[88:89], v210 offset:61440
    v_mfma_f32_16x16x32_bf16 v[52:55], v[72:75], a[116:119], v[52:55]
    ds_read_b64_tr_b16 v[90:91], v210 offset:63488
    s_waitcnt lgkmcnt(6)
    v_mfma_f32_16x16x32_bf16 v[60:63], v[76:79], a[116:119], v[60:63]
    ds_read_b64_tr_b16 v[92:93], v211 offset:61440
    v_mfma_f32_16x16x32_bf16 v[56:59], v[76:79], a[112:115], v[56:59]
    ds_read_b64_tr_b16 v[94:95], v211 offset:63488
    s_waitcnt lgkmcnt(6)
    v_mfma_f32_16x16x32_bf16 v[32:35], v[80:83], a[120:123], v[32:35]
    s_waitcnt lgkmcnt(0)
    s_barrier
    ds_read_b64_tr_b16 v[64:65], v212 offset:0
    v_mfma_f32_16x16x32_bf16 v[36:39], v[80:83], a[124:127], v[36:39]
    ds_read_b64_tr_b16 v[66:67], v212 offset:2048
    v_mfma_f32_16x16x32_bf16 v[44:47], v[84:87], a[124:127], v[44:47]
    ds_read_b64_tr_b16 v[68:69], v213 offset:0
    v_mfma_f32_16x16x32_bf16 v[40:43], v[84:87], a[120:123], v[40:43]
    ds_read_b64_tr_b16 v[70:71], v213 offset:2048
    v_mfma_f32_16x16x32_bf16 v[48:51], v[88:91], a[120:123], v[48:51]
    ds_read_b64_tr_b16 v[72:73], v214 offset:0
    v_mfma_f32_16x16x32_bf16 v[52:55], v[88:91], a[124:127], v[52:55]
    ds_read_b64_tr_b16 v[74:75], v214 offset:2048
    v_mfma_f32_16x16x32_bf16 v[60:63], v[92:95], a[124:127], v[60:63]
    ds_read_b64_tr_b16 v[76:77], v215 offset:0
    v_mfma_f32_16x16x32_bf16 v[56:59], v[92:95], a[120:123], v[56:59]
    ds_read_b64_tr_b16 v[78:79], v215 offset:2048
    s_waitcnt vmcnt(16) lgkmcnt(6)
    v_mfma_f32_16x16x32_bf16 v[32:35], v[64:67], a[0:3], v[32:35]
    ds_read_b64_tr_b16 v[80:81], v212 offset:4096
    v_mfma_f32_16x16x32_bf16 v[36:39], v[64:67], a[4:7], v[36:39]
    ds_read_b64_tr_b16 v[82:83], v212 offset:6144
    buffer_load_dwordx4 v[96:99], v202, s[16:19], s68 offen offset:0
    s_waitcnt lgkmcnt(6)
    v_mfma_f32_16x16x32_bf16 v[44:47], v[68:71], a[4:7], v[44:47]
    ds_read_b64_tr_b16 v[84:85], v213 offset:4096
    v_mfma_f32_16x16x32_bf16 v[40:43], v[68:71], a[0:3], v[40:43]
    ds_read_b64_tr_b16 v[86:87], v213 offset:6144
    buffer_load_dwordx4 v[100:103], v202, s[16:19], s68 offen offset:64
    s_waitcnt lgkmcnt(6)
    v_mfma_f32_16x16x32_bf16 v[48:51], v[72:75], a[0:3], v[48:51]
    ds_read_b64_tr_b16 v[88:89], v214 offset:4096
    v_mfma_f32_16x16x32_bf16 v[52:55], v[72:75], a[4:7], v[52:55]
    ds_read_b64_tr_b16 v[90:91], v214 offset:6144
    buffer_load_dwordx4 v[104:107], v202, s[16:19], s69 offen offset:0
    s_waitcnt lgkmcnt(6)
    v_mfma_f32_16x16x32_bf16 v[60:63], v[76:79], a[4:7], v[60:63]
    ds_read_b64_tr_b16 v[92:93], v215 offset:4096
    v_mfma_f32_16x16x32_bf16 v[56:59], v[76:79], a[0:3], v[56:59]
    ds_read_b64_tr_b16 v[94:95], v215 offset:6144
    buffer_load_dwordx4 v[108:111], v202, s[16:19], s69 offen offset:64
    s_waitcnt lgkmcnt(6)
    v_mfma_f32_16x16x32_bf16 v[32:35], v[80:83], a[8:11], v[32:35]
    s_waitcnt lgkmcnt(0)
    s_barrier
    ds_read_b64_tr_b16 v[64:65], v212 offset:8192
    v_mfma_f32_16x16x32_bf16 v[36:39], v[80:83], a[12:15], v[36:39]
    ds_read_b64_tr_b16 v[66:67], v212 offset:10240
    v_mfma_f32_16x16x32_bf16 v[44:47], v[84:87], a[12:15], v[44:47]
    ds_read_b64_tr_b16 v[68:69], v213 offset:8192
    v_mfma_f32_16x16x32_bf16 v[40:43], v[84:87], a[8:11], v[40:43]
    ds_read_b64_tr_b16 v[70:71], v213 offset:10240
    v_mfma_f32_16x16x32_bf16 v[48:51], v[88:91], a[8:11], v[48:51]
    ds_read_b64_tr_b16 v[72:73], v214 offset:8192
    v_mfma_f32_16x16x32_bf16 v[52:55], v[88:91], a[12:15], v[52:55]
    ds_read_b64_tr_b16 v[74:75], v214 offset:10240
    v_mfma_f32_16x16x32_bf16 v[60:63], v[92:95], a[12:15], v[60:63]
    ds_read_b64_tr_b16 v[76:77], v215 offset:8192
    v_mfma_f32_16x16x32_bf16 v[56:59], v[92:95], a[8:11], v[56:59]
    ds_read_b64_tr_b16 v[78:79], v215 offset:10240
    s_waitcnt vmcnt(14) lgkmcnt(6)
    v_mfma_f32_16x16x32_bf16 v[32:35], v[64:67], a[16:19], v[32:35]
    ds_read_b64_tr_b16 v[80:81], v212 offset:12288
    v_mfma_f32_16x16x32_bf16 v[36:39], v[64:67], a[20:23], v[36:39]
    ds_read_b64_tr_b16 v[82:83], v212 offset:14336
    s_waitcnt lgkmcnt(6)
    v_mfma_f32_16x16x32_bf16 v[44:47], v[68:71], a[20:23], v[44:47]
    ds_read_b64_tr_b16 v[84:85], v213 offset:12288
    v_mfma_f32_16x16x32_bf16 v[40:43], v[68:71], a[16:19], v[40:43]
    ds_read_b64_tr_b16 v[86:87], v213 offset:14336
    s_waitcnt lgkmcnt(6)
    v_mfma_f32_16x16x32_bf16 v[48:51], v[72:75], a[16:19], v[48:51]
    ds_read_b64_tr_b16 v[88:89], v214 offset:12288
    v_mfma_f32_16x16x32_bf16 v[52:55], v[72:75], a[20:23], v[52:55]
    ds_read_b64_tr_b16 v[90:91], v214 offset:14336
    s_waitcnt lgkmcnt(6)
    v_mfma_f32_16x16x32_bf16 v[60:63], v[76:79], a[20:23], v[60:63]
    ds_read_b64_tr_b16 v[92:93], v215 offset:12288
    v_mfma_f32_16x16x32_bf16 v[56:59], v[76:79], a[16:19], v[56:59]
    ds_read_b64_tr_b16 v[94:95], v215 offset:14336
    s_waitcnt lgkmcnt(6)
    v_mfma_f32_16x16x32_bf16 v[32:35], v[80:83], a[24:27], v[32:35]
    s_waitcnt lgkmcnt(0)
    s_barrier
    ds_read_b64_tr_b16 v[64:65], v212 offset:16384
    v_mfma_f32_16x16x32_bf16 v[36:39], v[80:83], a[28:31], v[36:39]
    ds_read_b64_tr_b16 v[66:67], v212 offset:18432
    v_mfma_f32_16x16x32_bf16 v[44:47], v[84:87], a[28:31], v[44:47]
    ds_read_b64_tr_b16 v[68:69], v213 offset:16384
    v_mfma_f32_16x16x32_bf16 v[40:43], v[84:87], a[24:27], v[40:43]
    ds_read_b64_tr_b16 v[70:71], v213 offset:18432
    v_mfma_f32_16x16x32_bf16 v[48:51], v[88:91], a[24:27], v[48:51]
    ds_read_b64_tr_b16 v[72:73], v214 offset:16384
    v_mfma_f32_16x16x32_bf16 v[52:55], v[88:91], a[28:31], v[52:55]
    ds_read_b64_tr_b16 v[74:75], v214 offset:18432
    v_mfma_f32_16x16x32_bf16 v[60:63], v[92:95], a[28:31], v[60:63]
    ds_read_b64_tr_b16 v[76:77], v215 offset:16384
    v_mfma_f32_16x16x32_bf16 v[56:59], v[92:95], a[24:27], v[56:59]
    ds_read_b64_tr_b16 v[78:79], v215 offset:18432
    s_waitcnt vmcnt(8) lgkmcnt(6)
    v_mfma_f32_16x16x32_bf16 v[32:35], v[64:67], a[32:35], v[32:35]
    ds_read_b64_tr_b16 v[80:81], v212 offset:20480
    v_mfma_f32_16x16x32_bf16 v[36:39], v[64:67], a[36:39], v[36:39]
    ds_read_b64_tr_b16 v[82:83], v212 offset:22528
    s_waitcnt lgkmcnt(6)
    v_mfma_f32_16x16x32_bf16 v[44:47], v[68:71], a[36:39], v[44:47]
    ds_read_b64_tr_b16 v[84:85], v213 offset:20480
    v_mfma_f32_16x16x32_bf16 v[40:43], v[68:71], a[32:35], v[40:43]
    ds_read_b64_tr_b16 v[86:87], v213 offset:22528
    s_waitcnt lgkmcnt(6)
    v_mfma_f32_16x16x32_bf16 v[48:51], v[72:75], a[32:35], v[48:51]
    ds_read_b64_tr_b16 v[88:89], v214 offset:20480
    v_mfma_f32_16x16x32_bf16 v[52:55], v[72:75], a[36:39], v[52:55]
    ds_read_b64_tr_b16 v[90:91], v214 offset:22528
    s_waitcnt lgkmcnt(6)
    v_mfma_f32_16x16x32_bf16 v[60:63], v[76:79], a[36:39], v[60:63]
    ds_read_b64_tr_b16 v[92:93], v215 offset:20480
    v_mfma_f32_16x16x32_bf16 v[56:59], v[76:79], a[32:35], v[56:59]
    ds_read_b64_tr_b16 v[94:95], v215 offset:22528
    s_waitcnt lgkmcnt(6)
    v_mfma_f32_16x16x32_bf16 v[32:35], v[80:83], a[40:43], v[32:35]
    s_waitcnt lgkmcnt(0)
    s_barrier
    ds_read_b64_tr_b16 v[64:65], v212 offset:24576
    v_mfma_f32_16x16x32_bf16 v[36:39], v[80:83], a[44:47], v[36:39]
    ds_read_b64_tr_b16 v[66:67], v212 offset:26624
    v_mfma_f32_16x16x32_bf16 v[44:47], v[84:87], a[44:47], v[44:47]
    ds_read_b64_tr_b16 v[68:69], v213 offset:24576
    v_mfma_f32_16x16x32_bf16 v[40:43], v[84:87], a[40:43], v[40:43]
    ds_read_b64_tr_b16 v[70:71], v213 offset:26624
    v_mfma_f32_16x16x32_bf16 v[48:51], v[88:91], a[40:43], v[48:51]
    ds_read_b64_tr_b16 v[72:73], v214 offset:24576
    v_mfma_f32_16x16x32_bf16 v[52:55], v[88:91], a[44:47], v[52:55]
    ds_read_b64_tr_b16 v[74:75], v214 offset:26624
    v_mfma_f32_16x16x32_bf16 v[60:63], v[92:95], a[44:47], v[60:63]
    ds_read_b64_tr_b16 v[76:77], v215 offset:24576
    v_mfma_f32_16x16x32_bf16 v[56:59], v[92:95], a[40:43], v[56:59]
    ds_read_b64_tr_b16 v[78:79], v215 offset:26624
    s_waitcnt vmcnt(4) lgkmcnt(6)
    v_mfma_f32_16x16x32_bf16 v[32:35], v[64:67], a[48:51], v[32:35]
    ds_read_b64_tr_b16 v[80:81], v212 offset:28672
    v_mfma_f32_16x16x32_bf16 v[36:39], v[64:67], a[52:55], v[36:39]
    ds_read_b64_tr_b16 v[82:83], v212 offset:30720
    s_waitcnt lgkmcnt(6)
    v_mfma_f32_16x16x32_bf16 v[44:47], v[68:71], a[52:55], v[44:47]
    ds_read_b64_tr_b16 v[84:85], v213 offset:28672
    v_mfma_f32_16x16x32_bf16 v[40:43], v[68:71], a[48:51], v[40:43]
    ds_read_b64_tr_b16 v[86:87], v213 offset:30720
    s_waitcnt lgkmcnt(6)
    v_mfma_f32_16x16x32_bf16 v[48:51], v[72:75], a[48:51], v[48:51]
    ds_read_b64_tr_b16 v[88:89], v214 offset:28672
    v_mfma_f32_16x16x32_bf16 v[52:55], v[72:75], a[52:55], v[52:55]
    ds_read_b64_tr_b16 v[90:91], v214 offset:30720
    s_waitcnt lgkmcnt(6)
    v_mfma_f32_16x16x32_bf16 v[60:63], v[76:79], a[52:55], v[60:63]
    ds_read_b64_tr_b16 v[92:93], v215 offset:28672
    v_mfma_f32_16x16x32_bf16 v[56:59], v[76:79], a[48:51], v[56:59]
    ds_read_b64_tr_b16 v[94:95], v215 offset:30720
    s_waitcnt lgkmcnt(6)
    v_mfma_f32_16x16x32_bf16 v[32:35], v[80:83], a[56:59], v[32:35]
    v_mfma_f32_16x16x32_bf16 v[36:39], v[80:83], a[60:63], v[36:39]
    s_waitcnt lgkmcnt(4)
    v_mfma_f32_16x16x32_bf16 v[44:47], v[84:87], a[60:63], v[44:47]
    v_mfma_f32_16x16x32_bf16 v[40:43], v[84:87], a[56:59], v[40:43]
    s_waitcnt lgkmcnt(2)
    v_mfma_f32_16x16x32_bf16 v[48:51], v[88:91], a[56:59], v[48:51]
    v_mfma_f32_16x16x32_bf16 v[52:55], v[88:91], a[60:63], v[52:55]
    s_waitcnt lgkmcnt(0)
    v_mfma_f32_16x16x32_bf16 v[60:63], v[92:95], a[60:63], v[60:63]
    v_mfma_f32_16x16x32_bf16 v[56:59], v[92:95], a[56:59], v[56:59]
    s_waitcnt vmcnt(0)
    v_mov_b32 v182, 0xbfb8aa3b
    s_nop 6
    v_pk_mul_f32 v[112:113], v[32:33], v[182:183] op_sel_hi:[1,0]
    v_pk_mul_f32 v[114:115], v[34:35], v[182:183] op_sel_hi:[1,0]
    v_pk_mul_f32 v[116:117], v[40:41], v[182:183] op_sel_hi:[1,0]
    v_pk_mul_f32 v[118:119], v[42:43], v[182:183] op_sel_hi:[1,0]
    v_exp_f32 v112, v112
    v_exp_f32 v113, v113
    v_exp_f32 v114, v114
    v_exp_f32 v115, v115
    v_exp_f32 v116, v116
    v_exp_f32 v117, v117
    v_exp_f32 v118, v118
    v_exp_f32 v119, v119
    v_pk_mul_f32 v[32:33], v[32:33], v[0:1]
    v_pk_add_f32 v[112:113], v[112:113], 1.0 op_sel_hi:[1,0]
    v_pk_mul_f32 v[34:35], v[34:35], v[2:3]
    v_pk_add_f32 v[114:115], v[114:115], 1.0 op_sel_hi:[1,0]
    v_pk_mul_f32 v[40:41], v[40:41], v[8:9]
    v_pk_add_f32 v[116:117], v[116:117], 1.0 op_sel_hi:[1,0]
    v_pk_mul_f32 v[42:43], v[42:43], v[10:11]
    v_pk_add_f32 v[118:119], v[118:119], 1.0 op_sel_hi:[1,0]
    v_rcp_f32 v112, v112
    v_rcp_f32 v113, v113
    v_rcp_f32 v114, v114
    v_rcp_f32 v115, v115
    v_rcp_f32 v116, v116
    v_rcp_f32 v117, v117
    v_rcp_f32 v118, v118
    v_rcp_f32 v119, v119
    v_lshlrev_b32 v120, 16, v96
    v_pk_mul_f32 v[32:33], v[32:33], v[112:113]
    v_lshlrev_b32 v122, 16, v97
    v_pk_mul_f32 v[34:35], v[34:35], v[114:115]
    v_lshlrev_b32 v124, 16, v98
    v_pk_mul_f32 v[40:41], v[40:41], v[116:117]
    v_lshlrev_b32 v126, 16, v99
    v_pk_mul_f32 v[42:43], v[42:43], v[118:119]
    v_and_b32 v121, 0xffff0000, v96
    v_and_b32 v123, 0xffff0000, v97
    v_and_b32 v125, 0xffff0000, v98
    v_and_b32 v127, 0xffff0000, v99
    v_permlane16_swap_b32 v32, v40
    v_permlane16_swap_b32 v33, v41
    v_permlane16_swap_b32 v34, v42
    v_permlane16_swap_b32 v35, v43
    v_pk_add_f32 v[32:33], v[32:33], v[120:121]
    v_pk_add_f32 v[34:35], v[34:35], v[122:123]
    v_pk_add_f32 v[40:41], v[40:41], v[124:125]
    v_pk_add_f32 v[42:43], v[42:43], v[126:127]
    v_cvt_pk_bf16_f32 v96, v32, v33
    v_cvt_pk_bf16_f32 v97, v34, v35
    v_cvt_pk_bf16_f32 v98, v40, v41
    v_cvt_pk_bf16_f32 v99, v42, v43
    buffer_store_dwordx4 v[96:99], v202, s[56:59], s68 offen offset:0
    v_pk_mul_f32 v[128:129], v[48:49], v[182:183] op_sel_hi:[1,0]
    v_pk_mul_f32 v[130:131], v[50:51], v[182:183] op_sel_hi:[1,0]
    v_pk_mul_f32 v[132:133], v[56:57], v[182:183] op_sel_hi:[1,0]
    v_pk_mul_f32 v[134:135], v[58:59], v[182:183] op_sel_hi:[1,0]
    v_exp_f32 v128, v128
    v_exp_f32 v129, v129
    v_exp_f32 v130, v130
    v_exp_f32 v131, v131
    v_exp_f32 v132, v132
    v_exp_f32 v133, v133
    v_exp_f32 v134, v134
    v_exp_f32 v135, v135
    v_pk_mul_f32 v[48:49], v[48:49], v[16:17]
    v_pk_add_f32 v[128:129], v[128:129], 1.0 op_sel_hi:[1,0]
    v_pk_mul_f32 v[50:51], v[50:51], v[18:19]
    v_pk_add_f32 v[130:131], v[130:131], 1.0 op_sel_hi:[1,0]
    v_pk_mul_f32 v[56:57], v[56:57], v[24:25]
    v_pk_add_f32 v[132:133], v[132:133], 1.0 op_sel_hi:[1,0]
    v_pk_mul_f32 v[58:59], v[58:59], v[26:27]
    v_pk_add_f32 v[134:135], v[134:135], 1.0 op_sel_hi:[1,0]
    v_rcp_f32 v128, v128
    v_rcp_f32 v129, v129
    v_rcp_f32 v130, v130
    v_rcp_f32 v131, v131
    v_rcp_f32 v132, v132
    v_rcp_f32 v133, v133
    v_rcp_f32 v134, v134
    v_rcp_f32 v135, v135
    v_lshlrev_b32 v136, 16, v100
    v_pk_mul_f32 v[48:49], v[48:49], v[128:129]
    v_lshlrev_b32 v138, 16, v101
    v_pk_mul_f32 v[50:51], v[50:51], v[130:131]
    v_lshlrev_b32 v140, 16, v102
    v_pk_mul_f32 v[56:57], v[56:57], v[132:133]
    v_lshlrev_b32 v142, 16, v103
    v_pk_mul_f32 v[58:59], v[58:59], v[134:135]
    v_and_b32 v137, 0xffff0000, v100
    v_and_b32 v139, 0xffff0000, v101
    v_and_b32 v141, 0xffff0000, v102
    v_and_b32 v143, 0xffff0000, v103
    v_permlane16_swap_b32 v48, v56
    v_permlane16_swap_b32 v49, v57
    v_permlane16_swap_b32 v50, v58
    v_permlane16_swap_b32 v51, v59
    v_pk_add_f32 v[48:49], v[48:49], v[136:137]
    v_pk_add_f32 v[50:51], v[50:51], v[138:139]
    v_pk_add_f32 v[56:57], v[56:57], v[140:141]
    v_pk_add_f32 v[58:59], v[58:59], v[142:143]
    v_cvt_pk_bf16_f32 v100, v48, v49
    v_cvt_pk_bf16_f32 v101, v50, v51
    v_cvt_pk_bf16_f32 v102, v56, v57
    v_cvt_pk_bf16_f32 v103, v58, v59
    buffer_store_dwordx4 v[100:103], v202, s[56:59], s68 offen offset:64
    v_pk_mul_f32 v[112:113], v[36:37], v[182:183] op_sel_hi:[1,0]
    v_pk_mul_f32 v[114:115], v[38:39], v[182:183] op_sel_hi:[1,0]
    v_pk_mul_f32 v[116:117], v[44:45], v[182:183] op_sel_hi:[1,0]
    v_pk_mul_f32 v[118:119], v[46:47], v[182:183] op_sel_hi:[1,0]
    v_exp_f32 v112, v112
    v_exp_f32 v113, v113
    v_exp_f32 v114, v114
    v_exp_f32 v115, v115
    v_exp_f32 v116, v116
    v_exp_f32 v117, v117
    v_exp_f32 v118, v118
    v_exp_f32 v119, v119
    v_pk_mul_f32 v[36:37], v[36:37], v[4:5]
    v_pk_add_f32 v[112:113], v[112:113], 1.0 op_sel_hi:[1,0]
    v_pk_mul_f32 v[38:39], v[38:39], v[6:7]
    v_pk_add_f32 v[114:115], v[114:115], 1.0 op_sel_hi:[1,0]
    v_pk_mul_f32 v[44:45], v[44:45], v[12:13]
    v_pk_add_f32 v[116:117], v[116:117], 1.0 op_sel_hi:[1,0]
    v_pk_mul_f32 v[46:47], v[46:47], v[14:15]
    v_pk_add_f32 v[118:119], v[118:119], 1.0 op_sel_hi:[1,0]
    v_rcp_f32 v112, v112
    v_rcp_f32 v113, v113
    v_rcp_f32 v114, v114
    v_rcp_f32 v115, v115
    v_rcp_f32 v116, v116
    v_rcp_f32 v117, v117
    v_rcp_f32 v118, v118
    v_rcp_f32 v119, v119
    v_lshlrev_b32 v120, 16, v104
    v_pk_mul_f32 v[36:37], v[36:37], v[112:113]
    v_lshlrev_b32 v122, 16, v105
    v_pk_mul_f32 v[38:39], v[38:39], v[114:115]
    v_lshlrev_b32 v124, 16, v106
    v_pk_mul_f32 v[44:45], v[44:45], v[116:117]
    v_lshlrev_b32 v126, 16, v107
    v_pk_mul_f32 v[46:47], v[46:47], v[118:119]
    v_and_b32 v121, 0xffff0000, v104
    v_and_b32 v123, 0xffff0000, v105
    v_and_b32 v125, 0xffff0000, v106
    v_and_b32 v127, 0xffff0000, v107
    v_permlane16_swap_b32 v36, v44
    v_permlane16_swap_b32 v37, v45
    v_permlane16_swap_b32 v38, v46
    v_permlane16_swap_b32 v39, v47
    v_pk_add_f32 v[36:37], v[36:37], v[120:121]
    v_pk_add_f32 v[38:39], v[38:39], v[122:123]
    v_pk_add_f32 v[44:45], v[44:45], v[124:125]
    v_pk_add_f32 v[46:47], v[46:47], v[126:127]
    v_cvt_pk_bf16_f32 v104, v36, v37
    v_cvt_pk_bf16_f32 v105, v38, v39
    v_cvt_pk_bf16_f32 v106, v44, v45
    v_cvt_pk_bf16_f32 v107, v46, v47
    buffer_store_dwordx4 v[104:107], v202, s[56:59], s69 offen offset:0
    v_pk_mul_f32 v[128:129], v[52:53], v[182:183] op_sel_hi:[1,0]
    v_pk_mul_f32 v[130:131], v[54:55], v[182:183] op_sel_hi:[1,0]
    v_pk_mul_f32 v[132:133], v[60:61], v[182:183] op_sel_hi:[1,0]
    v_pk_mul_f32 v[134:135], v[62:63], v[182:183] op_sel_hi:[1,0]
    v_exp_f32 v128, v128
    v_exp_f32 v129, v129
    v_exp_f32 v130, v130
    v_exp_f32 v131, v131
    v_exp_f32 v132, v132
    v_exp_f32 v133, v133
    v_exp_f32 v134, v134
    v_exp_f32 v135, v135
    v_pk_mul_f32 v[52:53], v[52:53], v[20:21]
    v_pk_add_f32 v[128:129], v[128:129], 1.0 op_sel_hi:[1,0]
    v_pk_mul_f32 v[54:55], v[54:55], v[22:23]
    v_pk_add_f32 v[130:131], v[130:131], 1.0 op_sel_hi:[1,0]
    v_pk_mul_f32 v[60:61], v[60:61], v[28:29]
    v_pk_add_f32 v[132:133], v[132:133], 1.0 op_sel_hi:[1,0]
    v_pk_mul_f32 v[62:63], v[62:63], v[30:31]
    v_pk_add_f32 v[134:135], v[134:135], 1.0 op_sel_hi:[1,0]
    v_rcp_f32 v128, v128
    v_rcp_f32 v129, v129
    v_rcp_f32 v130, v130
    v_rcp_f32 v131, v131
    v_rcp_f32 v132, v132
    v_rcp_f32 v133, v133
    v_rcp_f32 v134, v134
    v_rcp_f32 v135, v135
    v_lshlrev_b32 v136, 16, v108
    v_pk_mul_f32 v[52:53], v[52:53], v[128:129]
    v_lshlrev_b32 v138, 16, v109
    v_pk_mul_f32 v[54:55], v[54:55], v[130:131]
    v_lshlrev_b32 v140, 16, v110
    v_pk_mul_f32 v[60:61], v[60:61], v[132:133]
    v_lshlrev_b32 v142, 16, v111
    v_pk_mul_f32 v[62:63], v[62:63], v[134:135]
    v_and_b32 v137, 0xffff0000, v108
    v_and_b32 v139, 0xffff0000, v109
    v_and_b32 v141, 0xffff0000, v110
    v_and_b32 v143, 0xffff0000, v111
    v_permlane16_swap_b32 v52, v60
    v_permlane16_swap_b32 v53, v61
    v_permlane16_swap_b32 v54, v62
    v_permlane16_swap_b32 v55, v63
    v_pk_add_f32 v[52:53], v[52:53], v[136:137]
    v_pk_add_f32 v[54:55], v[54:55], v[138:139]
    v_pk_add_f32 v[60:61], v[60:61], v[140:141]
    v_pk_add_f32 v[62:63], v[62:63], v[142:143]
    v_cvt_pk_bf16_f32 v108, v52, v53
    v_cvt_pk_bf16_f32 v109, v54, v55
    v_cvt_pk_bf16_f32 v110, v60, v61
    v_cvt_pk_bf16_f32 v111, v62, v63
    buffer_store_dwordx4 v[108:111], v202, s[56:59], s69 offen offset:64
k23_kernel_end:
    s_endpgm
.section .rodata,"a"
.p2align 6
.amdhsa_kernel k1_kernel
  .amdhsa_next_free_vgpr 376
  .amdhsa_next_free_sgpr 96
  .amdhsa_accum_offset 256
  .amdhsa_group_segment_fixed_size 0
  .amdhsa_kernarg_size 88
  .amdhsa_user_sgpr_count 2
  .amdhsa_user_sgpr_kernarg_segment_ptr 1
  .amdhsa_system_sgpr_workgroup_id_x 1
  .amdhsa_float_denorm_mode_32 3
.end_amdhsa_kernel
.p2align 6
.amdhsa_kernel k23_kernel
  .amdhsa_next_free_vgpr 384
  .amdhsa_next_free_sgpr 96
  .amdhsa_accum_offset 256
  .amdhsa_group_segment_fixed_size 0
  .amdhsa_kernarg_size 88
  .amdhsa_user_sgpr_count 2
  .amdhsa_user_sgpr_kernarg_segment_ptr 1
  .amdhsa_system_sgpr_workgroup_id_x 1
  .amdhsa_float_denorm_mode_32 3
.end_amdhsa_kernel
```
